```python
import torch

def _softmax(x, axis=-1):
    return torch.softmax(x, dim=axis)
def _gelu(x):
    return torch.nn.functional.gelu(x, approximate="tanh")
def _silu(x):
    return torch.nn.functional.silu(x)
def _sigmoid(x):
    return torch.sigmoid(x)
def _layernorm(x, axis=-1, eps=1e-5):
    m = x.mean(dim=axis, keepdim=True)
    v = x.var(dim=axis, keepdim=True, unbiased=False)
    return (x - m) / torch.sqrt(v + eps)
def _scatter_add(tgt, idx, src, axis=0):
    return tgt.clone().index_add_(axis, idx, src)
def _segment_sum(src, seg, n):
    out = torch.zeros((n,) + src.shape[1:], dtype=src.dtype)
    return out.index_add_(0, seg, src)
def _pad(x, pw):
    flat = tuple(v for pair in reversed(pw) for v in pair)
    return torch.nn.functional.pad(x, flat)

kernel_name = 'sequential_preLN__sliding_block__geglu_ffn__prompt'

def setup_inputs():

    _w = (lambda a: (lambda t: t.to(torch.bfloat16) if t.is_floating_point() else t)(torch.as_tensor(a)))
    def _A_setup():
        B, S, D = 1, 2048, 448
        return {
            "x": _w((lambda *s: torch.randn(*s, dtype=torch.bfloat16) * 0.05)(B, S, D)),
            "wqkv": _w((lambda *s: torch.randn(*s, dtype=torch.bfloat16) * 0.05)(D, 3 * D)),
            "wo": _w((lambda *s: torch.randn(*s, dtype=torch.bfloat16) * 0.05)(D, D)),
        }
    _A_in = _A_setup()

    def _B_setup():
        B, S, D, F = 1, 2048, 448, 1792
        return {
            "x": _w((lambda *s: torch.randn(*s, dtype=torch.bfloat16) * 0.05)(B, S, D)),
            "w_gate": _w((lambda *s: torch.randn(*s, dtype=torch.bfloat16) * 0.05)(D, F)),
            "w_up": _w((lambda *s: torch.randn(*s, dtype=torch.bfloat16) * 0.05)(D, F)),
            "w_down": _w((lambda *s: torch.randn(*s, dtype=torch.bfloat16) * 0.05)(F, D)),
        }
    _B_in = _B_setup()

    return {
        "A_x": _A_in["x"],
        "A_wqkv": _A_in["wqkv"],
        "A_wo": _A_in["wo"],
        "B_x": _B_in["x"],
        "B_w_gate": _B_in["w_gate"],
        "B_w_up": _B_in["w_up"],
        "B_w_down": _B_in["w_down"],
    }

def reference(A_x, A_wqkv, A_wo, B_x, B_w_gate, B_w_up, B_w_down):
    def _A_ref(x, wqkv, wo):
        B, S, D = x.shape
        H = 16; Dh = D // H; W = 256
        qkv = (lambda x, *d: x.permute(*d))((x @ wqkv).reshape(B, S, 3, H, Dh), 2, 0, 3, 1, 4)
        q, k, v = qkv[0], qkv[1], qkv[2]
        scores = torch.einsum("bhqd,bhkd->bhqk", q, k) * (Dh ** -0.5)
        idx = torch.arange(S)
        mask = (idx[:, None] - idx[None, :] >= 0) & (idx[:, None] - idx[None, :] < W)
        scores = torch.where(mask[None, None], scores, -1e9)
        p = _softmax(scores, axis=-1)
        o = torch.einsum("bhqk,bhkd->bhqd", p, v)
        return (lambda x, *d: x.permute(*d))(o, 0, 2, 1, 3).reshape(B, S, D) @ wo

    def _B_ref(x, w_gate, w_up, w_down):
        return (_gelu(x @ w_gate) * (x @ w_up)) @ w_down

    x = A_x
    h = x + _A_ref(_layernorm(x, axis=-1), A_wqkv, A_wo)
    h2 = h + _B_ref(_layernorm(h, axis=-1), B_w_gate, B_w_up, B_w_down)
    return h2
```

```asm
; @launch grid=(256,1,1) block=(256,1,1) lds=163840
.amdgcn_target "amdgcn-amd-amdhsa--gfx950"
.text
.p2align 12
.globl sequential_preLN__sliding_block__geglu_ffn__prompt_kernel
.p2align 8
.type sequential_preLN__sliding_block__geglu_ffn__prompt_kernel,@function
sequential_preLN__sliding_block__geglu_ffn__prompt_kernel:
  s_cmp_ge_u32 s2, 256
  s_cbranch_scc1 L_end
  s_load_dwordx8 s[64:71], s[0:1], 0
  s_load_dwordx8 s[72:79], s[0:1], 32
  s_load_dwordx4 s[80:83], s[0:1], 64
  v_lshrrev_b32 v9, 6, v0
  v_and_b32 v0, 63, v0
  v_readfirstlane_b32 s6, v9
  s_and_b32 s4, s2, 7
  s_lshr_b32 s5, s2, 3
  s_getpc_b64 s[52:53]
L_wf_pc_1:
  s_lshl2_add_u32 s14, s5, s6
  s_mul_i32 s14, s14, 384
  v_mul_u32_u24 v253, 6, v0
  s_mov_b32 s54, L_end-L_wf_pc_1
  s_mov_b32 s55, 0x20000
  buffer_load_ubyte v253, v253, s[52:55], s14 offen
  s_cmp_ge_u32 s5, 28
  s_cbranch_scc1 L_spare
  s_mul_i32 s7, s5, 37
  s_lshr_b32 s7, s7, 8
  s_mul_i32 s14, s7, 7
  s_sub_u32 s8, s5, s14
  v_lshrrev_b32 v16, 3, v0
  v_and_b32 v17, 7, v0
  v_mul_u32_u24 v18, 896, v16
  v_lshl_add_u32 v9, v17, 4, v18
  s_lshl_b32 s14, s4, 2
  s_add_u32 s14, s14, s7
  s_mul_i32 s92, s14, 57344
  s_mul_i32 s15, s6, 14336
  s_add_u32 s14, s92, s15
  s_add_u32 s15, s14, 7168
  s_lshl_b32 s17, s8, 7
  s_add_u32 s16, s15, s17
  s_mov_b32 s34, 0x1c0000
  s_mov_b32 s35, 0x20000
  s_waitcnt lgkmcnt(0)
  s_mov_b64 s[32:33], s[64:65]
  buffer_load_dword v243, v18, s[32:35], s16 offen
  buffer_load_dwordx4 v[128:131], v9, s[32:35], s14 offen offset:0
  buffer_load_dwordx4 v[132:135], v9, s[32:35], s14 offen offset:128
  buffer_load_dwordx4 v[136:139], v9, s[32:35], s14 offen offset:256
  buffer_load_dwordx4 v[140:143], v9, s[32:35], s14 offen offset:384
  buffer_load_dwordx4 v[144:147], v9, s[32:35], s14 offen offset:512
  buffer_load_dwordx4 v[148:151], v9, s[32:35], s14 offen offset:640
  buffer_load_dwordx4 v[152:155], v9, s[32:35], s14 offen offset:768
  s_mov_b64 s[36:37], s[66:67]
  s_mov_b32 s38, 0x126000
  s_mov_b32 s39, 0x20000
  s_and_b32 s20, s6, 1
  s_lshr_b32 s21, s6, 1
  v_bfe_u32 v20, v0, 4, 1
  v_lshlrev_b32 v20, 6, v20
  v_xor_b32 v7, v20, v9
  v_mul_u32_u24 v12, 1792, v16
  s_mul_i32 s16, s6, 43008
  s_add_u32 s16, s16, s17
  v_add3_u32 v12, v12, v7, s16
  v_add_u32 v13, 20480, v12
  s_lshl_b32 s24, s6, 11
  v_mul_u32_u24 v10, 528, v17
  v_lshl_add_u32 v10, v16, 4, v10
  s_mul_i32 s16, s21, 29568
  s_lshl_b32 s17, s20, 8
  s_add_u32 s16, s16, s17
  v_add_u32 v10, s16, v10
  s_lshl_b32 s16, s6, 4
  v_add_lshl_u32 v250, v16, s16, 2
  v_mov_b32 v24, 0
  v_mov_b32 v25, 0
  v_mov_b32 v26, 0
  v_mov_b32 v27, 0
  v_mov_b32 v28, 0
  v_mov_b32 v29, 0
  v_mov_b32 v30, 0
  v_mov_b32 v31, 0
  s_mov_b32 s94, 0x3f803f80
  s_mov_b32 s95, 0xffff0000
  s_mov_b64 s[60:61], s[82:83]
  s_mov_b32 s62, 0xcd8000
  s_mov_b32 s63, 0x20000
  s_mov_b64 s[56:57], s[80:81]
  s_mov_b32 s58, 0x100
  s_mov_b32 s59, 0x20000
  s_mov_b64 s[40:41], s[68:69]
  s_mov_b32 s42, 0x62000
  s_mov_b32 s43, 0x20000
  s_mov_b64 s[48:49], s[76:77]
  s_mov_b32 s50, 0x188000
  s_mov_b32 s51, 0x20000
  s_getreg_b32 s9, hwreg(HW_REG_XCC_ID, 0, 4)
  s_add_u32 s9, s9, 1
  s_mul_i32 s10, s4, 0x19b000
  s_sub_u32 s11, s10, 0x19b000
  s_cmp_eq_u32 s4, 0
  s_cselect_b32 s11, 0x40000000, s11
  s_and_b32 s12, s5, 15
  s_lshr_b32 s13, s5, 4
  v_lshlrev_b32 v1, 4, v0
  v_lshlrev_b32 v2, 3, v0
  v_lshlrev_b32 v3, 2, v0
  v_mov_b32 v5, 1
  v_min_u32 v4, 1, v0
  v_lshlrev_b32 v4, 30, v4
  s_mov_b64 s[52:53], s[78:79]
  s_mov_b32 s54, 0x1c0000
  s_mov_b32 s55, 0x20000
  s_cmp_eq_u32 s21, 0
  s_cselect_b64 s[44:45], s[72:73], s[74:75]
  s_mov_b32 s46, 0x188000
  s_mov_b32 s47, 0x20000
  s_lshr_b32 s71, s7, 1
  s_mul_i32 s3, s71, 14
  s_sub_u32 s3, s5, s3
  s_lshl_b32 s22, s7, 1
  s_add_u32 s22, s22, s20
  s_lshl_b32 s23, s8, 1
  s_add_u32 s23, s23, s21
  v_bfe_u32 v20, v0, 2, 2
  v_lshlrev_b32 v6, 7, v20
  v_bfe_u32 v20, v0, 3, 1
  v_lshl_add_u32 v6, v20, 6, v6
  v_bfe_u32 v20, v0, 4, 1
  v_lshl_add_u32 v6, v20, 5, v6
  v_and_b32 v21, 3, v0
  v_lshl_add_u32 v6, v21, 3, v6
  v_lshrrev_b32 v18, 5, v0
  v_lshl_add_u32 v11, v18, 4, v1
  s_mul_i32 s16, s20, 29568
  v_add_u32 v11, s16, v11
  s_lshl_b32 s16, s21, 6
  v_xor_b32 v14, s16, v6
  v_lshl_add_u32 v14, v18, 10, v14
  v_add_u32 v15, 106496, v14
  v_add_u32 v14, 65536, v14
  s_lshl_b32 s16, s23, 3
  s_mul_i32 s17, s22, 1792
  s_lshl_b32 s18, s22, 15
  v_and_b32 v19, 31, v0
  v_add3_u32 v20, v18, s16, 0
  v_mul_u32_u24 v21, 147, v20
  v_lshrrev_b32 v21, 10, v21
  v_mad_i32_i24 v22, v21, -7, v20
  v_lshlrev_b32 v23, 8, v22
  v_lshl_add_u32 v23, v19, 3, v23
  v_lshl_add_u32 v20, v21, 11, s18
  v_add_u32 v232, v20, v23
  v_mul_u32_u24 v21, 14336, v21
  v_add3_u32 v244, v21, v23, s17
  v_lshlrev_b32 v22, 5, v22
  v_xor_b32 v252, v22, v244
  v_add3_u32 v20, v18, s16, 2
  v_mul_u32_u24 v21, 147, v20
  v_lshrrev_b32 v21, 10, v21
  v_mad_i32_i24 v22, v21, -7, v20
  v_lshlrev_b32 v23, 8, v22
  v_lshl_add_u32 v23, v19, 3, v23
  v_lshl_add_u32 v20, v21, 11, s18
  v_add_u32 v233, v20, v23
  v_mul_u32_u24 v21, 14336, v21
  v_add3_u32 v245, v21, v23, s17
  v_lshlrev_b32 v22, 5, v22
  s_waitcnt vmcnt(8)
  v_xor_b32 v253, v22, v245
  v_add3_u32 v20, v18, s16, 4
  v_mul_u32_u24 v21, 147, v20
  v_lshrrev_b32 v21, 10, v21
  v_mad_i32_i24 v22, v21, -7, v20
  v_lshlrev_b32 v23, 8, v22
  v_lshl_add_u32 v23, v19, 3, v23
  v_lshl_add_u32 v20, v21, 11, s18
  v_add_u32 v234, v20, v23
  v_mul_u32_u24 v21, 14336, v21
  v_add3_u32 v246, v21, v23, s17
  v_lshlrev_b32 v22, 5, v22
  v_xor_b32 v254, v22, v246
  v_add3_u32 v20, v18, s16, 6
  v_mul_u32_u24 v21, 147, v20
  v_lshrrev_b32 v21, 10, v21
  v_mad_i32_i24 v22, v21, -7, v20
  v_lshlrev_b32 v23, 8, v22
  v_lshl_add_u32 v23, v19, 3, v23
  v_lshl_add_u32 v20, v21, 11, s18
  v_add_u32 v235, v20, v23
  v_mul_u32_u24 v21, 14336, v21
  v_add3_u32 v247, v21, v23, s17
  v_lshlrev_b32 v22, 5, v22
  v_xor_b32 v255, v22, v247
  s_add_u32 s93, s10, 0x198000
  s_lshl_b32 s86, s13, 2
  s_add_u32 s86, s86, s6
  s_xor_b32 s87, s86, 4
  s_lshl_b32 s88, s86, 15
  s_lshl_b32 s16, s12, 11
  s_add_u32 s88, s88, s16
  s_add_u32 s88, s88, s10
  s_mul_i32 s16, s12, 14336
  s_add_u32 s16, s16, 0x40000
  s_mul_i32 s89, s86, 1792
  s_add_u32 s89, s89, s16
  s_mul_i32 s90, s87, 1792
  s_add_u32 s90, s90, s16
  s_cmp_eq_u32 s13, 1
  s_cselect_b32 s17, s10, s11
  s_add_u32 s68, s11, s89
  s_add_u32 s69, s17, s90
  s_add_u32 s70, s10, s89
  s_mul_i32 s16, s12, 28
  v_and_b32 v20, 1, v0
  v_mad_u32_u24 v20, v20, 27, s16
  v_lshrrev_b32 v20, 5, v20
  v_lshrrev_b32 v21, 2, v20
  v_mul_u32_u24 v21, 112, v21
  v_lshlrev_b32 v20, 2, v20
  s_lshl_b32 s16, s86, 6
  s_add_u32 s16, s16, s93
  s_add_u32 s16, s16, 256
  v_add_u32 v236, s16, v20
  s_lshl_b32 s16, s86, 9
  s_add_u32 s16, s16, s10
  s_add_u32 s16, s16, 0x199000
  s_mov_b64 exec, 0x3f
  v_add3_u32 v236, v20, v21, s16
  s_or_b32 s16, s4, s13
  s_cselect_b64 exec, 12, 0
  v_xor_b32 v236, 0x800, v236
  s_cmp_eq_u32 s13, 0
  s_cselect_b32 s16, 15, 3
  s_cmp_lg_u32 s4, 0
  s_cselect_b32 exec_lo, s16, 0
  v_subrev_u32 v236, 0x19b000, v236
  s_mov_b64 exec, -1
  v_mov_b32 v242, v236
  s_mov_b64 exec, 0x3f
  v_add_u32 v242, 0x1000, v236
  s_mov_b64 exec, -1
  s_lshl_b32 s16, s6, 11
  s_add_u32 s17, s16, 81920
  v_add_u32 v237, s17, v2
  s_add_u32 s16, s16, 57344
  v_bfe_u32 v20, v0, 4, 1
  v_and_b32 v21, 3, v0
  v_lshl_add_u32 v20, v20, 2, v21
  v_bfe_u32 v21, v0, 2, 2
  v_lshrrev_b32 v23, 5, v0
  v_lshl_add_u32 v21, v23, 2, v21
  v_lshlrev_b32 v22, 2, v20
  v_xor_b32 v21, v21, v22
  v_lshlrev_b32 v21, 3, v21
  v_lshl_add_u32 v21, v20, 8, v21
  v_add_u32 v238, s16, v21
  v_xor_b32 v239, 64, v238
  v_xor_b32 v240, 128, v238
  v_xor_b32 v241, 192, v238
  v_bfe_u32 v229, v0, 4, 1
  v_lshlrev_b32 v229, 5, v229
  s_lshl_b32 s16, s21, 6
  v_xor_b32 v229, s16, v229
  v_xor_b32 v229, v229, v9
  v_lshrrev_b32 v230, 3, v0
  v_mul_u32_u24 v230, 2688, v230
  s_mul_i32 s16, s20, 28672
  s_lshl_b32 s17, s3, 7
  s_add_u32 s16, s16, s17
  v_add3_u32 v228, v229, v230, s16
  v_add_u32 v229, 56320, v228
  v_add_u32 v230, 112640, v228
  v_add_u32 v231, 168960, v228
  s_mul_i32 s99, s6, 14336
  s_lshl_b32 s64, s22, 6
  s_lshl_b32 s16, s23, 2
  s_add_u32 s64, s64, s16
  s_add_u32 s64, s64, s93
  s_lshl_b32 s65, s22, 9
  s_lshr_b32 s17, s23, 2
  s_mul_i32 s17, s17, 112
  s_add_u32 s65, s65, s17
  s_add_u32 s65, s65, s16
  s_add_u32 s65, s65, s93
  s_add_u32 s65, s65, 0x1000
  s_add_u32 s66, s65, 0x1000
  s_cmp_ge_u32 s23, 7
  s_cselect_b32 s16, 7, 0
  s_cselect_b32 s67, 512, 0
  s_sub_u32 s16, s23, s16
  s_lshr_b32 s17, s16, 2
  s_mul_i32 s17, s17, 1008
  s_add_u32 s67, s67, s17
  s_lshl_b32 s16, s16, 2
  s_add_u32 s67, s67, s16
  s_lshl_b32 s16, s22, 11
  s_add_u32 s67, s67, s16
  s_add_u32 s67, s67, s10
  s_add_u32 s67, s67, 0x194000
  s_lshl_b32 s16, s20, 5
  v_add_lshl_u32 v251, v19, s16, 2
  s_mov_b32 s18, 0x3e8b97f6
  s_mov_b64 exec, 0
  s_cmp_eq_u32 s6, 0
  s_cbranch_scc1 L_hop_w0_to0
  s_cmp_eq_u32 s6, 1
  s_cbranch_scc1 L_hop_w0_to1
  s_cmp_eq_u32 s6, 2
  s_cbranch_scc1 L_hop_w0_to2
  s_branch L_hop_w0_to3
L_hop_w0:
  s_mov_b64 exec, -1
  s_waitcnt vmcnt(6)
  v_dot2c_f32_bf16 v24, s94, v128
  v_dot2c_f32_bf16 v25, v128, v128
  v_dot2c_f32_bf16 v26, s94, v129
  v_dot2c_f32_bf16 v27, v129, v129
  v_dot2c_f32_bf16 v24, s94, v130
  v_dot2c_f32_bf16 v25, v130, v130
  v_dot2c_f32_bf16 v26, s94, v131
  v_dot2c_f32_bf16 v27, v131, v131
  buffer_load_dwordx4 v[156:159], v9, s[32:35], s15 offen offset:0
  s_waitcnt vmcnt(6)
  v_dot2c_f32_bf16 v24, s94, v132
  v_dot2c_f32_bf16 v25, v132, v132
  v_dot2c_f32_bf16 v26, s94, v133
  v_dot2c_f32_bf16 v27, v133, v133
  v_dot2c_f32_bf16 v24, s94, v134
  v_dot2c_f32_bf16 v25, v134, v134
  v_dot2c_f32_bf16 v26, s94, v135
  v_dot2c_f32_bf16 v27, v135, v135
  buffer_load_dwordx4 v[160:163], v9, s[32:35], s15 offen offset:128
  s_waitcnt vmcnt(6)
  v_dot2c_f32_bf16 v24, s94, v136
  v_dot2c_f32_bf16 v25, v136, v136
  v_dot2c_f32_bf16 v26, s94, v137
  v_dot2c_f32_bf16 v27, v137, v137
  v_dot2c_f32_bf16 v24, s94, v138
  v_dot2c_f32_bf16 v25, v138, v138
  v_dot2c_f32_bf16 v26, s94, v139
  v_dot2c_f32_bf16 v27, v139, v139
  buffer_load_dwordx4 v[164:167], v9, s[32:35], s15 offen offset:256
  s_waitcnt vmcnt(6)
  v_dot2c_f32_bf16 v24, s94, v140
  v_dot2c_f32_bf16 v25, v140, v140
  v_dot2c_f32_bf16 v26, s94, v141
  v_dot2c_f32_bf16 v27, v141, v141
  v_dot2c_f32_bf16 v24, s94, v142
  v_dot2c_f32_bf16 v25, v142, v142
  v_dot2c_f32_bf16 v26, s94, v143
  v_dot2c_f32_bf16 v27, v143, v143
  buffer_load_dwordx4 v[168:171], v9, s[32:35], s15 offen offset:384
  s_waitcnt vmcnt(6)
  v_dot2c_f32_bf16 v24, s94, v144
  v_dot2c_f32_bf16 v25, v144, v144
  v_dot2c_f32_bf16 v26, s94, v145
  v_dot2c_f32_bf16 v27, v145, v145
  v_dot2c_f32_bf16 v24, s94, v146
  v_dot2c_f32_bf16 v25, v146, v146
  v_dot2c_f32_bf16 v26, s94, v147
  v_dot2c_f32_bf16 v27, v147, v147
  buffer_load_dwordx4 v[172:175], v9, s[32:35], s15 offen offset:512
  s_waitcnt vmcnt(6)
  v_dot2c_f32_bf16 v24, s94, v148
  v_dot2c_f32_bf16 v25, v148, v148
  v_dot2c_f32_bf16 v26, s94, v149
  v_dot2c_f32_bf16 v27, v149, v149
  v_dot2c_f32_bf16 v24, s94, v150
  v_dot2c_f32_bf16 v25, v150, v150
  v_dot2c_f32_bf16 v26, s94, v151
  v_dot2c_f32_bf16 v27, v151, v151
  buffer_load_dwordx4 v[176:179], v9, s[32:35], s15 offen offset:640
  s_waitcnt vmcnt(6)
  v_dot2c_f32_bf16 v24, s94, v152
  v_dot2c_f32_bf16 v25, v152, v152
  v_dot2c_f32_bf16 v26, s94, v153
  v_dot2c_f32_bf16 v27, v153, v153
  v_dot2c_f32_bf16 v24, s94, v154
  v_dot2c_f32_bf16 v25, v154, v154
  v_dot2c_f32_bf16 v26, s94, v155
  v_dot2c_f32_bf16 v27, v155, v155
  buffer_load_dwordx4 v[180:183], v9, s[32:35], s15 offen offset:768
  s_nop 1
  v_pk_add_f32 v[24:25], v[24:25], v[26:27]
  s_nop 1
  v_add_f32_dpp v24, v24, v24 quad_perm:[1,0,3,2] row_mask:0xf bank_mask:0xf
  v_add_f32_dpp v25, v25, v25 quad_perm:[1,0,3,2] row_mask:0xf bank_mask:0xf
  s_nop 0
  v_add_f32_dpp v24, v24, v24 quad_perm:[2,3,0,1] row_mask:0xf bank_mask:0xf
  v_add_f32_dpp v25, v25, v25 quad_perm:[2,3,0,1] row_mask:0xf bank_mask:0xf
  s_nop 0
  v_add_f32_dpp v24, v24, v24 row_half_mirror row_mask:0xf bank_mask:0xf
  v_add_f32_dpp v25, v25, v25 row_half_mirror row_mask:0xf bank_mask:0xf
  v_mul_f32 v24, 0x3b124925, v24
  v_mul_f32 v25, 0x3b124925, v25
  v_fma_f32 v25, -v24, v24, v25
  v_max_f32 v25, 0, v25
  v_add_f32 v25, 0x3727c5ac, v25
  v_rsq_f32 v26, v25
  ds_write_b32 v250, v24 offset:59392
  v_mul_f32 v27, -v24, v26
  v_lshlrev_b32 v32, 16, v128
  v_and_b32 v33, s95, v128
  v_lshlrev_b32 v34, 16, v129
  v_and_b32 v35, s95, v129
  v_lshlrev_b32 v36, 16, v130
  v_and_b32 v37, s95, v130
  v_lshlrev_b32 v38, 16, v131
  v_and_b32 v39, s95, v131
  s_add_u32 m0, s24, 106496
  s_mov_b32 s25, 896
  buffer_load_dwordx4 v12, s[36:39], s25 offen lds
  v_pk_fma_f32 v[32:33], v[32:33], v[26:27], v[26:27] op_sel:[0,0,1] op_sel_hi:[1,0,1]
  v_pk_fma_f32 v[34:35], v[34:35], v[26:27], v[26:27] op_sel:[0,0,1] op_sel_hi:[1,0,1]
  v_pk_fma_f32 v[36:37], v[36:37], v[26:27], v[26:27] op_sel:[0,0,1] op_sel_hi:[1,0,1]
  v_pk_fma_f32 v[38:39], v[38:39], v[26:27], v[26:27] op_sel:[0,0,1] op_sel_hi:[1,0,1]
  v_cvt_pk_bf16_f32 v128, v32, v33
  v_cvt_pk_bf16_f32 v129, v34, v35
  v_cvt_pk_bf16_f32 v130, v36, v37
  v_cvt_pk_bf16_f32 v131, v38, v39
  ds_write_b128 v10, v[128:131] offset:0
  v_lshlrev_b32 v32, 16, v132
  v_and_b32 v33, s95, v132
  v_lshlrev_b32 v34, 16, v133
  v_and_b32 v35, s95, v133
  v_lshlrev_b32 v36, 16, v134
  v_and_b32 v37, s95, v134
  v_lshlrev_b32 v38, 16, v135
  v_and_b32 v39, s95, v135
  buffer_load_dwordx4 v13, s[36:39], s25 offen offset:1024 lds
  v_pk_fma_f32 v[32:33], v[32:33], v[26:27], v[26:27] op_sel:[0,0,1] op_sel_hi:[1,0,1]
  v_pk_fma_f32 v[34:35], v[34:35], v[26:27], v[26:27] op_sel:[0,0,1] op_sel_hi:[1,0,1]
  v_pk_fma_f32 v[36:37], v[36:37], v[26:27], v[26:27] op_sel:[0,0,1] op_sel_hi:[1,0,1]
  v_pk_fma_f32 v[38:39], v[38:39], v[26:27], v[26:27] op_sel:[0,0,1] op_sel_hi:[1,0,1]
  v_cvt_pk_bf16_f32 v132, v32, v33
  v_cvt_pk_bf16_f32 v133, v34, v35
  v_cvt_pk_bf16_f32 v134, v36, v37
  v_cvt_pk_bf16_f32 v135, v38, v39
  ds_write_b128 v10, v[132:135] offset:4224
  v_lshlrev_b32 v32, 16, v136
  v_and_b32 v33, s95, v136
  v_lshlrev_b32 v34, 16, v137
  v_and_b32 v35, s95, v137
  v_lshlrev_b32 v36, 16, v138
  v_and_b32 v37, s95, v138
  v_lshlrev_b32 v38, 16, v139
  v_and_b32 v39, s95, v139
  s_add_u32 m0, s24, 114688
  s_mov_b32 s25, 172928
  buffer_load_dwordx4 v12, s[36:39], s25 offen lds
  v_pk_fma_f32 v[32:33], v[32:33], v[26:27], v[26:27] op_sel:[0,0,1] op_sel_hi:[1,0,1]
  v_pk_fma_f32 v[34:35], v[34:35], v[26:27], v[26:27] op_sel:[0,0,1] op_sel_hi:[1,0,1]
  v_pk_fma_f32 v[36:37], v[36:37], v[26:27], v[26:27] op_sel:[0,0,1] op_sel_hi:[1,0,1]
  v_pk_fma_f32 v[38:39], v[38:39], v[26:27], v[26:27] op_sel:[0,0,1] op_sel_hi:[1,0,1]
  v_cvt_pk_bf16_f32 v136, v32, v33
  v_cvt_pk_bf16_f32 v137, v34, v35
  v_cvt_pk_bf16_f32 v138, v36, v37
  v_cvt_pk_bf16_f32 v139, v38, v39
  ds_write_b128 v10, v[136:139] offset:8448
  v_lshlrev_b32 v32, 16, v140
  v_and_b32 v33, s95, v140
  v_lshlrev_b32 v34, 16, v141
  v_and_b32 v35, s95, v141
  v_lshlrev_b32 v36, 16, v142
  v_and_b32 v37, s95, v142
  v_lshlrev_b32 v38, 16, v143
  v_and_b32 v39, s95, v143
  buffer_load_dwordx4 v13, s[36:39], s25 offen offset:1024 lds
  v_pk_fma_f32 v[32:33], v[32:33], v[26:27], v[26:27] op_sel:[0,0,1] op_sel_hi:[1,0,1]
  v_pk_fma_f32 v[34:35], v[34:35], v[26:27], v[26:27] op_sel:[0,0,1] op_sel_hi:[1,0,1]
  v_pk_fma_f32 v[36:37], v[36:37], v[26:27], v[26:27] op_sel:[0,0,1] op_sel_hi:[1,0,1]
  v_pk_fma_f32 v[38:39], v[38:39], v[26:27], v[26:27] op_sel:[0,0,1] op_sel_hi:[1,0,1]
  v_cvt_pk_bf16_f32 v140, v32, v33
  v_cvt_pk_bf16_f32 v141, v34, v35
  v_cvt_pk_bf16_f32 v142, v36, v37
  v_cvt_pk_bf16_f32 v143, v38, v39
  ds_write_b128 v10, v[140:143] offset:12672
  v_lshlrev_b32 v32, 16, v144
  v_and_b32 v33, s95, v144
  v_lshlrev_b32 v34, 16, v145
  v_and_b32 v35, s95, v145
  v_lshlrev_b32 v36, 16, v146
  v_and_b32 v37, s95, v146
  v_lshlrev_b32 v38, 16, v147
  v_and_b32 v39, s95, v147
  s_add_u32 m0, s24, 122880
  s_mov_b32 s25, 344960
  buffer_load_dwordx4 v12, s[36:39], s25 offen lds
  v_pk_fma_f32 v[32:33], v[32:33], v[26:27], v[26:27] op_sel:[0,0,1] op_sel_hi:[1,0,1]
  v_pk_fma_f32 v[34:35], v[34:35], v[26:27], v[26:27] op_sel:[0,0,1] op_sel_hi:[1,0,1]
  v_pk_fma_f32 v[36:37], v[36:37], v[26:27], v[26:27] op_sel:[0,0,1] op_sel_hi:[1,0,1]
  v_pk_fma_f32 v[38:39], v[38:39], v[26:27], v[26:27] op_sel:[0,0,1] op_sel_hi:[1,0,1]
  v_cvt_pk_bf16_f32 v144, v32, v33
  v_cvt_pk_bf16_f32 v145, v34, v35
  v_cvt_pk_bf16_f32 v146, v36, v37
  v_cvt_pk_bf16_f32 v147, v38, v39
  ds_write_b128 v10, v[144:147] offset:16896
  v_lshlrev_b32 v32, 16, v148
  v_and_b32 v33, s95, v148
  v_lshlrev_b32 v34, 16, v149
  v_and_b32 v35, s95, v149
  v_lshlrev_b32 v36, 16, v150
  v_and_b32 v37, s95, v150
  v_lshlrev_b32 v38, 16, v151
  v_and_b32 v39, s95, v151
  buffer_load_dwordx4 v13, s[36:39], s25 offen offset:1024 lds
  v_pk_fma_f32 v[32:33], v[32:33], v[26:27], v[26:27] op_sel:[0,0,1] op_sel_hi:[1,0,1]
  v_pk_fma_f32 v[34:35], v[34:35], v[26:27], v[26:27] op_sel:[0,0,1] op_sel_hi:[1,0,1]
  v_pk_fma_f32 v[36:37], v[36:37], v[26:27], v[26:27] op_sel:[0,0,1] op_sel_hi:[1,0,1]
  v_pk_fma_f32 v[38:39], v[38:39], v[26:27], v[26:27] op_sel:[0,0,1] op_sel_hi:[1,0,1]
  v_cvt_pk_bf16_f32 v148, v32, v33
  v_cvt_pk_bf16_f32 v149, v34, v35
  v_cvt_pk_bf16_f32 v150, v36, v37
  v_cvt_pk_bf16_f32 v151, v38, v39
  ds_write_b128 v10, v[148:151] offset:21120
  v_lshlrev_b32 v32, 16, v152
  v_and_b32 v33, s95, v152
  v_lshlrev_b32 v34, 16, v153
  v_and_b32 v35, s95, v153
  v_lshlrev_b32 v36, 16, v154
  v_and_b32 v37, s95, v154
  v_lshlrev_b32 v38, 16, v155
  v_and_b32 v39, s95, v155
  s_add_u32 m0, s24, 131072
  s_mov_b32 s25, 516992
  buffer_load_dwordx4 v12, s[36:39], s25 offen lds
  v_pk_fma_f32 v[32:33], v[32:33], v[26:27], v[26:27] op_sel:[0,0,1] op_sel_hi:[1,0,1]
  v_pk_fma_f32 v[34:35], v[34:35], v[26:27], v[26:27] op_sel:[0,0,1] op_sel_hi:[1,0,1]
  v_pk_fma_f32 v[36:37], v[36:37], v[26:27], v[26:27] op_sel:[0,0,1] op_sel_hi:[1,0,1]
  v_pk_fma_f32 v[38:39], v[38:39], v[26:27], v[26:27] op_sel:[0,0,1] op_sel_hi:[1,0,1]
  v_cvt_pk_bf16_f32 v152, v32, v33
  v_cvt_pk_bf16_f32 v153, v34, v35
  v_cvt_pk_bf16_f32 v154, v36, v37
  v_cvt_pk_bf16_f32 v155, v38, v39
  ds_write_b128 v10, v[152:155] offset:25344
  s_waitcnt vmcnt(13)
  v_dot2c_f32_bf16 v28, s94, v156
  v_dot2c_f32_bf16 v29, v156, v156
  v_dot2c_f32_bf16 v30, s94, v157
  v_dot2c_f32_bf16 v31, v157, v157
  v_dot2c_f32_bf16 v28, s94, v158
  v_dot2c_f32_bf16 v29, v158, v158
  v_dot2c_f32_bf16 v30, s94, v159
  v_dot2c_f32_bf16 v31, v159, v159
  s_waitcnt vmcnt(12)
  v_dot2c_f32_bf16 v28, s94, v160
  v_dot2c_f32_bf16 v29, v160, v160
  v_dot2c_f32_bf16 v30, s94, v161
  v_dot2c_f32_bf16 v31, v161, v161
  v_dot2c_f32_bf16 v28, s94, v162
  v_dot2c_f32_bf16 v29, v162, v162
  v_dot2c_f32_bf16 v30, s94, v163
  v_dot2c_f32_bf16 v31, v163, v163
  buffer_load_dwordx4 v13, s[36:39], s25 offen offset:1024 lds
  s_waitcnt vmcnt(12)
  v_dot2c_f32_bf16 v28, s94, v164
  v_dot2c_f32_bf16 v29, v164, v164
  v_dot2c_f32_bf16 v30, s94, v165
  v_dot2c_f32_bf16 v31, v165, v165
  v_dot2c_f32_bf16 v28, s94, v166
  v_dot2c_f32_bf16 v29, v166, v166
  v_dot2c_f32_bf16 v30, s94, v167
  v_dot2c_f32_bf16 v31, v167, v167
  s_waitcnt vmcnt(11)
  v_dot2c_f32_bf16 v28, s94, v168
  v_dot2c_f32_bf16 v29, v168, v168
  v_dot2c_f32_bf16 v30, s94, v169
  v_dot2c_f32_bf16 v31, v169, v169
  v_dot2c_f32_bf16 v28, s94, v170
  v_dot2c_f32_bf16 v29, v170, v170
  v_dot2c_f32_bf16 v30, s94, v171
  v_dot2c_f32_bf16 v31, v171, v171
  s_add_u32 m0, s24, 139264
  s_mov_b32 s25, 689024
  buffer_load_dwordx4 v12, s[36:39], s25 offen lds
  s_waitcnt vmcnt(11)
  v_dot2c_f32_bf16 v28, s94, v172
  v_dot2c_f32_bf16 v29, v172, v172
  v_dot2c_f32_bf16 v30, s94, v173
  v_dot2c_f32_bf16 v31, v173, v173
  v_dot2c_f32_bf16 v28, s94, v174
  v_dot2c_f32_bf16 v29, v174, v174
  v_dot2c_f32_bf16 v30, s94, v175
  v_dot2c_f32_bf16 v31, v175, v175
  s_waitcnt vmcnt(10)
  v_dot2c_f32_bf16 v28, s94, v176
  v_dot2c_f32_bf16 v29, v176, v176
  v_dot2c_f32_bf16 v30, s94, v177
  v_dot2c_f32_bf16 v31, v177, v177
  v_dot2c_f32_bf16 v28, s94, v178
  v_dot2c_f32_bf16 v29, v178, v178
  v_dot2c_f32_bf16 v30, s94, v179
  v_dot2c_f32_bf16 v31, v179, v179
  buffer_load_dwordx4 v13, s[36:39], s25 offen offset:1024 lds
  s_waitcnt vmcnt(10)
  v_dot2c_f32_bf16 v28, s94, v180
  v_dot2c_f32_bf16 v29, v180, v180
  v_dot2c_f32_bf16 v30, s94, v181
  v_dot2c_f32_bf16 v31, v181, v181
  v_dot2c_f32_bf16 v28, s94, v182
  v_dot2c_f32_bf16 v29, v182, v182
  v_dot2c_f32_bf16 v30, s94, v183
  v_dot2c_f32_bf16 v31, v183, v183
  s_add_u32 m0, s24, 147456
  s_mov_b32 s25, 861056
L_hop_w0_to0:
  s_cbranch_execz L_hop_w0
  buffer_load_dwordx4 v12, s[36:39], s25 offen lds
  v_pk_add_f32 v[28:29], v[28:29], v[30:31]
  s_nop 1
  v_add_f32_dpp v28, v28, v28 quad_perm:[1,0,3,2] row_mask:0xf bank_mask:0xf
  v_add_f32_dpp v29, v29, v29 quad_perm:[1,0,3,2] row_mask:0xf bank_mask:0xf
  s_nop 0
  v_add_f32_dpp v28, v28, v28 quad_perm:[2,3,0,1] row_mask:0xf bank_mask:0xf
  v_add_f32_dpp v29, v29, v29 quad_perm:[2,3,0,1] row_mask:0xf bank_mask:0xf
  s_nop 0
  v_add_f32_dpp v28, v28, v28 row_half_mirror row_mask:0xf bank_mask:0xf
  v_add_f32_dpp v29, v29, v29 row_half_mirror row_mask:0xf bank_mask:0xf
  v_mul_f32 v28, 0x3b124925, v28
  v_mul_f32 v29, 0x3b124925, v29
  v_fma_f32 v29, -v28, v28, v29
  v_max_f32 v29, 0, v29
  v_add_f32 v29, 0x3727c5ac, v29
  v_rsq_f32 v30, v29
  ds_write_b32 v250, v28 offset:59424
  v_mul_f32 v31, -v28, v30
  v_lshlrev_b32 v32, 16, v156
  v_and_b32 v33, s95, v156
  v_lshlrev_b32 v34, 16, v157
  v_and_b32 v35, s95, v157
  v_lshlrev_b32 v36, 16, v158
  v_and_b32 v37, s95, v158
  v_lshlrev_b32 v38, 16, v159
  v_and_b32 v39, s95, v159
  buffer_load_dwordx4 v13, s[36:39], s25 offen offset:1024 lds
  v_pk_fma_f32 v[32:33], v[32:33], v[30:31], v[30:31] op_sel:[0,0,1] op_sel_hi:[1,0,1]
  v_pk_fma_f32 v[34:35], v[34:35], v[30:31], v[30:31] op_sel:[0,0,1] op_sel_hi:[1,0,1]
  v_pk_fma_f32 v[36:37], v[36:37], v[30:31], v[30:31] op_sel:[0,0,1] op_sel_hi:[1,0,1]
  v_pk_fma_f32 v[38:39], v[38:39], v[30:31], v[30:31] op_sel:[0,0,1] op_sel_hi:[1,0,1]
  v_cvt_pk_bf16_f32 v156, v32, v33
  v_cvt_pk_bf16_f32 v157, v34, v35
  v_cvt_pk_bf16_f32 v158, v36, v37
  v_cvt_pk_bf16_f32 v159, v38, v39
  ds_write_b128 v10, v[156:159] offset:128
  v_lshlrev_b32 v32, 16, v160
  v_and_b32 v33, s95, v160
  v_lshlrev_b32 v34, 16, v161
  v_and_b32 v35, s95, v161
  v_lshlrev_b32 v36, 16, v162
  v_and_b32 v37, s95, v162
  v_lshlrev_b32 v38, 16, v163
  v_and_b32 v39, s95, v163
  s_add_u32 m0, s24, 155648
  s_mov_b32 s25, 1033088
  buffer_load_dwordx4 v12, s[36:39], s25 offen lds
  v_pk_fma_f32 v[32:33], v[32:33], v[30:31], v[30:31] op_sel:[0,0,1] op_sel_hi:[1,0,1]
  v_pk_fma_f32 v[34:35], v[34:35], v[30:31], v[30:31] op_sel:[0,0,1] op_sel_hi:[1,0,1]
  v_pk_fma_f32 v[36:37], v[36:37], v[30:31], v[30:31] op_sel:[0,0,1] op_sel_hi:[1,0,1]
  v_pk_fma_f32 v[38:39], v[38:39], v[30:31], v[30:31] op_sel:[0,0,1] op_sel_hi:[1,0,1]
  v_cvt_pk_bf16_f32 v160, v32, v33
  buffer_load_dwordx4 v13, s[36:39], s25 offen offset:1024 lds
  v_cvt_pk_bf16_f32 v161, v34, v35
  v_cvt_pk_bf16_f32 v162, v36, v37
  v_cvt_pk_bf16_f32 v163, v38, v39
  ds_write_b128 v10, v[160:163] offset:4352
  v_lshlrev_b32 v32, 16, v164
  v_and_b32 v33, s95, v164
  v_lshlrev_b32 v34, 16, v165
  v_and_b32 v35, s95, v165
  v_lshlrev_b32 v36, 16, v166
  v_and_b32 v37, s95, v166
  v_lshlrev_b32 v38, 16, v167
  v_and_b32 v39, s95, v167
  s_add_u32 m0, s24, 65536
  s_mov_b32 s25, 1792
  buffer_load_dwordx4 v12, s[36:39], s25 offen lds
  v_pk_fma_f32 v[32:33], v[32:33], v[30:31], v[30:31] op_sel:[0,0,1] op_sel_hi:[1,0,1]
  v_pk_fma_f32 v[34:35], v[34:35], v[30:31], v[30:31] op_sel:[0,0,1] op_sel_hi:[1,0,1]
  v_pk_fma_f32 v[36:37], v[36:37], v[30:31], v[30:31] op_sel:[0,0,1] op_sel_hi:[1,0,1]
  v_pk_fma_f32 v[38:39], v[38:39], v[30:31], v[30:31] op_sel:[0,0,1] op_sel_hi:[1,0,1]
  v_cvt_pk_bf16_f32 v164, v32, v33
  v_cvt_pk_bf16_f32 v165, v34, v35
  v_cvt_pk_bf16_f32 v166, v36, v37
  v_cvt_pk_bf16_f32 v167, v38, v39
  ds_write_b128 v10, v[164:167] offset:8576
  v_lshlrev_b32 v32, 16, v168
  v_and_b32 v33, s95, v168
  v_lshlrev_b32 v34, 16, v169
  v_and_b32 v35, s95, v169
  v_lshlrev_b32 v36, 16, v170
  v_and_b32 v37, s95, v170
  v_lshlrev_b32 v38, 16, v171
  v_and_b32 v39, s95, v171
  buffer_load_dwordx4 v13, s[36:39], s25 offen offset:1024 lds
  v_pk_fma_f32 v[32:33], v[32:33], v[30:31], v[30:31] op_sel:[0,0,1] op_sel_hi:[1,0,1]
  v_pk_fma_f32 v[34:35], v[34:35], v[30:31], v[30:31] op_sel:[0,0,1] op_sel_hi:[1,0,1]
  v_pk_fma_f32 v[36:37], v[36:37], v[30:31], v[30:31] op_sel:[0,0,1] op_sel_hi:[1,0,1]
  v_pk_fma_f32 v[38:39], v[38:39], v[30:31], v[30:31] op_sel:[0,0,1] op_sel_hi:[1,0,1]
  v_cvt_pk_bf16_f32 v168, v32, v33
  s_add_u32 m0, s24, 73728
  s_mov_b32 s25, 173824
  buffer_load_dwordx4 v12, s[36:39], s25 offen lds
  v_cvt_pk_bf16_f32 v169, v34, v35
  v_cvt_pk_bf16_f32 v170, v36, v37
  v_cvt_pk_bf16_f32 v171, v38, v39
  ds_write_b128 v10, v[168:171] offset:12800
  v_lshlrev_b32 v32, 16, v172
  v_and_b32 v33, s95, v172
  v_lshlrev_b32 v34, 16, v173
  v_and_b32 v35, s95, v173
  v_lshlrev_b32 v36, 16, v174
  v_and_b32 v37, s95, v174
  v_lshlrev_b32 v38, 16, v175
  v_and_b32 v39, s95, v175
  buffer_load_dwordx4 v13, s[36:39], s25 offen offset:1024 lds
  v_pk_fma_f32 v[32:33], v[32:33], v[30:31], v[30:31] op_sel:[0,0,1] op_sel_hi:[1,0,1]
  v_pk_fma_f32 v[34:35], v[34:35], v[30:31], v[30:31] op_sel:[0,0,1] op_sel_hi:[1,0,1]
  v_pk_fma_f32 v[36:37], v[36:37], v[30:31], v[30:31] op_sel:[0,0,1] op_sel_hi:[1,0,1]
  v_pk_fma_f32 v[38:39], v[38:39], v[30:31], v[30:31] op_sel:[0,0,1] op_sel_hi:[1,0,1]
  v_cvt_pk_bf16_f32 v172, v32, v33
  v_cvt_pk_bf16_f32 v173, v34, v35
  v_cvt_pk_bf16_f32 v174, v36, v37
  v_cvt_pk_bf16_f32 v175, v38, v39
  ds_write_b128 v10, v[172:175] offset:17024
  v_lshlrev_b32 v32, 16, v176
  v_and_b32 v33, s95, v176
  v_lshlrev_b32 v34, 16, v177
  v_and_b32 v35, s95, v177
  v_lshlrev_b32 v36, 16, v178
  v_and_b32 v37, s95, v178
  v_lshlrev_b32 v38, 16, v179
  v_and_b32 v39, s95, v179
  s_add_u32 m0, s24, 81920
  s_mov_b32 s25, 345856
  buffer_load_dwordx4 v12, s[36:39], s25 offen lds
  v_pk_fma_f32 v[32:33], v[32:33], v[30:31], v[30:31] op_sel:[0,0,1] op_sel_hi:[1,0,1]
  v_pk_fma_f32 v[34:35], v[34:35], v[30:31], v[30:31] op_sel:[0,0,1] op_sel_hi:[1,0,1]
  v_pk_fma_f32 v[36:37], v[36:37], v[30:31], v[30:31] op_sel:[0,0,1] op_sel_hi:[1,0,1]
  v_pk_fma_f32 v[38:39], v[38:39], v[30:31], v[30:31] op_sel:[0,0,1] op_sel_hi:[1,0,1]
  v_cvt_pk_bf16_f32 v176, v32, v33
  buffer_load_dwordx4 v13, s[36:39], s25 offen offset:1024 lds
  v_cvt_pk_bf16_f32 v177, v34, v35
  v_cvt_pk_bf16_f32 v178, v36, v37
  v_cvt_pk_bf16_f32 v179, v38, v39
  ds_write_b128 v10, v[176:179] offset:21248
  v_lshlrev_b32 v32, 16, v180
  v_and_b32 v33, s95, v180
  v_lshlrev_b32 v34, 16, v181
  v_and_b32 v35, s95, v181
  v_lshlrev_b32 v36, 16, v182
  v_and_b32 v37, s95, v182
  v_lshlrev_b32 v38, 16, v183
  v_and_b32 v39, s95, v183
  s_add_u32 m0, s24, 90112
  s_mov_b32 s25, 517888
  buffer_load_dwordx4 v12, s[36:39], s25 offen lds
  v_pk_fma_f32 v[32:33], v[32:33], v[30:31], v[30:31] op_sel:[0,0,1] op_sel_hi:[1,0,1]
  v_pk_fma_f32 v[34:35], v[34:35], v[30:31], v[30:31] op_sel:[0,0,1] op_sel_hi:[1,0,1]
  v_pk_fma_f32 v[36:37], v[36:37], v[30:31], v[30:31] op_sel:[0,0,1] op_sel_hi:[1,0,1]
  v_pk_fma_f32 v[38:39], v[38:39], v[30:31], v[30:31] op_sel:[0,0,1] op_sel_hi:[1,0,1]
  v_cvt_pk_bf16_f32 v180, v32, v33
  v_cvt_pk_bf16_f32 v181, v34, v35
  v_cvt_pk_bf16_f32 v182, v36, v37
  v_cvt_pk_bf16_f32 v183, v38, v39
  ds_write_b128 v10, v[180:183] offset:25472
  s_waitcnt vmcnt(17) lgkmcnt(0)
  s_barrier
  ds_read_b64_tr_b16 v[128:129], v15 offset:0
  ds_read_b64_tr_b16 v[130:131], v15 offset:512
  ds_read_b128 v[16:19], v11 offset:0
  ds_read_b64_tr_b16 v[132:133], v15 offset:2048
  ds_read_b64_tr_b16 v[134:135], v15 offset:2560
  ds_read_b128 v[20:23], v11 offset:1056
  ds_read_b64_tr_b16 v[136:137], v15 offset:4096
  ds_read_b64_tr_b16 v[138:139], v15 offset:4608
  ds_read_b128 v[24:27], v11 offset:2112
  ds_read_b64_tr_b16 v[140:141], v15 offset:6144
  ds_read_b64_tr_b16 v[142:143], v15 offset:6656
  ds_read_b128 v[28:31], v11 offset:3168
  ds_read_b64_tr_b16 v[144:145], v15 offset:8192
  ds_read_b64_tr_b16 v[146:147], v15 offset:8704
  ds_read_b128 v[32:35], v11 offset:4224
  ds_read_b32 v251, v251 offset:59392
  s_waitcnt lgkmcnt(13)
  v_mfma_f32_32x32x16_bf16 v[184:199], v[128:131], v[16:19], 0
  buffer_load_dwordx4 v13, s[36:39], s25 offen offset:1024 lds
  ds_read_b64_tr_b16 v[148:149], v15 offset:10240
  ds_read_b64_tr_b16 v[150:151], v15 offset:10752
  ds_read_b128 v[36:39], v11 offset:5280
  s_waitcnt lgkmcnt(13)
  v_mfma_f32_32x32x16_bf16 v[184:199], v[132:135], v[20:23], v[184:199]
  s_add_u32 m0, s24, 98304
  s_mov_b32 s25, 689920
  buffer_load_dwordx4 v12, s[36:39], s25 offen lds
  ds_read_b64_tr_b16 v[152:153], v15 offset:12288
  ds_read_b64_tr_b16 v[154:155], v15 offset:12800
  ds_read_b128 v[40:43], v11 offset:6336
  s_waitcnt lgkmcnt(10)
  v_mfma_f32_32x32x16_bf16 v[184:199], v[136:139], v[24:27], v[184:199]
  buffer_load_dwordx4 v13, s[36:39], s25 offen offset:1024 lds
  ds_read_b64_tr_b16 v[156:157], v15 offset:14336
  ds_read_b64_tr_b16 v[158:159], v15 offset:14848
  ds_read_b128 v[44:47], v11 offset:7392
  v_mfma_f32_32x32x16_bf16 v[184:199], v[140:143], v[28:31], v[184:199]
  buffer_load_dword v248, v3, s[56:59], 0 offen sc1
  s_waitcnt vmcnt(17)
  s_barrier
  ds_read_b64_tr_b16 v[128:129], v15 offset:16384
  ds_read_b64_tr_b16 v[130:131], v15 offset:16896
  ds_read_b128 v[48:51], v11 offset:8448
  s_waitcnt lgkmcnt(9)
  v_mfma_f32_32x32x16_bf16 v[184:199], v[144:147], v[32:35], v[184:199]
  s_add_u32 m0, s24, 106496
  s_mov_b32 s25, 861952
  buffer_load_dwordx4 v12, s[36:39], s25 offen lds
  ds_read_b64_tr_b16 v[132:133], v15 offset:18432
  ds_read_b64_tr_b16 v[134:135], v15 offset:18944
  ds_read_b128 v[52:55], v11 offset:9504
  v_mfma_f32_32x32x16_bf16 v[184:199], v[148:151], v[36:39], v[184:199]
  ds_read_b64_tr_b16 v[136:137], v15 offset:20480
  ds_read_b64_tr_b16 v[138:139], v15 offset:20992
  ds_read_b128 v[56:59], v11 offset:10560
  s_waitcnt lgkmcnt(9)
  v_mfma_f32_32x32x16_bf16 v[184:199], v[152:155], v[40:43], v[184:199]
  buffer_load_dwordx4 v13, s[36:39], s25 offen offset:1024 lds
  ds_read_b64_tr_b16 v[140:141], v15 offset:22528
  ds_read_b64_tr_b16 v[142:143], v15 offset:23040
  ds_read_b128 v[60:63], v11 offset:11616
  v_mfma_f32_32x32x16_bf16 v[184:199], v[156:159], v[44:47], v[184:199]
  s_mul_i32 s16, s4, 28
  s_add_u32 s16, s16, s5
  s_lshl_b32 s17, s16, 1
  s_add_u32 s17, s17, s20
  s_mul_i32 s17, s17, 3584
  v_min_u32 v250, 13, v0
  v_lshlrev_b32 v250, 7, v250
  buffer_load_dword v243, v250, s[44:47], s17 offen
  ds_read_b64_tr_b16 v[144:145], v15 offset:24576
  ds_read_b64_tr_b16 v[146:147], v15 offset:25088
  ds_read_b128 v[64:67], v11 offset:12672
  s_waitcnt lgkmcnt(9)
  v_mfma_f32_32x32x16_bf16 v[184:199], v[128:131], v[48:51], v[184:199]
  ds_read_b64_tr_b16 v[148:149], v15 offset:26624
  ds_read_b64_tr_b16 v[150:151], v15 offset:27136
  ds_read_b128 v[68:71], v11 offset:13728
  v_mfma_f32_32x32x16_bf16 v[184:199], v[132:135], v[52:55], v[184:199]
  ds_read_b64_tr_b16 v[152:153], v15 offset:28672
  ds_read_b64_tr_b16 v[154:155], v15 offset:29184
  ds_read_b128 v[72:75], v11 offset:14784
  s_waitcnt lgkmcnt(9)
  v_mfma_f32_32x32x16_bf16 v[184:199], v[136:139], v[56:59], v[184:199]
  ds_read_b64_tr_b16 v[156:157], v15 offset:30720
  ds_read_b64_tr_b16 v[158:159], v15 offset:31232
  ds_read_b128 v[76:79], v11 offset:15840
  v_mfma_f32_32x32x16_bf16 v[184:199], v[140:143], v[60:63], v[184:199]
  s_waitcnt vmcnt(16)
  s_barrier
  ds_read_b64_tr_b16 v[128:129], v15 offset:32768
  ds_read_b64_tr_b16 v[130:131], v15 offset:33280
  ds_read_b128 v[80:83], v11 offset:16896
  s_waitcnt lgkmcnt(9)
  v_mfma_f32_32x32x16_bf16 v[184:199], v[144:147], v[64:67], v[184:199]
  s_add_u32 m0, s24, 114688
  s_mov_b32 s25, 1033984
  buffer_load_dwordx4 v12, s[36:39], s25 offen lds
  ds_read_b64_tr_b16 v[132:133], v15 offset:34816
  ds_read_b64_tr_b16 v[134:135], v15 offset:35328
  ds_read_b128 v[84:87], v11 offset:17952
  v_mfma_f32_32x32x16_bf16 v[184:199], v[148:151], v[68:71], v[184:199]
  ds_read_b64_tr_b16 v[136:137], v15 offset:36864
  ds_read_b64_tr_b16 v[138:139], v15 offset:37376
  ds_read_b128 v[88:91], v11 offset:19008
  s_waitcnt lgkmcnt(9)
  v_mfma_f32_32x32x16_bf16 v[184:199], v[152:155], v[72:75], v[184:199]
  buffer_load_dwordx4 v13, s[36:39], s25 offen offset:1024 lds
  ds_read_b64_tr_b16 v[140:141], v15 offset:38912
  ds_read_b64_tr_b16 v[142:143], v15 offset:39424
  ds_read_b128 v[92:95], v11 offset:20064
  v_mfma_f32_32x32x16_bf16 v[184:199], v[156:159], v[76:79], v[184:199]
  ds_read_b64_tr_b16 v[144:145], v15 offset:40960
  ds_read_b64_tr_b16 v[146:147], v15 offset:41472
  ds_read_b128 v[96:99], v11 offset:21120
  s_waitcnt lgkmcnt(9)
  v_mfma_f32_32x32x16_bf16 v[184:199], v[128:131], v[80:83], v[184:199]
  s_add_u32 m0, s24, 122880
  s_mov_b32 s25, 0
  buffer_load_dwordx4 v12, s[36:39], s25 offen lds
  ds_read_b64_tr_b16 v[148:149], v15 offset:43008
  ds_read_b64_tr_b16 v[150:151], v15 offset:43520
  ds_read_b128 v[100:103], v11 offset:22176
  v_mfma_f32_32x32x16_bf16 v[184:199], v[132:135], v[84:87], v[184:199]
  buffer_load_dwordx4 v13, s[36:39], s25 offen offset:1024 lds
  ds_read_b64_tr_b16 v[152:153], v15 offset:45056
  ds_read_b64_tr_b16 v[154:155], v15 offset:45568
  ds_read_b128 v[104:107], v11 offset:23232
  s_waitcnt lgkmcnt(9)
  v_mfma_f32_32x32x16_bf16 v[184:199], v[136:139], v[88:91], v[184:199]
  ds_read_b64_tr_b16 v[156:157], v15 offset:47104
  ds_read_b64_tr_b16 v[158:159], v15 offset:47616
  ds_read_b128 v[108:111], v11 offset:24288
  v_mfma_f32_32x32x16_bf16 v[184:199], v[140:143], v[92:95], v[184:199]
  s_waitcnt vmcnt(16)
  s_barrier
  ds_read_b64_tr_b16 v[128:129], v15 offset:49152
  ds_read_b64_tr_b16 v[130:131], v15 offset:49664
  ds_read_b128 v[112:115], v11 offset:25344
  s_waitcnt lgkmcnt(9)
  v_mfma_f32_32x32x16_bf16 v[184:199], v[144:147], v[96:99], v[184:199]
  s_add_u32 m0, s24, 131072
  s_mov_b32 s25, 172032
  buffer_load_dwordx4 v12, s[36:39], s25 offen lds
  ds_read_b64_tr_b16 v[132:133], v15 offset:51200
  ds_read_b64_tr_b16 v[134:135], v15 offset:51712
  ds_read_b128 v[116:119], v11 offset:26400
  v_mfma_f32_32x32x16_bf16 v[184:199], v[148:151], v[100:103], v[184:199]
  ds_read_b64_tr_b16 v[136:137], v15 offset:53248
  ds_read_b64_tr_b16 v[138:139], v15 offset:53760
  ds_read_b128 v[120:123], v11 offset:27456
  s_waitcnt lgkmcnt(9)
  v_mfma_f32_32x32x16_bf16 v[184:199], v[152:155], v[104:107], v[184:199]
  buffer_load_dwordx4 v13, s[36:39], s25 offen offset:1024 lds
  ds_read_b64_tr_b16 v[140:141], v15 offset:55296
  ds_read_b64_tr_b16 v[142:143], v15 offset:55808
  ds_read_b128 v[124:127], v11 offset:28512
  v_mfma_f32_32x32x16_bf16 v[184:199], v[156:159], v[108:111], v[184:199]
  s_waitcnt vmcnt(9)
  v_readlane_b32 s14, v248, s4
  s_cmp_eq_u32 s14, 0
  s_cbranch_scc1 L_wf_b2r_2
L_wf_b2b_3:
  s_lshl_b32 s15, s5, 2
  s_add_u32 s15, s15, s6
  s_add_u32 s15, s15, s10
  s_add_u32 s15, s15, 0x198000
  s_cmp_lg_u32 s14, s9
  s_cbranch_scc1 L_wf_b2d_4
  buffer_store_byte v5, v4, s[60:63], s15 offen
L_wf_b2o_5:
  ds_read_b64_tr_b16 v[144:145], v14 offset:0
  ds_read_b64_tr_b16 v[146:147], v14 offset:512
  s_waitcnt lgkmcnt(8)
  v_mfma_f32_32x32x16_bf16 v[184:199], v[128:131], v[112:115], v[184:199]
  s_add_u32 m0, s24, 139264
  s_mov_b32 s25, 344064
  buffer_load_dwordx4 v12, s[36:39], s25 offen lds
  ds_read_b64_tr_b16 v[148:149], v14 offset:2048
  ds_read_b64_tr_b16 v[150:151], v14 offset:2560
  v_mfma_f32_32x32x16_bf16 v[184:199], v[132:135], v[116:119], v[184:199]
  buffer_load_dwordx4 v13, s[36:39], s25 offen offset:1024 lds
  ds_read_b64_tr_b16 v[152:153], v14 offset:4096
  ds_read_b64_tr_b16 v[154:155], v14 offset:4608
  s_waitcnt lgkmcnt(6)
  v_mfma_f32_32x32x16_bf16 v[184:199], v[136:139], v[120:123], v[184:199]
  ds_read_b64_tr_b16 v[156:157], v14 offset:6144
  ds_read_b64_tr_b16 v[158:159], v14 offset:6656
  v_mfma_f32_32x32x16_bf16 v[184:199], v[140:143], v[124:127], v[184:199]
  s_barrier
  ds_read_b64_tr_b16 v[128:129], v14 offset:8192
  ds_read_b64_tr_b16 v[130:131], v14 offset:8704
  s_waitcnt lgkmcnt(6)
  v_mfma_f32_32x32x16_bf16 v[200:215], v[144:147], v[16:19], 0
  s_add_u32 m0, s24, 147456
  s_mov_b32 s25, 516096
  buffer_load_dwordx4 v12, s[36:39], s25 offen lds
  ds_read_b64_tr_b16 v[132:133], v14 offset:10240
  ds_read_b64_tr_b16 v[134:135], v14 offset:10752
  v_mfma_f32_32x32x16_bf16 v[200:215], v[148:151], v[20:23], v[200:215]
  ds_read_b64_tr_b16 v[136:137], v14 offset:12288
  ds_read_b64_tr_b16 v[138:139], v14 offset:12800
  v_cvt_pk_bf16_f32 v216, v184, v185
  v_cvt_pk_bf16_f32 v217, v186, v187
  v_cvt_pk_bf16_f32 v218, v188, v189
  v_cvt_pk_bf16_f32 v219, v190, v191
  s_waitcnt lgkmcnt(6)
  v_mfma_f32_32x32x16_bf16 v[200:215], v[152:155], v[24:27], v[200:215]
  buffer_load_dwordx4 v13, s[36:39], s25 offen offset:1024 lds
  ds_read_b64_tr_b16 v[140:141], v14 offset:14336
  ds_read_b64_tr_b16 v[142:143], v14 offset:14848
  v_cvt_pk_bf16_f32 v220, v192, v193
  v_cvt_pk_bf16_f32 v221, v194, v195
  v_cvt_pk_bf16_f32 v222, v196, v197
  v_cvt_pk_bf16_f32 v223, v198, v199
  v_mfma_f32_32x32x16_bf16 v[200:215], v[156:159], v[28:31], v[200:215]
  ds_read_b64_tr_b16 v[144:145], v14 offset:16384
  ds_read_b64_tr_b16 v[146:147], v14 offset:16896
  s_add_u32 s19, s10, 0x40000
  s_waitcnt lgkmcnt(6)
  v_mfma_f32_32x32x16_bf16 v[200:215], v[128:131], v[32:35], v[200:215]
  buffer_store_dwordx2 v[216:217], v244, s[60:63], s19 offen sc1
  ds_read_b64_tr_b16 v[148:149], v14 offset:18432
  ds_read_b64_tr_b16 v[150:151], v14 offset:18944
  v_add_u32 v225, 6144, v7
  v_add_u32 v226, 12288, v7
  v_add_u32 v227, 18432, v7
  v_mfma_f32_32x32x16_bf16 v[200:215], v[132:135], v[36:39], v[200:215]
  buffer_store_dwordx2 v[218:219], v245, s[60:63], s19 offen sc1
  ds_read_b64_tr_b16 v[152:153], v14 offset:20480
  ds_read_b64_tr_b16 v[154:155], v14 offset:20992
  v_mov_b32 v224, v7
  v_lshrrev_b32 v170, 4, v0
  v_lshlrev_b32 v170, 4, v170
  s_waitcnt lgkmcnt(6)
  v_mfma_f32_32x32x16_bf16 v[200:215], v[136:139], v[40:43], v[200:215]
  buffer_store_dwordx2 v[220:221], v246, s[60:63], s19 offen sc1
  ds_read_b64_tr_b16 v[156:157], v14 offset:22528
  ds_read_b64_tr_b16 v[158:159], v14 offset:23040
  v_xor_b32 v168, v170, v9
  v_xor_b32 v169, 64, v168
  v_add_u32 v169, 6144, v169
  v_mfma_f32_32x32x16_bf16 v[200:215], v[140:143], v[44:47], v[200:215]
  buffer_store_dwordx2 v[222:223], v247, s[60:63], s19 offen sc1
  s_waitcnt vmcnt(12)
  s_barrier
  ds_read_b64_tr_b16 v[128:129], v14 offset:24576
  ds_read_b64_tr_b16 v[130:131], v14 offset:25088
  s_lshl_b32 s14, s8, 7
  s_mul_i32 s15, s6, 100352
  s_add_u32 s98, s14, s15
  s_waitcnt lgkmcnt(6)
  v_mfma_f32_32x32x16_bf16 v[200:215], v[144:147], v[48:51], v[200:215]
  s_add_u32 m0, s24, 155648
  s_mov_b32 s25, 688128
  buffer_load_dwordx4 v12, s[36:39], s25 offen lds
  ds_read_b64_tr_b16 v[132:133], v14 offset:26624
  ds_read_b64_tr_b16 v[134:135], v14 offset:27136
  s_mul_i32 s15, s6, 14336
  s_add_u32 s15, s15, s14
  s_add_u32 s17, s15, s92
  v_mfma_f32_32x32x16_bf16 v[200:215], v[148:151], v[52:55], v[200:215]
  ds_read_b64_tr_b16 v[136:137], v14 offset:28672
  ds_read_b64_tr_b16 v[138:139], v14 offset:29184
  v_bfe_u32 v170, v0, 1, 3
  s_lshl_b32 s14, s21, 2
  v_xor_b32 v170, s14, v170
  s_waitcnt lgkmcnt(6)
  v_mfma_f32_32x32x16_bf16 v[200:215], v[152:155], v[56:59], v[200:215]
  buffer_load_dwordx4 v13, s[36:39], s25 offen offset:1024 lds
  ds_read_b64_tr_b16 v[140:141], v14 offset:30720
  ds_read_b64_tr_b16 v[142:143], v14 offset:31232
  v_lshlrev_b32 v170, 4, v170
  v_and_b32 v171, 31, v0
  v_lshl_add_u32 v170, v171, 7, v170
  v_mfma_f32_32x32x16_bf16 v[200:215], v[156:159], v[60:63], v[200:215]
  ds_read_b64_tr_b16 v[144:145], v14 offset:32768
  ds_read_b64_tr_b16 v[146:147], v14 offset:33280
  v_lshrrev_b32 v171, 5, v0
  v_lshl_add_u32 v170, v171, 3, v170
  s_lshl_b32 s14, s20, 12
  s_waitcnt lgkmcnt(6)
  v_mfma_f32_32x32x16_bf16 v[200:215], v[128:131], v[64:67], v[200:215]
  s_add_u32 m0, s24, 65536
  s_mov_b32 s25, 860160
  buffer_load_dwordx4 v12, s[36:39], s25 offen lds
  ds_read_b64_tr_b16 v[148:149], v14 offset:34816
  ds_read_b64_tr_b16 v[150:151], v14 offset:35328
  v_add_u32 v170, s14, v170
  v_xor_b32 v171, 16, v170
  v_xor_b32 v172, 32, v170
  v_mfma_f32_32x32x16_bf16 v[200:215], v[132:135], v[68:71], v[200:215]
  buffer_load_dwordx4 v13, s[36:39], s25 offen offset:1024 lds
  ds_read_b64_tr_b16 v[152:153], v14 offset:36864
  ds_read_b64_tr_b16 v[154:155], v14 offset:37376
  v_xor_b32 v173, 48, v170
  s_waitcnt lgkmcnt(6)
  v_mfma_f32_32x32x16_bf16 v[200:215], v[136:139], v[72:75], v[200:215]
  s_add_u32 m0, s24, 73728
  s_mov_b32 s25, 1032192
  buffer_load_dwordx4 v12, s[36:39], s25 offen lds
  ds_read_b64_tr_b16 v[156:157], v14 offset:38912
  ds_read_b64_tr_b16 v[158:159], v14 offset:39424
  v_mfma_f32_32x32x16_bf16 v[200:215], v[140:143], v[76:79], v[200:215]
  ds_read_b64_tr_b16 v[128:129], v15 offset:0
  ds_read_b64_tr_b16 v[130:131], v15 offset:512
  s_waitcnt lgkmcnt(6)
  v_mfma_f32_32x32x16_bf16 v[200:215], v[144:147], v[80:83], v[200:215]
  buffer_load_dwordx4 v13, s[36:39], s25 offen offset:1024 lds
  ds_read_b64_tr_b16 v[132:133], v15 offset:2048
  ds_read_b64_tr_b16 v[134:135], v15 offset:2560
  v_mfma_f32_32x32x16_bf16 v[200:215], v[148:151], v[84:87], v[200:215]
  ds_read_b64_tr_b16 v[136:137], v15 offset:4096
  ds_read_b64_tr_b16 v[138:139], v15 offset:4608
  s_waitcnt lgkmcnt(6)
  v_mfma_f32_32x32x16_bf16 v[200:215], v[152:155], v[88:91], v[200:215]
  s_add_u32 m0, s24, 57344
  s_mov_b32 s25, s17
  buffer_load_dwordx4 v168, s[32:35], s25 offen offset:0 lds
  ds_read_b64_tr_b16 v[140:141], v15 offset:6144
  ds_read_b64_tr_b16 v[142:143], v15 offset:6656
  v_mfma_f32_32x32x16_bf16 v[200:215], v[156:159], v[92:95], v[200:215]
  v_and_b32 v250, 127, v3
  buffer_load_dword v249, v250, s[60:63], s93 offen sc1
  ds_read_b64_tr_b16 v[144:145], v15 offset:8192
  ds_read_b64_tr_b16 v[146:147], v15 offset:8704
  s_waitcnt lgkmcnt(6)
  v_mfma_f32_32x32x16_bf16 v[200:215], v[128:131], v[96:99], v[200:215]
  buffer_load_dwordx4 v169, s[32:35], s25 offen offset:1024 lds
  ds_read_b64_tr_b16 v[148:149], v15 offset:10240
  ds_read_b64_tr_b16 v[150:151], v15 offset:10752
  v_mfma_f32_32x32x16_bf16 v[200:215], v[132:135], v[100:103], v[200:215]
  s_add_u32 m0, s99, 0
  s_mov_b32 s25, 0
  buffer_load_dwordx4 v228, s[44:47], s25 offen offset:0 lds
  ds_read_b64_tr_b16 v[152:153], v15 offset:12288
  ds_read_b64_tr_b16 v[154:155], v15 offset:12800
  s_waitcnt lgkmcnt(6)
  v_mfma_f32_32x32x16_bf16 v[200:215], v[136:139], v[104:107], v[200:215]
  buffer_load_dwordx4 v229, s[44:47], s25 offen offset:1024 lds
  ds_read_b64_tr_b16 v[156:157], v15 offset:14336
  ds_read_b64_tr_b16 v[158:159], v15 offset:14848
  v_mfma_f32_32x32x16_bf16 v[200:215], v[140:143], v[108:111], v[200:215]
  s_waitcnt vmcnt(15)
  s_barrier
  ds_read_b64_tr_b16 v[128:129], v15 offset:16384
  ds_read_b64_tr_b16 v[130:131], v15 offset:16896
  s_waitcnt lgkmcnt(6)
  v_mfma_f32_32x32x16_bf16 v[200:215], v[144:147], v[112:115], v[200:215]
  buffer_load_dwordx4 v230, s[44:47], s25 offen offset:2048 lds
  ds_read_b64_tr_b16 v[132:133], v15 offset:18432
  ds_read_b64_tr_b16 v[134:135], v15 offset:18944
  v_mfma_f32_32x32x16_bf16 v[200:215], v[148:151], v[116:119], v[200:215]
  ds_read_b64_tr_b16 v[136:137], v15 offset:20480
  ds_read_b64_tr_b16 v[138:139], v15 offset:20992
  s_waitcnt lgkmcnt(6)
  v_mfma_f32_32x32x16_bf16 v[200:215], v[152:155], v[120:123], v[200:215]
  buffer_load_dwordx4 v231, s[44:47], s25 offen offset:3072 lds
  ds_read_b64_tr_b16 v[140:141], v15 offset:22528
  ds_read_b64_tr_b16 v[142:143], v15 offset:23040
  v_mfma_f32_32x32x16_bf16 v[200:215], v[156:159], v[124:127], v[200:215]
  s_waitcnt vmcnt(13)
  buffer_store_dword v5, v4, s[60:63], s65 offen sc1
  ds_read_b64_tr_b16 v[144:145], v15 offset:24576
  ds_read_b64_tr_b16 v[146:147], v15 offset:25088
  s_waitcnt lgkmcnt(6)
  v_mfma_f32_32x32x16_bf16 v[184:199], v[128:131], v[16:19], 0
  s_add_u32 m0, s99, 4096
  s_mov_b32 s25, 229376
  buffer_load_dwordx4 v228, s[44:47], s25 offen offset:0 lds
  ds_read_b64_tr_b16 v[148:149], v15 offset:26624
  ds_read_b64_tr_b16 v[150:151], v15 offset:27136
  v_mfma_f32_32x32x16_bf16 v[184:199], v[132:135], v[20:23], v[184:199]
  buffer_load_dwordx4 v229, s[44:47], s25 offen offset:1024 lds
  ds_read_b64_tr_b16 v[152:153], v15 offset:28672
  ds_read_b64_tr_b16 v[154:155], v15 offset:29184
  v_cvt_pk_bf16_f32 v216, v200, v201
  v_cvt_pk_bf16_f32 v217, v202, v203
  v_cvt_pk_bf16_f32 v218, v204, v205
  v_cvt_pk_bf16_f32 v219, v206, v207
  s_waitcnt lgkmcnt(6)
  v_mfma_f32_32x32x16_bf16 v[184:199], v[136:139], v[24:27], v[184:199]
  buffer_load_dwordx4 v230, s[44:47], s25 offen offset:2048 lds
  ds_read_b64_tr_b16 v[156:157], v15 offset:30720
  ds_read_b64_tr_b16 v[158:159], v15 offset:31232
  v_cvt_pk_bf16_f32 v220, v208, v209
  v_cvt_pk_bf16_f32 v221, v210, v211
  v_cvt_pk_bf16_f32 v222, v212, v213
  v_cvt_pk_bf16_f32 v223, v214, v215
  v_mfma_f32_32x32x16_bf16 v[184:199], v[140:143], v[28:31], v[184:199]
  ds_read_b64_tr_b16 v[128:129], v15 offset:32768
  ds_read_b64_tr_b16 v[130:131], v15 offset:33280
  s_add_u32 s19, s10, 0x78000
  s_waitcnt lgkmcnt(6)
  v_mfma_f32_32x32x16_bf16 v[184:199], v[144:147], v[32:35], v[184:199]
  buffer_store_dwordx2 v[216:217], v252, s[60:63], s19 offen sc1
  ds_read_b64_tr_b16 v[132:133], v15 offset:34816
  ds_read_b64_tr_b16 v[134:135], v15 offset:35328
  v_mfma_f32_32x32x16_bf16 v[184:199], v[148:151], v[36:39], v[184:199]
  buffer_store_dwordx2 v[218:219], v253, s[60:63], s19 offen sc1
  ds_read_b64_tr_b16 v[136:137], v15 offset:36864
  ds_read_b64_tr_b16 v[138:139], v15 offset:37376
  s_waitcnt lgkmcnt(6)
  v_mfma_f32_32x32x16_bf16 v[184:199], v[152:155], v[40:43], v[184:199]
  buffer_store_dwordx2 v[220:221], v254, s[60:63], s19 offen sc1
  ds_read_b64_tr_b16 v[140:141], v15 offset:38912
  ds_read_b64_tr_b16 v[142:143], v15 offset:39424
  v_mfma_f32_32x32x16_bf16 v[184:199], v[156:159], v[44:47], v[184:199]
  buffer_store_dwordx2 v[222:223], v255, s[60:63], s19 offen sc1
  ds_read_b64_tr_b16 v[144:145], v15 offset:40960
  ds_read_b64_tr_b16 v[146:147], v15 offset:41472
  s_waitcnt vmcnt(13)
  v_cmp_ne_u32 vcc, 0x01010101, v249
  s_cbranch_vccnz L_wf_b3r_7
L_wf_b3b_8:
L_fork_wf:
  s_waitcnt lgkmcnt(6)
  v_mfma_f32_32x32x16_bf16 v[184:199], v[128:131], v[48:51], v[184:199]
  buffer_store_dword v5, v4, s[60:63], s64 offen offset:768
  ds_read_b64_tr_b16 v[148:149], v15 offset:43008
  ds_read_b64_tr_b16 v[150:151], v15 offset:43520
  v_mfma_f32_32x32x16_bf16 v[184:199], v[132:135], v[52:55], v[184:199]
  buffer_load_dwordx4 v231, s[44:47], s25 offen offset:3072 lds
  ds_read_b64_tr_b16 v[152:153], v15 offset:45056
  ds_read_b64_tr_b16 v[154:155], v15 offset:45568
  s_waitcnt lgkmcnt(6)
  v_mfma_f32_32x32x16_bf16 v[184:199], v[136:139], v[56:59], v[184:199]
  s_add_u32 m0, s99, 8192
  s_mov_b32 s25, 458752
  buffer_load_dwordx4 v228, s[44:47], s25 offen offset:0 lds
L_hop_w0_to1:
  s_cbranch_execz L_hop_w0
  ds_read_b64_tr_b16 v[156:157], v15 offset:47104
  ds_read_b64_tr_b16 v[158:159], v15 offset:47616
  v_mfma_f32_32x32x16_bf16 v[184:199], v[140:143], v[60:63], v[184:199]
  s_waitcnt vmcnt(15)
  s_barrier
  ds_read_b64_tr_b16 v[128:129], v15 offset:49152
  ds_read_b64_tr_b16 v[130:131], v15 offset:49664
  ds_read_b64 v[244:245], v170 offset:57344
  ds_read_b64 v[246:247], v171 offset:57344
  ds_read_b64 v[252:253], v172 offset:57344
  s_waitcnt lgkmcnt(9)
  v_mfma_f32_32x32x16_bf16 v[184:199], v[144:147], v[64:67], v[184:199]
  buffer_load_dwordx4 v229, s[44:47], s25 offen offset:1024 lds
  ds_read_b64_tr_b16 v[132:133], v15 offset:51200
  ds_read_b64_tr_b16 v[134:135], v15 offset:51712
  ds_read_b64 v[254:255], v173 offset:57344
  v_lshrrev_b32 v10, 5, v0
  v_mul_u32_u24 v13, 24832, v10
  v_mfma_f32_32x32x16_bf16 v[184:199], v[148:151], v[68:71], v[184:199]
  buffer_store_dword v5, v4, s[60:63], s64 offen offset:1280
  ds_read_b64_tr_b16 v[136:137], v15 offset:53248
  ds_read_b64_tr_b16 v[138:139], v15 offset:53760
  v_sub_u32 v13, v237, v13
  v_and_b32 v11, 31, v0
  v_mad_i32_i24 v11, v10, -4, v11
  s_waitcnt lgkmcnt(10)
  v_mfma_f32_32x32x16_bf16 v[184:199], v[152:155], v[72:75], v[184:199]
  buffer_load_dwordx4 v230, s[44:47], s25 offen offset:2048 lds
  ds_read_b64_tr_b16 v[140:141], v15 offset:55296
  ds_read_b64_tr_b16 v[142:143], v15 offset:55808
  v_mov_b32 v12, 0xf149f2ca
  s_cmp_eq_u32 s4, 0
  s_cselect_b32 s15, 0xf1490000, 0
  s_or_b32 s15, s15, 0x3f80
  v_mfma_f32_32x32x16_bf16 v[184:199], v[156:159], v[76:79], v[184:199]
  ds_read_b64_tr_b16 v[144:145], v14 offset:0
  ds_read_b64_tr_b16 v[146:147], v14 offset:512
  s_cmp_eq_u32 s13, 0
  s_cselect_b32 s17, s15, 0x3f80
  v_mov_b32 v160, 0x3f803f80
  s_waitcnt lgkmcnt(7)
  v_mfma_f32_32x32x16_bf16 v[184:199], v[128:131], v[80:83], v[184:199]
  buffer_load_dwordx4 v231, s[44:47], s25 offen offset:3072 lds
  ds_read_b64_tr_b16 v[148:149], v14 offset:2048
  ds_read_b64_tr_b16 v[150:151], v14 offset:2560
  v_mov_b32 v161, s15
  v_mov_b32 v162, 0x3f803f80
  v_mov_b32 v163, s17
  v_mfma_f32_32x32x16_bf16 v[184:199], v[132:135], v[84:87], v[184:199]
  s_add_u32 s16, s4, 7
  s_and_b32 s16, s16, 7
  s_lshl_b64 s[28:29], 1, s16
  s_lshr_b32 s16, s12, 1
  s_bitset1_b32 s28, s16
  s_add_u32 s16, s4, 1
  s_and_b32 s16, s16, 7
  s_bitset1_b32 s28, s16
  v_cmp_eq_u32 vcc, 0, v248
  s_and_b64 vcc, vcc, s[28:29]
  s_cbranch_vccnz L_wf_rr_10
L_wf_rb_11:
  buffer_load_dword v243, v236, s[60:63], 0 offen sc1
  ds_read_b64_tr_b16 v[152:153], v14 offset:4096
  ds_read_b64_tr_b16 v[154:155], v14 offset:4608
  v_mov_b32 v164, 0x3f803f80
  v_mov_b32 v165, 0x3f80
  s_mov_b32 exec_lo, 0
  v_mov_b32 v160, 0x3f80
  v_mov_b32 v161, 0
  s_mov_b32 exec_lo, -1
  s_waitcnt lgkmcnt(6)
  v_mfma_f32_32x32x16_bf16 v[184:199], v[136:139], v[88:91], v[184:199]
  s_add_u32 m0, s99, 12288
  s_mov_b32 s25, 688128
  buffer_load_dwordx4 v228, s[44:47], s25 offen offset:0 lds
  ds_read_b64_tr_b16 v[156:157], v14 offset:6144
  ds_read_b64_tr_b16 v[158:159], v14 offset:6656
  s_mov_b32 exec_lo, 0
  v_mov_b32 v162, 0x3f80
  v_mov_b32 v163, 0
  s_mov_b32 exec_lo, -1
  v_mfma_f32_32x32x16_bf16 v[184:199], v[140:143], v[92:95], v[184:199]
  ds_read_b64_tr_b16 v[128:129], v14 offset:8192
  ds_read_b64_tr_b16 v[130:131], v14 offset:8704
  s_mov_b32 exec_lo, 0
  v_mov_b32 v164, 0x3f80
  v_mov_b32 v165, 0
  s_mov_b32 exec_lo, -1
  s_waitcnt lgkmcnt(6)
  v_mfma_f32_32x32x16_bf16 v[184:199], v[144:147], v[96:99], v[184:199]
  buffer_load_dwordx4 v229, s[44:47], s25 offen offset:1024 lds
  ds_read_b64_tr_b16 v[132:133], v14 offset:10240
  ds_read_b64_tr_b16 v[134:135], v14 offset:10752
  v_bfe_u32 v167, v0, 4, 1
  v_bfe_u32 v166, v0, 3, 1
  v_lshl_add_u32 v166, v167, 1, v166
  v_mfma_f32_32x32x16_bf16 v[184:199], v[148:151], v[100:103], v[184:199]
  ds_read_b64_tr_b16 v[136:137], v14 offset:12288
  ds_read_b64_tr_b16 v[138:139], v14 offset:12800
  v_xor_b32 v166, s6, v166
  v_lshlrev_b32 v166, 5, v166
  v_mul_u32_u24 v167, 28672, v167
  s_waitcnt lgkmcnt(6)
  v_mfma_f32_32x32x16_bf16 v[184:199], v[152:155], v[104:107], v[184:199]
  ds_read_b64_tr_b16 v[140:141], v14 offset:14336
  ds_read_b64_tr_b16 v[142:143], v14 offset:14848
  v_add_u32 v166, v167, v166
  v_and_b32 v167, 0x198, v6
  v_add_u32 v166, v167, v166
  v_mfma_f32_32x32x16_bf16 v[184:199], v[156:159], v[108:111], v[184:199]
  v_lshrrev_b32 v167, 5, v0
  v_lshl_add_u32 v166, v167, 9, v166
  v_cmp_le_i32 s[30:31], 0, v11
  s_nop 1
  v_cndmask_b32 v200, v12, 0, s[30:31]
  v_cmp_le_i32 s[30:31], 1, v11
  s_waitcnt lgkmcnt(4)
  v_mfma_f32_32x32x16_bf16 v[184:199], v[128:131], v[112:115], v[184:199]
  v_sub_f32 v168, v12, v200
  v_cndmask_b32 v201, v12, 0, s[30:31]
  v_cmp_le_i32 s[30:31], 2, v11
  v_sub_f32 v169, v12, v201
  s_nop 0
  v_cndmask_b32 v202, v12, 0, s[30:31]
  v_mfma_f32_32x32x16_bf16 v[184:199], v[132:135], v[116:119], v[184:199]
  v_cmp_le_i32 s[30:31], 3, v11
  v_sub_f32 v170, v12, v202
  s_nop 0
  v_cndmask_b32 v203, v12, 0, s[30:31]
  v_cmp_le_i32 s[30:31], 8, v11
  v_sub_f32 v171, v12, v203
  s_waitcnt lgkmcnt(0)
  v_mfma_f32_32x32x16_bf16 v[184:199], v[136:139], v[120:123], v[184:199]
  v_cndmask_b32 v204, v12, 0, s[30:31]
  v_cmp_le_i32 s[30:31], 9, v11
  v_sub_f32 v172, v12, v204
  s_nop 0
  v_cndmask_b32 v205, v12, 0, s[30:31]
  v_cmp_le_i32 s[30:31], 10, v11
  v_mfma_f32_32x32x16_bf16 v[184:199], v[140:143], v[124:127], v[184:199]
  s_waitcnt vmcnt(10)
  buffer_store_dword v5, v4, s[60:63], s66 offen sc1
  v_sub_f32 v173, v12, v205
  v_cndmask_b32 v206, v12, 0, s[30:31]
  v_cmp_le_i32 s[30:31], 11, v11
  v_sub_f32 v174, v12, v206
  s_nop 0
  v_cndmask_b32 v207, v12, 0, s[30:31]
  s_nop 3
  v_pk_mul_f32 v[184:185], v[184:185], s[18:19] op_sel_hi:[1,0]
  v_pk_mul_f32 v[186:187], v[186:187], s[18:19] op_sel_hi:[1,0]
  v_pk_mul_f32 v[188:189], v[188:189], s[18:19] op_sel_hi:[1,0]
  v_pk_mul_f32 v[190:191], v[190:191], s[18:19] op_sel_hi:[1,0]
  v_pk_mul_f32 v[192:193], v[192:193], s[18:19] op_sel_hi:[1,0]
  v_pk_mul_f32 v[194:195], v[194:195], s[18:19] op_sel_hi:[1,0]
  v_pk_mul_f32 v[196:197], v[196:197], s[18:19] op_sel_hi:[1,0]
  v_pk_mul_f32 v[198:199], v[198:199], s[18:19] op_sel_hi:[1,0]
  v_cvt_pk_bf16_f32 v216, v184, v185
  v_cvt_pk_bf16_f32 v217, v186, v187
  v_cvt_pk_bf16_f32 v218, v188, v189
  v_cvt_pk_bf16_f32 v219, v190, v191
  v_cvt_pk_bf16_f32 v220, v192, v193
  v_cvt_pk_bf16_f32 v221, v194, v195
  v_cvt_pk_bf16_f32 v222, v196, v197
  v_cvt_pk_bf16_f32 v223, v198, v199
  s_add_u32 s19, s10, 0x0
  buffer_store_dwordx2 v[216:217], v232, s[60:63], s19 offen
  buffer_store_dwordx2 v[218:219], v233, s[60:63], s19 offen
  buffer_store_dwordx2 v[220:221], v234, s[60:63], s19 offen
  buffer_store_dwordx2 v[222:223], v235, s[60:63], s19 offen
  s_waitcnt vmcnt(7)
  v_cmp_ne_u32 vcc, 1, v243
  s_and_b64 vcc, vcc, 0x3f
  s_cbranch_vccnz L_wf_rr_13
L_wf_rb_14:
  s_add_u32 m0, s24, 81920
  s_nop 0
  buffer_load_dwordx4 v1, s[60:63], s68 offen offset:0 sc1 lds
  v_cmp_le_i32 s[30:31], 16, v11
  v_sub_f32 v175, v12, v207
  s_nop 0
  v_cndmask_b32 v208, v12, 0, s[30:31]
  v_cmp_le_i32 s[30:31], 17, v11
  s_add_u32 m0, s24, 90112
  s_nop 0
  buffer_load_dwordx4 v1, s[60:63], s69 offen offset:0 sc1 lds
  v_sub_f32 v176, v12, v208
  v_cndmask_b32 v209, v12, 0, s[30:31]
  v_cmp_le_i32 s[30:31], 18, v11
  v_sub_f32 v177, v12, v209
  s_add_u32 m0, s24, 98304
  s_nop 0
  buffer_load_dwordx4 v1, s[60:63], s70 offen offset:0 sc1 lds
  v_cndmask_b32 v210, v12, 0, s[30:31]
  v_cmp_le_i32 s[30:31], 19, v11
  v_sub_f32 v178, v12, v210
  s_nop 0
  v_cndmask_b32 v211, v12, 0, s[30:31]
  s_add_u32 m0, s24, 81920
  s_mov_b32 exec_hi, 0xffff
  buffer_load_dwordx4 v1, s[60:63], s68 offen offset:1024 sc1 lds
  s_mov_b32 exec_hi, -1
  v_cmp_le_i32 s[30:31], 24, v11
  v_sub_f32 v179, v12, v211
  s_nop 0
  v_cndmask_b32 v212, v12, 0, s[30:31]
  v_cmp_le_i32 s[30:31], 25, v11
  s_waitcnt vmcnt(4)
  buffer_store_dword v5, v4, s[60:63], s64 offen offset:256
  s_add_u32 m0, s24, 90112
  s_mov_b32 exec_hi, 0xffff
  buffer_load_dwordx4 v1, s[60:63], s69 offen offset:1024 sc1 lds
  s_mov_b32 exec_hi, -1
  v_sub_f32 v180, v12, v212
  v_cndmask_b32 v213, v12, 0, s[30:31]
  v_cmp_le_i32 s[30:31], 26, v11
  v_sub_f32 v181, v12, v213
  s_add_u32 m0, s24, 98304
  s_mov_b32 exec_hi, 0xffff
  buffer_load_dwordx4 v1, s[60:63], s70 offen offset:1024 sc1 lds
  s_mov_b32 exec_hi, -1
  v_cndmask_b32 v214, v12, 0, s[30:31]
  v_cmp_le_i32 s[30:31], 27, v11
  v_sub_f32 v182, v12, v214
  s_nop 0
  v_cndmask_b32 v215, v12, 0, s[30:31]
  v_sub_f32 v183, v12, v215
  s_add_u32 s68, s68, 0x38000
  s_add_u32 s69, s69, 0x38000
  s_add_u32 s70, s70, 0x38000
  s_barrier
  ds_write_b64 v13, v[160:161] offset:1792
  ds_write_b64 v13, v[162:163] offset:9984
  ds_write_b64 v13, v[164:165] offset:18176
  ds_read_b64_tr_b16 a[0:1], v166 offset:0
  ds_read_b64_tr_b16 a[2:3], v166 offset:14336
  ds_read_b64_tr_b16 a[4:5], v166 offset:1024
  ds_read_b64_tr_b16 a[6:7], v166 offset:15360
  ds_read_b64_tr_b16 a[8:9], v166 offset:2048
  ds_read_b64_tr_b16 a[10:11], v166 offset:16384
  ds_read_b64_tr_b16 a[12:13], v166 offset:3072
  ds_read_b64_tr_b16 a[14:15], v166 offset:17408
  ds_read_b64_tr_b16 a[16:17], v166 offset:4096
  ds_read_b64_tr_b16 a[18:19], v166 offset:18432
  ds_read_b64_tr_b16 a[20:21], v166 offset:5120
  ds_read_b64_tr_b16 a[22:23], v166 offset:19456
  ds_read_b64_tr_b16 a[24:25], v166 offset:6144
  ds_read_b64_tr_b16 a[26:27], v166 offset:20480
  ds_read_b64_tr_b16 a[28:29], v166 offset:7168
  ds_read_b64_tr_b16 a[30:31], v166 offset:21504
  ds_read_b64_tr_b16 a[32:33], v166 offset:8192
  ds_read_b64_tr_b16 a[34:35], v166 offset:22528
  ds_read_b64_tr_b16 a[36:37], v166 offset:9216
  ds_read_b64_tr_b16 a[38:39], v166 offset:23552
  ds_read_b64_tr_b16 a[40:41], v166 offset:10240
  ds_read_b64_tr_b16 a[42:43], v166 offset:24576
  ds_read_b64_tr_b16 a[44:45], v166 offset:11264
  ds_read_b64_tr_b16 a[46:47], v166 offset:25600
  ds_read_b64_tr_b16 a[48:49], v166 offset:12288
  ds_read_b64_tr_b16 a[50:51], v166 offset:26624
  ds_read_b64_tr_b16 a[52:53], v166 offset:13312
  ds_read_b64_tr_b16 a[54:55], v166 offset:27648
  buffer_load_dword v249, v242, s[60:63], 0 offen sc1
  s_add_u32 m0, s99, 106496
  s_mov_b32 s25, 802816
  buffer_load_dwordx4 v228, s[44:47], s25 offen offset:0 lds
  buffer_load_dwordx4 v229, s[44:47], s25 offen offset:1024 lds
  buffer_load_dwordx4 v230, s[44:47], s25 offen offset:2048 lds
  buffer_load_dwordx4 v231, s[44:47], s25 offen offset:3072 lds
  s_mov_b64 exec, 0
  s_cmp_eq_u32 s6, 0
  s_cbranch_scc1 L_hop_w1_to0
  s_cmp_eq_u32 s6, 1
  s_cbranch_scc1 L_hop_w1_to1
  s_cmp_eq_u32 s6, 2
  s_cbranch_scc1 L_hop_w1_to2
  s_branch L_hop_w1_to3
L_hop_w1_to3:
L_hop_w1:
  s_mov_b64 exec, -1
  s_waitcnt vmcnt(4)
  v_cmp_ne_u32 vcc, 1, v249
  s_cbranch_vccnz L_wf_rr_16
L_wf_rb_17:
  buffer_load_dwordx2 v[88:89], v2, s[60:63], s88 offen offset:0 sc1
  buffer_load_dwordx2 v[90:91], v2, s[60:63], s88 offen offset:512 sc1
  buffer_load_dwordx2 v[92:93], v2, s[60:63], s88 offen offset:1024 sc1
  buffer_load_dwordx2 v[94:95], v2, s[60:63], s88 offen offset:1536 sc1
  s_waitcnt lgkmcnt(0)
  s_barrier
  ds_read_b64 v[80:81], v237 offset:16384
  ds_read_b64 v[82:83], v237 offset:16896
  ds_read_b64 v[84:85], v237 offset:17408
  ds_read_b64 v[86:87], v237 offset:17920
  s_add_u32 m0, s24, 57344
  s_nop 0
  buffer_load_dwordx4 v1, s[60:63], s68 offen offset:0 sc1 lds
  ds_read_b64 v[16:17], v237 offset:0
  ds_read_b64 v[18:19], v237 offset:512
  ds_read_b64 v[20:21], v237 offset:1024
  ds_read_b64 v[22:23], v237 offset:1536
  s_add_u32 m0, s24, 65536
  s_nop 0
  buffer_load_dwordx4 v1, s[60:63], s69 offen offset:0 sc1 lds
  ds_read_b64 v[24:25], v237 offset:2048
  ds_read_b64 v[26:27], v237 offset:2560
  ds_read_b64 v[28:29], v237 offset:3072
  ds_read_b64 v[30:31], v237 offset:3584
  s_add_u32 m0, s24, 73728
  s_nop 0
  buffer_load_dwordx4 v1, s[60:63], s70 offen offset:0 sc1 lds
  s_mov_b32 exec_lo, 0
  s_waitcnt vmcnt(3)
  v_mov_b32 v94, 0
  v_mov_b32 v95, 1.0
  s_mov_b32 exec_lo, -1
  s_waitcnt lgkmcnt(10)
  v_mfma_f32_32x32x16_bf16 v[96:111], v[80:83], v[88:91], v[200:215]
  s_add_u32 m0, s24, 57344
  s_mov_b32 exec_hi, 0xffff
  buffer_load_dwordx4 v1, s[60:63], s68 offen offset:1024 sc1 lds
  s_mov_b32 exec_hi, -1
  s_waitcnt lgkmcnt(8)
  v_mfma_f32_32x32x16_bf16 v[96:111], v[84:87], v[92:95], v[96:111]
  s_add_u32 m0, s24, 65536
  s_mov_b32 exec_hi, 0xffff
  buffer_load_dwordx4 v1, s[60:63], s69 offen offset:1024 sc1 lds
  s_mov_b32 exec_hi, -1
  s_lshr_b32 s90, s12, 1
  s_mul_i32 s90, s90, 0x19b000
  s_and_b32 s14, s12, 1
  s_mul_i32 s14, s14, 112
  s_add_u32 s90, s90, s14
  s_add_u32 s90, s90, 0x198000
  s_add_u32 m0, s24, 73728
  s_mov_b32 exec_hi, 0xffff
  buffer_load_dwordx4 v1, s[60:63], s70 offen offset:1024 sc1 lds
  s_mov_b32 exec_hi, -1
  v_max_f32 v10, v96, v97
  v_max_f32 v11, v98, v99
  v_max3_f32 v10, v10, v100, v101
  v_max3_f32 v11, v11, v102, v103
  v_max3_f32 v10, v10, v104, v105
  v_max3_f32 v11, v11, v106, v107
  v_max3_f32 v10, v10, v108, v109
  v_max3_f32 v11, v11, v110, v111
  v_max_f32 v10, v10, v11
  v_mov_b32 v11, v10
  s_mov_b32 s16, 0xffff0000
  s_mov_b32 s17, 0x07060302
  v_permlane32_swap_b32 v10, v11
  v_min_f32 v10, -v10, -v11
  v_and_b32 v11, s16, v10
  v_sub_f32 v11, v10, v11
  v_and_b32 v14, s16, v11
  v_sub_f32 v14, v11, v14
  s_mov_b32 exec_lo, 0
  v_perm_b32 v94, v11, v10, s17
  v_perm_b32 v95, v95, v14, s17
  s_mov_b32 exec_lo, -1
  s_waitcnt lgkmcnt(6)
  v_mfma_f32_32x32x16_bf16 v[96:111], v[16:19], v[88:91], v[168:183]
  s_waitcnt lgkmcnt(4)
  v_mfma_f32_32x32x16_bf16 v[96:111], v[20:23], v[92:95], v[96:111]
  s_lshl_b32 s14, s6, 28
  s_lshl2_add_u32 s15, s5, s93
  s_add_u32 s14, s14, s15
  buffer_store_dword v5, v4, s[60:63], s14 offen offset:128 sc1
  v_lshrrev_b32 v13, 5, v0
  v_lshlrev_b32 v13, 4, v13
  v_mov_b32 v12, 0
  s_cmp_lt_u32 s4, 7
  s_cselect_b32 s14, 0x19b00, 0
  v_and_b32 v250, 127, v3
  v_mad_u32_u24 v250, v13, s14, v250
  s_add_u32 m0, s99, 110592
  s_mov_b32 s25, 1032192
  buffer_load_dwordx4 v228, s[44:47], s25 offen offset:0 lds
  v_exp_f32 v96, v96
  v_exp_f32 v97, v97
  v_exp_f32 v98, v98
  v_exp_f32 v99, v99
  buffer_load_dwordx4 v229, s[44:47], s25 offen offset:1024 lds
  v_exp_f32 v100, v100
  v_exp_f32 v101, v101
  v_exp_f32 v102, v102
  v_exp_f32 v103, v103
  s_waitcnt lgkmcnt(2)
  v_mfma_f32_32x32x16_bf16 v[112:127], v[24:27], v[88:91], 0
  buffer_load_dwordx4 v230, s[44:47], s25 offen offset:2048 lds
  ds_read_b64 v[32:33], v237 offset:4096
  ds_read_b64 v[34:35], v237 offset:4608
  ds_read_b64 v[36:37], v237 offset:5120
  ds_read_b64 v[38:39], v237 offset:5632
  v_cvt_pk_bf16_f32 v16, v96, v97
  v_cvt_pk_bf16_f32 v17, v98, v99
  v_cvt_pk_bf16_f32 v18, v100, v101
  v_cvt_pk_bf16_f32 v19, v102, v103
  v_exp_f32 v104, v104
  v_exp_f32 v105, v105
  s_waitcnt lgkmcnt(4)
  v_mfma_f32_32x32x16_bf16 v[112:127], v[28:31], v[92:95], v[112:127]
  buffer_load_dwordx4 v231, s[44:47], s25 offen offset:3072 lds
  v_exp_f32 v106, v106
  v_exp_f32 v107, v107
  v_exp_f32 v108, v108
  v_exp_f32 v109, v109
  v_exp_f32 v110, v110
  v_exp_f32 v111, v111
  v_cvt_pk_bf16_f32 v20, v104, v105
  v_cvt_pk_bf16_f32 v21, v106, v107
  v_cvt_pk_bf16_f32 v22, v108, v109
  v_cvt_pk_bf16_f32 v23, v110, v111
  s_add_u32 m0, s99, 114688
  s_mov_b32 s25, 1261568
  buffer_load_dwordx4 v228, s[44:47], s25 offen offset:0 lds
  v_exp_f32 v112, v112
  v_exp_f32 v113, v113
  v_exp_f32 v114, v114
  v_exp_f32 v115, v115
  buffer_load_dwordx4 v229, s[44:47], s25 offen offset:1024 lds
  v_exp_f32 v116, v116
  v_exp_f32 v117, v117
  v_exp_f32 v118, v118
  v_exp_f32 v119, v119
  s_waitcnt lgkmcnt(2)
  v_mfma_f32_32x32x16_bf16 v[96:111], v[32:35], v[88:91], 0
  buffer_load_dwordx4 v230, s[44:47], s25 offen offset:2048 lds
  ds_read_b64 v[40:41], v237 offset:6144
  ds_read_b64 v[42:43], v237 offset:6656
  ds_read_b64 v[44:45], v237 offset:7168
  ds_read_b64 v[46:47], v237 offset:7680
  v_cvt_pk_bf16_f32 v24, v112, v113
  v_cvt_pk_bf16_f32 v25, v114, v115
  v_cvt_pk_bf16_f32 v26, v116, v117
  v_cvt_pk_bf16_f32 v27, v118, v119
  v_exp_f32 v120, v120
  v_exp_f32 v121, v121
  s_waitcnt lgkmcnt(4)
  v_mfma_f32_32x32x16_bf16 v[96:111], v[36:39], v[92:95], v[96:111]
  buffer_load_dwordx4 v[168:171], v13, s[60:63], s90 offen offset:1792 sc1
  v_exp_f32 v122, v122
  v_exp_f32 v123, v123
  v_exp_f32 v124, v124
  v_exp_f32 v125, v125
  v_exp_f32 v126, v126
  v_exp_f32 v127, v127
  v_cvt_pk_bf16_f32 v28, v120, v121
  v_cvt_pk_bf16_f32 v29, v122, v123
  v_cvt_pk_bf16_f32 v30, v124, v125
  v_cvt_pk_bf16_f32 v31, v126, v127
  buffer_load_dwordx4 v231, s[44:47], s25 offen offset:3072 lds
  v_exp_f32 v96, v96
  v_exp_f32 v97, v97
  v_exp_f32 v98, v98
  v_exp_f32 v99, v99
  s_add_u32 m0, s99, 118784
  s_mov_b32 s25, 1490944
  buffer_load_dwordx4 v228, s[44:47], s25 offen offset:0 lds
  v_exp_f32 v100, v100
  v_exp_f32 v101, v101
  v_exp_f32 v102, v102
  v_exp_f32 v103, v103
  s_waitcnt lgkmcnt(2)
  v_mfma_f32_32x32x16_bf16 v[112:127], v[40:43], v[88:91], 0
  buffer_load_dwordx4 v229, s[44:47], s25 offen offset:1024 lds
  ds_read_b64 v[48:49], v237 offset:8192
  ds_read_b64 v[50:51], v237 offset:8704
  ds_read_b64 v[52:53], v237 offset:9216
  ds_read_b64 v[54:55], v237 offset:9728
  v_cvt_pk_bf16_f32 v32, v96, v97
  v_cvt_pk_bf16_f32 v33, v98, v99
  v_cvt_pk_bf16_f32 v34, v100, v101
  v_cvt_pk_bf16_f32 v35, v102, v103
  v_exp_f32 v104, v104
  v_exp_f32 v105, v105
  s_waitcnt lgkmcnt(4)
  v_mfma_f32_32x32x16_bf16 v[112:127], v[44:47], v[92:95], v[112:127]
  buffer_load_dwordx4 v[172:175], v13, s[60:63], s90 offen offset:1824 sc1
  v_exp_f32 v106, v106
  v_exp_f32 v107, v107
  s_waitcnt vmcnt(13)
  s_barrier
  ds_read_b64_tr_b16 v[144:145], v238 offset:0
  ds_read_b64_tr_b16 v[146:147], v239 offset:0
  ds_read_b64_tr_b16 v[148:149], v240 offset:0
  ds_read_b64_tr_b16 v[150:151], v241 offset:0
  ds_read_b64_tr_b16 v[152:153], v238 offset:2048
  ds_read_b64_tr_b16 v[154:155], v239 offset:2048
  ds_read_b64_tr_b16 v[156:157], v240 offset:2048
  ds_read_b64_tr_b16 v[158:159], v241 offset:2048
  v_exp_f32 v108, v108
  v_exp_f32 v109, v109
  v_exp_f32 v110, v110
  v_exp_f32 v111, v111
  v_cvt_pk_bf16_f32 v36, v104, v105
  v_cvt_pk_bf16_f32 v37, v106, v107
  v_cvt_pk_bf16_f32 v38, v108, v109
  v_cvt_pk_bf16_f32 v39, v110, v111
  s_waitcnt lgkmcnt(0)
  v_mfma_f32_32x32x16_bf16 v[128:143], v[144:147], v[16:19], 0
  s_add_u32 m0, s99, 0
  s_add_u32 s25, s98, 0
  buffer_load_dwordx4 v224, s[40:43], s25 offen offset:0 lds
  v_exp_f32 v112, v112
  v_exp_f32 v113, v113
  v_exp_f32 v114, v114
  v_mfma_f32_32x32x16_bf16 v[128:143], v[148:151], v[20:23], v[128:143]
  v_exp_f32 v115, v115
  v_exp_f32 v116, v116
  v_exp_f32 v117, v117
  v_mfma_f32_32x32x16_bf16 v[128:143], v[152:155], v[24:27], v[128:143]
  buffer_load_dwordx4 v225, s[40:43], s25 offen offset:1024 lds
  ds_read_b64_tr_b16 v[184:185], v238 offset:4096
  ds_read_b64_tr_b16 v[186:187], v239 offset:4096
  ds_read_b64_tr_b16 v[188:189], v240 offset:4096
  ds_read_b64_tr_b16 v[190:191], v241 offset:4096
  v_exp_f32 v118, v118
  v_exp_f32 v119, v119
  v_mfma_f32_32x32x16_bf16 v[128:143], v[156:159], v[28:31], v[128:143]
  ds_read_b64_tr_b16 v[192:193], v238 offset:6144
  ds_read_b64_tr_b16 v[194:195], v239 offset:6144
  ds_read_b64_tr_b16 v[196:197], v240 offset:6144
  ds_read_b64_tr_b16 v[198:199], v241 offset:6144
  v_cvt_pk_bf16_f32 v40, v112, v113
  v_cvt_pk_bf16_f32 v41, v114, v115
  v_cvt_pk_bf16_f32 v42, v116, v117
  v_cvt_pk_bf16_f32 v43, v118, v119
  v_mfma_f32_32x32x16_bf16 v[96:111], v[48:51], v[88:91], 0
  buffer_load_dwordx4 v226, s[40:43], s25 offen offset:2048 lds
  ds_read_b64 v[56:57], v237 offset:10240
  ds_read_b64 v[58:59], v237 offset:10752
  ds_read_b64 v[60:61], v237 offset:11264
  ds_read_b64 v[62:63], v237 offset:11776
  v_exp_f32 v120, v120
  v_exp_f32 v121, v121
  v_exp_f32 v122, v122
  v_mfma_f32_32x32x16_bf16 v[96:111], v[52:55], v[92:95], v[96:111]
  buffer_load_dwordx4 v[176:179], v13, s[60:63], s90 offen offset:1856 sc1
  v_exp_f32 v123, v123
  v_exp_f32 v124, v124
  v_exp_f32 v125, v125
  v_exp_f32 v126, v126
  v_exp_f32 v127, v127
  v_cvt_pk_bf16_f32 v44, v120, v121
  v_cvt_pk_bf16_f32 v45, v122, v123
  v_cvt_pk_bf16_f32 v46, v124, v125
  v_cvt_pk_bf16_f32 v47, v126, v127
  s_waitcnt lgkmcnt(4)
  v_mfma_f32_32x32x16_bf16 v[128:143], v[184:187], v[32:35], v[128:143]
  buffer_load_dwordx4 v227, s[40:43], s25 offen offset:3072 lds
  v_exp_f32 v96, v96
  v_exp_f32 v97, v97
  v_exp_f32 v98, v98
  v_mfma_f32_32x32x16_bf16 v[128:143], v[188:191], v[36:39], v[128:143]
  v_exp_f32 v99, v99
  v_exp_f32 v100, v100
  v_exp_f32 v101, v101
  v_mfma_f32_32x32x16_bf16 v[128:143], v[192:195], v[40:43], v[128:143]
  s_add_u32 m0, s99, 4096
  s_add_u32 s25, s98, 28672
  buffer_load_dwordx4 v224, s[40:43], s25 offen offset:0 lds
  ds_read_b64_tr_b16 v[144:145], v238 offset:8192
  ds_read_b64_tr_b16 v[146:147], v239 offset:8192
  ds_read_b64_tr_b16 v[148:149], v240 offset:8192
  ds_read_b64_tr_b16 v[150:151], v241 offset:8192
  v_exp_f32 v102, v102
  v_exp_f32 v103, v103
  v_mfma_f32_32x32x16_bf16 v[128:143], v[196:199], v[44:47], v[128:143]
  v_cvt_pk_bf16_f32 v48, v96, v97
  v_cvt_pk_bf16_f32 v49, v98, v99
  v_cvt_pk_bf16_f32 v50, v100, v101
  v_cvt_pk_bf16_f32 v51, v102, v103
  s_waitcnt lgkmcnt(6)
  v_mfma_f32_32x32x16_bf16 v[112:127], v[56:59], v[88:91], 0
  buffer_load_dwordx4 v225, s[40:43], s25 offen offset:1024 lds
  ds_read_b64 v[64:65], v237 offset:12288
  ds_read_b64 v[66:67], v237 offset:12800
  ds_read_b64 v[68:69], v237 offset:13312
  ds_read_b64 v[70:71], v237 offset:13824
  v_exp_f32 v104, v104
  v_exp_f32 v105, v105
  v_exp_f32 v106, v106
  s_waitcnt lgkmcnt(8)
  v_mfma_f32_32x32x16_bf16 v[112:127], v[60:63], v[92:95], v[112:127]
  buffer_load_dwordx4 v[180:183], v12, s[60:63], s90 offen offset:1888 sc1
  v_exp_f32 v107, v107
  v_exp_f32 v108, v108
  v_exp_f32 v109, v109
  v_exp_f32 v110, v110
  v_exp_f32 v111, v111
  v_cvt_pk_bf16_f32 v52, v104, v105
  v_cvt_pk_bf16_f32 v53, v106, v107
  v_cvt_pk_bf16_f32 v54, v108, v109
  v_cvt_pk_bf16_f32 v55, v110, v111
  s_waitcnt lgkmcnt(4)
  v_mfma_f32_32x32x16_bf16 v[128:143], v[144:147], v[48:51], v[128:143]
  buffer_load_dwordx4 v226, s[40:43], s25 offen offset:2048 lds
  v_exp_f32 v112, v112
  v_exp_f32 v113, v113
  v_exp_f32 v114, v114
  v_exp_f32 v115, v115
  v_mfma_f32_32x32x16_bf16 v[128:143], v[148:151], v[52:55], v[128:143]
  buffer_load_dwordx4 v227, s[40:43], s25 offen offset:3072 lds
  ds_read_b64_tr_b16 v[152:153], v238 offset:10240
  ds_read_b64_tr_b16 v[154:155], v239 offset:10240
  ds_read_b64_tr_b16 v[156:157], v240 offset:10240
  ds_read_b64_tr_b16 v[158:159], v241 offset:10240
  v_exp_f32 v116, v116
  v_exp_f32 v117, v117
  v_exp_f32 v118, v118
  v_exp_f32 v119, v119
  s_waitcnt lgkmcnt(6)
  v_mfma_f32_32x32x16_bf16 v[96:111], v[64:67], v[88:91], 0
  s_add_u32 m0, s99, 8192
  s_add_u32 s25, s98, 57344
  buffer_load_dwordx4 v224, s[40:43], s25 offen offset:0 lds
  ds_read_b64 v[72:73], v237 offset:14336
  ds_read_b64 v[74:75], v237 offset:14848
  ds_read_b64 v[76:77], v237 offset:15360
  ds_read_b64 v[78:79], v237 offset:15872
  v_cvt_pk_bf16_f32 v56, v112, v113
  v_cvt_pk_bf16_f32 v57, v114, v115
  v_cvt_pk_bf16_f32 v58, v116, v117
  v_cvt_pk_bf16_f32 v59, v118, v119
  v_exp_f32 v120, v120
  v_exp_f32 v121, v121
  v_exp_f32 v122, v122
  s_waitcnt lgkmcnt(8)
  v_mfma_f32_32x32x16_bf16 v[96:111], v[68:71], v[92:95], v[96:111]
  buffer_load_dwordx4 v225, s[40:43], s25 offen offset:1024 lds
  v_exp_f32 v123, v123
  v_exp_f32 v124, v124
  v_exp_f32 v125, v125
  v_exp_f32 v126, v126
  v_exp_f32 v127, v127
  v_cvt_pk_bf16_f32 v60, v120, v121
  v_cvt_pk_bf16_f32 v61, v122, v123
  v_cvt_pk_bf16_f32 v62, v124, v125
L_hop_w0_to2:
  s_cbranch_execz L_hop_w0
  v_cvt_pk_bf16_f32 v63, v126, v127
  s_waitcnt lgkmcnt(4)
  v_mfma_f32_32x32x16_bf16 v[128:143], v[152:155], v[56:59], v[128:143]
  buffer_load_dwordx4 v226, s[40:43], s25 offen offset:2048 lds
  v_exp_f32 v96, v96
  v_exp_f32 v97, v97
  v_exp_f32 v98, v98
  v_exp_f32 v99, v99
  v_mfma_f32_32x32x16_bf16 v[128:143], v[156:159], v[60:63], v[128:143]
  buffer_load_dwordx4 v227, s[40:43], s25 offen offset:3072 lds
  ds_read_b64_tr_b16 v[184:185], v238 offset:12288
  ds_read_b64_tr_b16 v[186:187], v239 offset:12288
  ds_read_b64_tr_b16 v[188:189], v240 offset:12288
  ds_read_b64_tr_b16 v[190:191], v241 offset:12288
  v_exp_f32 v100, v100
  v_exp_f32 v101, v101
  v_exp_f32 v102, v102
  v_exp_f32 v103, v103
  s_waitcnt lgkmcnt(6)
  v_mfma_f32_32x32x16_bf16 v[112:127], v[72:75], v[88:91], 0
  s_add_u32 m0, s99, 12288
  s_add_u32 s25, s98, 86016
  buffer_load_dwordx4 v224, s[40:43], s25 offen offset:0 lds
  v_cvt_pk_bf16_f32 v64, v96, v97
  v_cvt_pk_bf16_f32 v65, v98, v99
  v_cvt_pk_bf16_f32 v66, v100, v101
  v_cvt_pk_bf16_f32 v67, v102, v103
  v_exp_f32 v104, v104
  v_exp_f32 v105, v105
  v_exp_f32 v106, v106
  s_waitcnt lgkmcnt(4)
  v_mfma_f32_32x32x16_bf16 v[112:127], v[76:79], v[92:95], v[112:127]
  buffer_load_dwordx4 v225, s[40:43], s25 offen offset:1024 lds
  v_exp_f32 v107, v107
  v_exp_f32 v108, v108
  v_exp_f32 v109, v109
  v_exp_f32 v110, v110
  v_exp_f32 v111, v111
  v_cvt_pk_bf16_f32 v68, v104, v105
  v_cvt_pk_bf16_f32 v69, v106, v107
  v_cvt_pk_bf16_f32 v70, v108, v109
  v_cvt_pk_bf16_f32 v71, v110, v111
  s_waitcnt lgkmcnt(0)
  v_mfma_f32_32x32x16_bf16 v[128:143], v[184:187], v[64:67], v[128:143]
  buffer_load_dword v243, v250, s[60:63], s93 offen offset:128 sc1
  v_exp_f32 v112, v112
  v_exp_f32 v113, v113
  v_exp_f32 v114, v114
  v_exp_f32 v115, v115
  v_mfma_f32_32x32x16_bf16 v[128:143], v[188:191], v[68:71], v[128:143]
  ds_read_b64_tr_b16 v[192:193], v238 offset:14336
  ds_read_b64_tr_b16 v[194:195], v239 offset:14336
  ds_read_b64_tr_b16 v[196:197], v240 offset:14336
  ds_read_b64_tr_b16 v[198:199], v241 offset:14336
  v_exp_f32 v116, v116
  v_exp_f32 v117, v117
  v_exp_f32 v118, v118
  v_exp_f32 v119, v119
  v_mfma_f32_32x32x16_bf16 v[96:111], v[80:83], v[88:91], v[200:215]
  v_cvt_pk_bf16_f32 v72, v112, v113
  v_cvt_pk_bf16_f32 v73, v114, v115
  v_cvt_pk_bf16_f32 v74, v116, v117
  v_cvt_pk_bf16_f32 v75, v118, v119
  v_exp_f32 v120, v120
  v_exp_f32 v121, v121
  v_exp_f32 v122, v122
  v_mfma_f32_32x32x16_bf16 v[96:111], v[84:87], v[92:95], v[96:111]
  v_exp_f32 v123, v123
  v_exp_f32 v124, v124
  v_exp_f32 v125, v125
  v_exp_f32 v126, v126
  v_exp_f32 v127, v127
  v_cvt_pk_bf16_f32 v76, v120, v121
  v_cvt_pk_bf16_f32 v77, v122, v123
  v_cvt_pk_bf16_f32 v78, v124, v125
  v_cvt_pk_bf16_f32 v79, v126, v127
  s_waitcnt lgkmcnt(0)
  v_mfma_f32_32x32x16_bf16 v[128:143], v[192:195], v[72:75], v[128:143]
  s_nop 0
  v_exp_f32 v96, v96
  v_exp_f32 v97, v97
  v_exp_f32 v98, v98
  v_exp_f32 v99, v99
  v_mfma_f32_32x32x16_bf16 v[128:143], v[196:199], v[76:79], v[128:143]
  ds_read_b64_tr_b16 v[144:145], v238 offset:16384
  ds_read_b64_tr_b16 v[146:147], v239 offset:16384
  ds_read_b64_tr_b16 v[148:149], v240 offset:16384
  ds_read_b64_tr_b16 v[150:151], v241 offset:16384
  v_exp_f32 v100, v100
  v_exp_f32 v101, v101
  v_exp_f32 v102, v102
  v_exp_f32 v103, v103
  v_cvt_pk_bf16_f32 v80, v96, v97
  v_cvt_pk_bf16_f32 v81, v98, v99
  v_cvt_pk_bf16_f32 v82, v100, v101
  v_cvt_pk_bf16_f32 v83, v102, v103
  v_exp_f32 v104, v104
  v_exp_f32 v105, v105
  v_exp_f32 v106, v106
  v_exp_f32 v107, v107
  v_exp_f32 v108, v108
  v_exp_f32 v109, v109
  v_exp_f32 v110, v110
  v_exp_f32 v111, v111
  v_cvt_pk_bf16_f32 v84, v104, v105
  v_cvt_pk_bf16_f32 v85, v106, v107
  v_cvt_pk_bf16_f32 v86, v108, v109
  v_cvt_pk_bf16_f32 v87, v110, v111
  s_waitcnt lgkmcnt(2)
  v_mfma_f32_32x32x16_bf16 v[128:143], v[144:147], v[80:83], v[128:143]
  s_waitcnt lgkmcnt(0)
  v_mfma_f32_32x32x16_bf16 v[128:143], v[148:151], v[84:87], v[128:143]
  s_lshl_b32 s15, s86, 7
  s_add_u32 s15, s15, s12
  s_add_u32 s15, s15, s93
  s_waitcnt vmcnt(13)
  v_min3_u32 v10, v168, v172, v176
  s_waitcnt vmcnt(9)
  v_min_u32 v10, v10, v180
  v_cmp_eq_u32 vcc, 0, v10
  s_cbranch_vccnz L_wf_rr_21
L_wf_rb_22:
  s_nop 2
  v_mov_b32 v10, v140
  v_mov_b32 v11, v140
  s_nop 1
  v_permlane32_swap_b32 v10, v11
  v_cmp_ngt_f32 vcc, 0x5f800000, v11
  s_cbranch_vccnz L_wf_fb_19
L_wf_fbb_20:
  v_rcp_f32 v10, v11
  s_mov_b32 exec_lo, 0
  v_mov_b32 v140, 0
  s_mov_b32 exec_lo, -1
  v_pk_mul_f32 v[12:13], v[128:129], v[168:169]
  v_pk_mul_f32 v[128:129], v[128:129], v[10:11] op_sel_hi:[1,0]
  v_pk_fma_f32 v[12:13], v[130:131], v[170:171], v[12:13]
  v_pk_mul_f32 v[130:131], v[130:131], v[10:11] op_sel_hi:[1,0]
  v_pk_fma_f32 v[12:13], v[132:133], v[172:173], v[12:13]
  v_pk_mul_f32 v[132:133], v[132:133], v[10:11] op_sel_hi:[1,0]
  v_pk_fma_f32 v[12:13], v[134:135], v[174:175], v[12:13]
  v_pk_mul_f32 v[134:135], v[134:135], v[10:11] op_sel_hi:[1,0]
  v_pk_fma_f32 v[12:13], v[136:137], v[176:177], v[12:13]
  v_pk_mul_f32 v[136:137], v[136:137], v[10:11] op_sel_hi:[1,0]
  v_pk_fma_f32 v[12:13], v[138:139], v[178:179], v[12:13]
  v_pk_mul_f32 v[138:139], v[138:139], v[10:11] op_sel_hi:[1,0]
  v_pk_fma_f32 v[12:13], v[140:141], v[180:181], v[12:13]
  v_pk_mul_f32 v[140:141], v[140:141], v[10:11] op_sel_hi:[1,0]
  v_pk_fma_f32 v[12:13], v[142:143], v[182:183], v[12:13]
  v_pk_mul_f32 v[142:143], v[142:143], v[10:11] op_sel_hi:[1,0]
  v_add_f32 v12, v12, v13
  v_mul_f32 v12, v12, v10
  v_mov_b32 v13, v12
  v_cvt_pk_bf16_f32 v144, v128, v129
  v_cvt_pk_bf16_f32 v145, v130, v131
  v_permlane32_swap_b32 v12, v13
  v_cvt_pk_bf16_f32 v146, v132, v133
  v_cvt_pk_bf16_f32 v147, v134, v135
  v_cvt_pk_bf16_f32 v148, v136, v137
  v_cvt_pk_bf16_f32 v149, v138, v139
  v_cvt_pk_bf16_f32 v150, v140, v141
  v_cvt_pk_bf16_f32 v151, v142, v143
  s_mov_b32 exec_lo, 0
  v_add_f32 v150, v12, v13
  s_mov_b32 exec_lo, -1
  buffer_store_dwordx4 v[144:147], v1, s[60:63], s88 offen offset:0
  buffer_store_dwordx4 v[148:151], v1, s[60:63], s88 offen offset:1024
  s_lshl_b32 s14, s22, 7
  s_lshl_b32 s16, s21, 3
  s_add_u32 s14, s14, s16
  s_add_u32 s64, s14, s93
  v_and_b32 v156, 4, v3
  s_lshl_b32 s66, s22, 15
  s_add_u32 s66, s66, s10
  s_lshl_b32 s16, s21, 14
  s_add_u32 s65, s66, s16
  v_add_u32 v171, 106496, v166
  v_mov_b32 v170, v166
  v_lshrrev_b32 v153, 5, v0
  s_lshl_b32 s14, s21, 6
  v_xor_b32 v168, s14, v6
  v_lshl_add_u32 v168, v153, 9, v168
  s_mul_i32 s14, s21, 28672
  v_add_u32 v168, s14, v168
  v_xor_b32 v169, 64, v168
  s_lshl_b32 s14, s6, 12
  s_add_u32 s14, s14, 65536
  v_add_u32 v172, s14, v1
  v_xor_b32 v173, 0x2000, v172
  s_mov_b32 s17, 0xffff0000
  v_add_u32 v174, -1, v153
  v_mov_b32 v175, 0
  s_mul_i32 s18, s6, 4096
  s_lshl_b32 s14, s6, 8
  v_add_u32 v176, s14, v3
  v_xor_b32 v177, 0x200, v176
  s_lshl_b32 s14, s23, 11
  s_mul_i32 s68, s22, 28672
  s_add_u32 s68, s68, s14
  s_add_u32 s68, s68, s10
  s_add_u32 s68, s68, 0x40000
  s_lshl_b32 s14, s22, 7
  s_add_u32 s14, s14, s23
  s_add_u32 s69, s14, s93
  v_lshl_add_u32 v158, v153, 30, v1
  v_lshlrev_b32 v80, 16, v244
  v_and_b32 v81, s17, v244
  v_lshlrev_b32 v82, 16, v245
  v_and_b32 v83, s17, v245
  v_lshlrev_b32 v84, 16, v246
  v_and_b32 v85, s17, v246
  v_lshlrev_b32 v86, 16, v247
  v_and_b32 v87, s17, v247
  v_lshlrev_b32 v88, 16, v252
  v_and_b32 v89, s17, v252
  v_lshlrev_b32 v90, 16, v253
  v_and_b32 v91, s17, v253
  v_lshlrev_b32 v92, 16, v254
  v_and_b32 v93, s17, v254
  v_lshlrev_b32 v94, 16, v255
  v_and_b32 v95, s17, v255
  s_waitcnt vmcnt(0)
  buffer_store_byte v5, v4, s[60:63], s15 offen offset:3072
  s_barrier
  s_mov_b32 s27, 200000
  buffer_load_dword v10, v156, s[60:63], s64 offen offset:3072 sc1
  ds_read_b64_tr_b16 a[116:117], v169 offset:0
  ds_read_b64_tr_b16 a[118:119], v169 offset:1024
  ds_read_b64_tr_b16 a[112:113], v168 offset:0
  ds_read_b64_tr_b16 a[114:115], v168 offset:1024
  ds_read_b64_tr_b16 a[124:125], v169 offset:2048
  ds_read_b64_tr_b16 a[126:127], v169 offset:3072
  ds_read_b64_tr_b16 a[120:121], v168 offset:2048
  ds_read_b64_tr_b16 a[122:123], v168 offset:3072
  buffer_load_dword v11, v156, s[60:63], s64 offen offset:3072 sc1
  ds_read_b64_tr_b16 a[132:133], v169 offset:3584
  ds_read_b64_tr_b16 a[134:135], v169 offset:4608
  ds_read_b64_tr_b16 a[128:129], v168 offset:3584
  ds_read_b64_tr_b16 a[130:131], v168 offset:4608
  ds_read_b64_tr_b16 a[140:141], v169 offset:5632
  ds_read_b64_tr_b16 a[142:143], v169 offset:6656
  ds_read_b64_tr_b16 a[136:137], v168 offset:5632
  ds_read_b64_tr_b16 a[138:139], v168 offset:6656
L_wf_pp_24:
  buffer_load_dword v12, v156, s[60:63], s64 offen offset:3072 sc1
  s_waitcnt vmcnt(2)
  v_cmp_ne_u32 vcc, 0x01010101, v10
  s_cbranch_vccz L_wf_pd_25
  buffer_load_dword v10, v156, s[60:63], s64 offen offset:3072 sc1
  s_waitcnt vmcnt(2)
  v_cmp_ne_u32 vcc, 0x01010101, v11
  s_cbranch_vccz L_wf_pd_25
  buffer_load_dword v11, v156, s[60:63], s64 offen offset:3072 sc1
  s_waitcnt vmcnt(2)
  v_cmp_ne_u32 vcc, 0x01010101, v12
  s_cbranch_vccz L_wf_pd_25
  s_sub_u32 s27, s27, 1
  s_cmp_lg_u32 s27, 0
  s_cbranch_scc1 L_wf_pp_24
L_wf_pd_25:
  buffer_load_dwordx4 v[16:19], v1, s[60:63], s65 offen offset:0 sc1
  ds_read_b64_tr_b16 a[148:149], v169 offset:7168
  ds_read_b64_tr_b16 a[150:151], v169 offset:8192
  ds_read_b64_tr_b16 a[144:145], v168 offset:7168
  ds_read_b64_tr_b16 a[146:147], v168 offset:8192
  buffer_load_dwordx4 v[20:23], v1, s[60:63], s65 offen offset:1024 sc1
  ds_read_b64_tr_b16 a[156:157], v169 offset:9216
  ds_read_b64_tr_b16 a[158:159], v169 offset:10240
  ds_read_b64_tr_b16 a[152:153], v168 offset:9216
  ds_read_b64_tr_b16 a[154:155], v168 offset:10240
  buffer_load_dwordx4 v[24:27], v1, s[60:63], s65 offen offset:2048 sc1
  ds_read_b64_tr_b16 a[164:165], v169 offset:10752
  ds_read_b64_tr_b16 a[166:167], v169 offset:11776
  ds_read_b64_tr_b16 a[160:161], v168 offset:10752
  ds_read_b64_tr_b16 a[162:163], v168 offset:11776
  buffer_load_dwordx4 v[28:31], v1, s[60:63], s65 offen offset:3072 sc1
  ds_read_b64_tr_b16 a[172:173], v169 offset:12800
  ds_read_b64_tr_b16 a[174:175], v169 offset:13824
  ds_read_b64_tr_b16 a[168:169], v168 offset:12800
  ds_read_b64_tr_b16 a[170:171], v168 offset:13824
  s_add_u32 s65, s65, 4096
  buffer_load_dwordx4 v[32:35], v1, s[60:63], s65 offen offset:0 sc1
  ds_read_b64_tr_b16 a[180:181], v169 offset:14336
  ds_read_b64_tr_b16 a[182:183], v169 offset:15360
  ds_read_b64_tr_b16 a[176:177], v168 offset:14336
  ds_read_b64_tr_b16 a[178:179], v168 offset:15360
  buffer_load_dwordx4 v[36:39], v1, s[60:63], s65 offen offset:1024 sc1
  ds_read_b64_tr_b16 a[188:189], v169 offset:16384
  ds_read_b64_tr_b16 a[190:191], v169 offset:17408
  ds_read_b64_tr_b16 a[184:185], v168 offset:16384
  ds_read_b64_tr_b16 a[186:187], v168 offset:17408
  s_waitcnt vmcnt(5) lgkmcnt(15)
  v_mfma_f32_32x32x16_bf16 v[96:111], a[116:119], v[16:19], 0
  buffer_load_dwordx4 v[40:43], v1, s[60:63], s65 offen offset:2048 sc1
  v_mfma_f32_32x32x16_bf16 v[80:95], a[112:115], v[16:19], v[80:95]
  ds_read_b64_tr_b16 a[196:197], v169 offset:17920
  ds_read_b64_tr_b16 a[198:199], v169 offset:18944
  ds_read_b64_tr_b16 a[192:193], v168 offset:17920
  ds_read_b64_tr_b16 a[194:195], v168 offset:18944
  s_waitcnt vmcnt(5)
  v_add_f32 v175, v175, v22
  v_and_b32 v22, v174, v22
  s_nop 1
  v_mfma_f32_32x32x16_bf16 v[96:111], a[124:127], v[20:23], v[96:111]
  buffer_load_dwordx4 v[44:47], v1, s[60:63], s65 offen offset:3072 sc1
  v_mfma_f32_32x32x16_bf16 v[80:95], a[120:123], v[20:23], v[80:95]
  ds_read_b64_tr_b16 a[204:205], v169 offset:19968
  ds_read_b64_tr_b16 a[206:207], v169 offset:20992
  ds_read_b64_tr_b16 a[200:201], v168 offset:19968
  ds_read_b64_tr_b16 a[202:203], v168 offset:20992
  s_waitcnt vmcnt(5)
  v_mfma_f32_32x32x16_bf16 v[96:111], a[132:135], v[24:27], v[96:111]
  s_add_u32 s65, s65, 4096
  buffer_load_dwordx4 v[48:51], v1, s[60:63], s65 offen offset:0 sc1
  v_mfma_f32_32x32x16_bf16 v[80:95], a[128:131], v[24:27], v[80:95]
  ds_read_b64_tr_b16 a[212:213], v169 offset:21504
  ds_read_b64_tr_b16 a[214:215], v169 offset:22528
  ds_read_b64_tr_b16 a[208:209], v168 offset:21504
  ds_read_b64_tr_b16 a[210:211], v168 offset:22528
  s_waitcnt vmcnt(5)
  v_add_f32 v175, v175, v30
  v_and_b32 v30, v174, v30
  s_nop 1
  v_mfma_f32_32x32x16_bf16 v[96:111], a[140:143], v[28:31], v[96:111]
  buffer_load_dwordx4 v[52:55], v1, s[60:63], s65 offen offset:1024 sc1
  v_mfma_f32_32x32x16_bf16 v[80:95], a[136:139], v[28:31], v[80:95]
  ds_read_b64_tr_b16 a[220:221], v169 offset:23552
  ds_read_b64_tr_b16 a[222:223], v169 offset:24576
  ds_read_b64_tr_b16 a[216:217], v168 offset:23552
  ds_read_b64_tr_b16 a[218:219], v168 offset:24576
  s_waitcnt vmcnt(5)
  v_mfma_f32_32x32x16_bf16 v[96:111], a[148:151], v[32:35], v[96:111]
  buffer_load_dwordx4 v[56:59], v1, s[60:63], s65 offen offset:2048 sc1
  v_mfma_f32_32x32x16_bf16 v[80:95], a[144:147], v[32:35], v[80:95]
  ds_read_b64_tr_b16 a[228:229], v169 offset:25088
  ds_read_b64_tr_b16 a[230:231], v169 offset:26112
  ds_read_b64_tr_b16 a[224:225], v168 offset:25088
  ds_read_b64_tr_b16 a[226:227], v168 offset:26112
  s_waitcnt vmcnt(5)
  v_add_f32 v175, v175, v38
  v_and_b32 v38, v174, v38
  s_nop 1
  v_mfma_f32_32x32x16_bf16 v[96:111], a[156:159], v[36:39], v[96:111]
  buffer_load_dwordx4 v[60:63], v1, s[60:63], s65 offen offset:3072 sc1
  v_mfma_f32_32x32x16_bf16 v[80:95], a[152:155], v[36:39], v[80:95]
  ds_read_b64_tr_b16 a[236:237], v169 offset:27136
  ds_read_b64_tr_b16 a[238:239], v169 offset:28160
  ds_read_b64_tr_b16 a[232:233], v168 offset:27136
  ds_read_b64_tr_b16 a[234:235], v168 offset:28160
  s_waitcnt vmcnt(5) lgkmcnt(15)
  v_mfma_f32_32x32x16_bf16 v[96:111], a[164:167], v[40:43], v[96:111]
  s_add_u32 s65, s65, 4096
  buffer_load_dwordx4 v[64:67], v1, s[60:63], s65 offen offset:0 sc1
  v_mfma_f32_32x32x16_bf16 v[80:95], a[160:163], v[40:43], v[80:95]
  ds_read_b64_tr_b16 a[56:57], v171 offset:0
  ds_read_b64_tr_b16 a[58:59], v171 offset:14336
  ds_read_b64_tr_b16 a[60:61], v171 offset:1024
  ds_read_b64_tr_b16 a[62:63], v171 offset:15360
  s_waitcnt vmcnt(5)
  v_add_f32 v175, v175, v46
  v_and_b32 v46, v174, v46
  s_nop 1
  v_mfma_f32_32x32x16_bf16 v[96:111], a[172:175], v[44:47], v[96:111]
  buffer_load_dwordx4 v[68:71], v1, s[60:63], s65 offen offset:1024 sc1
  v_mfma_f32_32x32x16_bf16 v[80:95], a[168:171], v[44:47], v[80:95]
  ds_read_b64_tr_b16 a[64:65], v171 offset:2048
  ds_read_b64_tr_b16 a[66:67], v171 offset:16384
  ds_read_b64_tr_b16 a[68:69], v171 offset:3072
  ds_read_b64_tr_b16 a[70:71], v171 offset:17408
  s_waitcnt vmcnt(5)
  v_mfma_f32_32x32x16_bf16 v[96:111], a[180:183], v[48:51], v[96:111]
  buffer_load_dwordx4 v[72:75], v1, s[60:63], s65 offen offset:2048 sc1
  v_mfma_f32_32x32x16_bf16 v[80:95], a[176:179], v[48:51], v[80:95]
  ds_read_b64_tr_b16 a[72:73], v171 offset:4096
  ds_read_b64_tr_b16 a[74:75], v171 offset:18432
  ds_read_b64_tr_b16 a[76:77], v171 offset:5120
  ds_read_b64_tr_b16 a[78:79], v171 offset:19456
  s_waitcnt vmcnt(5)
  v_add_f32 v175, v175, v54
  v_and_b32 v54, v174, v54
  s_nop 1
  v_mfma_f32_32x32x16_bf16 v[96:111], a[188:191], v[52:55], v[96:111]
  buffer_load_dwordx4 v[76:79], v1, s[60:63], s65 offen offset:3072 sc1
  v_mfma_f32_32x32x16_bf16 v[80:95], a[184:187], v[52:55], v[80:95]
  ds_read_b64_tr_b16 a[80:81], v171 offset:6144
  ds_read_b64_tr_b16 a[82:83], v171 offset:20480
  ds_read_b64_tr_b16 a[84:85], v171 offset:7168
  ds_read_b64_tr_b16 a[86:87], v171 offset:21504
  s_waitcnt vmcnt(5)
  v_mfma_f32_32x32x16_bf16 v[96:111], a[196:199], v[56:59], v[96:111]
  v_mfma_f32_32x32x16_bf16 v[80:95], a[192:195], v[56:59], v[80:95]
  ds_read_b64_tr_b16 a[88:89], v171 offset:8192
  ds_read_b64_tr_b16 a[90:91], v171 offset:22528
  ds_read_b64_tr_b16 a[92:93], v171 offset:9216
  ds_read_b64_tr_b16 a[94:95], v171 offset:23552
  s_waitcnt vmcnt(4)
  v_add_f32 v175, v175, v62
  v_and_b32 v62, v174, v62
  s_nop 1
  v_mfma_f32_32x32x16_bf16 v[96:111], a[204:207], v[60:63], v[96:111]
  v_mfma_f32_32x32x16_bf16 v[80:95], a[200:203], v[60:63], v[80:95]
  ds_read_b64_tr_b16 a[96:97], v171 offset:10240
  ds_read_b64_tr_b16 a[98:99], v171 offset:24576
  ds_read_b64_tr_b16 a[100:101], v171 offset:11264
  ds_read_b64_tr_b16 a[102:103], v171 offset:25600
  s_waitcnt vmcnt(3) lgkmcnt(15)
  v_mfma_f32_32x32x16_bf16 v[96:111], a[212:215], v[64:67], v[96:111]
  v_mfma_f32_32x32x16_bf16 v[80:95], a[208:211], v[64:67], v[80:95]
  ds_read_b64_tr_b16 a[104:105], v171 offset:12288
  ds_read_b64_tr_b16 a[106:107], v171 offset:26624
  ds_read_b64_tr_b16 a[108:109], v171 offset:13312
  ds_read_b64_tr_b16 a[110:111], v171 offset:27648
  s_waitcnt vmcnt(2)
  v_add_f32 v175, v175, v70
  v_and_b32 v70, v174, v70
  s_nop 1
  v_mfma_f32_32x32x16_bf16 v[96:111], a[220:223], v[68:71], v[96:111]
  v_mfma_f32_32x32x16_bf16 v[80:95], a[216:219], v[68:71], v[80:95]
  s_waitcnt vmcnt(1)
  v_mfma_f32_32x32x16_bf16 v[96:111], a[228:231], v[72:75], v[96:111]
  v_mfma_f32_32x32x16_bf16 v[80:95], a[224:227], v[72:75], v[80:95]
  s_waitcnt vmcnt(0)
  v_add_f32 v175, v175, v78
  v_and_b32 v78, v174, v78
  s_nop 1
  v_mfma_f32_32x32x16_bf16 v[96:111], a[236:239], v[76:79], v[96:111]
  v_mfma_f32_32x32x16_bf16 v[80:95], a[232:235], v[76:79], v[80:95]
  ds_write_b32 v176, v175 offset:57856
  v_cmp_ne_u32 vcc, 1, v243
  s_cbranch_vccnz L_wf_rr_26
L_wf_rb_27:
  s_nop 7
  ds_write_b128 v172, v[96:99] offset:0
  ds_write_b128 v172, v[100:103] offset:1024
  ds_write_b128 v172, v[104:107] offset:2048
  ds_write_b128 v172, v[108:111] offset:3072
  s_waitcnt lgkmcnt(0)
  s_barrier
  ds_read_b32 v152, v177 offset:57856
  ds_read_b128 v[120:123], v173 offset:0
  ds_read_b128 v[124:127], v173 offset:1024
  ds_read_b128 v[128:131], v173 offset:2048
  ds_read_b128 v[132:135], v173 offset:3072
  s_sub_u32 s28, s20, 1
  s_not_b32 s29, s28
  s_waitcnt lgkmcnt(4)
  v_add_f32 v152, v152, v175
  v_mov_b32 v153, v152
  s_nop 1
  v_permlane32_swap_b32 v152, v153
  v_add_f32 v152, v153, v251
  s_waitcnt lgkmcnt(3)
  v_pk_add_f32 v[80:81], v[80:81], v[120:121]
  v_pk_add_f32 v[82:83], v[82:83], v[122:123]
  s_waitcnt lgkmcnt(2)
  v_pk_add_f32 v[84:85], v[84:85], v[124:125]
  v_pk_add_f32 v[86:87], v[86:87], v[126:127]
  v_pk_add_f32 v[120:121], v[80:81], v[152:153] op_sel_hi:[1,0] neg_lo:[0,1] neg_hi:[0,1]
  v_pk_add_f32 v[122:123], v[82:83], v[152:153] op_sel_hi:[1,0] neg_lo:[0,1] neg_hi:[0,1]
  v_pk_add_f32 v[124:125], v[84:85], v[152:153] op_sel_hi:[1,0] neg_lo:[0,1] neg_hi:[0,1]
  v_pk_add_f32 v[126:127], v[86:87], v[152:153] op_sel_hi:[1,0] neg_lo:[0,1] neg_hi:[0,1]
  v_cvt_pk_bf16_f32 v112, v120, v121
  v_cvt_pk_bf16_f32 v113, v122, v123
  v_cvt_pk_bf16_f32 v114, v124, v125
  v_cvt_pk_bf16_f32 v115, v126, v127
  buffer_store_dwordx4 v[112:115], v1, s[60:63], s68 offen offset:0
  s_waitcnt lgkmcnt(1)
  v_pk_add_f32 v[88:89], v[88:89], v[128:129]
  v_pk_add_f32 v[90:91], v[90:91], v[130:131]
  s_waitcnt lgkmcnt(0)
  v_pk_add_f32 v[92:93], v[92:93], v[132:133]
  v_pk_add_f32 v[94:95], v[94:95], v[134:135]
  v_pk_add_f32 v[128:129], v[88:89], v[152:153] op_sel_hi:[1,0] neg_lo:[0,1] neg_hi:[0,1]
  v_pk_add_f32 v[130:131], v[90:91], v[152:153] op_sel_hi:[1,0] neg_lo:[0,1] neg_hi:[0,1]
  v_pk_add_f32 v[132:133], v[92:93], v[152:153] op_sel_hi:[1,0] neg_lo:[0,1] neg_hi:[0,1]
  v_pk_add_f32 v[134:135], v[94:95], v[152:153] op_sel_hi:[1,0] neg_lo:[0,1] neg_hi:[0,1]
  v_cvt_pk_bf16_f32 v116, v128, v129
  v_cvt_pk_bf16_f32 v117, v130, v131
  v_cvt_pk_bf16_f32 v118, v132, v133
  v_cvt_pk_bf16_f32 v119, v134, v135
  buffer_store_dwordx4 v[116:119], v1, s[60:63], s68 offen offset:1024
  v_pk_mul_f32 v[152:153], v[120:121], v[120:121]
  v_pk_mul_f32 v[154:155], v[122:123], v[122:123]
  v_pk_fma_f32 v[152:153], v[124:125], v[124:125], v[152:153]
  v_pk_fma_f32 v[154:155], v[126:127], v[126:127], v[154:155]
  v_pk_fma_f32 v[152:153], v[128:129], v[128:129], v[152:153]
  v_pk_fma_f32 v[154:155], v[130:131], v[130:131], v[154:155]
  v_pk_fma_f32 v[152:153], v[132:133], v[132:133], v[152:153]
  v_pk_fma_f32 v[154:155], v[134:135], v[134:135], v[154:155]
  v_pk_add_f32 v[152:153], v[152:153], v[154:155]
  v_add_f32 v152, v152, v153
  v_mov_b32 v153, v152
  s_nop 1
  v_permlane32_swap_b32 v152, v153
  v_add_f32 v152, v152, v153
  buffer_store_dword v152, v158, s[60:63], s67 offen
  v_and_b32 v167, 12, v3
  v_bfe_u32 v166, v0, 2, 2
  v_lshl_add_u32 v166, v166, 7, v167
  v_mov_b32 v188, 0x01010101
  s_mov_b32 exec_lo, 0x88888888
  s_mov_b32 exec_hi, 0x88888888
  v_mov_b32 v188, 0x101
  s_mov_b64 exec, -1
  s_lshl_b32 s91, s71, 9
  s_add_u32 s91, s91, s93
  s_mul_i32 s86, s6, 7168
  s_mul_i32 s14, s71, 114688
  s_add_u32 s14, s14, s10
  s_add_u32 s14, s14, 0x40000
  s_add_u32 s87, s86, s14
  s_lshl_b32 s24, s6, 10
  s_add_u32 s70, s24, s14
  s_lshl_b32 s15, s71, 2
  s_add_u32 s15, s15, s6
  s_lshl_b32 s15, s15, 11
  s_add_u32 s15, s15, s10
  s_add_u32 s18, s15, 0x194000
  s_lshl_b32 s15, s6, 8
  v_add_u32 v180, s15, v3
  v_add_u32 v182, 106496, v1
  v_add_u32 v183, 49152, v1
  s_lshl_b32 s88, s6, 12
  v_bfe_u32 v161, v0, 4, 1
  v_mul_u32_u24 v163, 20480, v161
  v_sub_u32 v164, v170, v163
  v_add_u32 v164, 81920, v164
  v_mul_u32_u24 v161, 20480, v161
  v_sub_u32 v165, v170, v161
  s_lshl_b32 s14, s6, 4
  s_add_u32 s14, s14, s93
  s_lshl_b32 s15, s71, 9
  s_add_u32 s15, s15, s3
  s_add_u32 s90, s14, s15
  s_lshl_b32 s15, s7, 8
  s_add_u32 s65, s14, s15
  s_mul_i32 s14, s6, 28672
  s_add_u32 s14, s14, s10
  s_mul_i32 s15, s71, 458752
  s_lshl_b32 s17, s3, 10
  s_add_u32 s15, s15, s17
  s_add_u32 s89, s14, s15
  s_mul_i32 s15, s7, 229376
  s_add_u32 s66, s14, s15
  s_waitcnt vmcnt(0)
  buffer_store_byte v5, v4, s[60:63], s69 offen offset:3136
  s_add_u32 m0, s88, 0
  s_mov_b32 s25, 1792
  buffer_load_dwordx4 v228, s[44:47], s25 offen offset:0 lds
  buffer_load_dwordx4 v229, s[44:47], s25 offen offset:1024 lds
  buffer_load_dwordx4 v230, s[44:47], s25 offen offset:2048 lds
  buffer_load_dwordx4 v231, s[44:47], s25 offen offset:3072 lds
  s_mov_b32 s27, 200000
  buffer_load_dword v10, v167, s[60:63], s91 offen offset:3136 sc1
  s_mul_i32 s14, s6, 14336
  s_lshl_b32 s16, s8, 7
  s_add_u32 s64, s14, s16
  v_add_u32 v226, 55296, v224
  v_add_u32 v227, 55296, v225
  s_lshl_b32 s14, s21, 6
  v_xor_b32 v184, s14, v6
  v_lshrrev_b32 v161, 5, v0
  v_lshl_add_u32 v184, v161, 9, v184
  v_add_u32 v184, s88, v184
  v_xor_b32 v185, 64, v184
  v_bfe_u32 v163, v0, 2, 2
  v_and_b32 v186, 12, v3
  v_lshl_add_u32 v186, v163, 6, v186
  v_and_b32 v163, 31, v0
  v_mul_u32_u24 v163, 272, v163
  v_lshl_add_u32 v163, v161, 7, v163
  s_mul_i32 s14, s6, 8704
  buffer_load_dword v11, v167, s[60:63], s91 offen offset:3136 sc1
  s_add_u32 s14, s14, 94208
  s_lshl_b32 s15, s21, 6
  s_add_u32 s17, s14, s15
  v_add_u32 v189, s17, v163
  s_xor_b32 s15, s15, 64
  s_add_u32 s17, s14, s15
  v_add_u32 v190, s17, v163
  v_and_or_b32 v161, v0, 24, v161
  v_and_b32 v163, 0x70, v1
  s_mul_i32 s14, s6, 544
  s_add_u32 s14, s14, 94208
  v_mul_u32_u24 v191, 272, v161
  v_add3_u32 v191, v191, v163, s14
  v_mul_u32_u24 v9, 896, v161
  v_add_u32 v9, v9, v163
  s_mul_i32 s14, s6, 1792
  s_add_u32 s14, s14, s16
  s_add_u32 s67, s14, s92
L_wf_pp_29:
  buffer_load_dword v12, v167, s[60:63], s91 offen offset:3136 sc1
  s_waitcnt vmcnt(2)
  v_cmp_ne_u32 vcc, v188, v10
  s_cbranch_vccz L_wf_pd_30
  buffer_load_dword v10, v167, s[60:63], s91 offen offset:3136 sc1
  s_waitcnt vmcnt(2)
  v_cmp_ne_u32 vcc, v188, v11
  s_cbranch_vccz L_wf_pd_30
  buffer_load_dword v11, v167, s[60:63], s91 offen offset:3136 sc1
  s_waitcnt vmcnt(2)
  v_cmp_ne_u32 vcc, v188, v12
  s_cbranch_vccz L_wf_pd_30
  s_sub_u32 s27, s27, 1
  s_cmp_lg_u32 s27, 0
  s_cbranch_scc1 L_wf_pp_29
L_wf_pd_30:
  s_add_u32 m0, s24, 135168
  s_add_u32 s25, s70, 0
  buffer_load_dwordx4 v1, s[60:63], s25 offen sc1 lds
  s_add_u32 m0, s24, 139264
  s_add_u32 s25, s70, 4096
  buffer_load_dwordx4 v1, s[60:63], s25 offen sc1 lds
  s_add_u32 m0, s24, 143360
  s_add_u32 s25, s70, 8192
  buffer_load_dwordx4 v1, s[60:63], s25 offen sc1 lds
  s_add_u32 m0, s24, 147456
  s_add_u32 s25, s70, 12288
  buffer_load_dwordx4 v1, s[60:63], s25 offen sc1 lds
  buffer_load_dword v187, v166, s[60:63], s91 offen offset:3136 sc1
  s_add_u32 m0, s24, 151552
  s_add_u32 s25, s70, 16384
  buffer_load_dwordx4 v1, s[60:63], s25 offen sc1 lds
  s_waitcnt vmcnt(3)
  s_barrier
  ds_read_b128 v[128:131], v182 offset:28672
  ds_read_b128 v[132:135], v182 offset:29696
  ds_read_b128 v[136:139], v182 offset:30720
  ds_read_b128 v[140:143], v182 offset:31744
  ds_read_b128 v[144:147], v182 offset:32768
  s_add_u32 m0, s24, 155648
  s_add_u32 s25, s70, 20480
  buffer_load_dwordx4 v1, s[60:63], s25 offen sc1 lds
  s_add_u32 m0, s24, 159744
  s_add_u32 s25, s70, 24576
  buffer_load_dwordx4 v1, s[60:63], s25 offen sc1 lds
  s_waitcnt vmcnt(3)
  v_cmp_ne_u32 vcc, v188, v187
  s_cbranch_vccnz L_wf_rr_31
L_wf_rb_32:
  s_waitcnt lgkmcnt(3)
  v_mfma_f32_32x32x16_bf16 v[96:111], a[0:3], v[128:131], 0
  buffer_load_dwordx4 v[152:155], v1, s[60:63], s18 offen sc1
  ds_read_b128 v[148:151], v182 offset:33792
  v_and_b32 v192, s28, v80
  v_and_b32 v208, s29, v80
  v_and_b32 v193, s28, v81
  v_and_b32 v209, s29, v81
  v_mfma_f32_32x32x16_bf16 v[96:111], a[4:7], v[132:135], v[96:111]
  buffer_load_dwordx3 v[156:158], v1, s[60:63], s18 offen offset:1024 sc1
  ds_read_b128 v[128:131], v182 offset:34816
  s_waitcnt lgkmcnt(3)
  v_mfma_f32_32x32x16_bf16 v[96:111], a[8:11], v[136:139], v[96:111]
L_hop_w0_to3:
  s_cbranch_execz L_hop_w0
  s_add_u32 m0, s86, 106496
  s_add_u32 s25, s87, 57344
  buffer_load_dwordx4 v1, s[60:63], s25 offen offset:0 sc1 lds
  ds_read_b128 v[132:135], v182 offset:35840
  v_and_b32 v194, s28, v82
  v_and_b32 v210, s29, v82
  v_and_b32 v195, s28, v83
  v_and_b32 v211, s29, v83
  v_mfma_f32_32x32x16_bf16 v[96:111], a[12:15], v[140:143], v[96:111]
  buffer_load_dwordx4 v1, s[60:63], s25 offen offset:1024 sc1 lds
  ds_read_b128 v[136:139], v182 offset:36864
  s_waitcnt lgkmcnt(3)
  v_mfma_f32_32x32x16_bf16 v[96:111], a[16:19], v[144:147], v[96:111]
  buffer_load_dwordx4 v1, s[60:63], s25 offen offset:2048 sc1 lds
  ds_read_b128 v[140:143], v182 offset:37888
  v_and_b32 v196, s28, v84
  v_and_b32 v212, s29, v84
  v_and_b32 v197, s28, v85
  v_and_b32 v213, s29, v85
  v_mfma_f32_32x32x16_bf16 v[96:111], a[20:23], v[148:151], v[96:111]
  buffer_load_dwordx4 v1, s[60:63], s25 offen offset:3072 sc1 lds
  ds_read_b128 v[144:147], v182 offset:38912
  s_waitcnt lgkmcnt(3)
  v_mfma_f32_32x32x16_bf16 v[96:111], a[24:27], v[128:131], v[96:111]
  s_add_u32 m0, s86, 110592
  s_add_u32 s25, s87, 61440
  buffer_load_dwordx4 v1, s[60:63], s25 offen offset:0 sc1 lds
  ds_read_b128 v[148:151], v182 offset:39936
  v_and_b32 v198, s28, v86
  v_and_b32 v214, s29, v86
  v_and_b32 v199, s28, v87
  v_and_b32 v215, s29, v87
  v_mfma_f32_32x32x16_bf16 v[96:111], a[28:31], v[132:135], v[96:111]
  buffer_load_dwordx4 v1, s[60:63], s25 offen offset:1024 sc1 lds
  s_barrier
  ds_read_b128 v[128:131], v182 offset:40960
  s_waitcnt lgkmcnt(3)
  v_mfma_f32_32x32x16_bf16 v[96:111], a[32:35], v[136:139], v[96:111]
  buffer_load_dwordx4 v1, s[60:63], s25 offen offset:2048 sc1 lds
  ds_read_b128 v[132:135], v182 offset:41984
  v_and_b32 v200, s28, v88
  v_and_b32 v216, s29, v88
  v_and_b32 v201, s28, v89
  v_and_b32 v217, s29, v89
  v_mfma_f32_32x32x16_bf16 v[96:111], a[36:39], v[140:143], v[96:111]
  s_waitcnt vmcnt(9)
  s_barrier
  ds_read_b128 v[136:139], v182 offset:43008
  s_waitcnt lgkmcnt(3)
  v_mfma_f32_32x32x16_bf16 v[96:111], a[40:43], v[144:147], v[96:111]
  s_add_u32 m0, s88, 16384
  s_mov_b32 s25, 231168
  buffer_load_dwordx4 v228, s[44:47], s25 offen offset:0 lds
  ds_read_b128 v[140:143], v182 offset:44032
  v_and_b32 v202, s28, v90
  v_and_b32 v218, s29, v90
  v_and_b32 v203, s28, v91
  v_and_b32 v219, s29, v91
  v_mfma_f32_32x32x16_bf16 v[96:111], a[44:47], v[148:151], v[96:111]
  buffer_load_dwordx4 v229, s[44:47], s25 offen offset:1024 lds
  ds_read_b128 v[144:147], v182 offset:45056
  s_waitcnt lgkmcnt(3)
  v_mfma_f32_32x32x16_bf16 v[96:111], a[48:51], v[128:131], v[96:111]
  ds_read_b128 v[148:151], v182 offset:46080
  v_and_b32 v204, s28, v92
  v_and_b32 v220, s29, v92
  v_and_b32 v205, s28, v93
  v_and_b32 v221, s29, v93
  v_mfma_f32_32x32x16_bf16 v[96:111], a[52:55], v[132:135], v[96:111]
  buffer_load_dwordx4 v230, s[44:47], s25 offen offset:2048 lds
  ds_read_b128 v[128:131], v182 offset:47104
  s_waitcnt lgkmcnt(3)
  v_mfma_f32_32x32x16_bf16 v[96:111], a[56:59], v[136:139], v[96:111]
  buffer_load_dwordx4 v231, s[44:47], s25 offen offset:3072 lds
  ds_read_b128 v[132:135], v182 offset:48128
  v_mfma_f32_32x32x16_bf16 v[96:111], a[60:63], v[140:143], v[96:111]
  ds_read_b128 v[136:139], v182 offset:49152
  s_waitcnt vmcnt(12)
  v_add_f32 v152, v152, v153
  v_add_f32 v154, v154, v155
  s_waitcnt vmcnt(11)
  v_add_f32 v156, v156, v157
  s_waitcnt lgkmcnt(3)
  v_mfma_f32_32x32x16_bf16 v[96:111], a[64:67], v[144:147], v[96:111]
  s_add_u32 m0, s86, 77824
  s_add_u32 s25, s87, 28672
  buffer_load_dwordx4 v1, s[60:63], s25 offen offset:0 sc1 lds
  ds_read_b128 v[140:143], v182 offset:50176
  v_add_f32 v152, v152, v158
  v_add_f32 v154, v154, v156
  v_add_f32 v152, v152, v154
  v_mfma_f32_32x32x16_bf16 v[96:111], a[68:71], v[148:151], v[96:111]
  ds_read_b128 v[144:147], v182 offset:51200
  v_mov_b32 v153, v152
  v_mov_b32 v154, 0x3727c5ac
  s_nop 0
  s_waitcnt lgkmcnt(3)
  v_mfma_f32_32x32x16_bf16 v[96:111], a[72:75], v[128:131], v[96:111]
  buffer_load_dwordx4 v1, s[60:63], s25 offen offset:1024 sc1 lds
  ds_read_b128 v[148:151], v182 offset:52224
  v_permlane32_swap_b32 v152, v153
  v_add_f32 v152, v152, v153
  v_fmac_f32 v154, 0x3b124925, v152
  v_mfma_f32_32x32x16_bf16 v[96:111], a[76:79], v[132:135], v[96:111]
  buffer_load_dwordx4 v1, s[60:63], s25 offen offset:2048 sc1 lds
  ds_read_b128 v[128:131], v182 offset:53248
  ds_write_b32 v180, v154 offset:49152
  s_waitcnt lgkmcnt(4)
  v_mfma_f32_32x32x16_bf16 v[96:111], a[80:83], v[136:139], v[96:111]
  ds_read_b128 v[132:135], v182 offset:54272
  v_and_b32 v206, s28, v94
  v_and_b32 v222, s29, v94
  v_mfma_f32_32x32x16_bf16 v[96:111], a[84:87], v[140:143], v[96:111]
  buffer_load_dwordx4 v1, s[60:63], s25 offen offset:3072 sc1 lds
  ds_read_b128 v[136:139], v182 offset:55296
  v_and_b32 v207, s28, v95
  v_and_b32 v223, s29, v95
  s_waitcnt lgkmcnt(4)
  v_mfma_f32_32x32x16_bf16 v[96:111], a[88:91], v[144:147], v[96:111]
  ds_read_b128 v[140:143], v182 offset:56320
  v_mfma_f32_32x32x16_bf16 v[96:111], a[92:95], v[148:151], v[96:111]
  s_waitcnt lgkmcnt(3)
  s_waitcnt vmcnt(8)
  s_barrier
  ds_read_b32 v232, v3 offset:49152
  ds_read_b32 v233, v3 offset:49408
  ds_read_b32 v234, v3 offset:49664
  ds_read_b32 v235, v3 offset:49920
  ds_read_b128 v[144:147], v182 offset:0
  s_waitcnt lgkmcnt(7)
  v_mfma_f32_32x32x16_bf16 v[96:111], a[96:99], v[128:131], v[96:111]
  s_add_u32 m0, s88, 32768
  s_mov_b32 s25, 460544
  buffer_load_dwordx4 v228, s[44:47], s25 offen offset:0 lds
  ds_read_b64_tr_b16 a[112:113], v165 offset:0
  ds_read_b128 v[148:151], v182 offset:1024
  v_mfma_f32_32x32x16_bf16 v[96:111], a[100:103], v[132:135], v[96:111]
  buffer_load_dwordx4 v229, s[44:47], s25 offen offset:1024 lds
  ds_read_b64_tr_b16 a[114:115], v165 offset:4096
  ds_read_b128 v[128:131], v182 offset:2048
  s_waitcnt lgkmcnt(9)
  v_mfma_f32_32x32x16_bf16 v[96:111], a[104:107], v[136:139], v[96:111]
  ds_read_b64_tr_b16 a[116:117], v165 offset:1024
  ds_read_b128 v[132:135], v182 offset:3072
  s_waitcnt lgkmcnt(10)
  v_rsq_f32 v236, v232
  v_rcp_f32 v240, v232
  v_mul_f32 v236, 0xc0135761, v236
  v_mfma_f32_32x32x16_bf16 v[96:111], a[108:111], v[140:143], v[96:111]
  buffer_load_dwordx4 v230, s[44:47], s25 offen offset:2048 lds
  ds_read_b64_tr_b16 a[118:119], v165 offset:5120
  ds_read_b128 v[136:139], v182 offset:4096
  v_mul_f32 v240, 0x3d372713, v240
  v_mul_f32 v240, v240, v236
  s_waitcnt lgkmcnt(11)
  v_rsq_f32 v237, v233
  v_rcp_f32 v241, v233
  v_mul_f32 v237, 0xc0135761, v237
  s_waitcnt lgkmcnt(6)
  v_mfma_f32_32x32x16_bf16 v[112:127], a[0:3], v[144:147], 0
  ds_read_b64_tr_b16 a[120:121], v165 offset:2048
  ds_read_b128 v[140:143], v182 offset:5120
  v_mul_f32 v241, 0x3d372713, v241
  v_mul_f32 v241, v241, v237
  v_rsq_f32 v238, v234
  v_rcp_f32 v242, v234
  v_mul_f32 v238, 0xc0135761, v238
  v_mfma_f32_32x32x16_bf16 v[112:127], a[4:7], v[148:151], v[112:127]
  buffer_load_dwordx4 v231, s[44:47], s25 offen offset:3072 lds
  ds_read_b64_tr_b16 a[122:123], v165 offset:6144
  ds_read_b128 v[144:147], v182 offset:6144
  v_mul_f32 v242, 0x3d372713, v242
  v_mul_f32 v242, v242, v238
  v_rsq_f32 v239, v235
  v_rcp_f32 v243, v235
  v_mul_f32 v239, 0xc0135761, v239
  s_waitcnt lgkmcnt(6)
  v_mfma_f32_32x32x16_bf16 v[112:127], a[8:11], v[128:131], v[112:127]
  ds_read_b64_tr_b16 a[124:125], v165 offset:3072
  ds_read_b128 v[148:151], v182 offset:7168
  v_mul_f32 v243, 0x3d372713, v243
  v_mul_f32 v243, v243, v239
  v_mul_f32 v152, v96, v96
  v_mul_f32 v153, v97, v97
  v_mfma_f32_32x32x16_bf16 v[112:127], a[12:15], v[132:135], v[112:127]
  s_add_u32 m0, s86, 81920
  s_add_u32 s25, s87, 32768
  buffer_load_dwordx4 v1, s[60:63], s25 offen offset:0 sc1 lds
  ds_read_b64_tr_b16 a[126:127], v165 offset:7168
  ds_read_b128 v[128:131], v182 offset:8192
  v_mul_f32 v154, v98, v98
  s_waitcnt lgkmcnt(6)
  v_mfma_f32_32x32x16_bf16 v[112:127], a[16:19], v[136:139], v[112:127]
  ds_read_b128 v[132:135], v182 offset:9216
  v_mul_f32 v155, v99, v99
  v_fma_f32 v152, v152, v240, v236
  v_fma_f32 v153, v153, v240, v236
  v_fma_f32 v154, v154, v240, v236
  v_fma_f32 v155, v155, v240, v236
  v_mfma_f32_32x32x16_bf16 v[112:127], a[20:23], v[140:143], v[112:127]
  buffer_load_dwordx4 v1, s[60:63], s25 offen offset:1024 sc1 lds
  ds_read_b128 v[136:139], v182 offset:10240
  v_mul_f32 v152, v152, v96
  v_mul_f32 v153, v153, v97
  v_mul_f32 v154, v154, v98
  v_mul_f32 v155, v155, v99
  s_waitcnt lgkmcnt(4)
  v_mfma_f32_32x32x16_bf16 v[112:127], a[24:27], v[144:147], v[112:127]
  ds_read_b128 v[140:143], v182 offset:11264
  v_exp_f32 v152, v152
  v_mul_f32 v104, v104, v96
  v_exp_f32 v153, v153
  v_mfma_f32_32x32x16_bf16 v[112:127], a[28:31], v[148:151], v[112:127]
  buffer_load_dwordx4 v1, s[60:63], s25 offen offset:2048 sc1 lds
  ds_read_b128 v[144:147], v182 offset:12288
  v_mul_f32 v105, v105, v97
  v_exp_f32 v154, v154
  v_mul_f32 v106, v106, v98
  s_waitcnt lgkmcnt(3)
  v_mfma_f32_32x32x16_bf16 v[112:127], a[32:35], v[128:131], v[112:127]
  ds_read_b128 v[148:151], v182 offset:13312
  v_exp_f32 v155, v155
  v_mul_f32 v107, v107, v99
  v_fma_f32 v152, v152, v232, v232
  v_mfma_f32_32x32x16_bf16 v[112:127], a[36:39], v[132:135], v[112:127]
  s_waitcnt vmcnt(11)
  s_barrier
  ds_read_b128 v[128:131], v182 offset:14336
  v_rcp_f32 v152, v152
  v_fma_f32 v153, v153, v232, v232
  s_waitcnt lgkmcnt(3)
  v_mfma_f32_32x32x16_bf16 v[112:127], a[40:43], v[136:139], v[112:127]
  s_add_u32 m0, s88, 0
  s_mov_b32 s25, 689920
  buffer_load_dwordx4 v228, s[44:47], s25 offen offset:0 lds
  ds_read_b64_tr_b16 a[128:129], v165 offset:16384
  ds_read_b128 v[132:135], v182 offset:15360
  v_mfma_f32_32x32x16_bf16 v[112:127], a[44:47], v[140:143], v[112:127]
  buffer_load_dwordx4 v229, s[44:47], s25 offen offset:1024 lds
  ds_read_b64_tr_b16 a[130:131], v165 offset:20480
  ds_read_b128 v[136:139], v182 offset:16384
  v_rcp_f32 v153, v153
  v_fma_f32 v154, v154, v232, v232
  s_waitcnt lgkmcnt(5)
  v_mfma_f32_32x32x16_bf16 v[112:127], a[48:51], v[144:147], v[112:127]
  ds_read_b64_tr_b16 a[132:133], v165 offset:17408
  ds_read_b128 v[140:143], v182 offset:17408
  v_rcp_f32 v154, v154
  v_fma_f32 v155, v155, v232, v232
  v_rcp_f32 v155, v155
  v_mfma_f32_32x32x16_bf16 v[112:127], a[52:55], v[148:151], v[112:127]
  buffer_load_dwordx4 v230, s[44:47], s25 offen offset:2048 lds
  ds_read_b64_tr_b16 a[134:135], v165 offset:21504
  ds_read_b128 v[144:147], v182 offset:18432
  v_mul_f32 v104, v104, v152
  v_mul_f32 v105, v105, v153
  v_mul_f32 v106, v106, v154
  s_waitcnt lgkmcnt(6)
  v_mfma_f32_32x32x16_bf16 v[112:127], a[56:59], v[128:131], v[112:127]
  buffer_load_dwordx4 v231, s[44:47], s25 offen offset:3072 lds
  ds_read_b64_tr_b16 a[136:137], v165 offset:18432
  ds_read_b128 v[148:151], v182 offset:19456
  v_mul_f32 v107, v107, v155
  v_cvt_pk_bf16_f32 v176, v104, v105
  v_cvt_pk_bf16_f32 v177, v106, v107
  v_mfma_f32_32x32x16_bf16 v[112:127], a[60:63], v[132:135], v[112:127]
  ds_read_b64_tr_b16 a[138:139], v165 offset:22528
  ds_read_b128 v[128:131], v182 offset:20480
  v_mul_f32 v156, v100, v100
  v_mul_f32 v157, v101, v101
  v_mul_f32 v158, v102, v102
  v_mul_f32 v159, v103, v103
  s_waitcnt lgkmcnt(6)
  v_mfma_f32_32x32x16_bf16 v[112:127], a[64:67], v[136:139], v[112:127]
  s_add_u32 m0, s86, 49152
  s_add_u32 s25, s87, 86016
  buffer_load_dwordx4 v1, s[60:63], s25 offen offset:0 sc1 lds
  ds_read_b64_tr_b16 a[140:141], v165 offset:19456
  ds_read_b128 v[132:135], v182 offset:21504
  v_fma_f32 v156, v156, v240, v236
  v_mfma_f32_32x32x16_bf16 v[112:127], a[68:71], v[140:143], v[112:127]
  ds_read_b64_tr_b16 a[142:143], v165 offset:23552
  ds_read_b128 v[136:139], v182 offset:22528
  v_fma_f32 v157, v157, v240, v236
  v_fma_f32 v158, v158, v240, v236
  v_fma_f32 v159, v159, v240, v236
  v_mul_f32 v156, v156, v100
  s_waitcnt lgkmcnt(6)
  v_mfma_f32_32x32x16_bf16 v[112:127], a[72:75], v[144:147], v[112:127]
  buffer_load_dwordx4 v1, s[60:63], s25 offen offset:1024 sc1 lds
  ds_read_b128 v[140:143], v182 offset:23552
  v_mul_f32 v157, v157, v101
  v_mul_f32 v158, v158, v102
  v_mul_f32 v159, v159, v103
  v_mfma_f32_32x32x16_bf16 v[112:127], a[76:79], v[148:151], v[112:127]
  buffer_load_dwordx4 v1, s[60:63], s25 offen offset:2048 sc1 lds
  ds_read_b128 v[144:147], v182 offset:24576
  v_exp_f32 v156, v156
  v_mul_f32 v108, v108, v100
  v_exp_f32 v157, v157
  s_waitcnt lgkmcnt(4)
  v_mfma_f32_32x32x16_bf16 v[112:127], a[80:83], v[128:131], v[112:127]
  ds_read_b128 v[148:151], v182 offset:25600
  v_mul_f32 v109, v109, v101
  v_exp_f32 v158, v158
  v_mul_f32 v110, v110, v102
  v_mfma_f32_32x32x16_bf16 v[112:127], a[84:87], v[132:135], v[112:127]
  buffer_load_dwordx4 v1, s[60:63], s25 offen offset:3072 sc1 lds
  ds_read_b128 v[128:131], v182 offset:26624
  v_exp_f32 v159, v159
  v_mul_f32 v111, v111, v103
  v_fma_f32 v156, v156, v232, v232
  s_waitcnt lgkmcnt(3)
  v_mfma_f32_32x32x16_bf16 v[112:127], a[88:91], v[136:139], v[112:127]
  ds_read_b128 v[132:135], v182 offset:27648
  v_rcp_f32 v156, v156
  v_fma_f32 v157, v157, v232, v232
  v_rcp_f32 v157, v157
  v_fma_f32 v158, v158, v232, v232
  v_mfma_f32_32x32x16_bf16 v[112:127], a[92:95], v[140:143], v[112:127]
  s_waitcnt vmcnt(8)
  s_barrier
  ds_read_b128 v[136:139], v183 offset:28672
  v_rcp_f32 v158, v158
  v_fma_f32 v159, v159, v232, v232
  s_waitcnt lgkmcnt(3)
  v_mfma_f32_32x32x16_bf16 v[112:127], a[96:99], v[144:147], v[112:127]
  s_add_u32 m0, s88, 16384
  s_mov_b32 s25, 919296
  buffer_load_dwordx4 v228, s[44:47], s25 offen offset:0 lds
  ds_read_b64_tr_b16 a[144:145], v165 offset:32768
  ds_read_b128 v[140:143], v183 offset:29696
  v_mfma_f32_32x32x16_bf16 v[112:127], a[100:103], v[148:151], v[112:127]
  buffer_load_dwordx4 v229, s[44:47], s25 offen offset:1024 lds
  ds_read_b64_tr_b16 a[146:147], v165 offset:36864
  ds_read_b128 v[144:147], v183 offset:30720
  v_rcp_f32 v159, v159
  v_mul_f32 v108, v108, v156
  v_mul_f32 v109, v109, v157
  s_waitcnt lgkmcnt(5)
  v_mfma_f32_32x32x16_bf16 v[112:127], a[104:107], v[128:131], v[112:127]
  ds_read_b64_tr_b16 a[148:149], v165 offset:33792
  ds_read_b128 v[148:151], v183 offset:31744
  v_mul_f32 v110, v110, v158
  v_mul_f32 v111, v111, v159
  v_cvt_pk_bf16_f32 v178, v108, v109
  v_cvt_pk_bf16_f32 v179, v110, v111
  v_mfma_f32_32x32x16_bf16 v[112:127], a[108:111], v[132:135], v[112:127]
  s_add_u32 s26, s89, 0xb0000
  buffer_store_dwordx4 v[176:179], v1, s[60:63], s26 offen sc1
  ds_read_b64_tr_b16 a[150:151], v165 offset:37888
  ds_read_b128 v[128:131], v183 offset:32768
  s_waitcnt lgkmcnt(6)
  v_mfma_f32_32x32x16_bf16 v[96:111], a[0:3], v[136:139], 0
  buffer_load_dwordx4 v230, s[44:47], s25 offen offset:2048 lds
  ds_read_b64_tr_b16 a[152:153], v165 offset:34816
  ds_read_b128 v[132:135], v183 offset:33792
  v_mfma_f32_32x32x16_bf16 v[96:111], a[4:7], v[140:143], v[96:111]
  ds_read_b64_tr_b16 a[154:155], v165 offset:38912
  ds_read_b128 v[136:139], v183 offset:34816
  s_waitcnt lgkmcnt(6)
  v_mfma_f32_32x32x16_bf16 v[96:111], a[8:11], v[144:147], v[96:111]
  buffer_load_dwordx4 v231, s[44:47], s25 offen offset:3072 lds
  ds_read_b64_tr_b16 a[156:157], v165 offset:35840
  ds_read_b128 v[140:143], v183 offset:35840
  v_mul_f32 v152, v112, v112
  v_mul_f32 v153, v113, v113
  v_mul_f32 v154, v114, v114
  v_mfma_f32_32x32x16_bf16 v[96:111], a[12:15], v[148:151], v[96:111]
  s_add_u32 m0, s86, 53248
  s_add_u32 s25, s87, 90112
  buffer_load_dwordx4 v1, s[60:63], s25 offen offset:0 sc1 lds
  ds_read_b64_tr_b16 a[158:159], v165 offset:39936
  ds_read_b128 v[144:147], v183 offset:36864
  s_waitcnt lgkmcnt(6)
  v_mfma_f32_32x32x16_bf16 v[96:111], a[16:19], v[128:131], v[96:111]
  ds_read_b128 v[148:151], v183 offset:37888
  v_mul_f32 v155, v115, v115
  v_fma_f32 v152, v152, v242, v238
  v_fma_f32 v153, v153, v242, v238
  v_fma_f32 v154, v154, v242, v238
  v_fma_f32 v155, v155, v242, v238
  v_mul_f32 v152, v152, v112
  v_mfma_f32_32x32x16_bf16 v[96:111], a[20:23], v[132:135], v[96:111]
  buffer_load_dwordx4 v1, s[60:63], s25 offen offset:1024 sc1 lds
  ds_read_b128 v[128:131], v183 offset:38912
  v_mul_f32 v153, v153, v113
  v_mul_f32 v154, v154, v114
  v_mul_f32 v155, v155, v115
  s_waitcnt lgkmcnt(4)
  v_mfma_f32_32x32x16_bf16 v[96:111], a[24:27], v[136:139], v[96:111]
  ds_read_b128 v[132:135], v183 offset:39936
  v_exp_f32 v152, v152
  v_mul_f32 v120, v120, v112
  v_exp_f32 v153, v153
  v_mfma_f32_32x32x16_bf16 v[96:111], a[28:31], v[140:143], v[96:111]
  buffer_load_dwordx4 v1, s[60:63], s25 offen offset:2048 sc1 lds
  ds_read_b128 v[136:139], v183 offset:40960
  v_mul_f32 v121, v121, v113
  v_exp_f32 v154, v154
  s_waitcnt lgkmcnt(3)
  v_mfma_f32_32x32x16_bf16 v[96:111], a[32:35], v[144:147], v[96:111]
  ds_read_b128 v[140:143], v183 offset:41984
  v_mul_f32 v122, v122, v114
  v_exp_f32 v155, v155
  v_mul_f32 v123, v123, v115
  v_fma_f32 v152, v152, v234, v234
  v_mfma_f32_32x32x16_bf16 v[96:111], a[36:39], v[148:151], v[96:111]
  s_waitcnt vmcnt(12)
  s_barrier
  ds_read_b128 v[144:147], v183 offset:43008
  v_rcp_f32 v152, v152
  v_fma_f32 v153, v153, v234, v234
  s_waitcnt lgkmcnt(3)
  v_mfma_f32_32x32x16_bf16 v[96:111], a[40:43], v[128:131], v[96:111]
  s_add_u32 m0, s88, 32768
  s_mov_b32 s25, 1148672
  buffer_load_dwordx4 v228, s[44:47], s25 offen offset:0 lds
  ds_read_b64_tr_b16 a[160:161], v165 offset:0
  ds_read_b128 v[148:151], v183 offset:44032
  v_mfma_f32_32x32x16_bf16 v[96:111], a[44:47], v[132:135], v[96:111]
  ds_read_b64_tr_b16 a[162:163], v165 offset:4096
  ds_read_b128 v[128:131], v183 offset:45056
  v_rcp_f32 v153, v153
  v_fma_f32 v154, v154, v234, v234
  s_waitcnt lgkmcnt(5)
  v_mfma_f32_32x32x16_bf16 v[96:111], a[48:51], v[136:139], v[96:111]
  buffer_load_dwordx4 v229, s[44:47], s25 offen offset:1024 lds
  ds_read_b64_tr_b16 a[164:165], v165 offset:1024
  ds_read_b128 v[132:135], v183 offset:46080
  v_rcp_f32 v154, v154
  v_fma_f32 v155, v155, v234, v234
  v_rcp_f32 v155, v155
  v_mfma_f32_32x32x16_bf16 v[96:111], a[52:55], v[140:143], v[96:111]
  ds_read_b64_tr_b16 a[166:167], v165 offset:5120
  ds_read_b128 v[136:139], v183 offset:47104
  v_mul_f32 v120, v120, v152
  v_mul_f32 v121, v121, v153
  v_mul_f32 v122, v122, v154
  s_waitcnt lgkmcnt(6)
  v_mfma_f32_32x32x16_bf16 v[96:111], a[56:59], v[144:147], v[96:111]
  buffer_load_dwordx4 v230, s[44:47], s25 offen offset:2048 lds
  ds_read_b64_tr_b16 a[168:169], v165 offset:2048
  ds_read_b128 v[140:143], v183 offset:48128
  v_mul_f32 v123, v123, v155
  v_cvt_pk_bf16_f32 v176, v120, v121
  v_cvt_pk_bf16_f32 v177, v122, v123
  v_mfma_f32_32x32x16_bf16 v[96:111], a[60:63], v[148:151], v[96:111]
  ds_read_b64_tr_b16 a[170:171], v165 offset:6144
  ds_read_b128 v[144:147], v183 offset:49152
  v_mul_f32 v156, v116, v116
  v_mul_f32 v157, v117, v117
  v_mul_f32 v158, v118, v118
  s_waitcnt lgkmcnt(6)
  v_mfma_f32_32x32x16_bf16 v[96:111], a[64:67], v[128:131], v[96:111]
  buffer_load_dwordx4 v231, s[44:47], s25 offen offset:3072 lds
  ds_read_b64_tr_b16 a[172:173], v165 offset:3072
  ds_read_b128 v[148:151], v183 offset:50176
  v_mul_f32 v159, v119, v119
  v_fma_f32 v156, v156, v242, v238
  v_fma_f32 v157, v157, v242, v238
  v_fma_f32 v158, v158, v242, v238
  v_mfma_f32_32x32x16_bf16 v[96:111], a[68:71], v[132:135], v[96:111]
  ds_read_b64_tr_b16 a[174:175], v165 offset:7168
  ds_read_b128 v[128:131], v183 offset:51200
  v_fma_f32 v159, v159, v242, v238
  v_mul_f32 v156, v156, v116
  v_mul_f32 v157, v157, v117
  s_waitcnt lgkmcnt(6)
  v_mfma_f32_32x32x16_bf16 v[96:111], a[72:75], v[136:139], v[96:111]
  ds_read_b128 v[132:135], v183 offset:52224
  v_mul_f32 v158, v158, v118
  v_mul_f32 v159, v159, v119
  v_exp_f32 v156, v156
  v_mul_f32 v124, v124, v116
  v_mfma_f32_32x32x16_bf16 v[96:111], a[76:79], v[140:143], v[96:111]
  s_waitcnt vmcnt(9)
  buffer_store_byte v5, v4, s[60:63], s90 offen offset:2048
  ds_read_b128 v[136:139], v183 offset:53248
  v_exp_f32 v157, v157
  s_waitcnt lgkmcnt(4)
  v_mfma_f32_32x32x16_bf16 v[96:111], a[80:83], v[144:147], v[96:111]
  ds_read_b128 v[140:143], v183 offset:54272
  v_mul_f32 v125, v125, v117
  v_exp_f32 v158, v158
  v_mul_f32 v126, v126, v118
  v_exp_f32 v159, v159
  v_mfma_f32_32x32x16_bf16 v[96:111], a[84:87], v[148:151], v[96:111]
  ds_read_b128 v[144:147], v183 offset:55296
  v_mul_f32 v127, v127, v119
  v_fma_f32 v156, v156, v234, v234
  v_rcp_f32 v156, v156
  s_waitcnt lgkmcnt(3)
  v_mfma_f32_32x32x16_bf16 v[96:111], a[88:91], v[128:131], v[96:111]
  ds_read_b128 v[148:151], v183 offset:56320
  v_fma_f32 v157, v157, v234, v234
  v_rcp_f32 v157, v157
  v_fma_f32 v158, v158, v234, v234
  v_mfma_f32_32x32x16_bf16 v[96:111], a[92:95], v[132:135], v[96:111]
  s_waitcnt vmcnt(5)
  s_barrier
  ds_read_b128 v[128:131], v183 offset:0
  v_rcp_f32 v158, v158
  v_fma_f32 v159, v159, v234, v234
  s_waitcnt lgkmcnt(3)
  v_mfma_f32_32x32x16_bf16 v[96:111], a[96:99], v[136:139], v[96:111]
  s_add_u32 m0, s88, 0
  s_mov_b32 s25, 1378048
  buffer_load_dwordx4 v228, s[44:47], s25 offen offset:0 lds
  ds_read_b64_tr_b16 a[176:177], v165 offset:16384
  ds_read_b128 v[132:135], v183 offset:1024
  v_rcp_f32 v159, v159
  v_mfma_f32_32x32x16_bf16 v[96:111], a[100:103], v[140:143], v[96:111]
  ds_read_b64_tr_b16 a[178:179], v165 offset:20480
  ds_read_b128 v[136:139], v183 offset:2048
  v_mul_f32 v124, v124, v156
  v_mul_f32 v125, v125, v157
  v_mul_f32 v126, v126, v158
  s_waitcnt lgkmcnt(5)
  v_mfma_f32_32x32x16_bf16 v[96:111], a[104:107], v[144:147], v[96:111]
  buffer_load_dwordx4 v229, s[44:47], s25 offen offset:1024 lds
  ds_read_b64_tr_b16 a[180:181], v165 offset:17408
  ds_read_b128 v[140:143], v183 offset:3072
  v_mul_f32 v127, v127, v159
  v_cvt_pk_bf16_f32 v178, v124, v125
  v_cvt_pk_bf16_f32 v179, v126, v127
  v_mfma_f32_32x32x16_bf16 v[96:111], a[108:111], v[148:151], v[96:111]
  s_add_u32 s26, s89, 0xe8000
  buffer_store_dwordx4 v[176:179], v1, s[60:63], s26 offen sc1
  ds_read_b64_tr_b16 a[182:183], v165 offset:21504
  ds_read_b128 v[144:147], v183 offset:4096
  s_waitcnt lgkmcnt(6)
  v_mfma_f32_32x32x16_bf16 v[112:127], a[0:3], v[128:131], 0
  ds_read_b64_tr_b16 a[184:185], v165 offset:18432
  ds_read_b128 v[148:151], v183 offset:5120
  v_mfma_f32_32x32x16_bf16 v[112:127], a[4:7], v[132:135], v[112:127]
  buffer_load_dwordx4 v230, s[44:47], s25 offen offset:2048 lds
  ds_read_b64_tr_b16 a[186:187], v165 offset:22528
  ds_read_b128 v[128:131], v183 offset:6144
  s_waitcnt lgkmcnt(6)
  v_mfma_f32_32x32x16_bf16 v[112:127], a[8:11], v[136:139], v[112:127]
  ds_read_b64_tr_b16 a[188:189], v165 offset:19456
  ds_read_b128 v[132:135], v183 offset:7168
  v_mul_f32 v152, v96, v96
  v_mul_f32 v153, v97, v97
  v_mul_f32 v154, v98, v98
  v_mul_f32 v155, v99, v99
  v_mfma_f32_32x32x16_bf16 v[112:127], a[12:15], v[140:143], v[112:127]
  buffer_load_dwordx4 v231, s[44:47], s25 offen offset:3072 lds
  ds_read_b64_tr_b16 a[190:191], v165 offset:23552
  ds_read_b128 v[136:139], v183 offset:8192
  v_fma_f32 v152, v152, v241, v237
  v_fma_f32 v153, v153, v241, v237
  s_waitcnt lgkmcnt(6)
  v_mfma_f32_32x32x16_bf16 v[112:127], a[16:19], v[144:147], v[112:127]
  ds_read_b128 v[140:143], v183 offset:9216
  v_fma_f32 v154, v154, v241, v237
  v_fma_f32 v155, v155, v241, v237
  v_mul_f32 v152, v152, v96
  v_mul_f32 v153, v153, v97
  v_mul_f32 v154, v154, v98
  v_mfma_f32_32x32x16_bf16 v[112:127], a[20:23], v[148:151], v[112:127]
  ds_read_b128 v[144:147], v183 offset:10240
  v_mul_f32 v155, v155, v99
  v_exp_f32 v152, v152
  v_mul_f32 v104, v104, v96
  s_waitcnt lgkmcnt(4)
  v_mfma_f32_32x32x16_bf16 v[112:127], a[24:27], v[128:131], v[112:127]
  ds_read_b128 v[148:151], v183 offset:11264
  v_exp_f32 v153, v153
  v_mul_f32 v105, v105, v97
  v_exp_f32 v154, v154
  v_mfma_f32_32x32x16_bf16 v[112:127], a[28:31], v[132:135], v[112:127]
  ds_read_b128 v[128:131], v183 offset:12288
  v_mul_f32 v106, v106, v98
  v_exp_f32 v155, v155
  v_mul_f32 v107, v107, v99
  s_waitcnt lgkmcnt(3)
  v_mfma_f32_32x32x16_bf16 v[112:127], a[32:35], v[136:139], v[112:127]
  ds_read_b128 v[132:135], v183 offset:13312
  v_fma_f32 v152, v152, v233, v233
  v_rcp_f32 v152, v152
  v_fma_f32 v153, v153, v233, v233
  v_mfma_f32_32x32x16_bf16 v[112:127], a[36:39], v[140:143], v[112:127]
  s_waitcnt vmcnt(6)
  s_barrier
  ds_read_b128 v[136:139], v183 offset:14336
  v_rcp_f32 v153, v153
  v_fma_f32 v154, v154, v233, v233
  s_waitcnt lgkmcnt(3)
  v_mfma_f32_32x32x16_bf16 v[112:127], a[40:43], v[144:147], v[112:127]
  s_add_u32 m0, s88, 16384
  s_add_u32 s25, s64, 0
  buffer_load_dwordx4 v224, s[48:51], s25 offen offset:0 lds
  ds_read_b64_tr_b16 a[192:193], v165 offset:32768
  ds_read_b128 v[140:143], v183 offset:15360
  v_mfma_f32_32x32x16_bf16 v[112:127], a[44:47], v[148:151], v[112:127]
  ds_read_b64_tr_b16 a[194:195], v165 offset:36864
  ds_read_b128 v[144:147], v183 offset:16384
  v_rcp_f32 v154, v154
  v_fma_f32 v155, v155, v233, v233
  s_waitcnt lgkmcnt(5)
  v_mfma_f32_32x32x16_bf16 v[112:127], a[48:51], v[128:131], v[112:127]
  buffer_load_dwordx4 v225, s[48:51], s25 offen offset:1024 lds
  ds_read_b64_tr_b16 a[196:197], v165 offset:33792
  ds_read_b128 v[148:151], v183 offset:17408
  v_rcp_f32 v155, v155
  v_mul_f32 v104, v104, v152
  v_mul_f32 v105, v105, v153
  v_mul_f32 v106, v106, v154
  v_mfma_f32_32x32x16_bf16 v[112:127], a[52:55], v[132:135], v[112:127]
  ds_read_b64_tr_b16 a[198:199], v165 offset:37888
  ds_read_b128 v[128:131], v183 offset:18432
  v_mul_f32 v107, v107, v155
  v_cvt_pk_bf16_f32 v176, v104, v105
  v_cvt_pk_bf16_f32 v177, v106, v107
  s_waitcnt lgkmcnt(6)
  v_mfma_f32_32x32x16_bf16 v[112:127], a[56:59], v[136:139], v[112:127]
  buffer_load_dwordx4 v226, s[48:51], s25 offen offset:2048 lds
  ds_read_b64_tr_b16 a[200:201], v165 offset:34816
  ds_read_b128 v[132:135], v183 offset:19456
  v_mul_f32 v156, v100, v100
  v_mul_f32 v157, v101, v101
  v_mul_f32 v158, v102, v102
  v_mfma_f32_32x32x16_bf16 v[112:127], a[60:63], v[140:143], v[112:127]
  ds_read_b64_tr_b16 a[202:203], v165 offset:38912
  ds_read_b128 v[136:139], v183 offset:20480
  v_mul_f32 v159, v103, v103
  v_fma_f32 v156, v156, v241, v237
  v_fma_f32 v157, v157, v241, v237
  s_waitcnt lgkmcnt(6)
  v_mfma_f32_32x32x16_bf16 v[112:127], a[64:67], v[144:147], v[112:127]
  buffer_load_dwordx4 v227, s[48:51], s25 offen offset:3072 lds
  ds_read_b64_tr_b16 a[204:205], v165 offset:35840
  ds_read_b128 v[140:143], v183 offset:21504
L_hop_w1_to0:
  s_cbranch_execz L_hop_w1
  v_fma_f32 v158, v158, v241, v237
  v_fma_f32 v159, v159, v241, v237
  v_mul_f32 v156, v156, v100
  v_mfma_f32_32x32x16_bf16 v[112:127], a[68:71], v[148:151], v[112:127]
  ds_read_b64_tr_b16 a[206:207], v165 offset:39936
  ds_read_b128 v[144:147], v183 offset:22528
  v_mul_f32 v157, v157, v101
  v_mul_f32 v158, v158, v102
  v_mul_f32 v159, v159, v103
  s_waitcnt lgkmcnt(6)
  v_mfma_f32_32x32x16_bf16 v[112:127], a[72:75], v[128:131], v[112:127]
  ds_read_b128 v[148:151], v183 offset:23552
  v_exp_f32 v156, v156
  v_mul_f32 v108, v108, v100
  v_exp_f32 v157, v157
  v_mfma_f32_32x32x16_bf16 v[112:127], a[76:79], v[132:135], v[112:127]
  s_waitcnt vmcnt(6)
  buffer_store_byte v5, v4, s[60:63], s90 offen offset:2304
  ds_read_b128 v[128:131], v183 offset:24576
  v_mul_f32 v109, v109, v101
  s_waitcnt lgkmcnt(4)
  v_mfma_f32_32x32x16_bf16 v[112:127], a[80:83], v[136:139], v[112:127]
  ds_read_b128 v[132:135], v183 offset:25600
  v_exp_f32 v158, v158
  v_mul_f32 v110, v110, v102
  v_exp_f32 v159, v159
  v_mul_f32 v111, v111, v103
  v_mfma_f32_32x32x16_bf16 v[112:127], a[84:87], v[140:143], v[112:127]
  ds_read_b128 v[136:139], v183 offset:26624
  v_fma_f32 v156, v156, v233, v233
  v_rcp_f32 v156, v156
  v_fma_f32 v157, v157, v233, v233
  s_waitcnt lgkmcnt(3)
  v_mfma_f32_32x32x16_bf16 v[112:127], a[88:91], v[144:147], v[112:127]
  ds_read_b128 v[140:143], v183 offset:27648
  v_rcp_f32 v157, v157
  v_fma_f32 v158, v158, v233, v233
  v_rcp_f32 v158, v158
  v_mfma_f32_32x32x16_bf16 v[112:127], a[92:95], v[148:151], v[112:127]
  s_waitcnt vmcnt(5)
  s_barrier
  ds_read_b128 v[144:147], v182 offset:28672
  v_fma_f32 v159, v159, v233, v233
  s_waitcnt lgkmcnt(3)
  v_mfma_f32_32x32x16_bf16 v[112:127], a[96:99], v[128:131], v[112:127]
  s_add_u32 m0, s88, 32768
  s_add_u32 s25, s64, 114688
  buffer_load_dwordx4 v224, s[48:51], s25 offen offset:0 lds
  ds_read_b64_tr_b16 a[208:209], v165 offset:0
  ds_read_b128 v[148:151], v182 offset:29696
  v_rcp_f32 v159, v159
  v_mfma_f32_32x32x16_bf16 v[112:127], a[100:103], v[132:135], v[112:127]
  ds_read_b64_tr_b16 a[210:211], v165 offset:4096
  ds_read_b128 v[128:131], v182 offset:30720
  v_mul_f32 v108, v108, v156
  v_mul_f32 v109, v109, v157
  v_mul_f32 v110, v110, v158
  s_waitcnt lgkmcnt(5)
  v_mfma_f32_32x32x16_bf16 v[112:127], a[104:107], v[136:139], v[112:127]
  buffer_load_dwordx4 v225, s[48:51], s25 offen offset:1024 lds
  ds_read_b64_tr_b16 a[212:213], v165 offset:1024
  ds_read_b128 v[132:135], v182 offset:31744
  v_mul_f32 v111, v111, v159
  v_cvt_pk_bf16_f32 v178, v108, v109
  v_cvt_pk_bf16_f32 v179, v110, v111
  v_mfma_f32_32x32x16_bf16 v[112:127], a[108:111], v[140:143], v[112:127]
  s_add_u32 s26, s89, 0xcc000
  buffer_store_dwordx4 v[176:179], v1, s[60:63], s26 offen sc1
  ds_read_b64_tr_b16 a[214:215], v165 offset:5120
  ds_read_b128 v[136:139], v182 offset:32768
  s_waitcnt lgkmcnt(6)
  v_mfma_f32_32x32x16_bf16 v[96:111], a[112:115], v[144:147], 0
  buffer_load_dwordx4 v226, s[48:51], s25 offen offset:2048 lds
  ds_read_b64_tr_b16 a[216:217], v165 offset:2048
  ds_read_b128 v[140:143], v182 offset:33792
  v_mfma_f32_32x32x16_bf16 v[96:111], a[116:119], v[148:151], v[96:111]
  ds_read_b64_tr_b16 a[218:219], v165 offset:6144
  ds_read_b128 v[144:147], v182 offset:34816
  s_waitcnt lgkmcnt(6)
  v_mfma_f32_32x32x16_bf16 v[96:111], a[120:123], v[128:131], v[96:111]
  buffer_load_dwordx4 v227, s[48:51], s25 offen offset:3072 lds
  ds_read_b64_tr_b16 a[220:221], v165 offset:3072
  s_waitcnt vmcnt(9)
  ds_read_b64_tr_b16 v[16:17], v184 offset:16384
  ds_read_b64_tr_b16 v[20:21], v185 offset:16384
  ds_read_b128 v[148:151], v182 offset:35840
  v_mul_f32 v152, v112, v112
  v_mfma_f32_32x32x16_bf16 v[96:111], a[124:127], v[132:135], v[96:111]
  ds_read_b64_tr_b16 a[222:223], v165 offset:7168
  ds_read_b128 v[128:131], v182 offset:36864
  v_mul_f32 v153, v113, v113
  v_mul_f32 v154, v114, v114
  v_mul_f32 v155, v115, v115
  v_fma_f32 v152, v152, v243, v239
  s_waitcnt lgkmcnt(8)
  v_mfma_f32_32x32x16_bf16 v[96:111], a[128:131], v[136:139], v[96:111]
  s_waitcnt vmcnt(8)
  ds_read_b64_tr_b16 v[18:19], v184 offset:17408
  ds_read_b64_tr_b16 v[22:23], v185 offset:17408
  ds_read_b128 v[132:135], v182 offset:37888
  v_fma_f32 v153, v153, v243, v239
  v_fma_f32 v154, v154, v243, v239
  v_fma_f32 v155, v155, v243, v239
  v_mfma_f32_32x32x16_bf16 v[96:111], a[132:135], v[140:143], v[96:111]
  ds_read_b128 v[136:139], v182 offset:38912
  v_mul_f32 v152, v152, v112
  v_mul_f32 v153, v153, v113
  v_mul_f32 v154, v154, v114
  v_mul_f32 v155, v155, v115
  s_waitcnt lgkmcnt(6)
  v_mfma_f32_32x32x16_bf16 v[96:111], a[136:139], v[144:147], v[96:111]
  s_waitcnt vmcnt(7)
  ds_read_b64_tr_b16 v[24:25], v184 offset:18432
  ds_read_b64_tr_b16 v[28:29], v185 offset:18432
  ds_read_b128 v[140:143], v182 offset:39936
  v_exp_f32 v152, v152
  v_mul_f32 v120, v120, v112
  v_mfma_f32_32x32x16_bf16 v[96:111], a[140:143], v[148:151], v[96:111]
  ds_read_b128 v[144:147], v182 offset:40960
  v_exp_f32 v153, v153
  v_mul_f32 v121, v121, v113
  v_exp_f32 v154, v154
  s_waitcnt lgkmcnt(5)
  v_mfma_f32_32x32x16_bf16 v[96:111], a[144:147], v[128:131], v[96:111]
  s_waitcnt vmcnt(6)
  ds_read_b64_tr_b16 v[26:27], v184 offset:19456
  ds_read_b64_tr_b16 v[30:31], v185 offset:19456
  ds_read_b128 v[148:151], v182 offset:41984
  v_mul_f32 v122, v122, v114
  v_exp_f32 v155, v155
  v_mfma_f32_32x32x16_bf16 v[96:111], a[148:151], v[132:135], v[96:111]
  s_barrier
  ds_read_b128 v[128:131], v182 offset:43008
  v_mul_f32 v123, v123, v115
  v_fma_f32 v152, v152, v235, v235
  s_waitcnt lgkmcnt(5)
  v_mfma_f32_32x32x16_bf16 v[96:111], a[152:155], v[136:139], v[96:111]
  s_add_u32 m0, s88, 0
  s_add_u32 s25, s64, 229376
  buffer_load_dwordx4 v224, s[48:51], s25 offen offset:0 lds
  ds_read_b128 v[132:135], v182 offset:44032
  v_rcp_f32 v152, v152
  v_fma_f32 v153, v153, v235, v235
  v_mfma_f32_32x32x16_bf16 v[96:111], a[156:159], v[140:143], v[96:111]
  ds_read_b128 v[136:139], v182 offset:45056
  v_rcp_f32 v153, v153
  v_fma_f32 v154, v154, v235, v235
  v_rcp_f32 v154, v154
  s_waitcnt lgkmcnt(3)
  v_mfma_f32_32x32x16_bf16 v[96:111], a[160:163], v[144:147], v[96:111]
  buffer_load_dwordx4 v225, s[48:51], s25 offen offset:1024 lds
  ds_read_b128 v[140:143], v182 offset:46080
  v_fma_f32 v155, v155, v235, v235
  v_rcp_f32 v155, v155
  v_mul_f32 v120, v120, v152
  v_mul_f32 v121, v121, v153
  v_mfma_f32_32x32x16_bf16 v[96:111], a[164:167], v[148:151], v[96:111]
  ds_read_b128 v[144:147], v182 offset:47104
  v_mul_f32 v122, v122, v154
  v_mul_f32 v123, v123, v155
  v_cvt_pk_bf16_f32 v176, v120, v121
  v_cvt_pk_bf16_f32 v177, v122, v123
  v_mul_f32 v156, v116, v116
  s_waitcnt lgkmcnt(3)
  v_mfma_f32_32x32x16_bf16 v[96:111], a[168:171], v[128:131], v[96:111]
  buffer_load_dwordx4 v226, s[48:51], s25 offen offset:2048 lds
  ds_read_b128 v[148:151], v182 offset:48128
  v_mul_f32 v157, v117, v117
  v_mul_f32 v158, v118, v118
  v_mul_f32 v159, v119, v119
  v_fma_f32 v156, v156, v243, v239
  v_fma_f32 v157, v157, v243, v239
  v_mfma_f32_32x32x16_bf16 v[96:111], a[172:175], v[132:135], v[96:111]
  ds_read_b128 v[128:131], v182 offset:49152
  v_fma_f32 v158, v158, v243, v239
  v_fma_f32 v159, v159, v243, v239
  v_mul_f32 v156, v156, v116
  v_mul_f32 v157, v157, v117
  v_mul_f32 v158, v158, v118
  s_waitcnt lgkmcnt(3)
  v_mfma_f32_32x32x16_bf16 v[96:111], a[176:179], v[136:139], v[96:111]
  buffer_load_dwordx4 v227, s[48:51], s25 offen offset:3072 lds
  s_waitcnt vmcnt(8)
  ds_read_b64_tr_b16 v[32:33], v184 offset:32768
  ds_read_b64_tr_b16 v[36:37], v185 offset:32768
  ds_read_b128 v[132:135], v182 offset:50176
  v_mul_f32 v159, v159, v119
  v_mfma_f32_32x32x16_bf16 v[96:111], a[180:183], v[140:143], v[96:111]
  ds_read_b128 v[136:139], v182 offset:51200
  v_exp_f32 v156, v156
  v_mul_f32 v124, v124, v116
  v_exp_f32 v157, v157
  v_mul_f32 v125, v125, v117
  s_waitcnt lgkmcnt(5)
  v_mfma_f32_32x32x16_bf16 v[96:111], a[184:187], v[144:147], v[96:111]
  s_add_u32 m0, s88, 16384
  s_add_u32 s25, s64, 344064
  buffer_load_dwordx4 v224, s[48:51], s25 offen offset:0 lds
  s_waitcnt vmcnt(8)
  ds_read_b64_tr_b16 v[34:35], v184 offset:33792
  ds_read_b64_tr_b16 v[38:39], v185 offset:33792
  ds_read_b128 v[140:143], v182 offset:52224
  v_mfma_f32_32x32x16_bf16 v[96:111], a[188:191], v[148:151], v[96:111]
  s_waitcnt vmcnt(7)
  buffer_store_byte v5, v4, s[60:63], s90 offen offset:2176
  ds_read_b128 v[144:147], v182 offset:53248
  v_exp_f32 v158, v158
  s_waitcnt lgkmcnt(5)
  v_mfma_f32_32x32x16_bf16 v[96:111], a[192:195], v[128:131], v[96:111]
  buffer_load_dwordx4 v225, s[48:51], s25 offen offset:1024 lds
  s_waitcnt vmcnt(8)
  ds_read_b64_tr_b16 v[40:41], v184 offset:34816
  ds_read_b64_tr_b16 v[44:45], v185 offset:34816
  ds_read_b128 v[148:151], v182 offset:54272
  v_mul_f32 v126, v126, v118
  v_mfma_f32_32x32x16_bf16 v[96:111], a[196:199], v[132:135], v[96:111]
  ds_read_b128 v[128:131], v182 offset:55296
  v_exp_f32 v159, v159
  v_mul_f32 v127, v127, v119
  v_fma_f32 v156, v156, v235, v235
  s_waitcnt lgkmcnt(5)
  v_mfma_f32_32x32x16_bf16 v[96:111], a[200:203], v[136:139], v[96:111]
  buffer_load_dwordx4 v226, s[48:51], s25 offen offset:2048 lds
  s_waitcnt vmcnt(8)
  ds_read_b64_tr_b16 v[42:43], v184 offset:35840
  ds_read_b64_tr_b16 v[46:47], v185 offset:35840
  ds_read_b128 v[132:135], v182 offset:56320
  v_rcp_f32 v156, v156
  v_mfma_f32_32x32x16_bf16 v[96:111], a[204:207], v[140:143], v[96:111]
  ds_read_b128 v[136:139], v182 offset:0
  v_fma_f32 v157, v157, v235, v235
  v_rcp_f32 v157, v157
  v_fma_f32 v158, v158, v235, v235
  s_waitcnt lgkmcnt(5)
  v_mfma_f32_32x32x16_bf16 v[96:111], a[208:211], v[144:147], v[96:111]
  buffer_load_dwordx4 v227, s[48:51], s25 offen offset:3072 lds
  ds_read_b128 v[140:143], v182 offset:1024
  v_rcp_f32 v158, v158
  v_fma_f32 v159, v159, v235, v235
  v_rcp_f32 v159, v159
  v_mfma_f32_32x32x16_bf16 v[96:111], a[212:215], v[148:151], v[96:111]
  ds_read_b128 v[144:147], v182 offset:2048
  v_mul_f32 v124, v124, v156
  v_mul_f32 v125, v125, v157
  v_mul_f32 v126, v126, v158
  v_mul_f32 v127, v127, v159
  v_cvt_pk_bf16_f32 v178, v124, v125
  s_waitcnt lgkmcnt(3)
  v_mfma_f32_32x32x16_bf16 v[96:111], a[216:219], v[128:131], v[96:111]
  s_add_u32 m0, s88, 32768
  s_add_u32 s25, s64, 458752
  buffer_load_dwordx4 v224, s[48:51], s25 offen offset:0 lds
  ds_read_b128 v[148:151], v182 offset:3072
  v_cvt_pk_bf16_f32 v179, v126, v127
  v_mfma_f32_32x32x16_bf16 v[96:111], a[220:223], v[132:135], v[96:111]
  s_add_u32 s26, s89, 0x104000
  buffer_store_dwordx4 v[176:179], v1, s[60:63], s26 offen sc1
  ds_read_b128 v[128:131], v182 offset:4096
  s_waitcnt lgkmcnt(3)
  v_mfma_f32_32x32x16_bf16 v[112:127], a[112:115], v[136:139], 0
  buffer_load_dwordx4 v225, s[48:51], s25 offen offset:1024 lds
  ds_read_b128 v[132:135], v182 offset:5120
  v_mfma_f32_32x32x16_bf16 v[112:127], a[116:119], v[140:143], v[112:127]
  s_waitcnt vmcnt(11)
  ds_read_b64_tr_b16 v[48:49], v184 offset:0
  ds_read_b64_tr_b16 v[52:53], v185 offset:0
  ds_read_b128 v[136:139], v182 offset:6144
  s_waitcnt lgkmcnt(5)
  v_mfma_f32_32x32x16_bf16 v[112:127], a[120:123], v[144:147], v[112:127]
  buffer_load_dwordx4 v226, s[48:51], s25 offen offset:2048 lds
  ds_read_b128 v[140:143], v182 offset:7168
  v_mul_f32 v152, v96, v96
  v_mul_f32 v153, v97, v97
  v_mul_f32 v154, v98, v98
  v_mul_f32 v155, v99, v99
  v_fma_f32 v152, v152, v240, v236
  v_mfma_f32_32x32x16_bf16 v[112:127], a[124:127], v[148:151], v[112:127]
  s_waitcnt vmcnt(11)
  ds_read_b64_tr_b16 v[50:51], v184 offset:1024
  ds_read_b64_tr_b16 v[54:55], v185 offset:1024
  ds_read_b128 v[144:147], v182 offset:8192
  v_fma_f32 v153, v153, v240, v236
  v_fma_f32 v154, v154, v240, v236
  s_waitcnt lgkmcnt(7)
  v_mfma_f32_32x32x16_bf16 v[112:127], a[128:131], v[128:131], v[112:127]
  buffer_load_dwordx4 v227, s[48:51], s25 offen offset:3072 lds
  ds_read_b128 v[148:151], v182 offset:9216
  v_fma_f32 v155, v155, v240, v236
  v_mul_f32 v152, v152, v96
  v_mul_f32 v153, v153, v97
  v_mul_f32 v154, v154, v98
  v_mul_f32 v155, v155, v99
  v_mfma_f32_32x32x16_bf16 v[112:127], a[132:135], v[132:135], v[112:127]
  s_waitcnt vmcnt(11)
  ds_read_b64_tr_b16 v[56:57], v184 offset:2048
  ds_read_b64_tr_b16 v[60:61], v185 offset:2048
  ds_read_b128 v[128:131], v182 offset:10240
  v_exp_f32 v152, v152
  v_mul_f32 v104, v104, v96
  s_waitcnt lgkmcnt(7)
  v_mfma_f32_32x32x16_bf16 v[112:127], a[136:139], v[136:139], v[112:127]
  s_add_u32 m0, s88, 0
  s_add_u32 s25, s64, 573440
  buffer_load_dwordx4 v224, s[48:51], s25 offen offset:0 lds
  ds_read_b128 v[132:135], v182 offset:11264
  v_exp_f32 v153, v153
  v_mfma_f32_32x32x16_bf16 v[112:127], a[140:143], v[140:143], v[112:127]
  s_waitcnt vmcnt(11)
  ds_read_b64_tr_b16 v[58:59], v184 offset:3072
  ds_read_b64_tr_b16 v[62:63], v185 offset:3072
  ds_read_b128 v[136:139], v182 offset:12288
  v_mul_f32 v105, v105, v97
  v_exp_f32 v154, v154
  s_waitcnt lgkmcnt(7)
  v_mfma_f32_32x32x16_bf16 v[112:127], a[144:147], v[144:147], v[112:127]
  buffer_load_dwordx4 v225, s[48:51], s25 offen offset:1024 lds
  ds_read_b128 v[140:143], v182 offset:13312
  v_mul_f32 v106, v106, v98
  v_exp_f32 v155, v155
  v_mul_f32 v107, v107, v99
  v_fma_f32 v152, v152, v232, v232
  v_mfma_f32_32x32x16_bf16 v[112:127], a[148:151], v[148:151], v[112:127]
  s_waitcnt vmcnt(11)
  ds_read_b64_tr_b16 v[64:65], v184 offset:16384
  ds_read_b64_tr_b16 v[68:69], v185 offset:16384
  ds_read_b128 v[144:147], v182 offset:14336
  v_rcp_f32 v152, v152
  s_waitcnt lgkmcnt(7)
  v_mfma_f32_32x32x16_bf16 v[112:127], a[152:155], v[128:131], v[112:127]
  buffer_load_dwordx4 v226, s[48:51], s25 offen offset:2048 lds
  ds_read_b128 v[148:151], v182 offset:15360
  v_fma_f32 v153, v153, v232, v232
  v_rcp_f32 v153, v153
  v_fma_f32 v154, v154, v232, v232
  v_mfma_f32_32x32x16_bf16 v[112:127], a[156:159], v[132:135], v[112:127]
  s_waitcnt vmcnt(10)
  ds_read_b64_tr_b16 v[66:67], v184 offset:17408
  ds_read_b64_tr_b16 v[70:71], v185 offset:17408
  ds_read_b128 v[128:131], v182 offset:16384
  v_rcp_f32 v154, v154
  v_fma_f32 v155, v155, v232, v232
  s_waitcnt lgkmcnt(7)
  v_mfma_f32_32x32x16_bf16 v[112:127], a[160:163], v[136:139], v[112:127]
  buffer_load_dwordx4 v227, s[48:51], s25 offen offset:3072 lds
  ds_read_b128 v[132:135], v182 offset:17408
  v_rcp_f32 v155, v155
  v_mul_f32 v104, v104, v152
  v_mul_f32 v105, v105, v153
  v_mul_f32 v106, v106, v154
  v_mfma_f32_32x32x16_bf16 v[112:127], a[164:167], v[140:143], v[112:127]
  s_waitcnt vmcnt(10)
  ds_read_b64_tr_b16 v[72:73], v184 offset:18432
  ds_read_b64_tr_b16 v[76:77], v185 offset:18432
  ds_read_b128 v[136:139], v182 offset:18432
  v_mul_f32 v107, v107, v155
  v_cvt_pk_bf16_f32 v176, v104, v105
  v_cvt_pk_bf16_f32 v177, v106, v107
  s_waitcnt lgkmcnt(7)
  v_mfma_f32_32x32x16_bf16 v[112:127], a[168:171], v[144:147], v[112:127]
  s_add_u32 m0, s88, 16384
  s_add_u32 s25, s64, 688128
  buffer_load_dwordx4 v224, s[48:51], s25 offen offset:0 lds
  ds_read_b128 v[140:143], v182 offset:19456
  v_mul_f32 v156, v100, v100
  v_mul_f32 v157, v101, v101
  v_mfma_f32_32x32x16_bf16 v[112:127], a[172:175], v[148:151], v[112:127]
  s_waitcnt vmcnt(10)
  ds_read_b64_tr_b16 v[74:75], v184 offset:19456
  ds_read_b64_tr_b16 v[78:79], v185 offset:19456
  ds_read_b128 v[144:147], v182 offset:20480
  v_mul_f32 v158, v102, v102
  v_mul_f32 v159, v103, v103
  v_fma_f32 v156, v156, v240, v236
  s_waitcnt lgkmcnt(7)
  v_mfma_f32_32x32x16_bf16 v[112:127], a[176:179], v[128:131], v[112:127]
  buffer_load_dwordx4 v225, s[48:51], s25 offen offset:1024 lds
  ds_read_b128 v[148:151], v182 offset:21504
  v_fma_f32 v157, v157, v240, v236
  v_fma_f32 v158, v158, v240, v236
  v_fma_f32 v159, v159, v240, v236
  v_mul_f32 v156, v156, v100
  v_mul_f32 v157, v157, v101
  v_mfma_f32_32x32x16_bf16 v[112:127], a[180:183], v[132:135], v[112:127]
  s_waitcnt vmcnt(10)
  ds_read_b64_tr_b16 v[80:81], v184 offset:32768
  ds_read_b64_tr_b16 v[84:85], v185 offset:32768
  ds_read_b128 v[128:131], v182 offset:22528
  v_mul_f32 v158, v158, v102
  v_mul_f32 v159, v159, v103
  s_waitcnt lgkmcnt(7)
  v_mfma_f32_32x32x16_bf16 v[112:127], a[184:187], v[136:139], v[112:127]
  buffer_load_dwordx4 v226, s[48:51], s25 offen offset:2048 lds
  ds_read_b128 v[132:135], v182 offset:23552
  v_exp_f32 v156, v156
  v_mul_f32 v108, v108, v100
  v_exp_f32 v157, v157
  v_mfma_f32_32x32x16_bf16 v[112:127], a[188:191], v[140:143], v[112:127]
  s_waitcnt vmcnt(10)
  buffer_store_byte v5, v4, s[60:63], s90 offen offset:2432
  s_waitcnt vmcnt(10)
  ds_read_b64_tr_b16 v[82:83], v184 offset:33792
  ds_read_b64_tr_b16 v[86:87], v185 offset:33792
  ds_read_b128 v[136:139], v182 offset:24576
  v_mul_f32 v109, v109, v101
  s_waitcnt lgkmcnt(7)
  v_mfma_f32_32x32x16_bf16 v[112:127], a[192:195], v[144:147], v[112:127]
  buffer_load_dwordx4 v227, s[48:51], s25 offen offset:3072 lds
  ds_read_b128 v[140:143], v182 offset:25600
  v_exp_f32 v158, v158
  v_mul_f32 v110, v110, v102
  v_mfma_f32_32x32x16_bf16 v[112:127], a[196:199], v[148:151], v[112:127]
  s_waitcnt vmcnt(10)
  ds_read_b64_tr_b16 v[88:89], v184 offset:34816
  ds_read_b64_tr_b16 v[92:93], v185 offset:34816
  ds_read_b128 v[144:147], v182 offset:26624
  v_exp_f32 v159, v159
  v_mul_f32 v111, v111, v103
  v_fma_f32 v156, v156, v232, v232
  s_waitcnt lgkmcnt(7)
  v_mfma_f32_32x32x16_bf16 v[112:127], a[200:203], v[128:131], v[112:127]
  s_add_u32 m0, s88, 32768
  s_add_u32 s25, s64, 802816
  buffer_load_dwordx4 v224, s[48:51], s25 offen offset:0 lds
  ds_read_b128 v[148:151], v182 offset:27648
  v_rcp_f32 v156, v156
  v_fma_f32 v157, v157, v232, v232
  v_mfma_f32_32x32x16_bf16 v[112:127], a[204:207], v[132:135], v[112:127]
  s_waitcnt vmcnt(10)
  ds_read_b64_tr_b16 v[90:91], v184 offset:35840
  ds_read_b64_tr_b16 v[94:95], v185 offset:35840
  ds_read_b128 v[128:131], v183 offset:28672
  v_rcp_f32 v157, v157
  s_waitcnt lgkmcnt(7)
  v_mfma_f32_32x32x16_bf16 v[112:127], a[208:211], v[136:139], v[112:127]
  buffer_load_dwordx4 v225, s[48:51], s25 offen offset:1024 lds
  ds_read_b128 v[132:135], v183 offset:29696
  v_fma_f32 v158, v158, v232, v232
  v_rcp_f32 v158, v158
  v_fma_f32 v159, v159, v232, v232
  v_mfma_f32_32x32x16_bf16 v[112:127], a[212:215], v[140:143], v[112:127]
  s_waitcnt vmcnt(10)
  ds_read_b64_tr_b16 a[224:225], v184 offset:0
  ds_read_b64_tr_b16 a[228:229], v185 offset:0
  ds_read_b128 v[136:139], v183 offset:30720
  v_rcp_f32 v159, v159
  v_mul_f32 v108, v108, v156
  v_mul_f32 v109, v109, v157
  s_waitcnt lgkmcnt(7)
  v_mfma_f32_32x32x16_bf16 v[112:127], a[216:219], v[144:147], v[112:127]
  buffer_load_dwordx4 v226, s[48:51], s25 offen offset:2048 lds
  ds_read_b128 v[140:143], v183 offset:31744
  v_mul_f32 v110, v110, v158
  v_mul_f32 v111, v111, v159
  v_cvt_pk_bf16_f32 v178, v108, v109
  v_cvt_pk_bf16_f32 v179, v110, v111
  v_mfma_f32_32x32x16_bf16 v[112:127], a[220:223], v[148:151], v[112:127]
  s_add_u32 s26, s89, 0xb3800
  buffer_store_dwordx4 v[176:179], v1, s[60:63], s26 offen sc1
  s_waitcnt vmcnt(11)
  ds_read_b64_tr_b16 a[226:227], v184 offset:1024
  ds_read_b64_tr_b16 a[230:231], v185 offset:1024
  ds_read_b128 v[144:147], v183 offset:32768
  s_waitcnt lgkmcnt(7)
  v_mfma_f32_32x32x16_bf16 v[96:111], a[112:115], v[128:131], 0
  buffer_load_dwordx4 v227, s[48:51], s25 offen offset:3072 lds
  ds_read_b128 v[148:151], v183 offset:33792
  v_mfma_f32_32x32x16_bf16 v[96:111], a[116:119], v[132:135], v[96:111]
  s_waitcnt vmcnt(11)
  ds_read_b64_tr_b16 a[232:233], v184 offset:2048
  ds_read_b64_tr_b16 a[236:237], v185 offset:2048
  ds_read_b128 v[128:131], v183 offset:34816
  s_waitcnt lgkmcnt(7)
  v_mfma_f32_32x32x16_bf16 v[96:111], a[120:123], v[136:139], v[96:111]
  s_add_u32 m0, s88, 0
  s_add_u32 s25, s64, 917504
  buffer_load_dwordx4 v224, s[48:51], s25 offen offset:0 lds
  ds_read_b128 v[132:135], v183 offset:35840
  v_mul_f32 v152, v112, v112
  v_mul_f32 v153, v113, v113
  v_mul_f32 v154, v114, v114
  v_mfma_f32_32x32x16_bf16 v[96:111], a[124:127], v[140:143], v[96:111]
  s_waitcnt vmcnt(11)
  ds_read_b64_tr_b16 a[234:235], v184 offset:3072
  ds_read_b64_tr_b16 a[238:239], v185 offset:3072
  ds_read_b128 v[136:139], v183 offset:36864
  v_mul_f32 v155, v115, v115
  v_fma_f32 v152, v152, v242, v238
  v_fma_f32 v153, v153, v242, v238
  s_waitcnt lgkmcnt(7)
  v_mfma_f32_32x32x16_bf16 v[96:111], a[128:131], v[144:147], v[96:111]
  buffer_load_dwordx4 v225, s[48:51], s25 offen offset:1024 lds
  ds_read_b128 v[140:143], v183 offset:37888
  v_fma_f32 v154, v154, v242, v238
  v_fma_f32 v155, v155, v242, v238
  v_mul_f32 v152, v152, v112
  v_mul_f32 v153, v153, v113
  v_mfma_f32_32x32x16_bf16 v[96:111], a[132:135], v[148:151], v[96:111]
  s_waitcnt vmcnt(11)
  ds_read_b64_tr_b16 a[240:241], v184 offset:16384
  ds_read_b64_tr_b16 a[244:245], v185 offset:16384
  ds_read_b128 v[144:147], v183 offset:38912
  v_mul_f32 v154, v154, v114
  v_mul_f32 v155, v155, v115
  s_waitcnt lgkmcnt(7)
  v_mfma_f32_32x32x16_bf16 v[96:111], a[136:139], v[128:131], v[96:111]
  buffer_load_dwordx4 v226, s[48:51], s25 offen offset:2048 lds
  ds_read_b128 v[148:151], v183 offset:39936
  v_exp_f32 v152, v152
  v_mul_f32 v120, v120, v112
  v_exp_f32 v153, v153
  v_mul_f32 v121, v121, v113
  v_mfma_f32_32x32x16_bf16 v[96:111], a[140:143], v[132:135], v[96:111]
  s_waitcnt vmcnt(11)
  ds_read_b64_tr_b16 a[242:243], v184 offset:17408
  ds_read_b64_tr_b16 a[246:247], v185 offset:17408
  ds_read_b128 v[128:131], v183 offset:40960
  v_exp_f32 v154, v154
  v_mul_f32 v122, v122, v114
  s_waitcnt lgkmcnt(7)
  v_mfma_f32_32x32x16_bf16 v[96:111], a[144:147], v[136:139], v[96:111]
  buffer_load_dwordx4 v227, s[48:51], s25 offen offset:3072 lds
  ds_read_b128 v[132:135], v183 offset:41984
  v_exp_f32 v155, v155
  v_mul_f32 v123, v123, v115
  v_fma_f32 v152, v152, v234, v234
  v_mfma_f32_32x32x16_bf16 v[96:111], a[148:151], v[140:143], v[96:111]
  s_waitcnt vmcnt(11)
  ds_read_b64_tr_b16 a[248:249], v184 offset:18432
  ds_read_b64_tr_b16 a[252:253], v185 offset:18432
  ds_read_b128 v[136:139], v183 offset:43008
  v_rcp_f32 v152, v152
  v_fma_f32 v153, v153, v234, v234
  s_waitcnt lgkmcnt(7)
  v_mfma_f32_32x32x16_bf16 v[96:111], a[152:155], v[144:147], v[96:111]
  s_add_u32 m0, s88, 16384
  s_add_u32 s25, s64, 1032192
  buffer_load_dwordx4 v224, s[48:51], s25 offen offset:0 lds
  ds_read_b128 v[140:143], v183 offset:44032
  v_rcp_f32 v153, v153
  v_fma_f32 v154, v154, v234, v234
  v_mfma_f32_32x32x16_bf16 v[96:111], a[156:159], v[148:151], v[96:111]
  s_waitcnt vmcnt(10)
  ds_read_b64_tr_b16 a[250:251], v184 offset:19456
  ds_read_b64_tr_b16 a[254:255], v185 offset:19456
  ds_read_b128 v[144:147], v183 offset:45056
  v_rcp_f32 v154, v154
  v_fma_f32 v155, v155, v234, v234
  s_waitcnt lgkmcnt(7)
  v_mfma_f32_32x32x16_bf16 v[96:111], a[160:163], v[128:131], v[96:111]
  buffer_load_dwordx4 v225, s[48:51], s25 offen offset:1024 lds
  ds_read_b128 v[148:151], v183 offset:46080
  v_rcp_f32 v155, v155
  v_mul_f32 v120, v120, v152
  v_mul_f32 v121, v121, v153
  v_mul_f32 v122, v122, v154
  v_mfma_f32_32x32x16_bf16 v[96:111], a[164:167], v[132:135], v[96:111]
  s_waitcnt vmcnt(10)
  ds_read_b64_tr_b16 a[0:1], v184 offset:32768
  ds_read_b64_tr_b16 a[4:5], v185 offset:32768
  ds_read_b128 v[128:131], v183 offset:47104
  v_mul_f32 v123, v123, v155
  v_cvt_pk_bf16_f32 v176, v120, v121
  v_cvt_pk_bf16_f32 v177, v122, v123
  s_waitcnt lgkmcnt(7)
  v_mfma_f32_32x32x16_bf16 v[96:111], a[168:171], v[136:139], v[96:111]
  buffer_load_dwordx4 v226, s[48:51], s25 offen offset:2048 lds
  ds_read_b128 v[132:135], v183 offset:48128
  v_mul_f32 v156, v116, v116
  v_mul_f32 v157, v117, v117
  v_mul_f32 v158, v118, v118
  v_mul_f32 v159, v119, v119
  v_mfma_f32_32x32x16_bf16 v[96:111], a[172:175], v[140:143], v[96:111]
  s_waitcnt vmcnt(10)
  ds_read_b64_tr_b16 a[2:3], v184 offset:33792
  ds_read_b64_tr_b16 a[6:7], v185 offset:33792
  ds_read_b128 v[136:139], v183 offset:49152
  v_fma_f32 v156, v156, v242, v238
  v_fma_f32 v157, v157, v242, v238
  v_fma_f32 v158, v158, v242, v238
  s_waitcnt lgkmcnt(7)
  v_mfma_f32_32x32x16_bf16 v[96:111], a[176:179], v[144:147], v[96:111]
  buffer_load_dwordx4 v227, s[48:51], s25 offen offset:3072 lds
  ds_read_b128 v[140:143], v183 offset:50176
  v_fma_f32 v159, v159, v242, v238
  v_mul_f32 v156, v156, v116
  v_mul_f32 v157, v157, v117
  v_mul_f32 v158, v158, v118
  v_mul_f32 v159, v159, v119
  v_mfma_f32_32x32x16_bf16 v[96:111], a[180:183], v[148:151], v[96:111]
  s_waitcnt vmcnt(10)
  ds_read_b64_tr_b16 a[8:9], v184 offset:34816
  ds_read_b64_tr_b16 a[12:13], v185 offset:34816
  ds_read_b128 v[144:147], v183 offset:51200
  v_exp_f32 v156, v156
  v_mul_f32 v124, v124, v116
  s_waitcnt lgkmcnt(7)
  v_mfma_f32_32x32x16_bf16 v[96:111], a[184:187], v[128:131], v[96:111]
  s_add_u32 m0, s88, 32768
  s_add_u32 s25, s64, 1146880
  buffer_load_dwordx4 v224, s[48:51], s25 offen offset:0 lds
  ds_read_b128 v[148:151], v183 offset:52224
  v_exp_f32 v157, v157
  v_mul_f32 v125, v125, v117
  v_mfma_f32_32x32x16_bf16 v[96:111], a[188:191], v[132:135], v[96:111]
  s_waitcnt vmcnt(10)
  buffer_store_byte v5, v4, s[60:63], s90 offen offset:2112
  s_waitcnt vmcnt(10)
  ds_read_b64_tr_b16 a[10:11], v184 offset:35840
  ds_read_b64_tr_b16 a[14:15], v185 offset:35840
  ds_read_b128 v[128:131], v183 offset:53248
  s_waitcnt lgkmcnt(7)
  v_mfma_f32_32x32x16_bf16 v[96:111], a[192:195], v[136:139], v[96:111]
  buffer_load_dwordx4 v225, s[48:51], s25 offen offset:1024 lds
  ds_read_b128 v[132:135], v183 offset:54272
  v_exp_f32 v158, v158
  v_mul_f32 v126, v126, v118
  v_exp_f32 v159, v159
  v_mfma_f32_32x32x16_bf16 v[96:111], a[196:199], v[140:143], v[96:111]
  s_waitcnt vmcnt(10)
  ds_read_b64_tr_b16 a[16:17], v184 offset:0
  ds_read_b64_tr_b16 a[20:21], v185 offset:0
  ds_read_b128 v[136:139], v183 offset:55296
  v_mul_f32 v127, v127, v119
  v_fma_f32 v156, v156, v234, v234
  s_waitcnt lgkmcnt(7)
  v_mfma_f32_32x32x16_bf16 v[96:111], a[200:203], v[144:147], v[96:111]
  buffer_load_dwordx4 v226, s[48:51], s25 offen offset:2048 lds
  ds_read_b128 v[140:143], v183 offset:56320
  v_rcp_f32 v156, v156
  v_fma_f32 v157, v157, v234, v234
  v_rcp_f32 v157, v157
  v_fma_f32 v158, v158, v234, v234
  v_mfma_f32_32x32x16_bf16 v[96:111], a[204:207], v[148:151], v[96:111]
  buffer_load_dword v187, v186, s[60:63], s65 offen offset:2048 sc1
  s_waitcnt vmcnt(11)
L_hop_w1_to1:
  s_cbranch_execz L_hop_w1
  ds_read_b64_tr_b16 a[18:19], v184 offset:1024
  ds_read_b64_tr_b16 a[22:23], v185 offset:1024
  ds_read_b128 v[144:147], v183 offset:0
  v_rcp_f32 v158, v158
  s_waitcnt lgkmcnt(7)
  v_mfma_f32_32x32x16_bf16 v[96:111], a[208:211], v[128:131], v[96:111]
  buffer_load_dwordx4 v227, s[48:51], s25 offen offset:3072 lds
  ds_read_b128 v[148:151], v183 offset:1024
  v_fma_f32 v159, v159, v234, v234
  v_rcp_f32 v159, v159
  v_mul_f32 v124, v124, v156
  v_mfma_f32_32x32x16_bf16 v[96:111], a[212:215], v[132:135], v[96:111]
  s_waitcnt vmcnt(11)
  ds_read_b64_tr_b16 a[24:25], v184 offset:2048
  ds_read_b64_tr_b16 a[28:29], v185 offset:2048
  ds_read_b128 v[128:131], v183 offset:2048
  v_mul_f32 v125, v125, v157
  v_mul_f32 v126, v126, v158
  v_mul_f32 v127, v127, v159
  s_waitcnt lgkmcnt(7)
  v_mfma_f32_32x32x16_bf16 v[96:111], a[216:219], v[136:139], v[96:111]
  s_add_u32 m0, s88, 0
  s_add_u32 s25, s64, 1261568
  buffer_load_dwordx4 v224, s[48:51], s25 offen offset:0 lds
  ds_read_b128 v[132:135], v183 offset:3072
  v_cvt_pk_bf16_f32 v178, v124, v125
  v_cvt_pk_bf16_f32 v179, v126, v127
  v_mfma_f32_32x32x16_bf16 v[96:111], a[220:223], v[140:143], v[96:111]
  s_add_u32 s26, s89, 0xeb800
  buffer_store_dwordx4 v[176:179], v1, s[60:63], s26 offen sc1
  s_waitcnt vmcnt(12)
  ds_read_b64_tr_b16 a[26:27], v184 offset:3072
  ds_read_b64_tr_b16 a[30:31], v185 offset:3072
  ds_read_b128 v[136:139], v183 offset:4096
  s_waitcnt lgkmcnt(7)
  v_mfma_f32_32x32x16_bf16 v[112:127], a[112:115], v[144:147], 0
  buffer_load_dwordx4 v225, s[48:51], s25 offen offset:1024 lds
  ds_read_b128 v[140:143], v183 offset:5120
  v_mfma_f32_32x32x16_bf16 v[112:127], a[116:119], v[148:151], v[112:127]
  s_waitcnt vmcnt(12)
  ds_read_b64_tr_b16 a[32:33], v184 offset:16384
  ds_read_b64_tr_b16 a[36:37], v185 offset:16384
  ds_read_b128 v[144:147], v183 offset:6144
  s_waitcnt lgkmcnt(7)
  v_mfma_f32_32x32x16_bf16 v[112:127], a[120:123], v[128:131], v[112:127]
  buffer_load_dwordx4 v226, s[48:51], s25 offen offset:2048 lds
  ds_read_b128 v[148:151], v183 offset:7168
  v_mul_f32 v152, v96, v96
  v_mul_f32 v153, v97, v97
  v_mul_f32 v154, v98, v98
  v_mul_f32 v155, v99, v99
  v_mfma_f32_32x32x16_bf16 v[112:127], a[124:127], v[132:135], v[112:127]
  s_waitcnt vmcnt(12)
  ds_read_b64_tr_b16 a[34:35], v184 offset:17408
  ds_read_b64_tr_b16 a[38:39], v185 offset:17408
  ds_read_b128 v[128:131], v183 offset:8192
  v_fma_f32 v152, v152, v241, v237
  v_fma_f32 v153, v153, v241, v237
  s_waitcnt lgkmcnt(7)
  v_mfma_f32_32x32x16_bf16 v[112:127], a[128:131], v[136:139], v[112:127]
  buffer_load_dwordx4 v227, s[48:51], s25 offen offset:3072 lds
  ds_read_b128 v[132:135], v183 offset:9216
  v_fma_f32 v154, v154, v241, v237
  v_fma_f32 v155, v155, v241, v237
  v_mul_f32 v152, v152, v96
  v_mul_f32 v153, v153, v97
  v_mul_f32 v154, v154, v98
  v_mfma_f32_32x32x16_bf16 v[112:127], a[132:135], v[140:143], v[112:127]
  s_waitcnt vmcnt(12)
  ds_read_b64_tr_b16 a[40:41], v184 offset:18432
  ds_read_b64_tr_b16 a[44:45], v185 offset:18432
  ds_read_b128 v[136:139], v183 offset:10240
  v_mul_f32 v155, v155, v99
  s_waitcnt lgkmcnt(7)
  v_mfma_f32_32x32x16_bf16 v[112:127], a[136:139], v[144:147], v[112:127]
  s_add_u32 m0, s88, 16384
  s_add_u32 s25, s64, 1376256
  buffer_load_dwordx4 v224, s[48:51], s25 offen offset:0 lds
  ds_read_b128 v[140:143], v183 offset:11264
  v_exp_f32 v152, v152
  v_mul_f32 v104, v104, v96
  v_mfma_f32_32x32x16_bf16 v[112:127], a[140:143], v[148:151], v[112:127]
  ds_read_b128 v[144:147], v183 offset:12288
  v_exp_f32 v153, v153
  v_mul_f32 v105, v105, v97
  v_exp_f32 v154, v154
  s_waitcnt lgkmcnt(5)
  v_mfma_f32_32x32x16_bf16 v[112:127], a[144:147], v[128:131], v[112:127]
  buffer_load_dwordx4 v225, s[48:51], s25 offen offset:1024 lds
  s_waitcnt vmcnt(13)
  ds_read_b64_tr_b16 a[42:43], v184 offset:19456
  ds_read_b64_tr_b16 a[46:47], v185 offset:19456
  ds_read_b128 v[148:151], v183 offset:13312
  v_mul_f32 v106, v106, v98
  v_mfma_f32_32x32x16_bf16 v[112:127], a[148:151], v[132:135], v[112:127]
  ds_read_b128 v[128:131], v183 offset:14336
  v_exp_f32 v155, v155
  v_mul_f32 v107, v107, v99
  v_fma_f32 v152, v152, v233, v233
  v_rcp_f32 v152, v152
  s_waitcnt lgkmcnt(5)
  v_mfma_f32_32x32x16_bf16 v[112:127], a[152:155], v[136:139], v[112:127]
  buffer_load_dwordx4 v226, s[48:51], s25 offen offset:2048 lds
  s_waitcnt vmcnt(13)
  ds_read_b64_tr_b16 a[48:49], v184 offset:32768
  ds_read_b64_tr_b16 a[52:53], v185 offset:32768
  ds_read_b128 v[132:135], v183 offset:15360
  v_fma_f32 v153, v153, v233, v233
  v_mfma_f32_32x32x16_bf16 v[112:127], a[156:159], v[140:143], v[112:127]
  s_waitcnt vmcnt(9)
  v_cmp_ne_u32 vcc, v188, v187
  s_and_b64 vcc, vcc, 0xf0f
  s_cbranch_vccnz L_wf_rr_34
L_wf_rb_35:
  ds_read_b128 v[136:139], v183 offset:16384
  s_waitcnt lgkmcnt(5)
  v_mfma_f32_32x32x16_bf16 v[112:127], a[160:163], v[144:147], v[112:127]
  s_add_u32 s18, s66, 0xb0000
  buffer_load_dwordx4 a[112:115], v1, s[60:63], s18 offen offset:0 sc1
  ds_read_b64_tr_b16 a[50:51], v184 offset:33792
  ds_read_b64_tr_b16 a[54:55], v185 offset:33792
  ds_read_b128 v[140:143], v183 offset:17408
  v_rcp_f32 v153, v153
  v_fma_f32 v154, v154, v233, v233
  v_mfma_f32_32x32x16_bf16 v[112:127], a[164:167], v[148:151], v[112:127]
  ds_read_b128 v[144:147], v183 offset:18432
  v_rcp_f32 v154, v154
  v_fma_f32 v155, v155, v233, v233
  v_rcp_f32 v155, v155
  s_waitcnt lgkmcnt(5)
  v_mfma_f32_32x32x16_bf16 v[112:127], a[168:171], v[128:131], v[112:127]
  s_add_u32 s19, s66, 0xcc000
  buffer_load_dwordx4 a[116:119], v1, s[60:63], s19 offen offset:0 sc1
  ds_read_b64_tr_b16 a[56:57], v184 offset:34816
  ds_read_b64_tr_b16 a[60:61], v185 offset:34816
  ds_read_b128 v[148:151], v183 offset:19456
  v_mul_f32 v104, v104, v152
  v_mfma_f32_32x32x16_bf16 v[112:127], a[172:175], v[132:135], v[112:127]
  ds_read_b128 v[128:131], v183 offset:20480
  v_mul_f32 v105, v105, v153
  v_mul_f32 v106, v106, v154
  v_mul_f32 v107, v107, v155
  v_cvt_pk_bf16_f32 v176, v104, v105
  v_cvt_pk_bf16_f32 v177, v106, v107
  s_waitcnt lgkmcnt(5)
  v_mfma_f32_32x32x16_bf16 v[112:127], a[176:179], v[136:139], v[112:127]
  buffer_load_dwordx4 a[120:123], v1, s[60:63], s18 offen offset:1024 sc1
  s_waitcnt vmcnt(11)
  ds_read_b64_tr_b16 a[58:59], v184 offset:35840
  ds_read_b64_tr_b16 a[62:63], v185 offset:35840
  ds_read_b128 v[132:135], v183 offset:21504
  v_mul_f32 v156, v100, v100
  v_mul_f32 v157, v101, v101
  v_mul_f32 v158, v102, v102
  v_mfma_f32_32x32x16_bf16 v[112:127], a[180:183], v[140:143], v[112:127]
  ds_read_b128 v[136:139], v183 offset:22528
  v_mul_f32 v159, v103, v103
  v_fma_f32 v156, v156, v241, v237
  v_fma_f32 v157, v157, v241, v237
  v_fma_f32 v158, v158, v241, v237
  v_fma_f32 v159, v159, v241, v237
  s_waitcnt lgkmcnt(5)
  v_mfma_f32_32x32x16_bf16 v[112:127], a[184:187], v[144:147], v[112:127]
  buffer_load_dwordx4 a[124:127], v1, s[60:63], s19 offen offset:1024 sc1
  s_waitcnt vmcnt(11)
  ds_read_b64_tr_b16 a[64:65], v184 offset:0
  ds_read_b64_tr_b16 a[68:69], v185 offset:0
  ds_read_b128 v[140:143], v183 offset:23552
  v_mul_f32 v156, v156, v100
  v_mul_f32 v157, v157, v101
  v_mfma_f32_32x32x16_bf16 v[112:127], a[188:191], v[148:151], v[112:127]
  s_waitcnt vmcnt(10)
  buffer_store_byte v5, v4, s[60:63], s90 offen offset:2368
  ds_read_b128 v[144:147], v183 offset:24576
  v_mul_f32 v158, v158, v102
  v_mul_f32 v159, v159, v103
  s_waitcnt lgkmcnt(5)
  v_mfma_f32_32x32x16_bf16 v[112:127], a[192:195], v[128:131], v[112:127]
  buffer_load_dwordx4 a[128:131], v1, s[60:63], s18 offen offset:2048 sc1
  s_waitcnt vmcnt(11)
  ds_read_b64_tr_b16 a[66:67], v184 offset:1024
  ds_read_b64_tr_b16 a[70:71], v185 offset:1024
  ds_read_b128 v[148:151], v183 offset:25600
  v_exp_f32 v156, v156
  v_mul_f32 v108, v108, v100
  v_mfma_f32_32x32x16_bf16 v[112:127], a[196:199], v[132:135], v[112:127]
  ds_read_b128 v[128:131], v183 offset:26624
  v_exp_f32 v157, v157
  v_mul_f32 v109, v109, v101
  v_exp_f32 v158, v158
  v_mul_f32 v110, v110, v102
  s_waitcnt lgkmcnt(5)
  v_mfma_f32_32x32x16_bf16 v[112:127], a[200:203], v[136:139], v[112:127]
  buffer_load_dwordx4 a[132:135], v1, s[60:63], s19 offen offset:2048 sc1
  s_waitcnt vmcnt(11)
  ds_read_b64_tr_b16 a[72:73], v184 offset:2048
  ds_read_b64_tr_b16 a[76:77], v185 offset:2048
  ds_read_b128 v[132:135], v183 offset:27648
  v_exp_f32 v159, v159
  v_mfma_f32_32x32x16_bf16 v[112:127], a[204:207], v[140:143], v[112:127]
  v_mul_f32 v111, v111, v103
  v_fma_f32 v156, v156, v233, v233
  v_rcp_f32 v156, v156
  v_fma_f32 v157, v157, v233, v233
  s_waitcnt lgkmcnt(4)
  v_mfma_f32_32x32x16_bf16 v[112:127], a[208:211], v[144:147], v[112:127]
  buffer_load_dwordx4 a[136:139], v1, s[60:63], s18 offen offset:3072 sc1
  s_waitcnt vmcnt(11)
  ds_read_b64_tr_b16 a[74:75], v184 offset:3072
  ds_read_b64_tr_b16 a[78:79], v185 offset:3072
  v_rcp_f32 v157, v157
  v_fma_f32 v158, v158, v233, v233
  v_rcp_f32 v158, v158
  v_mfma_f32_32x32x16_bf16 v[112:127], a[212:215], v[148:151], v[112:127]
  v_fma_f32 v159, v159, v233, v233
  v_rcp_f32 v159, v159
  v_mul_f32 v108, v108, v156
  v_mul_f32 v109, v109, v157
  v_mul_f32 v110, v110, v158
  s_waitcnt lgkmcnt(2)
  v_mfma_f32_32x32x16_bf16 v[112:127], a[216:219], v[128:131], v[112:127]
  buffer_load_dwordx4 a[140:143], v1, s[60:63], s19 offen offset:3072 sc1
  s_waitcnt vmcnt(11)
  ds_read_b64_tr_b16 a[80:81], v184 offset:16384
  ds_read_b64_tr_b16 a[84:85], v185 offset:16384
  v_mul_f32 v111, v111, v159
  v_cvt_pk_bf16_f32 v178, v108, v109
  v_cvt_pk_bf16_f32 v179, v110, v111
  v_mfma_f32_32x32x16_bf16 v[112:127], a[220:223], v[132:135], v[112:127]
  s_add_u32 s26, s89, 0xcf800
  buffer_store_dwordx4 v[176:179], v1, s[60:63], s26 offen sc1
  s_waitcnt vmcnt(9)
  v_mfma_f32_32x32x16_bf16 v[192:207], v[16:19], a[112:115], v[192:207]
  s_add_u32 s18, s66, 0xb1000
  buffer_load_dwordx4 a[144:147], v1, s[60:63], s18 offen offset:0 sc1
  ds_read_b64_tr_b16 a[82:83], v184 offset:17408
  ds_read_b64_tr_b16 a[86:87], v185 offset:17408
  v_mfma_f32_32x32x16_bf16 v[96:111], v[20:23], a[112:115], 0
  buffer_load_dwordx4 v227, s[48:51], s25 offen offset:3072 lds
  s_waitcnt vmcnt(10)
  v_mfma_f32_32x32x16_bf16 v[208:223], v[16:19], a[116:119], v[208:223]
  s_add_u32 s19, s66, 0xcd000
  buffer_load_dwordx4 a[148:151], v1, s[60:63], s19 offen offset:0 sc1
  ds_read_b64_tr_b16 a[88:89], v184 offset:18432
  ds_read_b64_tr_b16 a[92:93], v185 offset:18432
  v_mul_f32 v152, v112, v112
  v_mfma_f32_32x32x16_bf16 v[128:143], v[20:23], a[116:119], 0
  v_mul_f32 v153, v113, v113
  v_mul_f32 v154, v114, v114
  v_mul_f32 v155, v115, v115
  v_fma_f32 v152, v152, v243, v239
  v_fma_f32 v153, v153, v243, v239
  v_fma_f32 v154, v154, v243, v239
  s_waitcnt vmcnt(10)
  v_mfma_f32_32x32x16_bf16 v[192:207], v[24:27], a[120:123], v[192:207]
  buffer_load_dwordx4 a[152:155], v1, s[60:63], s18 offen offset:1024 sc1
  v_fma_f32 v155, v155, v243, v239
  v_mul_f32 v152, v152, v112
  v_mul_f32 v153, v153, v113
  v_mul_f32 v154, v154, v114
  v_mul_f32 v155, v155, v115
  v_mfma_f32_32x32x16_bf16 v[96:111], v[28:31], a[120:123], v[96:111]
  s_add_u32 m0, s88, 32768
  s_add_u32 s25, s64, 1490944
  buffer_load_dwordx4 v224, s[48:51], s25 offen offset:0 lds
  v_exp_f32 v152, v152
  s_waitcnt vmcnt(11)
  v_mfma_f32_32x32x16_bf16 v[208:223], v[24:27], a[124:127], v[208:223]
  buffer_load_dwordx4 a[156:159], v1, s[60:63], s19 offen offset:1024 sc1
  v_mul_f32 v120, v120, v112
  v_exp_f32 v153, v153
  v_mul_f32 v121, v121, v113
  v_mfma_f32_32x32x16_bf16 v[128:143], v[28:31], a[124:127], v[128:143]
  v_exp_f32 v154, v154
  v_mul_f32 v122, v122, v114
  v_exp_f32 v155, v155
  v_mul_f32 v123, v123, v115
  s_waitcnt vmcnt(10)
  v_mfma_f32_32x32x16_bf16 v[192:207], v[32:35], a[128:131], v[192:207]
  buffer_load_dwordx4 a[160:163], v1, s[60:63], s18 offen offset:2048 sc1
  v_fma_f32 v152, v152, v235, v235
  v_rcp_f32 v152, v152
  v_fma_f32 v153, v153, v235, v235
  v_mfma_f32_32x32x16_bf16 v[96:111], v[36:39], a[128:131], v[96:111]
  buffer_load_dwordx4 v225, s[48:51], s25 offen offset:1024 lds
  v_rcp_f32 v153, v153
  v_fma_f32 v154, v154, v235, v235
  v_rcp_f32 v154, v154
  s_waitcnt vmcnt(11)
  v_mfma_f32_32x32x16_bf16 v[208:223], v[32:35], a[132:135], v[208:223]
  buffer_load_dwordx4 a[164:167], v1, s[60:63], s19 offen offset:2048 sc1
  v_fma_f32 v155, v155, v235, v235
  v_rcp_f32 v155, v155
  v_mul_f32 v120, v120, v152
  v_mul_f32 v121, v121, v153
  v_mfma_f32_32x32x16_bf16 v[128:143], v[36:39], a[132:135], v[128:143]
  v_mul_f32 v122, v122, v154
  v_mul_f32 v123, v123, v155
  v_cvt_pk_bf16_f32 v176, v120, v121
  v_cvt_pk_bf16_f32 v177, v122, v123
  v_mul_f32 v156, v116, v116
  v_mul_f32 v157, v117, v117
  s_waitcnt vmcnt(11)
  v_mfma_f32_32x32x16_bf16 v[192:207], v[40:43], a[136:139], v[192:207]
  buffer_load_dwordx4 a[168:171], v1, s[60:63], s18 offen offset:3072 sc1
  v_mul_f32 v158, v118, v118
  v_mul_f32 v159, v119, v119
  v_fma_f32 v156, v156, v243, v239
  v_fma_f32 v157, v157, v243, v239
  v_fma_f32 v158, v158, v243, v239
  v_mfma_f32_32x32x16_bf16 v[96:111], v[44:47], a[136:139], v[96:111]
  buffer_load_dwordx4 v226, s[48:51], s25 offen offset:2048 lds
  v_fma_f32 v159, v159, v243, v239
  v_mul_f32 v156, v156, v116
  v_mul_f32 v157, v157, v117
  v_mul_f32 v158, v158, v118
  s_waitcnt vmcnt(12)
  v_mfma_f32_32x32x16_bf16 v[208:223], v[40:43], a[140:143], v[208:223]
  buffer_load_dwordx4 a[172:175], v1, s[60:63], s19 offen offset:3072 sc1
  v_mul_f32 v159, v159, v119
  v_exp_f32 v156, v156
  v_mul_f32 v124, v124, v116
  v_mfma_f32_32x32x16_bf16 v[128:143], v[44:47], a[140:143], v[128:143]
  v_exp_f32 v157, v157
  v_mul_f32 v125, v125, v117
  v_exp_f32 v158, v158
  v_mul_f32 v126, v126, v118
  s_waitcnt vmcnt(11)
  v_mfma_f32_32x32x16_bf16 v[192:207], v[48:51], a[144:147], v[192:207]
  s_add_u32 s18, s66, 0xb2000
  buffer_load_dwordx4 a[176:179], v1, s[60:63], s18 offen offset:0 sc1
  v_exp_f32 v159, v159
  v_mul_f32 v127, v127, v119
  v_fma_f32 v156, v156, v235, v235
  v_mfma_f32_32x32x16_bf16 v[96:111], v[52:55], a[144:147], v[96:111]
  buffer_load_dwordx4 v227, s[48:51], s25 offen offset:3072 lds
  v_rcp_f32 v156, v156
  v_fma_f32 v157, v157, v235, v235
  s_waitcnt vmcnt(11)
  v_mfma_f32_32x32x16_bf16 v[208:223], v[48:51], a[148:151], v[208:223]
  s_add_u32 s19, s66, 0xce000
  buffer_load_dwordx4 a[180:183], v1, s[60:63], s19 offen offset:0 sc1
  v_rcp_f32 v157, v157
  v_fma_f32 v158, v158, v235, v235
  v_rcp_f32 v158, v158
  v_mfma_f32_32x32x16_bf16 v[128:143], v[52:55], a[148:151], v[128:143]
  buffer_store_byte v5, v4, s[60:63], s90 offen offset:2240
  v_fma_f32 v159, v159, v235, v235
  v_rcp_f32 v159, v159
  v_mul_f32 v124, v124, v156
  s_waitcnt vmcnt(12)
  v_mfma_f32_32x32x16_bf16 v[192:207], v[56:59], a[152:155], v[192:207]
  buffer_load_dwordx4 a[184:187], v1, s[60:63], s18 offen offset:1024 sc1
  v_mul_f32 v125, v125, v157
  v_mul_f32 v126, v126, v158
  v_mul_f32 v127, v127, v159
  v_cvt_pk_bf16_f32 v178, v124, v125
  v_cvt_pk_bf16_f32 v179, v126, v127
  v_mfma_f32_32x32x16_bf16 v[96:111], v[60:63], a[152:155], v[96:111]
  s_add_u32 s26, s89, 0x107800
  buffer_store_dwordx4 v[176:179], v1, s[60:63], s26 offen sc1
  ds_read_b64_tr_b16 a[90:91], v184 offset:19456
  ds_read_b64_tr_b16 a[94:95], v185 offset:19456
  s_waitcnt vmcnt(12)
  v_mfma_f32_32x32x16_bf16 v[208:223], v[56:59], a[156:159], v[208:223]
  buffer_load_dwordx4 a[188:191], v1, s[60:63], s19 offen offset:1024 sc1
  v_mfma_f32_32x32x16_bf16 v[128:143], v[60:63], a[156:159], v[128:143]
  buffer_load_dword v187, v186, s[60:63], s65 offen offset:2048 sc1
  s_waitcnt vmcnt(13)
  v_mfma_f32_32x32x16_bf16 v[192:207], v[64:67], a[160:163], v[192:207]
  buffer_load_dwordx4 a[192:195], v1, s[60:63], s18 offen offset:2048 sc1
  v_mfma_f32_32x32x16_bf16 v[96:111], v[68:71], a[160:163], v[96:111]
  ds_read_b64_tr_b16 a[96:97], v184 offset:32768
  ds_read_b64_tr_b16 a[100:101], v185 offset:32768
  s_waitcnt vmcnt(12)
  v_mfma_f32_32x32x16_bf16 v[208:223], v[64:67], a[164:167], v[208:223]
  buffer_load_dwordx4 a[196:199], v1, s[60:63], s19 offen offset:2048 sc1
  v_mfma_f32_32x32x16_bf16 v[128:143], v[68:71], a[164:167], v[128:143]
  s_waitcnt vmcnt(12)
  v_mfma_f32_32x32x16_bf16 v[192:207], v[72:75], a[168:171], v[192:207]
  buffer_load_dwordx4 a[200:203], v1, s[60:63], s18 offen offset:3072 sc1
  v_mfma_f32_32x32x16_bf16 v[96:111], v[76:79], a[168:171], v[96:111]
  ds_read_b64_tr_b16 a[98:99], v184 offset:33792
  ds_read_b64_tr_b16 a[102:103], v185 offset:33792
  s_waitcnt vmcnt(11)
  v_mfma_f32_32x32x16_bf16 v[208:223], v[72:75], a[172:175], v[208:223]
  buffer_load_dwordx4 a[204:207], v1, s[60:63], s19 offen offset:3072 sc1
  v_mfma_f32_32x32x16_bf16 v[128:143], v[76:79], a[172:175], v[128:143]
  s_waitcnt vmcnt(11)
  v_mfma_f32_32x32x16_bf16 v[192:207], v[80:83], a[176:179], v[192:207]
  s_add_u32 s18, s66, 0xb3000
  buffer_load_dwordx4 a[208:211], v1, s[60:63], s18 offen offset:0 sc1
  v_mfma_f32_32x32x16_bf16 v[96:111], v[84:87], a[176:179], v[96:111]
  ds_read_b64_tr_b16 a[104:105], v184 offset:34816
  ds_read_b64_tr_b16 a[108:109], v185 offset:34816
  s_waitcnt vmcnt(10)
  v_mfma_f32_32x32x16_bf16 v[208:223], v[80:83], a[180:183], v[208:223]
  s_add_u32 s19, s66, 0xcf000
  buffer_load_dwordx4 a[212:215], v1, s[60:63], s19 offen offset:0 sc1
  v_mfma_f32_32x32x16_bf16 v[128:143], v[84:87], a[180:183], v[128:143]
  s_waitcnt vmcnt(9)
  v_mfma_f32_32x32x16_bf16 v[192:207], v[88:91], a[184:187], v[192:207]
  buffer_load_dwordx4 a[216:219], v1, s[60:63], s18 offen offset:1024 sc1
  v_mfma_f32_32x32x16_bf16 v[96:111], v[92:95], a[184:187], v[96:111]
  ds_read_b64_tr_b16 a[106:107], v184 offset:35840
  ds_read_b64_tr_b16 a[110:111], v185 offset:35840
  s_waitcnt vmcnt(8)
  v_mfma_f32_32x32x16_bf16 v[208:223], v[88:91], a[188:191], v[208:223]
  buffer_load_dwordx4 a[220:223], v1, s[60:63], s19 offen offset:1024 sc1
  v_mfma_f32_32x32x16_bf16 v[128:143], v[92:95], a[188:191], v[128:143]
  s_waitcnt vmcnt(8)
  v_cmp_ne_u32 vcc, v188, v187
  s_and_b64 vcc, vcc, 0xf0
  s_cbranch_vccnz L_wf_rr_37
L_wf_rb_38:
  s_waitcnt vmcnt(7)
  v_mfma_f32_32x32x16_bf16 v[192:207], a[224:227], a[192:195], v[192:207]
  s_add_u32 s18, s66, 0xb3000
  buffer_load_dwordx4 a[112:115], v1, s[60:63], s18 offen offset:2048 sc1
  v_mfma_f32_32x32x16_bf16 v[96:111], a[228:231], a[192:195], v[96:111]
  buffer_store_byte v5, v4, s[60:63], s90 offen offset:2496
  s_waitcnt vmcnt(8)
  v_mfma_f32_32x32x16_bf16 v[208:223], a[224:227], a[196:199], v[208:223]
  buffer_load_dwordx4 a[116:119], v1, s[60:63], s18 offen offset:3072 sc1
  v_mfma_f32_32x32x16_bf16 v[128:143], a[228:231], a[196:199], v[128:143]
  s_waitcnt vmcnt(8)
  v_mfma_f32_32x32x16_bf16 v[192:207], a[232:235], a[200:203], v[192:207]
  s_add_u32 s18, s66, 0xb4000
  buffer_load_dwordx4 a[120:123], v1, s[60:63], s18 offen offset:0 sc1
  v_mfma_f32_32x32x16_bf16 v[96:111], a[236:239], a[200:203], v[96:111]
  s_waitcnt vmcnt(8)
  v_mfma_f32_32x32x16_bf16 v[208:223], a[232:235], a[204:207], v[208:223]
  buffer_load_dwordx4 a[124:127], v1, s[60:63], s18 offen offset:1024 sc1
  v_mfma_f32_32x32x16_bf16 v[128:143], a[236:239], a[204:207], v[128:143]
  s_waitcnt vmcnt(8)
  v_mfma_f32_32x32x16_bf16 v[192:207], a[240:243], a[208:211], v[192:207]
  buffer_load_dwordx4 a[128:131], v1, s[60:63], s18 offen offset:2048 sc1
  v_mfma_f32_32x32x16_bf16 v[96:111], a[244:247], a[208:211], v[96:111]
  s_waitcnt vmcnt(8)
  v_mfma_f32_32x32x16_bf16 v[208:223], a[240:243], a[212:215], v[208:223]
  buffer_load_dwordx4 a[132:135], v1, s[60:63], s18 offen offset:3072 sc1
  v_mfma_f32_32x32x16_bf16 v[128:143], a[244:247], a[212:215], v[128:143]
  buffer_load_dword v187, v186, s[60:63], s65 offen offset:2048 sc1
  s_waitcnt vmcnt(9)
  v_mfma_f32_32x32x16_bf16 v[192:207], a[248:251], a[216:219], v[192:207]
  s_add_u32 s18, s66, 0xb5000
  buffer_load_dwordx4 a[136:139], v1, s[60:63], s18 offen offset:0 sc1
  v_mfma_f32_32x32x16_bf16 v[96:111], a[252:255], a[216:219], v[96:111]
  s_waitcnt vmcnt(9)
  v_mfma_f32_32x32x16_bf16 v[208:223], a[248:251], a[220:223], v[208:223]
  buffer_load_dwordx4 a[140:143], v1, s[60:63], s18 offen offset:1024 sc1
  v_mfma_f32_32x32x16_bf16 v[128:143], a[252:255], a[220:223], v[128:143]
  s_waitcnt vmcnt(9)
  v_mfma_f32_32x32x16_bf16 v[192:207], a[0:3], a[112:115], v[192:207]
  buffer_load_dwordx4 a[144:147], v1, s[60:63], s18 offen offset:2048 sc1
  v_mfma_f32_32x32x16_bf16 v[96:111], a[4:7], a[112:115], v[96:111]
  s_waitcnt vmcnt(8)
  v_mfma_f32_32x32x16_bf16 v[192:207], a[8:11], a[116:119], v[192:207]
  buffer_load_dwordx4 a[148:151], v1, s[60:63], s18 offen offset:3072 sc1
  v_mfma_f32_32x32x16_bf16 v[96:111], a[12:15], a[116:119], v[96:111]
  s_waitcnt vmcnt(8)
  v_mfma_f32_32x32x16_bf16 v[192:207], a[16:19], a[120:123], v[192:207]
  s_add_u32 s18, s66, 0xb6000
  buffer_load_dwordx4 a[152:155], v1, s[60:63], s18 offen offset:0 sc1
  v_mfma_f32_32x32x16_bf16 v[96:111], a[20:23], a[120:123], v[96:111]
  s_waitcnt vmcnt(8)
  v_mfma_f32_32x32x16_bf16 v[192:207], a[24:27], a[124:127], v[192:207]
  buffer_load_dwordx4 a[156:159], v1, s[60:63], s18 offen offset:1024 sc1
  v_mfma_f32_32x32x16_bf16 v[96:111], a[28:31], a[124:127], v[96:111]
  s_waitcnt vmcnt(8)
  v_mfma_f32_32x32x16_bf16 v[192:207], a[32:35], a[128:131], v[192:207]
  buffer_load_dwordx4 a[160:163], v1, s[60:63], s18 offen offset:2048 sc1
  v_mfma_f32_32x32x16_bf16 v[96:111], a[36:39], a[128:131], v[96:111]
  s_waitcnt vmcnt(8)
  v_mfma_f32_32x32x16_bf16 v[192:207], a[40:43], a[132:135], v[192:207]
  buffer_load_dwordx4 a[164:167], v1, s[60:63], s18 offen offset:3072 sc1
  s_barrier
  v_mfma_f32_32x32x16_bf16 v[96:111], a[44:47], a[132:135], v[96:111]
  s_waitcnt vmcnt(8)
  v_cmp_ne_u32 vcc, v188, v187
  s_and_b64 vcc, vcc, 0xf000
  s_cbranch_vccnz L_wf_rr_40
L_wf_rb_41:
  s_waitcnt vmcnt(7)
  v_mfma_f32_32x32x16_bf16 v[192:207], a[48:51], a[136:139], v[192:207]
  s_add_u32 s19, s66, 0xcf000
  buffer_load_dwordx4 a[168:171], v1, s[60:63], s19 offen offset:2048 sc1
  v_mfma_f32_32x32x16_bf16 v[96:111], a[52:55], a[136:139], v[96:111]
  s_waitcnt vmcnt(7)
  v_mfma_f32_32x32x16_bf16 v[192:207], a[56:59], a[140:143], v[192:207]
  buffer_load_dwordx4 a[172:175], v1, s[60:63], s19 offen offset:3072 sc1
  v_mfma_f32_32x32x16_bf16 v[96:111], a[60:63], a[140:143], v[96:111]
  s_waitcnt vmcnt(7)
  v_mfma_f32_32x32x16_bf16 v[192:207], a[64:67], a[144:147], v[192:207]
  s_add_u32 s19, s66, 0xd0000
  buffer_load_dwordx4 a[176:179], v1, s[60:63], s19 offen offset:0 sc1
  v_mfma_f32_32x32x16_bf16 v[96:111], a[68:71], a[144:147], v[96:111]
  s_waitcnt vmcnt(7) lgkmcnt(15)
  v_mfma_f32_32x32x16_bf16 v[192:207], a[72:75], a[148:151], v[192:207]
  buffer_load_dwordx4 a[180:183], v1, s[60:63], s19 offen offset:1024 sc1
  v_mfma_f32_32x32x16_bf16 v[96:111], a[76:79], a[148:151], v[96:111]
  s_waitcnt vmcnt(7) lgkmcnt(13)
  v_mfma_f32_32x32x16_bf16 v[192:207], a[80:83], a[152:155], v[192:207]
  buffer_load_dwordx4 a[184:187], v1, s[60:63], s19 offen offset:2048 sc1
  s_waitcnt lgkmcnt(12)
  v_mfma_f32_32x32x16_bf16 v[96:111], a[84:87], a[152:155], v[96:111]
  s_waitcnt vmcnt(7) lgkmcnt(9)
  v_mfma_f32_32x32x16_bf16 v[192:207], a[88:91], a[156:159], v[192:207]
  buffer_load_dwordx4 a[188:191], v1, s[60:63], s19 offen offset:3072 sc1
  s_waitcnt lgkmcnt(8)
  v_mfma_f32_32x32x16_bf16 v[96:111], a[92:95], a[156:159], v[96:111]
  s_waitcnt vmcnt(7) lgkmcnt(5)
  v_mfma_f32_32x32x16_bf16 v[192:207], a[96:99], a[160:163], v[192:207]
  s_add_u32 s19, s66, 0xd1000
  buffer_load_dwordx4 a[192:195], v1, s[60:63], s19 offen offset:0 sc1
  s_waitcnt lgkmcnt(4)
  v_mfma_f32_32x32x16_bf16 v[96:111], a[100:103], a[160:163], v[96:111]
  s_waitcnt vmcnt(7) lgkmcnt(1)
  v_mfma_f32_32x32x16_bf16 v[192:207], a[104:107], a[164:167], v[192:207]
  buffer_load_dwordx4 a[196:199], v1, s[60:63], s19 offen offset:1024 sc1
  s_waitcnt lgkmcnt(0)
  v_mfma_f32_32x32x16_bf16 v[96:111], a[108:111], a[164:167], v[96:111]
  s_waitcnt vmcnt(7)
  v_mfma_f32_32x32x16_bf16 v[208:223], a[0:3], a[168:171], v[208:223]
  buffer_load_dwordx4 a[200:203], v1, s[60:63], s19 offen offset:2048 sc1
  v_mfma_f32_32x32x16_bf16 v[128:143], a[4:7], a[168:171], v[128:143]
  s_waitcnt vmcnt(7)
  v_mfma_f32_32x32x16_bf16 v[208:223], a[8:11], a[172:175], v[208:223]
  buffer_load_dwordx4 a[204:207], v1, s[60:63], s19 offen offset:3072 sc1
  s_nop 1
  ds_write_b128 v189, v[192:195] offset:0
  v_mfma_f32_32x32x16_bf16 v[128:143], a[12:15], a[172:175], v[128:143]
  ds_write_b128 v189, v[196:199] offset:16
  s_waitcnt vmcnt(7)
  v_mfma_f32_32x32x16_bf16 v[208:223], a[16:19], a[176:179], v[208:223]
  s_add_u32 s19, s66, 0xd2000
  buffer_load_dwordx4 a[208:211], v1, s[60:63], s19 offen offset:0 sc1
  ds_write_b128 v189, v[200:203] offset:32
  v_mfma_f32_32x32x16_bf16 v[128:143], a[20:23], a[176:179], v[128:143]
  ds_write_b128 v189, v[204:207] offset:48
  s_waitcnt vmcnt(7)
  v_mfma_f32_32x32x16_bf16 v[208:223], a[24:27], a[180:183], v[208:223]
  buffer_load_dwordx4 a[212:215], v1, s[60:63], s19 offen offset:1024 sc1
  ds_write_b128 v190, v[96:99] offset:0
  v_mfma_f32_32x32x16_bf16 v[128:143], a[28:31], a[180:183], v[128:143]
  ds_write_b128 v190, v[100:103] offset:16
  s_waitcnt vmcnt(7)
  v_mfma_f32_32x32x16_bf16 v[208:223], a[32:35], a[184:187], v[208:223]
  buffer_load_dwordx4 a[216:219], v1, s[60:63], s19 offen offset:2048 sc1
  ds_write_b128 v190, v[104:107] offset:32
  v_mfma_f32_32x32x16_bf16 v[128:143], a[36:39], a[184:187], v[128:143]
  ds_write_b128 v190, v[108:111] offset:48
  s_waitcnt vmcnt(7)
  v_mfma_f32_32x32x16_bf16 v[208:223], a[40:43], a[188:191], v[208:223]
  buffer_load_dwordx4 a[220:223], v1, s[60:63], s19 offen offset:3072 sc1
  s_waitcnt lgkmcnt(0)
  s_barrier
  v_mfma_f32_32x32x16_bf16 v[128:143], a[44:47], a[188:191], v[128:143]
  ds_read_b128 v[112:115], v191 offset:0
  ds_read_b128 v[116:119], v191 offset:128
  s_waitcnt vmcnt(7)
  v_mfma_f32_32x32x16_bf16 v[208:223], a[48:51], a[192:195], v[208:223]
  ds_read_b128 v[120:123], v191 offset:8704
  ds_read_b128 v[124:127], v191 offset:8832
  v_mfma_f32_32x32x16_bf16 v[128:143], a[52:55], a[192:195], v[128:143]
  ds_read_b128 v[144:147], v191 offset:17408
  ds_read_b128 v[148:151], v191 offset:17536
  s_waitcnt vmcnt(6)
  v_mfma_f32_32x32x16_bf16 v[208:223], a[56:59], a[196:199], v[208:223]
  ds_read_b128 v[152:155], v191 offset:26112
  ds_read_b128 v[156:159], v191 offset:26240
  v_mfma_f32_32x32x16_bf16 v[128:143], a[60:63], a[196:199], v[128:143]
  s_waitcnt vmcnt(5)
  v_mfma_f32_32x32x16_bf16 v[208:223], a[64:67], a[200:203], v[208:223]
  s_waitcnt vmcnt(4)
  v_mfma_f32_32x32x16_bf16 v[208:223], a[72:75], a[204:207], v[208:223]
  s_waitcnt lgkmcnt(5)
  v_add_f32 v112, v112, v120
  v_add_f32 v113, v113, v121
  v_add_f32 v114, v114, v122
  v_add_f32 v115, v115, v123
  s_waitcnt vmcnt(3)
  v_mfma_f32_32x32x16_bf16 v[208:223], a[80:83], a[208:211], v[208:223]
  s_waitcnt lgkmcnt(4)
  v_add_f32 v116, v116, v124
  v_add_f32 v117, v117, v125
  v_add_f32 v118, v118, v126
  v_add_f32 v119, v119, v127
  s_waitcnt vmcnt(2)
  v_mfma_f32_32x32x16_bf16 v[208:223], a[88:91], a[212:215], v[208:223]
  s_waitcnt lgkmcnt(1)
  v_add_f32 v144, v144, v152
  v_add_f32 v145, v145, v153
  v_add_f32 v146, v146, v154
  v_add_f32 v147, v147, v155
  s_waitcnt vmcnt(1)
  v_mfma_f32_32x32x16_bf16 v[208:223], a[96:99], a[216:219], v[208:223]
  s_waitcnt lgkmcnt(0)
  v_add_f32 v148, v148, v156
  v_add_f32 v149, v149, v157
  v_add_f32 v150, v150, v158
  v_add_f32 v151, v151, v159
  s_waitcnt vmcnt(0)
  v_mfma_f32_32x32x16_bf16 v[208:223], a[104:107], a[220:223], v[208:223]
  v_add_f32 v112, v112, v144
  v_add_f32 v113, v113, v145
  v_add_f32 v114, v114, v146
  v_add_f32 v115, v115, v147
  v_mfma_f32_32x32x16_bf16 v[128:143], a[68:71], a[200:203], v[128:143]
  v_add_f32 v116, v116, v148
  v_add_f32 v117, v117, v149
  v_add_f32 v118, v118, v150
  v_add_f32 v119, v119, v151
  v_mfma_f32_32x32x16_bf16 v[128:143], a[76:79], a[204:207], v[128:143]
  v_cvt_pk_bf16_f32 v176, v112, v113
  v_cvt_pk_bf16_f32 v177, v114, v115
  v_cvt_pk_bf16_f32 v178, v116, v117
  v_cvt_pk_bf16_f32 v179, v118, v119
  v_mfma_f32_32x32x16_bf16 v[128:143], a[84:87], a[208:211], v[128:143]
  s_add_u32 s26, s67, 0
  buffer_store_dwordx4 v[176:179], v9, s[52:55], s26 offen sc1
  ds_write_b128 v189, v[208:211] offset:34816
  v_mfma_f32_32x32x16_bf16 v[128:143], a[92:95], a[212:215], v[128:143]
  ds_write_b128 v189, v[212:215] offset:34832
  v_mfma_f32_32x32x16_bf16 v[128:143], a[100:103], a[216:219], v[128:143]
  ds_write_b128 v189, v[216:219] offset:34848
  v_mfma_f32_32x32x16_bf16 v[128:143], a[108:111], a[220:223], v[128:143]
  ds_write_b128 v189, v[220:223] offset:34864
  s_nop 10
  ds_write_b128 v190, v[128:131] offset:34816
  ds_write_b128 v190, v[132:135] offset:34832
  ds_write_b128 v190, v[136:139] offset:34848
  ds_write_b128 v190, v[140:143] offset:34864
L_hop_w1_to2:
  s_cbranch_execz L_hop_w1
  s_waitcnt lgkmcnt(0)
  s_barrier
  ds_read_b128 v[112:115], v191 offset:34816
  ds_read_b128 v[120:123], v191 offset:43520
  ds_read_b128 v[144:147], v191 offset:52224
  ds_read_b128 v[152:155], v191 offset:60928
  ds_read_b128 v[116:119], v191 offset:34944
  ds_read_b128 v[124:127], v191 offset:43648
  ds_read_b128 v[148:151], v191 offset:52352
  ds_read_b128 v[156:159], v191 offset:61056
  s_add_u32 s26, s67, 28672
  s_waitcnt lgkmcnt(6)
  v_pk_add_f32 v[112:113], v[112:113], v[120:121]
  v_pk_add_f32 v[114:115], v[114:115], v[122:123]
  s_waitcnt lgkmcnt(4)
  v_pk_add_f32 v[144:145], v[144:145], v[152:153]
  v_pk_add_f32 v[146:147], v[146:147], v[154:155]
  v_pk_add_f32 v[112:113], v[112:113], v[144:145]
  v_pk_add_f32 v[114:115], v[114:115], v[146:147]
  v_cvt_pk_bf16_f32 v176, v112, v113
  v_cvt_pk_bf16_f32 v177, v114, v115
  s_waitcnt lgkmcnt(2)
  v_pk_add_f32 v[116:117], v[116:117], v[124:125]
  v_pk_add_f32 v[118:119], v[118:119], v[126:127]
  s_waitcnt lgkmcnt(0)
  v_pk_add_f32 v[148:149], v[148:149], v[156:157]
  v_pk_add_f32 v[150:151], v[150:151], v[158:159]
  v_pk_add_f32 v[116:117], v[116:117], v[148:149]
  v_pk_add_f32 v[118:119], v[118:119], v[150:151]
  v_cvt_pk_bf16_f32 v178, v116, v117
  v_cvt_pk_bf16_f32 v179, v118, v119
  buffer_store_dwordx4 v[176:179], v9, s[52:55], s26 offen sc1
  s_endpgm
L_spare:
  s_sub_u32 s17, s5, 28
  s_lshl_b32 s17, s17, 2
  s_add_u32 s17, s17, s6
  s_lshl_b32 s14, s17, 13
  v_lshl_add_u32 v254, v0, 7, s14
  s_mov_b32 s3, s17
  s_waitcnt lgkmcnt(0)
  s_mov_b64 s[60:61], s[82:83]
  s_mov_b32 s62, 0xcd8000
  s_mov_b32 s63, 0x20000
  s_mov_b64 s[56:57], s[80:81]
  s_mov_b32 s58, 0x100
  s_mov_b32 s59, 0x20000
  s_mov_b64 s[40:41], s[68:69]
  s_mov_b32 s42, 0x62000
  s_mov_b32 s43, 0x20000
  s_mov_b64 s[48:49], s[76:77]
  s_mov_b32 s50, 0x188000
  s_mov_b32 s51, 0x20000
  s_getreg_b32 s9, hwreg(HW_REG_XCC_ID, 0, 4)
  s_add_u32 s9, s9, 1
  s_mul_i32 s10, s4, 0x19b000
  s_sub_u32 s11, s10, 0x19b000
  s_cmp_eq_u32 s4, 0
  s_cselect_b32 s11, 0x40000000, s11
  s_and_b32 s12, s5, 15
  s_lshr_b32 s13, s5, 4
  v_lshlrev_b32 v1, 4, v0
  v_lshlrev_b32 v2, 3, v0
  v_lshlrev_b32 v3, 2, v0
  v_mov_b32 v5, 1
  v_min_u32 v4, 1, v0
  v_lshlrev_b32 v4, 30, v4
  s_cmp_lg_u32 s5, 31
  s_cbranch_scc1 L_sf_nolead_43
  v_mov_b32 v16, 0
  v_mov_b32 v17, 0
  v_mov_b32 v18, 0
  v_mov_b32 v19, 0
  s_mul_i32 s14, s6, 3072
  s_add_u32 s14, s14, s10
  s_add_u32 s14, s14, 0x198000
  buffer_store_dwordx4 v[16:19], v1, s[60:63], s14 offen offset:0 sc1
  buffer_store_dwordx4 v[16:19], v1, s[60:63], s14 offen offset:1024 sc1
  buffer_store_dwordx4 v[16:19], v1, s[60:63], s14 offen offset:2048 sc1
L_sf_nolead_43:
  s_mov_b64 s[36:37], s[78:79]
  s_mov_b32 s38, 0x1c0000
  s_mov_b32 s39, 0x20000
  s_mov_b64 s[32:33], s[66:67]
  s_mov_b32 s34, 0x126000
  s_mov_b32 s35, 0x20000
  s_mul_i32 s14, s4, 150528
  s_add_u32 s14, s14, 0
  buffer_load_dword v253, v254, s[32:35], s14 offen
  s_cmp_lg_u32 s5, 31
  s_cbranch_scc1 L_sf_nolead_44
  v_mov_b32 v20, s9
  s_lshl_b32 s14, s4, 2
  s_lshl_b32 s15, s6, 20
  s_add_u32 s14, s14, s15
  s_waitcnt vmcnt(1)
  s_barrier
  buffer_store_dword v20, v4, s[56:59], s14 offen sc1
  s_add_u32 s14, s10, s6
  s_add_u32 s14, s14, 0x19807c
  buffer_store_byte v5, v4, s[60:63], s14 offen
L_sf_nolead_44:
  s_mul_i32 s14, s4, 150528
  s_add_u32 s14, s14, 131072
  s_mul_i32 s15, s3, 10
  v_min_u32 v252, 9, v0
  v_add_lshl_u32 v252, v252, s15, 7
  buffer_load_dword v253, v252, s[32:35], s14 offen
  s_mul_i32 s14, s4, 229376
  buffer_load_dword v253, v4, s[36:39], s14 offen
  s_add_u32 s93, s10, 0x198000
  s_lshl_b32 s86, s13, 2
  s_add_u32 s86, s86, s6
  s_xor_b32 s87, s86, 4
  s_lshl_b32 s88, s86, 15
  s_lshl_b32 s16, s12, 11
  s_add_u32 s88, s88, s16
  s_add_u32 s88, s88, s10
  s_mul_i32 s16, s12, 14336
  s_add_u32 s16, s16, 0x40000
  s_mul_i32 s89, s86, 1792
  s_add_u32 s89, s89, s16
  s_mul_i32 s90, s87, 1792
  s_add_u32 s90, s90, s16
  s_cmp_eq_u32 s13, 1
  s_cselect_b32 s17, s10, s11
  s_add_u32 s68, s11, s89
  s_add_u32 s69, s17, s90
  s_add_u32 s70, s10, s89
  s_mul_i32 s16, s12, 28
  v_and_b32 v20, 1, v0
  v_mad_u32_u24 v20, v20, 27, s16
  v_lshrrev_b32 v20, 5, v20
  v_lshrrev_b32 v21, 2, v20
  v_mul_u32_u24 v21, 112, v21
  v_lshlrev_b32 v20, 2, v20
  s_lshl_b32 s16, s86, 6
  s_add_u32 s16, s16, s93
  s_add_u32 s16, s16, 256
  v_add_u32 v236, s16, v20
  s_lshl_b32 s16, s86, 9
  s_add_u32 s16, s16, s10
  s_add_u32 s16, s16, 0x199000
  s_mov_b64 exec, 0x3f
  v_add3_u32 v236, v20, v21, s16
  s_or_b32 s16, s4, s13
  s_cselect_b64 exec, 12, 0
  v_xor_b32 v236, 0x800, v236
  s_cmp_eq_u32 s13, 0
  s_cselect_b32 s16, 15, 3
  s_cmp_lg_u32 s4, 0
  s_cselect_b32 exec_lo, s16, 0
  v_subrev_u32 v236, 0x19b000, v236
  s_mov_b64 exec, -1
  v_mov_b32 v242, v236
  s_mov_b64 exec, 0x3f
  v_add_u32 v242, 0x1000, v236
  s_mov_b64 exec, -1
  s_lshl_b32 s16, s6, 11
  s_add_u32 s17, s16, 81920
  v_add_u32 v237, s17, v2
  s_add_u32 s16, s16, 57344
  v_bfe_u32 v20, v0, 4, 1
  v_and_b32 v21, 3, v0
  v_lshl_add_u32 v20, v20, 2, v21
  v_bfe_u32 v21, v0, 2, 2
  v_lshrrev_b32 v23, 5, v0
  v_lshl_add_u32 v21, v23, 2, v21
  v_lshlrev_b32 v22, 2, v20
  v_xor_b32 v21, v21, v22
  v_lshlrev_b32 v21, 3, v21
  v_lshl_add_u32 v21, v20, 8, v21
  v_add_u32 v238, s16, v21
  v_xor_b32 v239, 64, v238
  v_xor_b32 v240, 128, v238
  v_xor_b32 v241, 192, v238
  s_lshl_b32 s24, s6, 11
  s_mov_b64 s[32:33], s[72:73]
  s_mov_b32 s34, 0x188000
  s_mov_b32 s35, 0x20000
  s_mov_b64 s[36:37], s[74:75]
  s_mov_b32 s38, 0x188000
  s_mov_b32 s39, 0x20000
  v_mul_u32_u24 v252, 147, v0
  v_lshrrev_b32 v252, 11, v252
  v_mul_u32_u24 v252, 1792, v252
  v_lshl_add_u32 v255, v0, 7, v252
  s_mul_i32 s14, s4, 14
  s_add_u32 s14, s14, s3
  s_mul_i32 s14, s14, 3584
  buffer_load_dwordx4 v[24:27], v1, s[40:43], s14 offen offset:0
  buffer_load_dwordx4 v[28:31], v1, s[40:43], s14 offen offset:896
  buffer_load_dwordx4 v[32:35], v1, s[40:43], s14 offen offset:1792
  buffer_load_dwordx4 v[36:39], v1, s[40:43], s14 offen offset:2688
  v_lshrrev_b32 v10, 5, v0
  v_mul_u32_u24 v13, 24832, v10
  v_sub_u32 v13, v237, v13
  v_and_b32 v11, 31, v0
  v_mad_i32_i24 v11, v10, -4, v11
  v_mov_b32 v12, 0xf149f2ca
  s_cmp_eq_u32 s4, 0
  s_cselect_b32 s15, 0xf1490000, 0
  s_or_b32 s15, s15, 0x3f80
  s_cmp_eq_u32 s13, 0
  s_cselect_b32 s17, s15, 0x3f80
  v_mov_b32 v160, 0x3f803f80
  v_mov_b32 v161, s15
  v_mov_b32 v162, 0x3f803f80
  v_mov_b32 v163, s17
  v_mov_b32 v164, 0x3f803f80
  v_mov_b32 v165, 0x3f80
  s_mov_b32 exec_lo, 0
  v_mov_b32 v160, 0x3f80
  v_mov_b32 v161, 0
  s_mov_b32 exec_lo, -1
  s_mov_b32 exec_lo, 0
  v_mov_b32 v162, 0x3f80
  v_mov_b32 v163, 0
  s_mov_b32 exec_lo, -1
  s_mov_b32 exec_lo, 0
  v_mov_b32 v164, 0x3f80
  v_mov_b32 v165, 0
  s_mov_b32 exec_lo, -1
  v_cmp_le_i32 s[30:31], 0, v11
  s_nop 1
  v_cndmask_b32 v200, v12, 0, s[30:31]
  v_cmp_le_i32 s[30:31], 1, v11
  v_sub_f32 v168, v12, v200
  s_nop 0
  v_cndmask_b32 v201, v12, 0, s[30:31]
  v_cmp_le_i32 s[30:31], 2, v11
  v_sub_f32 v169, v12, v201
  s_nop 0
  v_cndmask_b32 v202, v12, 0, s[30:31]
  v_cmp_le_i32 s[30:31], 3, v11
  v_sub_f32 v170, v12, v202
  s_nop 0
  v_cndmask_b32 v203, v12, 0, s[30:31]
  v_cmp_le_i32 s[30:31], 8, v11
  v_sub_f32 v171, v12, v203
  s_nop 0
  v_cndmask_b32 v204, v12, 0, s[30:31]
  v_cmp_le_i32 s[30:31], 9, v11
  v_sub_f32 v172, v12, v204
  s_nop 0
  v_cndmask_b32 v205, v12, 0, s[30:31]
  v_cmp_le_i32 s[30:31], 10, v11
  v_sub_f32 v173, v12, v205
  s_nop 0
  v_cndmask_b32 v206, v12, 0, s[30:31]
  v_cmp_le_i32 s[30:31], 11, v11
  v_sub_f32 v174, v12, v206
  s_nop 0
  v_cndmask_b32 v207, v12, 0, s[30:31]
  v_cmp_le_i32 s[30:31], 16, v11
  v_sub_f32 v175, v12, v207
  s_nop 0
  v_cndmask_b32 v208, v12, 0, s[30:31]
  v_cmp_le_i32 s[30:31], 17, v11
  v_sub_f32 v176, v12, v208
  s_nop 0
  v_cndmask_b32 v209, v12, 0, s[30:31]
  v_cmp_le_i32 s[30:31], 18, v11
  v_sub_f32 v177, v12, v209
  s_nop 0
  v_cndmask_b32 v210, v12, 0, s[30:31]
  v_cmp_le_i32 s[30:31], 19, v11
  v_sub_f32 v178, v12, v210
  s_nop 0
  v_cndmask_b32 v211, v12, 0, s[30:31]
  v_cmp_le_i32 s[30:31], 24, v11
  v_sub_f32 v179, v12, v211
  s_nop 0
  v_cndmask_b32 v212, v12, 0, s[30:31]
  v_cmp_le_i32 s[30:31], 25, v11
  v_sub_f32 v180, v12, v212
  s_nop 0
  v_cndmask_b32 v213, v12, 0, s[30:31]
  v_cmp_le_i32 s[30:31], 26, v11
  v_sub_f32 v181, v12, v213
  s_nop 0
  v_cndmask_b32 v214, v12, 0, s[30:31]
  v_cmp_le_i32 s[30:31], 27, v11
  v_sub_f32 v182, v12, v214
  s_nop 0
  v_cndmask_b32 v215, v12, 0, s[30:31]
  v_sub_f32 v183, v12, v215
  s_mul_i32 s14, s4, 1683456
  s_add_u32 s14, s14, 0
  buffer_load_dword v253, v254, s[60:63], s14 offen
  s_waitcnt vmcnt(0)
  v_mov_b32 v40, 0
  v_mov_b32 v41, 0
  v_mov_b32 v42, 0
  v_mov_b32 v43, 0
  s_mov_b32 s16, 0x3f803f80
  s_mov_b32 exec_hi, 0xffffff
  v_dot2c_f32_bf16 v40, s16, v24
  v_dot2c_f32_bf16 v41, s16, v28
  v_dot2c_f32_bf16 v42, s16, v32
  v_dot2c_f32_bf16 v43, s16, v36
  v_dot2c_f32_bf16 v40, s16, v25
  v_dot2c_f32_bf16 v41, s16, v29
  v_dot2c_f32_bf16 v42, s16, v33
  v_dot2c_f32_bf16 v43, s16, v37
  v_dot2c_f32_bf16 v40, s16, v26
  v_dot2c_f32_bf16 v41, s16, v30
  v_dot2c_f32_bf16 v42, s16, v34
  v_dot2c_f32_bf16 v43, s16, v38
  v_dot2c_f32_bf16 v40, s16, v27
  v_dot2c_f32_bf16 v41, s16, v31
  v_dot2c_f32_bf16 v42, s16, v35
  v_dot2c_f32_bf16 v43, s16, v39
  s_mov_b32 exec_hi, -1
  v_add_f32_dpp v40, v40, v40 quad_perm:[1,0,3,2] row_mask:0xf bank_mask:0xf
  v_add_f32_dpp v41, v41, v41 quad_perm:[1,0,3,2] row_mask:0xf bank_mask:0xf
  v_add_f32_dpp v42, v42, v42 quad_perm:[1,0,3,2] row_mask:0xf bank_mask:0xf
  v_add_f32_dpp v43, v43, v43 quad_perm:[1,0,3,2] row_mask:0xf bank_mask:0xf
  v_add_f32_dpp v40, v40, v40 quad_perm:[2,3,0,1] row_mask:0xf bank_mask:0xf
  v_add_f32_dpp v41, v41, v41 quad_perm:[2,3,0,1] row_mask:0xf bank_mask:0xf
  v_add_f32_dpp v42, v42, v42 quad_perm:[2,3,0,1] row_mask:0xf bank_mask:0xf
  v_add_f32_dpp v43, v43, v43 quad_perm:[2,3,0,1] row_mask:0xf bank_mask:0xf
  v_add_f32_dpp v40, v40, v40 row_half_mirror row_mask:0xf bank_mask:0xf
  v_add_f32_dpp v41, v41, v41 row_half_mirror row_mask:0xf bank_mask:0xf
  v_add_f32_dpp v42, v42, v42 row_half_mirror row_mask:0xf bank_mask:0xf
  v_add_f32_dpp v43, v43, v43 row_half_mirror row_mask:0xf bank_mask:0xf
  v_add_f32_dpp v40, v40, v40 row_mirror row_mask:0xf bank_mask:0xf
  v_add_f32_dpp v41, v41, v41 row_mirror row_mask:0xf bank_mask:0xf
  v_add_f32_dpp v42, v42, v42 row_mirror row_mask:0xf bank_mask:0xf
  v_add_f32_dpp v43, v43, v43 row_mirror row_mask:0xf bank_mask:0xf
  v_mov_b32 v44, v40
  v_mov_b32 v45, v41
  v_mov_b32 v46, v42
  v_mov_b32 v47, v43
  v_permlane16_swap_b32 v40, v44
  v_permlane16_swap_b32 v41, v45
  v_permlane16_swap_b32 v42, v46
  v_permlane16_swap_b32 v43, v47
  v_add_f32 v40, v40, v44
  v_add_f32 v41, v41, v45
  v_add_f32 v42, v42, v46
  v_add_f32 v43, v43, v47
  v_mov_b32 v44, v40
  v_mov_b32 v45, v41
  v_mov_b32 v46, v42
  v_mov_b32 v47, v43
  v_permlane32_swap_b32 v40, v44
  v_permlane32_swap_b32 v41, v45
  v_permlane32_swap_b32 v42, v46
  v_permlane32_swap_b32 v43, v47
  v_add_f32 v40, v40, v44
  v_add_f32 v41, v41, v45
  v_add_f32 v42, v42, v46
  v_add_f32 v43, v43, v47
  v_mul_f32 v40, 0x3b124925, v40
  v_mul_f32 v41, 0x3b124925, v41
  v_mul_f32 v42, 0x3b124925, v42
  v_mul_f32 v43, 0x3b124925, v43
  v_or_b32 v40, 1, v40
  buffer_load_dword v248, v3, s[56:59], 0 offen sc1
  s_waitcnt vmcnt(0)
  v_readlane_b32 s14, v248, s4
  s_cmp_eq_u32 s14, 0
  s_cbranch_scc1 L_sf_b2r_45
L_sf_b2b_46:
  s_lshl_b32 s15, s5, 2
  s_add_u32 s15, s15, s6
  s_add_u32 s15, s15, s10
  s_add_u32 s15, s15, 0x198000
  s_cmp_lg_u32 s14, s9
  s_cbranch_scc1 L_sf_b2d_47
  buffer_store_byte v5, v4, s[60:63], s15 offen
L_sf_b2o_48:
  s_lshl_b32 s14, s3, 4
  s_add_u32 s14, s14, s93
  buffer_store_dwordx4 v[40:43], v4, s[60:63], s14 offen offset:1792 sc1
  s_mov_b64 exec, 0
  s_cmp_eq_u32 s6, 0
  s_cbranch_scc1 L_hop_s0_to0
  s_cmp_eq_u32 s6, 1
  s_cbranch_scc1 L_hop_s0_to1
  s_cmp_eq_u32 s6, 2
  s_cbranch_scc1 L_hop_s0_to2
  s_branch L_hop_s0_to3
L_hop_s0_to1:
L_hop_s0_to2:
L_hop_s0_to3:
L_hop_s0:
  s_mov_b64 exec, -1
  s_barrier
  s_mul_i32 s14, s4, 1683456
  s_add_u32 s14, s14, 1654784
  s_mul_i32 s15, s3, 10
  v_min_u32 v252, 9, v0
  v_add_lshl_u32 v252, v252, s15, 7
  buffer_load_dword v253, v252, s[60:63], s14 offen
  v_readlane_b32 s89, v236, 12
  s_mov_b32 s91, 0
  s_mul_i32 s14, s4, 1683456
  s_add_u32 s14, s14, 131072
  buffer_load_dword v253, v254, s[60:63], s14 offen
  s_mov_b32 s91, 1
  s_waitcnt vmcnt(0)
  buffer_load_dword v253, off, s[60:63], s89 offset:512 sc1
  s_waitcnt vmcnt(0)
  v_cmp_eq_u32 vcc, 1, v253
  s_cbranch_vccnz L_sf_pfx_50
L_sf_pfx_50:
  v_and_b32 v250, 127, v3
  buffer_load_dword v249, v250, s[60:63], s93 offen sc1
  s_waitcnt vmcnt(0)
  v_cmp_ne_u32 vcc, 0x01010101, v249
  s_cbranch_vccnz L_sf_b3r_51
L_sf_b3b_52:
L_fork_sf:
  s_mov_b32 s27, 200000
L_sf_poll_54:
  buffer_load_dword v253, off, s[60:63], s89 offset:1024 sc1
  s_waitcnt vmcnt(0)
  v_cmp_ne_u32 vcc, 1, v253
  s_cbranch_vccz L_sf_done_55
  s_sub_u32 s27, s27, 1
  s_cmp_lg_u32 s27, 0
  s_cbranch_scc1 L_sf_poll_54
L_sf_done_55:
  s_add_u32 s16, s4, 7
  s_and_b32 s16, s16, 7
  s_lshl_b64 s[28:29], 1, s16
  s_lshr_b32 s16, s12, 1
  s_bitset1_b32 s28, s16
  s_add_u32 s16, s4, 1
  s_and_b32 s16, s16, 7
  s_bitset1_b32 s28, s16
  v_cmp_eq_u32 vcc, 0, v248
  s_and_b64 vcc, vcc, s[28:29]
  s_cbranch_vccnz L_sf_rr_56
L_sf_rb_57:
  buffer_load_dword v243, v236, s[60:63], 0 offen sc1
  s_waitcnt vmcnt(0)
  v_cmp_ne_u32 vcc, 1, v243
  s_and_b64 vcc, vcc, 0x3f
  s_cbranch_vccnz L_sf_rr_59
L_sf_rb_60:
  s_add_u32 m0, s24, 81920
  s_nop 0
  buffer_load_dwordx4 v1, s[60:63], s68 offen offset:0 sc1 lds
  s_add_u32 m0, s24, 90112
  s_nop 0
  buffer_load_dwordx4 v1, s[60:63], s69 offen offset:0 sc1 lds
  s_add_u32 m0, s24, 98304
  s_nop 0
  buffer_load_dwordx4 v1, s[60:63], s70 offen offset:0 sc1 lds
  s_add_u32 m0, s24, 81920
  s_mov_b32 exec_hi, 0xffff
  buffer_load_dwordx4 v1, s[60:63], s68 offen offset:1024 sc1 lds
  s_mov_b32 exec_hi, -1
  s_add_u32 m0, s24, 90112
  s_mov_b32 exec_hi, 0xffff
  buffer_load_dwordx4 v1, s[60:63], s69 offen offset:1024 sc1 lds
  s_mov_b32 exec_hi, -1
  s_add_u32 m0, s24, 98304
  s_mov_b32 exec_hi, 0xffff
  buffer_load_dwordx4 v1, s[60:63], s70 offen offset:1024 sc1 lds
  s_mov_b32 exec_hi, -1
  s_add_u32 s68, s68, 0x38000
  s_add_u32 s69, s69, 0x38000
  s_add_u32 s70, s70, 0x38000
  ds_write_b64 v13, v[160:161] offset:1792
  ds_write_b64 v13, v[162:163] offset:9984
  ds_write_b64 v13, v[164:165] offset:18176
  s_waitcnt vmcnt(5)
  buffer_load_dword v249, v242, s[60:63], 0 offen sc1
  s_waitcnt vmcnt(0)
  v_cmp_ne_u32 vcc, 1, v249
  s_cbranch_vccnz L_sf_rr_62
L_sf_rb_63:
  buffer_load_dwordx2 v[88:89], v2, s[60:63], s88 offen offset:0 sc1
  buffer_load_dwordx2 v[90:91], v2, s[60:63], s88 offen offset:512 sc1
  buffer_load_dwordx2 v[92:93], v2, s[60:63], s88 offen offset:1024 sc1
  buffer_load_dwordx2 v[94:95], v2, s[60:63], s88 offen offset:1536 sc1
  s_waitcnt lgkmcnt(0)
  s_barrier
  ds_read_b64 v[80:81], v237 offset:16384
  ds_read_b64 v[82:83], v237 offset:16896
  ds_read_b64 v[84:85], v237 offset:17408
  ds_read_b64 v[86:87], v237 offset:17920
  s_add_u32 m0, s24, 57344
  s_nop 0
  buffer_load_dwordx4 v1, s[60:63], s68 offen offset:0 sc1 lds
  ds_read_b64 v[16:17], v237 offset:0
  ds_read_b64 v[18:19], v237 offset:512
  ds_read_b64 v[20:21], v237 offset:1024
  ds_read_b64 v[22:23], v237 offset:1536
  s_add_u32 m0, s24, 65536
  s_nop 0
  buffer_load_dwordx4 v1, s[60:63], s69 offen offset:0 sc1 lds
  ds_read_b64 v[24:25], v237 offset:2048
  ds_read_b64 v[26:27], v237 offset:2560
  ds_read_b64 v[28:29], v237 offset:3072
  ds_read_b64 v[30:31], v237 offset:3584
  s_add_u32 m0, s24, 73728
  s_nop 0
  buffer_load_dwordx4 v1, s[60:63], s70 offen offset:0 sc1 lds
  s_mov_b32 exec_lo, 0
  s_waitcnt vmcnt(3)
  v_mov_b32 v94, 0
  v_mov_b32 v95, 1.0
  s_mov_b32 exec_lo, -1
  s_waitcnt lgkmcnt(10)
  v_mfma_f32_32x32x16_bf16 v[96:111], v[80:83], v[88:91], v[200:215]
  s_add_u32 m0, s24, 57344
  s_mov_b32 exec_hi, 0xffff
  buffer_load_dwordx4 v1, s[60:63], s68 offen offset:1024 sc1 lds
  s_mov_b32 exec_hi, -1
  s_waitcnt lgkmcnt(8)
  v_mfma_f32_32x32x16_bf16 v[96:111], v[84:87], v[92:95], v[96:111]
  s_add_u32 m0, s24, 65536
  s_mov_b32 exec_hi, 0xffff
  buffer_load_dwordx4 v1, s[60:63], s69 offen offset:1024 sc1 lds
  s_mov_b32 exec_hi, -1
  s_lshr_b32 s90, s12, 1
  s_mul_i32 s90, s90, 0x19b000
  s_and_b32 s14, s12, 1
  s_mul_i32 s14, s14, 112
  s_add_u32 s90, s90, s14
  s_add_u32 s90, s90, 0x198000
  s_add_u32 m0, s24, 73728
  s_mov_b32 exec_hi, 0xffff
  buffer_load_dwordx4 v1, s[60:63], s70 offen offset:1024 sc1 lds
  s_mov_b32 exec_hi, -1
  v_max_f32 v10, v96, v97
  v_max_f32 v11, v98, v99
  v_max3_f32 v10, v10, v100, v101
  v_max3_f32 v11, v11, v102, v103
  v_max3_f32 v10, v10, v104, v105
  v_max3_f32 v11, v11, v106, v107
  v_max3_f32 v10, v10, v108, v109
  v_max3_f32 v11, v11, v110, v111
  v_max_f32 v10, v10, v11
  v_mov_b32 v11, v10
  s_mov_b32 s16, 0xffff0000
  s_mov_b32 s17, 0x07060302
  v_permlane32_swap_b32 v10, v11
  v_min_f32 v10, -v10, -v11
  v_and_b32 v11, s16, v10
  v_sub_f32 v11, v10, v11
  v_and_b32 v14, s16, v11
  v_sub_f32 v14, v11, v14
  s_mov_b32 exec_lo, 0
  v_perm_b32 v94, v11, v10, s17
  v_perm_b32 v95, v95, v14, s17
  s_mov_b32 exec_lo, -1
  s_waitcnt lgkmcnt(6)
  v_mfma_f32_32x32x16_bf16 v[96:111], v[16:19], v[88:91], v[168:183]
  s_waitcnt lgkmcnt(4)
  v_mfma_f32_32x32x16_bf16 v[96:111], v[20:23], v[92:95], v[96:111]
  s_lshl_b32 s14, s6, 28
  s_lshl2_add_u32 s15, s5, s93
  s_add_u32 s14, s14, s15
  buffer_store_dword v5, v4, s[60:63], s14 offen offset:128 sc1
  v_lshrrev_b32 v13, 5, v0
  v_lshlrev_b32 v13, 4, v13
  v_mov_b32 v12, 0
  s_nop 4
  v_exp_f32 v96, v96
  v_exp_f32 v97, v97
  v_exp_f32 v98, v98
  v_exp_f32 v99, v99
  v_exp_f32 v100, v100
  v_exp_f32 v101, v101
  v_exp_f32 v102, v102
  v_exp_f32 v103, v103
  s_waitcnt lgkmcnt(2)
  v_mfma_f32_32x32x16_bf16 v[112:127], v[24:27], v[88:91], 0
  ds_read_b64 v[32:33], v237 offset:4096
  ds_read_b64 v[34:35], v237 offset:4608
  ds_read_b64 v[36:37], v237 offset:5120
  ds_read_b64 v[38:39], v237 offset:5632
  v_cvt_pk_bf16_f32 v16, v96, v97
  v_cvt_pk_bf16_f32 v17, v98, v99
  v_cvt_pk_bf16_f32 v18, v100, v101
  v_cvt_pk_bf16_f32 v19, v102, v103
  v_exp_f32 v104, v104
  v_exp_f32 v105, v105
  s_waitcnt lgkmcnt(4)
  v_mfma_f32_32x32x16_bf16 v[112:127], v[28:31], v[92:95], v[112:127]
  v_exp_f32 v106, v106
  v_exp_f32 v107, v107
  v_exp_f32 v108, v108
  v_exp_f32 v109, v109
  v_exp_f32 v110, v110
  v_exp_f32 v111, v111
  v_cvt_pk_bf16_f32 v20, v104, v105
  v_cvt_pk_bf16_f32 v21, v106, v107
  v_cvt_pk_bf16_f32 v22, v108, v109
  v_cvt_pk_bf16_f32 v23, v110, v111
  buffer_load_dwordx4 v[168:171], v13, s[60:63], s90 offen offset:1792 sc1
  s_nop 0
  v_exp_f32 v112, v112
  v_exp_f32 v113, v113
  v_exp_f32 v114, v114
  v_exp_f32 v115, v115
  v_exp_f32 v116, v116
  v_exp_f32 v117, v117
  v_exp_f32 v118, v118
  v_exp_f32 v119, v119
  s_waitcnt lgkmcnt(2)
  v_mfma_f32_32x32x16_bf16 v[96:111], v[32:35], v[88:91], 0
  ds_read_b64 v[40:41], v237 offset:6144
  ds_read_b64 v[42:43], v237 offset:6656
  ds_read_b64 v[44:45], v237 offset:7168
  ds_read_b64 v[46:47], v237 offset:7680
  v_cvt_pk_bf16_f32 v24, v112, v113
  v_cvt_pk_bf16_f32 v25, v114, v115
  v_cvt_pk_bf16_f32 v26, v116, v117
  v_cvt_pk_bf16_f32 v27, v118, v119
  v_exp_f32 v120, v120
  v_exp_f32 v121, v121
  s_waitcnt lgkmcnt(4)
  v_mfma_f32_32x32x16_bf16 v[96:111], v[36:39], v[92:95], v[96:111]
  v_exp_f32 v122, v122
  v_exp_f32 v123, v123
  v_exp_f32 v124, v124
  v_exp_f32 v125, v125
  v_exp_f32 v126, v126
  v_exp_f32 v127, v127
  v_cvt_pk_bf16_f32 v28, v120, v121
  v_cvt_pk_bf16_f32 v29, v122, v123
  v_cvt_pk_bf16_f32 v30, v124, v125
  v_cvt_pk_bf16_f32 v31, v126, v127
  buffer_load_dwordx4 v[172:175], v13, s[60:63], s90 offen offset:1824 sc1
  s_nop 0
  v_exp_f32 v96, v96
  v_exp_f32 v97, v97
  v_exp_f32 v98, v98
  v_exp_f32 v99, v99
  v_exp_f32 v100, v100
  v_exp_f32 v101, v101
  v_exp_f32 v102, v102
  v_exp_f32 v103, v103
  s_waitcnt lgkmcnt(2)
  v_mfma_f32_32x32x16_bf16 v[112:127], v[40:43], v[88:91], 0
  ds_read_b64 v[48:49], v237 offset:8192
  ds_read_b64 v[50:51], v237 offset:8704
  ds_read_b64 v[52:53], v237 offset:9216
  ds_read_b64 v[54:55], v237 offset:9728
  v_cvt_pk_bf16_f32 v32, v96, v97
  v_cvt_pk_bf16_f32 v33, v98, v99
  v_cvt_pk_bf16_f32 v34, v100, v101
  v_cvt_pk_bf16_f32 v35, v102, v103
  v_exp_f32 v104, v104
  v_exp_f32 v105, v105
  s_waitcnt lgkmcnt(4)
  v_mfma_f32_32x32x16_bf16 v[112:127], v[44:47], v[92:95], v[112:127]
  v_exp_f32 v106, v106
  v_exp_f32 v107, v107
  s_waitcnt vmcnt(3)
  s_barrier
  ds_read_b64_tr_b16 v[144:145], v238 offset:0
  ds_read_b64_tr_b16 v[146:147], v239 offset:0
  ds_read_b64_tr_b16 v[148:149], v240 offset:0
  ds_read_b64_tr_b16 v[150:151], v241 offset:0
  ds_read_b64_tr_b16 v[152:153], v238 offset:2048
  ds_read_b64_tr_b16 v[154:155], v239 offset:2048
  ds_read_b64_tr_b16 v[156:157], v240 offset:2048
  ds_read_b64_tr_b16 v[158:159], v241 offset:2048
  v_exp_f32 v108, v108
  v_exp_f32 v109, v109
  v_exp_f32 v110, v110
  v_exp_f32 v111, v111
  v_cvt_pk_bf16_f32 v36, v104, v105
  v_cvt_pk_bf16_f32 v37, v106, v107
  v_cvt_pk_bf16_f32 v38, v108, v109
  v_cvt_pk_bf16_f32 v39, v110, v111
  s_waitcnt lgkmcnt(0)
  v_mfma_f32_32x32x16_bf16 v[128:143], v[144:147], v[16:19], 0
  buffer_load_dwordx4 v[176:179], v13, s[60:63], s90 offen offset:1856 sc1
  v_exp_f32 v112, v112
  v_exp_f32 v113, v113
  v_exp_f32 v114, v114
  v_mfma_f32_32x32x16_bf16 v[128:143], v[148:151], v[20:23], v[128:143]
  v_exp_f32 v115, v115
  v_exp_f32 v116, v116
  v_exp_f32 v117, v117
  v_mfma_f32_32x32x16_bf16 v[128:143], v[152:155], v[24:27], v[128:143]
  ds_read_b64_tr_b16 v[184:185], v238 offset:4096
  ds_read_b64_tr_b16 v[186:187], v239 offset:4096
  ds_read_b64_tr_b16 v[188:189], v240 offset:4096
  ds_read_b64_tr_b16 v[190:191], v241 offset:4096
  v_exp_f32 v118, v118
  v_exp_f32 v119, v119
  v_mfma_f32_32x32x16_bf16 v[128:143], v[156:159], v[28:31], v[128:143]
  ds_read_b64_tr_b16 v[192:193], v238 offset:6144
  ds_read_b64_tr_b16 v[194:195], v239 offset:6144
  ds_read_b64_tr_b16 v[196:197], v240 offset:6144
  ds_read_b64_tr_b16 v[198:199], v241 offset:6144
  v_cvt_pk_bf16_f32 v40, v112, v113
  v_cvt_pk_bf16_f32 v41, v114, v115
  v_cvt_pk_bf16_f32 v42, v116, v117
  v_cvt_pk_bf16_f32 v43, v118, v119
  v_mfma_f32_32x32x16_bf16 v[96:111], v[48:51], v[88:91], 0
  ds_read_b64 v[56:57], v237 offset:10240
  ds_read_b64 v[58:59], v237 offset:10752
  ds_read_b64 v[60:61], v237 offset:11264
  ds_read_b64 v[62:63], v237 offset:11776
  v_exp_f32 v120, v120
  v_exp_f32 v121, v121
  v_exp_f32 v122, v122
  v_mfma_f32_32x32x16_bf16 v[96:111], v[52:55], v[92:95], v[96:111]
  v_exp_f32 v123, v123
  v_exp_f32 v124, v124
  v_exp_f32 v125, v125
L_hop_s0_to0:
  s_cbranch_execz L_hop_s0
  v_exp_f32 v126, v126
  v_exp_f32 v127, v127
  v_cvt_pk_bf16_f32 v44, v120, v121
  v_cvt_pk_bf16_f32 v45, v122, v123
  v_cvt_pk_bf16_f32 v46, v124, v125
  v_cvt_pk_bf16_f32 v47, v126, v127
  s_waitcnt lgkmcnt(4)
  v_mfma_f32_32x32x16_bf16 v[128:143], v[184:187], v[32:35], v[128:143]
  buffer_load_dwordx4 v[180:183], v12, s[60:63], s90 offen offset:1888 sc1
  v_exp_f32 v96, v96
  v_exp_f32 v97, v97
  v_exp_f32 v98, v98
  v_mfma_f32_32x32x16_bf16 v[128:143], v[188:191], v[36:39], v[128:143]
  v_exp_f32 v99, v99
  v_exp_f32 v100, v100
  v_exp_f32 v101, v101
  v_mfma_f32_32x32x16_bf16 v[128:143], v[192:195], v[40:43], v[128:143]
  ds_read_b64_tr_b16 v[144:145], v238 offset:8192
  ds_read_b64_tr_b16 v[146:147], v239 offset:8192
  ds_read_b64_tr_b16 v[148:149], v240 offset:8192
  ds_read_b64_tr_b16 v[150:151], v241 offset:8192
  v_exp_f32 v102, v102
  v_exp_f32 v103, v103
  v_mfma_f32_32x32x16_bf16 v[128:143], v[196:199], v[44:47], v[128:143]
  v_cvt_pk_bf16_f32 v48, v96, v97
  v_cvt_pk_bf16_f32 v49, v98, v99
  v_cvt_pk_bf16_f32 v50, v100, v101
  v_cvt_pk_bf16_f32 v51, v102, v103
  s_waitcnt lgkmcnt(6)
  v_mfma_f32_32x32x16_bf16 v[112:127], v[56:59], v[88:91], 0
  ds_read_b64 v[64:65], v237 offset:12288
  ds_read_b64 v[66:67], v237 offset:12800
  ds_read_b64 v[68:69], v237 offset:13312
  ds_read_b64 v[70:71], v237 offset:13824
  v_exp_f32 v104, v104
  v_exp_f32 v105, v105
  v_exp_f32 v106, v106
  s_waitcnt lgkmcnt(8)
  v_mfma_f32_32x32x16_bf16 v[112:127], v[60:63], v[92:95], v[112:127]
  v_exp_f32 v107, v107
  v_exp_f32 v108, v108
  v_exp_f32 v109, v109
  v_exp_f32 v110, v110
  v_exp_f32 v111, v111
  v_cvt_pk_bf16_f32 v52, v104, v105
  v_cvt_pk_bf16_f32 v53, v106, v107
  v_cvt_pk_bf16_f32 v54, v108, v109
  v_cvt_pk_bf16_f32 v55, v110, v111
  s_waitcnt lgkmcnt(4)
  v_mfma_f32_32x32x16_bf16 v[128:143], v[144:147], v[48:51], v[128:143]
  s_nop 0
  v_exp_f32 v112, v112
  v_exp_f32 v113, v113
  v_exp_f32 v114, v114
  v_exp_f32 v115, v115
  v_mfma_f32_32x32x16_bf16 v[128:143], v[148:151], v[52:55], v[128:143]
  ds_read_b64_tr_b16 v[152:153], v238 offset:10240
  ds_read_b64_tr_b16 v[154:155], v239 offset:10240
  ds_read_b64_tr_b16 v[156:157], v240 offset:10240
  ds_read_b64_tr_b16 v[158:159], v241 offset:10240
  v_exp_f32 v116, v116
  v_exp_f32 v117, v117
  v_exp_f32 v118, v118
  v_exp_f32 v119, v119
  s_waitcnt lgkmcnt(6)
  v_mfma_f32_32x32x16_bf16 v[96:111], v[64:67], v[88:91], 0
  ds_read_b64 v[72:73], v237 offset:14336
  ds_read_b64 v[74:75], v237 offset:14848
  ds_read_b64 v[76:77], v237 offset:15360
  ds_read_b64 v[78:79], v237 offset:15872
  v_cvt_pk_bf16_f32 v56, v112, v113
  v_cvt_pk_bf16_f32 v57, v114, v115
  v_cvt_pk_bf16_f32 v58, v116, v117
  v_cvt_pk_bf16_f32 v59, v118, v119
  v_exp_f32 v120, v120
  v_exp_f32 v121, v121
  v_exp_f32 v122, v122
  s_waitcnt lgkmcnt(8)
  v_mfma_f32_32x32x16_bf16 v[96:111], v[68:71], v[92:95], v[96:111]
  v_exp_f32 v123, v123
  v_exp_f32 v124, v124
  v_exp_f32 v125, v125
  v_exp_f32 v126, v126
  v_exp_f32 v127, v127
  v_cvt_pk_bf16_f32 v60, v120, v121
  v_cvt_pk_bf16_f32 v61, v122, v123
  v_cvt_pk_bf16_f32 v62, v124, v125
  v_cvt_pk_bf16_f32 v63, v126, v127
  s_waitcnt lgkmcnt(4)
  v_mfma_f32_32x32x16_bf16 v[128:143], v[152:155], v[56:59], v[128:143]
  s_nop 0
  v_exp_f32 v96, v96
  v_exp_f32 v97, v97
  v_exp_f32 v98, v98
  v_exp_f32 v99, v99
  v_mfma_f32_32x32x16_bf16 v[128:143], v[156:159], v[60:63], v[128:143]
  ds_read_b64_tr_b16 v[184:185], v238 offset:12288
  ds_read_b64_tr_b16 v[186:187], v239 offset:12288
  ds_read_b64_tr_b16 v[188:189], v240 offset:12288
  ds_read_b64_tr_b16 v[190:191], v241 offset:12288
  v_exp_f32 v100, v100
  v_exp_f32 v101, v101
  v_exp_f32 v102, v102
  v_exp_f32 v103, v103
  s_waitcnt lgkmcnt(6)
  v_mfma_f32_32x32x16_bf16 v[112:127], v[72:75], v[88:91], 0
  v_cvt_pk_bf16_f32 v64, v96, v97
  v_cvt_pk_bf16_f32 v65, v98, v99
  v_cvt_pk_bf16_f32 v66, v100, v101
  v_cvt_pk_bf16_f32 v67, v102, v103
  v_exp_f32 v104, v104
  v_exp_f32 v105, v105
  v_exp_f32 v106, v106
  s_waitcnt lgkmcnt(4)
  v_mfma_f32_32x32x16_bf16 v[112:127], v[76:79], v[92:95], v[112:127]
  v_exp_f32 v107, v107
  v_exp_f32 v108, v108
  v_exp_f32 v109, v109
  v_exp_f32 v110, v110
  v_exp_f32 v111, v111
  v_cvt_pk_bf16_f32 v68, v104, v105
  v_cvt_pk_bf16_f32 v69, v106, v107
  v_cvt_pk_bf16_f32 v70, v108, v109
  v_cvt_pk_bf16_f32 v71, v110, v111
  s_waitcnt lgkmcnt(0)
  v_mfma_f32_32x32x16_bf16 v[128:143], v[184:187], v[64:67], v[128:143]
  s_nop 0
  v_exp_f32 v112, v112
  v_exp_f32 v113, v113
  v_exp_f32 v114, v114
  v_exp_f32 v115, v115
  v_mfma_f32_32x32x16_bf16 v[128:143], v[188:191], v[68:71], v[128:143]
  ds_read_b64_tr_b16 v[192:193], v238 offset:14336
  ds_read_b64_tr_b16 v[194:195], v239 offset:14336
  ds_read_b64_tr_b16 v[196:197], v240 offset:14336
  ds_read_b64_tr_b16 v[198:199], v241 offset:14336
  v_exp_f32 v116, v116
  v_exp_f32 v117, v117
  v_exp_f32 v118, v118
  v_exp_f32 v119, v119
  v_mfma_f32_32x32x16_bf16 v[96:111], v[80:83], v[88:91], v[200:215]
  v_cvt_pk_bf16_f32 v72, v112, v113
  v_cvt_pk_bf16_f32 v73, v114, v115
  v_cvt_pk_bf16_f32 v74, v116, v117
  v_cvt_pk_bf16_f32 v75, v118, v119
  v_exp_f32 v120, v120
  v_exp_f32 v121, v121
  v_exp_f32 v122, v122
  v_mfma_f32_32x32x16_bf16 v[96:111], v[84:87], v[92:95], v[96:111]
  v_exp_f32 v123, v123
  v_exp_f32 v124, v124
  v_exp_f32 v125, v125
  v_exp_f32 v126, v126
  v_exp_f32 v127, v127
  v_cvt_pk_bf16_f32 v76, v120, v121
  v_cvt_pk_bf16_f32 v77, v122, v123
  v_cvt_pk_bf16_f32 v78, v124, v125
  v_cvt_pk_bf16_f32 v79, v126, v127
  s_waitcnt lgkmcnt(0)
  v_mfma_f32_32x32x16_bf16 v[128:143], v[192:195], v[72:75], v[128:143]
  s_nop 0
  v_exp_f32 v96, v96
  v_exp_f32 v97, v97
  v_exp_f32 v98, v98
  v_exp_f32 v99, v99
  v_mfma_f32_32x32x16_bf16 v[128:143], v[196:199], v[76:79], v[128:143]
  ds_read_b64_tr_b16 v[144:145], v238 offset:16384
  ds_read_b64_tr_b16 v[146:147], v239 offset:16384
  ds_read_b64_tr_b16 v[148:149], v240 offset:16384
  ds_read_b64_tr_b16 v[150:151], v241 offset:16384
  v_exp_f32 v100, v100
  v_exp_f32 v101, v101
  v_exp_f32 v102, v102
  v_exp_f32 v103, v103
  v_cvt_pk_bf16_f32 v80, v96, v97
  v_cvt_pk_bf16_f32 v81, v98, v99
  v_cvt_pk_bf16_f32 v82, v100, v101
  v_cvt_pk_bf16_f32 v83, v102, v103
  v_exp_f32 v104, v104
  v_exp_f32 v105, v105
  v_exp_f32 v106, v106
  v_exp_f32 v107, v107
  v_exp_f32 v108, v108
  v_exp_f32 v109, v109
  v_exp_f32 v110, v110
  v_exp_f32 v111, v111
  v_cvt_pk_bf16_f32 v84, v104, v105
  v_cvt_pk_bf16_f32 v85, v106, v107
  v_cvt_pk_bf16_f32 v86, v108, v109
  v_cvt_pk_bf16_f32 v87, v110, v111
  s_waitcnt lgkmcnt(2)
  v_mfma_f32_32x32x16_bf16 v[128:143], v[144:147], v[80:83], v[128:143]
  s_waitcnt lgkmcnt(0)
  v_mfma_f32_32x32x16_bf16 v[128:143], v[148:151], v[84:87], v[128:143]
  s_lshl_b32 s15, s86, 7
  s_add_u32 s15, s15, s12
  s_add_u32 s15, s15, s93
  s_waitcnt vmcnt(1)
  v_min3_u32 v10, v168, v172, v176
  s_waitcnt vmcnt(0)
  v_min_u32 v10, v10, v180
  v_cmp_eq_u32 vcc, 0, v10
  s_cbranch_vccnz L_sf_rr_67
L_sf_rb_68:
  s_nop 2
  v_mov_b32 v10, v140
  v_mov_b32 v11, v140
  s_nop 1
  v_permlane32_swap_b32 v10, v11
  v_cmp_ngt_f32 vcc, 0x5f800000, v11
  s_cbranch_vccnz L_sf_fb_65
L_sf_fbb_66:
  v_rcp_f32 v10, v11
  s_mov_b32 exec_lo, 0
  v_mov_b32 v140, 0
  s_mov_b32 exec_lo, -1
  v_pk_mul_f32 v[12:13], v[128:129], v[168:169]
  v_pk_mul_f32 v[128:129], v[128:129], v[10:11] op_sel_hi:[1,0]
  v_pk_fma_f32 v[12:13], v[130:131], v[170:171], v[12:13]
  v_pk_mul_f32 v[130:131], v[130:131], v[10:11] op_sel_hi:[1,0]
  v_pk_fma_f32 v[12:13], v[132:133], v[172:173], v[12:13]
  v_pk_mul_f32 v[132:133], v[132:133], v[10:11] op_sel_hi:[1,0]
  v_pk_fma_f32 v[12:13], v[134:135], v[174:175], v[12:13]
  v_pk_mul_f32 v[134:135], v[134:135], v[10:11] op_sel_hi:[1,0]
  v_pk_fma_f32 v[12:13], v[136:137], v[176:177], v[12:13]
  v_pk_mul_f32 v[136:137], v[136:137], v[10:11] op_sel_hi:[1,0]
  v_pk_fma_f32 v[12:13], v[138:139], v[178:179], v[12:13]
  v_pk_mul_f32 v[138:139], v[138:139], v[10:11] op_sel_hi:[1,0]
  v_pk_fma_f32 v[12:13], v[140:141], v[180:181], v[12:13]
  v_pk_mul_f32 v[140:141], v[140:141], v[10:11] op_sel_hi:[1,0]
  v_pk_fma_f32 v[12:13], v[142:143], v[182:183], v[12:13]
  v_pk_mul_f32 v[142:143], v[142:143], v[10:11] op_sel_hi:[1,0]
  v_add_f32 v12, v12, v13
  v_mul_f32 v12, v12, v10
  v_mov_b32 v13, v12
  v_cvt_pk_bf16_f32 v144, v128, v129
  v_cvt_pk_bf16_f32 v145, v130, v131
  v_permlane32_swap_b32 v12, v13
  v_cvt_pk_bf16_f32 v146, v132, v133
  v_cvt_pk_bf16_f32 v147, v134, v135
  v_cvt_pk_bf16_f32 v148, v136, v137
  v_cvt_pk_bf16_f32 v149, v138, v139
  v_cvt_pk_bf16_f32 v150, v140, v141
  v_cvt_pk_bf16_f32 v151, v142, v143
  s_mov_b32 exec_lo, 0
  v_add_f32 v150, v12, v13
  s_mov_b32 exec_lo, -1
  buffer_store_dwordx4 v[144:147], v1, s[60:63], s88 offen offset:0
  buffer_store_dwordx4 v[148:151], v1, s[60:63], s88 offen offset:1024
  s_waitcnt vmcnt(0)
  buffer_store_byte v5, v4, s[60:63], s15 offen offset:3072
  s_mov_b64 s[32:33], s[72:73]
  s_mov_b32 s34, 0x188000
  s_mov_b32 s35, 0x20000
  s_mov_b64 s[36:37], s[74:75]
  s_mov_b32 s38, 0x188000
  s_mov_b32 s39, 0x20000
  s_mul_i32 s14, s4, 1683456
  s_add_u32 s14, s14, 1654784
  s_mul_i32 s15, s3, 10
  v_min_u32 v252, 9, v0
  v_add_lshl_u32 v252, v252, s15, 7
  buffer_load_dword v253, v252, s[60:63], s14 offen
  buffer_load_dword v253, v254, s[52:55], 0 offen
  s_mul_i32 s14, s4, 0
  s_add_u32 s14, s14, 1792
  s_mul_i32 s15, s3, 14336
  s_add_u32 s14, s14, s15
  v_min_u32 v252, 12416, v255
  buffer_load_dword v253, v252, s[32:35], s14 offen
  s_waitcnt vmcnt(1)
L_sf_pfs_70:
  s_mul_i32 s14, s4, 0
  s_add_u32 s14, s14, 1792
  s_mul_i32 s15, s3, 14336
  s_add_u32 s14, s14, s15
  v_min_u32 v252, 12416, v255
  buffer_load_dword v253, v252, s[36:39], s14 offen
  s_waitcnt vmcnt(1)
L_sf_pfs_71:
  s_mul_i32 s14, s4, 200704
  s_add_u32 s14, s14, 1792
  s_mul_i32 s15, s3, 14336
  s_add_u32 s14, s14, s15
  v_min_u32 v252, 12416, v255
  buffer_load_dword v253, v252, s[32:35], s14 offen
  s_waitcnt vmcnt(1)
L_sf_pfs_72:
  s_mul_i32 s14, s4, 200704
  s_add_u32 s14, s14, 1792
  s_mul_i32 s15, s3, 14336
  s_add_u32 s14, s14, s15
  v_min_u32 v252, 12416, v255
  buffer_load_dword v253, v252, s[36:39], s14 offen
  s_waitcnt vmcnt(1)
L_sf_pfs_73:
  s_mul_i32 s14, s4, 200704
  s_add_u32 s14, s14, 0
  s_mul_i32 s15, s3, 49
  v_min_u32 v252, 48, v0
  v_add_lshl_u32 v252, v252, s15, 7
  buffer_load_dword v253, v252, s[48:51], s14 offen
  s_waitcnt vmcnt(1)
L_sf_pfs_74:
  s_mul_i32 s14, s4, 200704
  s_add_u32 s14, s14, 100352
  s_mul_i32 s15, s3, 49
  v_min_u32 v252, 48, v0
  v_add_lshl_u32 v252, v252, s15, 7
  buffer_load_dword v253, v252, s[48:51], s14 offen
  s_waitcnt vmcnt(1)
L_sf_pfs_75:
  s_endpgm
L_ool:
L_wf_b2r_2:
  s_mov_b32 s27, 200000
L_wf_b2l_6:
  buffer_load_dword v248, v3, s[56:59], 0 offen sc1
  s_waitcnt vmcnt(0)
  v_readlane_b32 s14, v248, s4
  s_cmp_lg_u32 s14, 0
  s_cbranch_scc1 L_wf_b2b_3
  s_sub_u32 s27, s27, 1
  s_cmp_lg_u32 s27, 0
  s_cbranch_scc1 L_wf_b2l_6
  s_branch L_wf_b2b_3
L_wf_b2d_4:
  s_lshl_b32 s15, s4, 2
  buffer_store_dword v5, v4, s[56:59], s15 offen offset:32 sc1
  s_branch L_wf_b2o_5
L_wf_b3r_7:
  s_mov_b32 s27, 200000
  s_add_u32 s16, s4, 8
L_wf_b3l_9:
  buffer_load_dword v249, v250, s[60:63], s93 offen sc1
  s_waitcnt vmcnt(0)
  v_cmp_ne_u32 vcc, 0x01010101, v249
  s_cbranch_vccz L_wf_b3b_8
  buffer_load_dword v249, v3, s[56:59], 0 offen sc1
  s_waitcnt vmcnt(0)
  v_readlane_b32 s14, v249, s16
  s_cmp_lg_u32 s14, 0
  s_cbranch_scc1 L_worker_slow
  s_sub_u32 s27, s27, 1
  s_cmp_lg_u32 s27, 0
  s_cbranch_scc1 L_wf_b3l_9
  s_branch L_worker_slow
L_wf_rr_10:
  s_mov_b32 s27, 200000
L_wf_rl_12:
  buffer_load_dword v248, v3, s[56:59], 0 offen sc1
  s_waitcnt vmcnt(0)
  v_cmp_eq_u32 vcc, 0, v248
  s_and_b64 vcc, vcc, s[28:29]
  s_cbranch_vccz L_wf_rb_11
  s_sub_u32 s27, s27, 1
  s_cmp_lg_u32 s27, 0
  s_cbranch_scc1 L_wf_rl_12
  s_branch L_wf_rb_11
L_wf_rr_13:
  s_mov_b32 s27, 200000
L_wf_rl_15:
  buffer_load_dword v243, v236, s[60:63], 0 offen sc1
  s_waitcnt vmcnt(0)
  v_cmp_ne_u32 vcc, 1, v243
  s_and_b64 vcc, vcc, 0x3f
  s_cbranch_vccz L_wf_rb_14
  s_sub_u32 s27, s27, 1
  s_cmp_lg_u32 s27, 0
  s_cbranch_scc1 L_wf_rl_15
  s_branch L_wf_rb_14
L_wf_rr_16:
  s_mov_b32 s27, 200000
L_wf_rl_18:
  buffer_load_dword v249, v242, s[60:63], 0 offen sc1
  s_waitcnt vmcnt(0)
  v_cmp_ne_u32 vcc, 1, v249
  s_cbranch_vccz L_wf_rb_17
  s_sub_u32 s27, s27, 1
  s_cmp_lg_u32 s27, 0
  s_cbranch_scc1 L_wf_rl_18
  s_branch L_wf_rb_17
L_wf_rr_21:
  s_mov_b32 s27, 200000
L_wf_rl_23:
  buffer_load_dwordx4 v[168:171], v13, s[60:63], s90 offen offset:1792 sc1
  buffer_load_dwordx4 v[172:175], v13, s[60:63], s90 offen offset:1824 sc1
  buffer_load_dwordx4 v[176:179], v13, s[60:63], s90 offen offset:1856 sc1
  buffer_load_dwordx4 v[180:183], v12, s[60:63], s90 offen offset:1888 sc1
  s_waitcnt vmcnt(0)
  v_min3_u32 v10, v168, v172, v176
  v_min_u32 v10, v10, v180
  v_cmp_eq_u32 vcc, 0, v10
  s_cbranch_vccz L_wf_rb_22
  s_sub_u32 s27, s27, 1
  s_cmp_lg_u32 s27, 0
  s_cbranch_scc1 L_wf_rl_23
  s_branch L_wf_rb_22
L_wf_rr_26:
  s_mov_b32 s27, 200000
L_wf_rl_28:
  buffer_load_dword v243, v250, s[60:63], s93 offen offset:128 sc1
  s_waitcnt vmcnt(0)
  v_cmp_ne_u32 vcc, 1, v243
  s_cbranch_vccz L_wf_rb_27
  s_sub_u32 s27, s27, 1
  s_cmp_lg_u32 s27, 0
  s_cbranch_scc1 L_wf_rl_28
  s_branch L_wf_rb_27
L_wf_rr_31:
  s_mov_b32 s27, 200000
L_wf_rl_33:
  buffer_load_dword v187, v166, s[60:63], s91 offen offset:3136 sc1
  s_waitcnt vmcnt(0)
  v_cmp_ne_u32 vcc, v188, v187
  s_cbranch_vccz L_wf_rb_32
  s_sub_u32 s27, s27, 1
  s_cmp_lg_u32 s27, 0
  s_cbranch_scc1 L_wf_rl_33
  s_branch L_wf_rb_32
L_wf_rr_34:
  s_mov_b32 s27, 200000
L_wf_rl_36:
  buffer_load_dword v187, v186, s[60:63], s65 offen offset:2048 sc1
  s_waitcnt vmcnt(0)
  v_cmp_ne_u32 vcc, v188, v187
  s_and_b64 vcc, vcc, 0xf0f
  s_cbranch_vccz L_wf_rb_35
  s_sub_u32 s27, s27, 1
  s_cmp_lg_u32 s27, 0
  s_cbranch_scc1 L_wf_rl_36
  s_branch L_wf_rb_35
L_wf_rr_37:
  s_mov_b32 s27, 200000
L_wf_rl_39:
  buffer_load_dword v187, v186, s[60:63], s65 offen offset:2048 sc1
  s_waitcnt vmcnt(0)
  v_cmp_ne_u32 vcc, v188, v187
  s_and_b64 vcc, vcc, 0xf0
  s_cbranch_vccz L_wf_rb_38
  s_sub_u32 s27, s27, 1
  s_cmp_lg_u32 s27, 0
  s_cbranch_scc1 L_wf_rl_39
  s_branch L_wf_rb_38
L_wf_rr_40:
  s_mov_b32 s27, 200000
L_wf_rl_42:
  buffer_load_dword v187, v186, s[60:63], s65 offen offset:2048 sc1
  s_waitcnt vmcnt(0)
  v_cmp_ne_u32 vcc, v188, v187
  s_and_b64 vcc, vcc, 0xf000
  s_cbranch_vccz L_wf_rb_41
  s_sub_u32 s27, s27, 1
  s_cmp_lg_u32 s27, 0
  s_cbranch_scc1 L_wf_rl_42
  s_branch L_wf_rb_41
L_sf_b2r_45:
  s_mov_b32 s27, 200000
L_sf_b2l_49:
  buffer_load_dword v248, v3, s[56:59], 0 offen sc1
  s_waitcnt vmcnt(0)
  v_readlane_b32 s14, v248, s4
  s_cmp_lg_u32 s14, 0
  s_cbranch_scc1 L_sf_b2b_46
  s_sub_u32 s27, s27, 1
  s_cmp_lg_u32 s27, 0
  s_cbranch_scc1 L_sf_b2l_49
  s_branch L_sf_b2b_46
L_sf_b2d_47:
  s_lshl_b32 s15, s4, 2
  buffer_store_dword v5, v4, s[56:59], s15 offen offset:32 sc1
  s_branch L_sf_b2o_48
L_sf_b3r_51:
  s_mov_b32 s27, 200000
  s_add_u32 s16, s4, 8
L_sf_b3l_53:
  buffer_load_dword v249, v250, s[60:63], s93 offen sc1
  s_waitcnt vmcnt(0)
  v_cmp_ne_u32 vcc, 0x01010101, v249
  s_cbranch_vccz L_sf_b3b_52
  buffer_load_dword v249, v3, s[56:59], 0 offen sc1
  s_waitcnt vmcnt(0)
  v_readlane_b32 s14, v249, s16
  s_cmp_lg_u32 s14, 0
  s_cbranch_scc1 L_spare_slow
  s_sub_u32 s27, s27, 1
  s_cmp_lg_u32 s27, 0
  s_cbranch_scc1 L_sf_b3l_53
  s_branch L_spare_slow
L_sf_rr_56:
  s_mov_b32 s27, 200000
L_sf_rl_58:
  buffer_load_dword v248, v3, s[56:59], 0 offen sc1
  s_waitcnt vmcnt(0)
  v_cmp_eq_u32 vcc, 0, v248
  s_and_b64 vcc, vcc, s[28:29]
  s_cbranch_vccz L_sf_rb_57
  s_sub_u32 s27, s27, 1
  s_cmp_lg_u32 s27, 0
  s_cbranch_scc1 L_sf_rl_58
  s_branch L_sf_rb_57
L_sf_rr_59:
  s_mov_b32 s27, 200000
L_sf_rl_61:
  buffer_load_dword v243, v236, s[60:63], 0 offen sc1
  s_waitcnt vmcnt(0)
  v_cmp_ne_u32 vcc, 1, v243
  s_and_b64 vcc, vcc, 0x3f
  s_cbranch_vccz L_sf_rb_60
  s_sub_u32 s27, s27, 1
  s_cmp_lg_u32 s27, 0
  s_cbranch_scc1 L_sf_rl_61
  s_branch L_sf_rb_60
L_sf_rr_62:
  s_mov_b32 s27, 200000
L_sf_rl_64:
  buffer_load_dword v249, v242, s[60:63], 0 offen sc1
  s_waitcnt vmcnt(0)
  v_cmp_ne_u32 vcc, 1, v249
  s_cbranch_vccz L_sf_rb_63
  s_sub_u32 s27, s27, 1
  s_cmp_lg_u32 s27, 0
  s_cbranch_scc1 L_sf_rl_64
  s_branch L_sf_rb_63
L_sf_rr_67:
  s_mov_b32 s27, 200000
L_sf_rl_69:
  buffer_load_dwordx4 v[168:171], v13, s[60:63], s90 offen offset:1792 sc1
  buffer_load_dwordx4 v[172:175], v13, s[60:63], s90 offen offset:1824 sc1
  buffer_load_dwordx4 v[176:179], v13, s[60:63], s90 offen offset:1856 sc1
  buffer_load_dwordx4 v[180:183], v12, s[60:63], s90 offen offset:1888 sc1
  s_waitcnt vmcnt(0)
  v_min3_u32 v10, v168, v172, v176
  v_min_u32 v10, v10, v180
  v_cmp_eq_u32 vcc, 0, v10
  s_cbranch_vccz L_sf_rb_68
  s_sub_u32 s27, s27, 1
  s_cmp_lg_u32 s27, 0
  s_cbranch_scc1 L_sf_rl_69
  s_branch L_sf_rb_68
L_end:
  s_endpgm
L_worker_slow:
  s_waitcnt lgkmcnt(6)
  v_mfma_f32_32x32x16_bf16 v[184:199], v[128:131], v[48:51], v[184:199]
  buffer_store_dword v5, v4, s[60:63], s64 offen offset:768 sc1
  ds_read_b64_tr_b16 v[148:149], v15 offset:43008
  ds_read_b64_tr_b16 v[150:151], v15 offset:43520
  v_mfma_f32_32x32x16_bf16 v[184:199], v[132:135], v[52:55], v[184:199]
  buffer_load_dwordx4 v231, s[44:47], s25 offen offset:3072 lds
  ds_read_b64_tr_b16 v[152:153], v15 offset:45056
  ds_read_b64_tr_b16 v[154:155], v15 offset:45568
  s_waitcnt lgkmcnt(6)
  v_mfma_f32_32x32x16_bf16 v[184:199], v[136:139], v[56:59], v[184:199]
  s_add_u32 m0, s99, 8192
  s_mov_b32 s25, 458752
  buffer_load_dwordx4 v228, s[44:47], s25 offen offset:0 lds
  ds_read_b64_tr_b16 v[156:157], v15 offset:47104
  ds_read_b64_tr_b16 v[158:159], v15 offset:47616
  v_mfma_f32_32x32x16_bf16 v[184:199], v[140:143], v[60:63], v[184:199]
  s_waitcnt vmcnt(15)
  s_barrier
  ds_read_b64_tr_b16 v[128:129], v15 offset:49152
  ds_read_b64_tr_b16 v[130:131], v15 offset:49664
  ds_read_b64 v[244:245], v170 offset:57344
  ds_read_b64 v[246:247], v171 offset:57344
  ds_read_b64 v[252:253], v172 offset:57344
  s_waitcnt lgkmcnt(9)
  v_mfma_f32_32x32x16_bf16 v[184:199], v[144:147], v[64:67], v[184:199]
  buffer_load_dwordx4 v229, s[44:47], s25 offen offset:1024 lds
  ds_read_b64_tr_b16 v[132:133], v15 offset:51200
  ds_read_b64_tr_b16 v[134:135], v15 offset:51712
  ds_read_b64 v[254:255], v173 offset:57344
  v_lshrrev_b32 v10, 5, v0
  v_mul_u32_u24 v13, 24832, v10
  v_mfma_f32_32x32x16_bf16 v[184:199], v[148:151], v[68:71], v[184:199]
  buffer_store_dword v5, v4, s[60:63], s64 offen offset:1280 sc1
  ds_read_b64_tr_b16 v[136:137], v15 offset:53248
  ds_read_b64_tr_b16 v[138:139], v15 offset:53760
  v_sub_u32 v13, v237, v13
  v_and_b32 v11, 31, v0
  v_mad_i32_i24 v11, v10, -4, v11
  s_waitcnt lgkmcnt(10)
  v_mfma_f32_32x32x16_bf16 v[184:199], v[152:155], v[72:75], v[184:199]
  buffer_load_dwordx4 v230, s[44:47], s25 offen offset:2048 lds
  ds_read_b64_tr_b16 v[140:141], v15 offset:55296
  ds_read_b64_tr_b16 v[142:143], v15 offset:55808
  v_mov_b32 v12, 0xf149f2ca
  s_cmp_eq_u32 s4, 0
  s_cselect_b32 s15, 0xf1490000, 0
  s_or_b32 s15, s15, 0x3f80
  v_mfma_f32_32x32x16_bf16 v[184:199], v[156:159], v[76:79], v[184:199]
  ds_read_b64_tr_b16 v[144:145], v14 offset:0
  ds_read_b64_tr_b16 v[146:147], v14 offset:512
  s_cmp_eq_u32 s13, 0
  s_cselect_b32 s17, s15, 0x3f80
  v_mov_b32 v160, 0x3f803f80
  s_waitcnt lgkmcnt(7)
  v_mfma_f32_32x32x16_bf16 v[184:199], v[128:131], v[80:83], v[184:199]
  buffer_load_dwordx4 v231, s[44:47], s25 offen offset:3072 lds
  ds_read_b64_tr_b16 v[148:149], v14 offset:2048
  ds_read_b64_tr_b16 v[150:151], v14 offset:2560
  v_mov_b32 v161, s15
  v_mov_b32 v162, 0x3f803f80
  v_mov_b32 v163, s17
  v_mfma_f32_32x32x16_bf16 v[184:199], v[132:135], v[84:87], v[184:199]
  s_add_u32 s16, s4, 7
  s_and_b32 s16, s16, 7
  s_lshl_b64 s[28:29], 1, s16
  s_lshr_b32 s16, s12, 1
  s_bitset1_b32 s28, s16
  s_add_u32 s16, s4, 1
  s_and_b32 s16, s16, 7
  s_bitset1_b32 s28, s16
  v_cmp_eq_u32 vcc, 0, v248
  s_and_b64 vcc, vcc, s[28:29]
  s_cbranch_vccnz L_ws_rr_85
L_ws_rb_86:
  buffer_load_dword v243, v236, s[60:63], 0 offen sc1
  ds_read_b64_tr_b16 v[152:153], v14 offset:4096
  ds_read_b64_tr_b16 v[154:155], v14 offset:4608
  v_mov_b32 v164, 0x3f803f80
  v_mov_b32 v165, 0x3f80
  s_mov_b32 exec_lo, 0
  v_mov_b32 v160, 0x3f80
  v_mov_b32 v161, 0
  s_mov_b32 exec_lo, -1
  s_waitcnt lgkmcnt(6)
  v_mfma_f32_32x32x16_bf16 v[184:199], v[136:139], v[88:91], v[184:199]
  s_add_u32 m0, s99, 12288
  s_mov_b32 s25, 688128
  buffer_load_dwordx4 v228, s[44:47], s25 offen offset:0 lds
  ds_read_b64_tr_b16 v[156:157], v14 offset:6144
  ds_read_b64_tr_b16 v[158:159], v14 offset:6656
  s_mov_b32 exec_lo, 0
  v_mov_b32 v162, 0x3f80
  v_mov_b32 v163, 0
  s_mov_b32 exec_lo, -1
  v_mfma_f32_32x32x16_bf16 v[184:199], v[140:143], v[92:95], v[184:199]
  ds_read_b64_tr_b16 v[128:129], v14 offset:8192
  ds_read_b64_tr_b16 v[130:131], v14 offset:8704
  s_mov_b32 exec_lo, 0
  v_mov_b32 v164, 0x3f80
  v_mov_b32 v165, 0
  s_mov_b32 exec_lo, -1
  s_waitcnt lgkmcnt(6)
  v_mfma_f32_32x32x16_bf16 v[184:199], v[144:147], v[96:99], v[184:199]
  buffer_load_dwordx4 v229, s[44:47], s25 offen offset:1024 lds
  ds_read_b64_tr_b16 v[132:133], v14 offset:10240
  ds_read_b64_tr_b16 v[134:135], v14 offset:10752
  v_bfe_u32 v167, v0, 4, 1
  v_bfe_u32 v166, v0, 3, 1
  v_lshl_add_u32 v166, v167, 1, v166
  v_mfma_f32_32x32x16_bf16 v[184:199], v[148:151], v[100:103], v[184:199]
  ds_read_b64_tr_b16 v[136:137], v14 offset:12288
  ds_read_b64_tr_b16 v[138:139], v14 offset:12800
  v_xor_b32 v166, s6, v166
  v_lshlrev_b32 v166, 5, v166
  v_mul_u32_u24 v167, 28672, v167
  s_waitcnt lgkmcnt(6)
  v_mfma_f32_32x32x16_bf16 v[184:199], v[152:155], v[104:107], v[184:199]
  ds_read_b64_tr_b16 v[140:141], v14 offset:14336
  ds_read_b64_tr_b16 v[142:143], v14 offset:14848
  v_add_u32 v166, v167, v166
  v_and_b32 v167, 0x198, v6
  v_add_u32 v166, v167, v166
  v_mfma_f32_32x32x16_bf16 v[184:199], v[156:159], v[108:111], v[184:199]
  v_lshrrev_b32 v167, 5, v0
  v_lshl_add_u32 v166, v167, 9, v166
  v_cmp_le_i32 s[30:31], 0, v11
  s_nop 1
  v_cndmask_b32 v200, v12, 0, s[30:31]
  v_cmp_le_i32 s[30:31], 1, v11
  s_waitcnt lgkmcnt(4)
  v_mfma_f32_32x32x16_bf16 v[184:199], v[128:131], v[112:115], v[184:199]
  v_sub_f32 v168, v12, v200
  v_cndmask_b32 v201, v12, 0, s[30:31]
  v_cmp_le_i32 s[30:31], 2, v11
  v_sub_f32 v169, v12, v201
  s_nop 0
  v_cndmask_b32 v202, v12, 0, s[30:31]
  v_mfma_f32_32x32x16_bf16 v[184:199], v[132:135], v[116:119], v[184:199]
  v_cmp_le_i32 s[30:31], 3, v11
  v_sub_f32 v170, v12, v202
  s_nop 0
  v_cndmask_b32 v203, v12, 0, s[30:31]
  v_cmp_le_i32 s[30:31], 8, v11
  v_sub_f32 v171, v12, v203
  s_waitcnt lgkmcnt(0)
  v_mfma_f32_32x32x16_bf16 v[184:199], v[136:139], v[120:123], v[184:199]
  v_cndmask_b32 v204, v12, 0, s[30:31]
  v_cmp_le_i32 s[30:31], 9, v11
  v_sub_f32 v172, v12, v204
  s_nop 0
  v_cndmask_b32 v205, v12, 0, s[30:31]
  v_cmp_le_i32 s[30:31], 10, v11
  v_mfma_f32_32x32x16_bf16 v[184:199], v[140:143], v[124:127], v[184:199]
  s_waitcnt vmcnt(10)
  buffer_store_dword v5, v4, s[60:63], s66 offen sc1
  v_sub_f32 v173, v12, v205
  v_cndmask_b32 v206, v12, 0, s[30:31]
  v_cmp_le_i32 s[30:31], 11, v11
  v_sub_f32 v174, v12, v206
  s_nop 0
  v_cndmask_b32 v207, v12, 0, s[30:31]
  s_nop 3
  v_pk_mul_f32 v[184:185], v[184:185], s[18:19] op_sel_hi:[1,0]
  v_pk_mul_f32 v[186:187], v[186:187], s[18:19] op_sel_hi:[1,0]
  v_pk_mul_f32 v[188:189], v[188:189], s[18:19] op_sel_hi:[1,0]
  v_pk_mul_f32 v[190:191], v[190:191], s[18:19] op_sel_hi:[1,0]
  v_pk_mul_f32 v[192:193], v[192:193], s[18:19] op_sel_hi:[1,0]
  v_pk_mul_f32 v[194:195], v[194:195], s[18:19] op_sel_hi:[1,0]
  v_pk_mul_f32 v[196:197], v[196:197], s[18:19] op_sel_hi:[1,0]
  v_pk_mul_f32 v[198:199], v[198:199], s[18:19] op_sel_hi:[1,0]
  v_cvt_pk_bf16_f32 v216, v184, v185
  v_cvt_pk_bf16_f32 v217, v186, v187
  v_cvt_pk_bf16_f32 v218, v188, v189
  v_cvt_pk_bf16_f32 v219, v190, v191
  v_cvt_pk_bf16_f32 v220, v192, v193
  v_cvt_pk_bf16_f32 v221, v194, v195
  v_cvt_pk_bf16_f32 v222, v196, v197
  v_cvt_pk_bf16_f32 v223, v198, v199
  s_add_u32 s19, s10, 0x0
  buffer_store_dwordx2 v[216:217], v232, s[60:63], s19 offen sc1
  buffer_store_dwordx2 v[218:219], v233, s[60:63], s19 offen sc1
  buffer_store_dwordx2 v[220:221], v234, s[60:63], s19 offen sc1
  buffer_store_dwordx2 v[222:223], v235, s[60:63], s19 offen sc1
  s_waitcnt vmcnt(7)
  v_cmp_ne_u32 vcc, 1, v243
  s_and_b64 vcc, vcc, 0x3f
  s_cbranch_vccnz L_ws_rr_88
L_ws_rb_89:
  s_add_u32 m0, s24, 81920
  s_nop 0
  buffer_load_dwordx4 v1, s[60:63], s68 offen offset:0 sc1 lds
  v_cmp_le_i32 s[30:31], 16, v11
  v_sub_f32 v175, v12, v207
  s_nop 0
  v_cndmask_b32 v208, v12, 0, s[30:31]
  v_cmp_le_i32 s[30:31], 17, v11
  s_add_u32 m0, s24, 90112
  s_nop 0
  buffer_load_dwordx4 v1, s[60:63], s69 offen offset:0 sc1 lds
  v_sub_f32 v176, v12, v208
  v_cndmask_b32 v209, v12, 0, s[30:31]
  v_cmp_le_i32 s[30:31], 18, v11
  v_sub_f32 v177, v12, v209
  s_add_u32 m0, s24, 98304
  s_nop 0
  buffer_load_dwordx4 v1, s[60:63], s70 offen offset:0 sc1 lds
  v_cndmask_b32 v210, v12, 0, s[30:31]
  v_cmp_le_i32 s[30:31], 19, v11
  v_sub_f32 v178, v12, v210
  s_nop 0
  v_cndmask_b32 v211, v12, 0, s[30:31]
  s_add_u32 m0, s24, 81920
  s_mov_b32 exec_hi, 0xffff
  buffer_load_dwordx4 v1, s[60:63], s68 offen offset:1024 sc1 lds
  s_mov_b32 exec_hi, -1
  v_cmp_le_i32 s[30:31], 24, v11
  v_sub_f32 v179, v12, v211
  s_nop 0
  v_cndmask_b32 v212, v12, 0, s[30:31]
  v_cmp_le_i32 s[30:31], 25, v11
  s_waitcnt vmcnt(4)
  buffer_store_dword v5, v4, s[60:63], s64 offen offset:256 sc1
  s_add_u32 m0, s24, 90112
  s_mov_b32 exec_hi, 0xffff
  buffer_load_dwordx4 v1, s[60:63], s69 offen offset:1024 sc1 lds
  s_mov_b32 exec_hi, -1
  v_sub_f32 v180, v12, v212
  v_cndmask_b32 v213, v12, 0, s[30:31]
  v_cmp_le_i32 s[30:31], 26, v11
  v_sub_f32 v181, v12, v213
  s_add_u32 m0, s24, 98304
  s_mov_b32 exec_hi, 0xffff
  buffer_load_dwordx4 v1, s[60:63], s70 offen offset:1024 sc1 lds
  s_mov_b32 exec_hi, -1
  v_cndmask_b32 v214, v12, 0, s[30:31]
  v_cmp_le_i32 s[30:31], 27, v11
  v_sub_f32 v182, v12, v214
  s_nop 0
  v_cndmask_b32 v215, v12, 0, s[30:31]
  v_sub_f32 v183, v12, v215
  s_add_u32 s68, s68, 0x38000
  s_add_u32 s69, s69, 0x38000
  s_add_u32 s70, s70, 0x38000
  s_barrier
  ds_write_b64 v13, v[160:161] offset:1792
  ds_write_b64 v13, v[162:163] offset:9984
  ds_write_b64 v13, v[164:165] offset:18176
  ds_read_b64_tr_b16 a[0:1], v166 offset:0
  ds_read_b64_tr_b16 a[2:3], v166 offset:14336
  ds_read_b64_tr_b16 a[4:5], v166 offset:1024
  ds_read_b64_tr_b16 a[6:7], v166 offset:15360
  ds_read_b64_tr_b16 a[8:9], v166 offset:2048
  ds_read_b64_tr_b16 a[10:11], v166 offset:16384
  ds_read_b64_tr_b16 a[12:13], v166 offset:3072
  ds_read_b64_tr_b16 a[14:15], v166 offset:17408
  ds_read_b64_tr_b16 a[16:17], v166 offset:4096
  ds_read_b64_tr_b16 a[18:19], v166 offset:18432
  ds_read_b64_tr_b16 a[20:21], v166 offset:5120
  ds_read_b64_tr_b16 a[22:23], v166 offset:19456
  ds_read_b64_tr_b16 a[24:25], v166 offset:6144
  ds_read_b64_tr_b16 a[26:27], v166 offset:20480
  ds_read_b64_tr_b16 a[28:29], v166 offset:7168
  ds_read_b64_tr_b16 a[30:31], v166 offset:21504
  ds_read_b64_tr_b16 a[32:33], v166 offset:8192
  ds_read_b64_tr_b16 a[34:35], v166 offset:22528
  ds_read_b64_tr_b16 a[36:37], v166 offset:9216
  ds_read_b64_tr_b16 a[38:39], v166 offset:23552
  ds_read_b64_tr_b16 a[40:41], v166 offset:10240
  ds_read_b64_tr_b16 a[42:43], v166 offset:24576
  ds_read_b64_tr_b16 a[44:45], v166 offset:11264
  ds_read_b64_tr_b16 a[46:47], v166 offset:25600
  ds_read_b64_tr_b16 a[48:49], v166 offset:12288
  ds_read_b64_tr_b16 a[50:51], v166 offset:26624
  ds_read_b64_tr_b16 a[52:53], v166 offset:13312
  ds_read_b64_tr_b16 a[54:55], v166 offset:27648
  buffer_load_dword v249, v242, s[60:63], 0 offen sc1
  s_add_u32 m0, s99, 106496
  s_mov_b32 s25, 802816
  buffer_load_dwordx4 v228, s[44:47], s25 offen offset:0 lds
  buffer_load_dwordx4 v229, s[44:47], s25 offen offset:1024 lds
  buffer_load_dwordx4 v230, s[44:47], s25 offen offset:2048 lds
  buffer_load_dwordx4 v231, s[44:47], s25 offen offset:3072 lds
  s_waitcnt vmcnt(4)
  v_cmp_ne_u32 vcc, 1, v249
  s_cbranch_vccnz L_ws_rr_91
L_ws_rb_92:
  buffer_load_dwordx2 v[88:89], v2, s[60:63], s88 offen offset:0 sc1
  buffer_load_dwordx2 v[90:91], v2, s[60:63], s88 offen offset:512 sc1
  buffer_load_dwordx2 v[92:93], v2, s[60:63], s88 offen offset:1024 sc1
  buffer_load_dwordx2 v[94:95], v2, s[60:63], s88 offen offset:1536 sc1
  s_waitcnt lgkmcnt(0)
  s_barrier
  ds_read_b64 v[80:81], v237 offset:16384
  ds_read_b64 v[82:83], v237 offset:16896
  ds_read_b64 v[84:85], v237 offset:17408
  ds_read_b64 v[86:87], v237 offset:17920
  s_add_u32 m0, s24, 57344
  s_nop 0
  buffer_load_dwordx4 v1, s[60:63], s68 offen offset:0 sc1 lds
  ds_read_b64 v[16:17], v237 offset:0
  ds_read_b64 v[18:19], v237 offset:512
  ds_read_b64 v[20:21], v237 offset:1024
  ds_read_b64 v[22:23], v237 offset:1536
  s_add_u32 m0, s24, 65536
  s_nop 0
  buffer_load_dwordx4 v1, s[60:63], s69 offen offset:0 sc1 lds
  ds_read_b64 v[24:25], v237 offset:2048
  ds_read_b64 v[26:27], v237 offset:2560
  ds_read_b64 v[28:29], v237 offset:3072
  ds_read_b64 v[30:31], v237 offset:3584
  s_add_u32 m0, s24, 73728
  s_nop 0
  buffer_load_dwordx4 v1, s[60:63], s70 offen offset:0 sc1 lds
  s_mov_b32 exec_lo, 0
  s_waitcnt vmcnt(3)
  v_mov_b32 v94, 0
  v_mov_b32 v95, 1.0
  s_mov_b32 exec_lo, -1
  s_waitcnt lgkmcnt(10)
  v_mfma_f32_32x32x16_bf16 v[96:111], v[80:83], v[88:91], v[200:215]
  s_add_u32 m0, s24, 57344
  s_mov_b32 exec_hi, 0xffff
  buffer_load_dwordx4 v1, s[60:63], s68 offen offset:1024 sc1 lds
  s_mov_b32 exec_hi, -1
  s_waitcnt lgkmcnt(8)
  v_mfma_f32_32x32x16_bf16 v[96:111], v[84:87], v[92:95], v[96:111]
  s_add_u32 m0, s24, 65536
  s_mov_b32 exec_hi, 0xffff
  buffer_load_dwordx4 v1, s[60:63], s69 offen offset:1024 sc1 lds
  s_mov_b32 exec_hi, -1
  s_lshr_b32 s90, s12, 1
  s_mul_i32 s90, s90, 0x19b000
  s_and_b32 s14, s12, 1
  s_mul_i32 s14, s14, 112
  s_add_u32 s90, s90, s14
  s_add_u32 s90, s90, 0x198000
  s_add_u32 m0, s24, 73728
  s_mov_b32 exec_hi, 0xffff
  buffer_load_dwordx4 v1, s[60:63], s70 offen offset:1024 sc1 lds
  s_mov_b32 exec_hi, -1
  v_max_f32 v10, v96, v97
  v_max_f32 v11, v98, v99
  v_max3_f32 v10, v10, v100, v101
  v_max3_f32 v11, v11, v102, v103
  v_max3_f32 v10, v10, v104, v105
  v_max3_f32 v11, v11, v106, v107
  v_max3_f32 v10, v10, v108, v109
  v_max3_f32 v11, v11, v110, v111
  v_max_f32 v10, v10, v11
  v_mov_b32 v11, v10
  s_mov_b32 s16, 0xffff0000
  s_mov_b32 s17, 0x07060302
  v_permlane32_swap_b32 v10, v11
  v_min_f32 v10, -v10, -v11
  v_and_b32 v11, s16, v10
  v_sub_f32 v11, v10, v11
  v_and_b32 v14, s16, v11
  v_sub_f32 v14, v11, v14
  s_mov_b32 exec_lo, 0
  v_perm_b32 v94, v11, v10, s17
  v_perm_b32 v95, v95, v14, s17
  s_mov_b32 exec_lo, -1
  s_waitcnt lgkmcnt(6)
  v_mfma_f32_32x32x16_bf16 v[96:111], v[16:19], v[88:91], v[168:183]
  s_waitcnt lgkmcnt(4)
  v_mfma_f32_32x32x16_bf16 v[96:111], v[20:23], v[92:95], v[96:111]
  s_lshl_b32 s14, s6, 28
  s_lshl2_add_u32 s15, s5, s93
  s_add_u32 s14, s14, s15
  buffer_store_dword v5, v4, s[60:63], s14 offen offset:128 sc1
  v_lshrrev_b32 v13, 5, v0
  v_lshlrev_b32 v13, 4, v13
  v_mov_b32 v12, 0
  s_cmp_lt_u32 s4, 7
  s_cselect_b32 s14, 0x19b00, 0
  v_and_b32 v250, 127, v3
  v_mad_u32_u24 v250, v13, s14, v250
  s_add_u32 m0, s99, 110592
  s_mov_b32 s25, 1032192
  buffer_load_dwordx4 v228, s[44:47], s25 offen offset:0 lds
  v_exp_f32 v96, v96
  v_exp_f32 v97, v97
  v_exp_f32 v98, v98
  v_exp_f32 v99, v99
  buffer_load_dwordx4 v229, s[44:47], s25 offen offset:1024 lds
  v_exp_f32 v100, v100
  v_exp_f32 v101, v101
  v_exp_f32 v102, v102
  v_exp_f32 v103, v103
  s_waitcnt lgkmcnt(2)
  v_mfma_f32_32x32x16_bf16 v[112:127], v[24:27], v[88:91], 0
  buffer_load_dwordx4 v230, s[44:47], s25 offen offset:2048 lds
  ds_read_b64 v[32:33], v237 offset:4096
  ds_read_b64 v[34:35], v237 offset:4608
  ds_read_b64 v[36:37], v237 offset:5120
  ds_read_b64 v[38:39], v237 offset:5632
  v_cvt_pk_bf16_f32 v16, v96, v97
  v_cvt_pk_bf16_f32 v17, v98, v99
  v_cvt_pk_bf16_f32 v18, v100, v101
  v_cvt_pk_bf16_f32 v19, v102, v103
  v_exp_f32 v104, v104
  v_exp_f32 v105, v105
  s_waitcnt lgkmcnt(4)
  v_mfma_f32_32x32x16_bf16 v[112:127], v[28:31], v[92:95], v[112:127]
  buffer_load_dwordx4 v231, s[44:47], s25 offen offset:3072 lds
  v_exp_f32 v106, v106
  v_exp_f32 v107, v107
  v_exp_f32 v108, v108
  v_exp_f32 v109, v109
  v_exp_f32 v110, v110
  v_exp_f32 v111, v111
  v_cvt_pk_bf16_f32 v20, v104, v105
  v_cvt_pk_bf16_f32 v21, v106, v107
  v_cvt_pk_bf16_f32 v22, v108, v109
  v_cvt_pk_bf16_f32 v23, v110, v111
  s_add_u32 m0, s99, 114688
  s_mov_b32 s25, 1261568
  buffer_load_dwordx4 v228, s[44:47], s25 offen offset:0 lds
  v_exp_f32 v112, v112
  v_exp_f32 v113, v113
  v_exp_f32 v114, v114
  v_exp_f32 v115, v115
  buffer_load_dwordx4 v229, s[44:47], s25 offen offset:1024 lds
  v_exp_f32 v116, v116
  v_exp_f32 v117, v117
  v_exp_f32 v118, v118
  v_exp_f32 v119, v119
  s_waitcnt lgkmcnt(2)
  v_mfma_f32_32x32x16_bf16 v[96:111], v[32:35], v[88:91], 0
  buffer_load_dwordx4 v230, s[44:47], s25 offen offset:2048 lds
  ds_read_b64 v[40:41], v237 offset:6144
  ds_read_b64 v[42:43], v237 offset:6656
  ds_read_b64 v[44:45], v237 offset:7168
  ds_read_b64 v[46:47], v237 offset:7680
  v_cvt_pk_bf16_f32 v24, v112, v113
  v_cvt_pk_bf16_f32 v25, v114, v115
  v_cvt_pk_bf16_f32 v26, v116, v117
  v_cvt_pk_bf16_f32 v27, v118, v119
  v_exp_f32 v120, v120
  v_exp_f32 v121, v121
  s_waitcnt lgkmcnt(4)
  v_mfma_f32_32x32x16_bf16 v[96:111], v[36:39], v[92:95], v[96:111]
  buffer_load_dwordx4 v[168:171], v13, s[60:63], s90 offen offset:1792 sc1
  v_exp_f32 v122, v122
  v_exp_f32 v123, v123
  v_exp_f32 v124, v124
  v_exp_f32 v125, v125
  v_exp_f32 v126, v126
  v_exp_f32 v127, v127
  v_cvt_pk_bf16_f32 v28, v120, v121
  v_cvt_pk_bf16_f32 v29, v122, v123
  v_cvt_pk_bf16_f32 v30, v124, v125
  v_cvt_pk_bf16_f32 v31, v126, v127
  buffer_load_dwordx4 v231, s[44:47], s25 offen offset:3072 lds
  v_exp_f32 v96, v96
  v_exp_f32 v97, v97
  v_exp_f32 v98, v98
  v_exp_f32 v99, v99
  s_add_u32 m0, s99, 118784
  s_mov_b32 s25, 1490944
  buffer_load_dwordx4 v228, s[44:47], s25 offen offset:0 lds
  v_exp_f32 v100, v100
  v_exp_f32 v101, v101
  v_exp_f32 v102, v102
  v_exp_f32 v103, v103
  s_waitcnt lgkmcnt(2)
  v_mfma_f32_32x32x16_bf16 v[112:127], v[40:43], v[88:91], 0
  buffer_load_dwordx4 v229, s[44:47], s25 offen offset:1024 lds
  ds_read_b64 v[48:49], v237 offset:8192
  ds_read_b64 v[50:51], v237 offset:8704
  ds_read_b64 v[52:53], v237 offset:9216
  ds_read_b64 v[54:55], v237 offset:9728
  v_cvt_pk_bf16_f32 v32, v96, v97
  v_cvt_pk_bf16_f32 v33, v98, v99
  v_cvt_pk_bf16_f32 v34, v100, v101
  v_cvt_pk_bf16_f32 v35, v102, v103
  v_exp_f32 v104, v104
  v_exp_f32 v105, v105
  s_waitcnt lgkmcnt(4)
  v_mfma_f32_32x32x16_bf16 v[112:127], v[44:47], v[92:95], v[112:127]
  buffer_load_dwordx4 v[172:175], v13, s[60:63], s90 offen offset:1824 sc1
  v_exp_f32 v106, v106
  v_exp_f32 v107, v107
  s_waitcnt vmcnt(13)
  s_barrier
  ds_read_b64_tr_b16 v[144:145], v238 offset:0
  ds_read_b64_tr_b16 v[146:147], v239 offset:0
  ds_read_b64_tr_b16 v[148:149], v240 offset:0
  ds_read_b64_tr_b16 v[150:151], v241 offset:0
  ds_read_b64_tr_b16 v[152:153], v238 offset:2048
  ds_read_b64_tr_b16 v[154:155], v239 offset:2048
  ds_read_b64_tr_b16 v[156:157], v240 offset:2048
  ds_read_b64_tr_b16 v[158:159], v241 offset:2048
  v_exp_f32 v108, v108
  v_exp_f32 v109, v109
  v_exp_f32 v110, v110
  v_exp_f32 v111, v111
  v_cvt_pk_bf16_f32 v36, v104, v105
  v_cvt_pk_bf16_f32 v37, v106, v107
  v_cvt_pk_bf16_f32 v38, v108, v109
  v_cvt_pk_bf16_f32 v39, v110, v111
  s_waitcnt lgkmcnt(0)
  v_mfma_f32_32x32x16_bf16 v[128:143], v[144:147], v[16:19], 0
  s_add_u32 m0, s99, 0
  s_add_u32 s25, s98, 0
  buffer_load_dwordx4 v224, s[40:43], s25 offen offset:0 lds
  v_exp_f32 v112, v112
  v_exp_f32 v113, v113
  v_exp_f32 v114, v114
  v_mfma_f32_32x32x16_bf16 v[128:143], v[148:151], v[20:23], v[128:143]
  v_exp_f32 v115, v115
  v_exp_f32 v116, v116
  v_exp_f32 v117, v117
  v_mfma_f32_32x32x16_bf16 v[128:143], v[152:155], v[24:27], v[128:143]
  buffer_load_dwordx4 v225, s[40:43], s25 offen offset:1024 lds
  ds_read_b64_tr_b16 v[184:185], v238 offset:4096
  ds_read_b64_tr_b16 v[186:187], v239 offset:4096
  ds_read_b64_tr_b16 v[188:189], v240 offset:4096
  ds_read_b64_tr_b16 v[190:191], v241 offset:4096
  v_exp_f32 v118, v118
  v_exp_f32 v119, v119
  v_mfma_f32_32x32x16_bf16 v[128:143], v[156:159], v[28:31], v[128:143]
  ds_read_b64_tr_b16 v[192:193], v238 offset:6144
  ds_read_b64_tr_b16 v[194:195], v239 offset:6144
  ds_read_b64_tr_b16 v[196:197], v240 offset:6144
  ds_read_b64_tr_b16 v[198:199], v241 offset:6144
  v_cvt_pk_bf16_f32 v40, v112, v113
  v_cvt_pk_bf16_f32 v41, v114, v115
  v_cvt_pk_bf16_f32 v42, v116, v117
  v_cvt_pk_bf16_f32 v43, v118, v119
  v_mfma_f32_32x32x16_bf16 v[96:111], v[48:51], v[88:91], 0
  buffer_load_dwordx4 v226, s[40:43], s25 offen offset:2048 lds
  ds_read_b64 v[56:57], v237 offset:10240
  ds_read_b64 v[58:59], v237 offset:10752
  ds_read_b64 v[60:61], v237 offset:11264
  ds_read_b64 v[62:63], v237 offset:11776
  v_exp_f32 v120, v120
  v_exp_f32 v121, v121
  v_exp_f32 v122, v122
  v_mfma_f32_32x32x16_bf16 v[96:111], v[52:55], v[92:95], v[96:111]
  buffer_load_dwordx4 v[176:179], v13, s[60:63], s90 offen offset:1856 sc1
  v_exp_f32 v123, v123
  v_exp_f32 v124, v124
  v_exp_f32 v125, v125
  v_exp_f32 v126, v126
  v_exp_f32 v127, v127
  v_cvt_pk_bf16_f32 v44, v120, v121
  v_cvt_pk_bf16_f32 v45, v122, v123
  v_cvt_pk_bf16_f32 v46, v124, v125
  v_cvt_pk_bf16_f32 v47, v126, v127
  s_waitcnt lgkmcnt(4)
  v_mfma_f32_32x32x16_bf16 v[128:143], v[184:187], v[32:35], v[128:143]
  buffer_load_dwordx4 v227, s[40:43], s25 offen offset:3072 lds
  v_exp_f32 v96, v96
  v_exp_f32 v97, v97
  v_exp_f32 v98, v98
  v_mfma_f32_32x32x16_bf16 v[128:143], v[188:191], v[36:39], v[128:143]
  v_exp_f32 v99, v99
  v_exp_f32 v100, v100
  v_exp_f32 v101, v101
  v_mfma_f32_32x32x16_bf16 v[128:143], v[192:195], v[40:43], v[128:143]
  s_add_u32 m0, s99, 4096
  s_add_u32 s25, s98, 28672
  buffer_load_dwordx4 v224, s[40:43], s25 offen offset:0 lds
  ds_read_b64_tr_b16 v[144:145], v238 offset:8192
  ds_read_b64_tr_b16 v[146:147], v239 offset:8192
  ds_read_b64_tr_b16 v[148:149], v240 offset:8192
  ds_read_b64_tr_b16 v[150:151], v241 offset:8192
  v_exp_f32 v102, v102
  v_exp_f32 v103, v103
  v_mfma_f32_32x32x16_bf16 v[128:143], v[196:199], v[44:47], v[128:143]
  v_cvt_pk_bf16_f32 v48, v96, v97
  v_cvt_pk_bf16_f32 v49, v98, v99
  v_cvt_pk_bf16_f32 v50, v100, v101
  v_cvt_pk_bf16_f32 v51, v102, v103
  s_waitcnt lgkmcnt(6)
  v_mfma_f32_32x32x16_bf16 v[112:127], v[56:59], v[88:91], 0
  buffer_load_dwordx4 v225, s[40:43], s25 offen offset:1024 lds
  ds_read_b64 v[64:65], v237 offset:12288
  ds_read_b64 v[66:67], v237 offset:12800
  ds_read_b64 v[68:69], v237 offset:13312
  ds_read_b64 v[70:71], v237 offset:13824
  v_exp_f32 v104, v104
  v_exp_f32 v105, v105
  v_exp_f32 v106, v106
  s_waitcnt lgkmcnt(8)
  v_mfma_f32_32x32x16_bf16 v[112:127], v[60:63], v[92:95], v[112:127]
  buffer_load_dwordx4 v[180:183], v12, s[60:63], s90 offen offset:1888 sc1
  v_exp_f32 v107, v107
  v_exp_f32 v108, v108
  v_exp_f32 v109, v109
  v_exp_f32 v110, v110
  v_exp_f32 v111, v111
  v_cvt_pk_bf16_f32 v52, v104, v105
  v_cvt_pk_bf16_f32 v53, v106, v107
  v_cvt_pk_bf16_f32 v54, v108, v109
  v_cvt_pk_bf16_f32 v55, v110, v111
  s_waitcnt lgkmcnt(4)
  v_mfma_f32_32x32x16_bf16 v[128:143], v[144:147], v[48:51], v[128:143]
  buffer_load_dwordx4 v226, s[40:43], s25 offen offset:2048 lds
  v_exp_f32 v112, v112
  v_exp_f32 v113, v113
  v_exp_f32 v114, v114
  v_exp_f32 v115, v115
  v_mfma_f32_32x32x16_bf16 v[128:143], v[148:151], v[52:55], v[128:143]
  buffer_load_dwordx4 v227, s[40:43], s25 offen offset:3072 lds
  ds_read_b64_tr_b16 v[152:153], v238 offset:10240
  ds_read_b64_tr_b16 v[154:155], v239 offset:10240
  ds_read_b64_tr_b16 v[156:157], v240 offset:10240
  ds_read_b64_tr_b16 v[158:159], v241 offset:10240
  v_exp_f32 v116, v116
  v_exp_f32 v117, v117
  v_exp_f32 v118, v118
  v_exp_f32 v119, v119
  s_waitcnt lgkmcnt(6)
  v_mfma_f32_32x32x16_bf16 v[96:111], v[64:67], v[88:91], 0
  s_add_u32 m0, s99, 8192
  s_add_u32 s25, s98, 57344
  buffer_load_dwordx4 v224, s[40:43], s25 offen offset:0 lds
  ds_read_b64 v[72:73], v237 offset:14336
  ds_read_b64 v[74:75], v237 offset:14848
  ds_read_b64 v[76:77], v237 offset:15360
  ds_read_b64 v[78:79], v237 offset:15872
  v_cvt_pk_bf16_f32 v56, v112, v113
  v_cvt_pk_bf16_f32 v57, v114, v115
  v_cvt_pk_bf16_f32 v58, v116, v117
  v_cvt_pk_bf16_f32 v59, v118, v119
  v_exp_f32 v120, v120
  v_exp_f32 v121, v121
  v_exp_f32 v122, v122
  s_waitcnt lgkmcnt(8)
  v_mfma_f32_32x32x16_bf16 v[96:111], v[68:71], v[92:95], v[96:111]
  buffer_load_dwordx4 v225, s[40:43], s25 offen offset:1024 lds
  v_exp_f32 v123, v123
  v_exp_f32 v124, v124
  v_exp_f32 v125, v125
  v_exp_f32 v126, v126
  v_exp_f32 v127, v127
  v_cvt_pk_bf16_f32 v60, v120, v121
  v_cvt_pk_bf16_f32 v61, v122, v123
  v_cvt_pk_bf16_f32 v62, v124, v125
  v_cvt_pk_bf16_f32 v63, v126, v127
  s_waitcnt lgkmcnt(4)
  v_mfma_f32_32x32x16_bf16 v[128:143], v[152:155], v[56:59], v[128:143]
  buffer_load_dwordx4 v226, s[40:43], s25 offen offset:2048 lds
  v_exp_f32 v96, v96
  v_exp_f32 v97, v97
  v_exp_f32 v98, v98
  v_exp_f32 v99, v99
  v_mfma_f32_32x32x16_bf16 v[128:143], v[156:159], v[60:63], v[128:143]
  buffer_load_dwordx4 v227, s[40:43], s25 offen offset:3072 lds
  ds_read_b64_tr_b16 v[184:185], v238 offset:12288
  ds_read_b64_tr_b16 v[186:187], v239 offset:12288
  ds_read_b64_tr_b16 v[188:189], v240 offset:12288
  ds_read_b64_tr_b16 v[190:191], v241 offset:12288
  v_exp_f32 v100, v100
  v_exp_f32 v101, v101
  v_exp_f32 v102, v102
  v_exp_f32 v103, v103
  s_waitcnt lgkmcnt(6)
  v_mfma_f32_32x32x16_bf16 v[112:127], v[72:75], v[88:91], 0
  s_add_u32 m0, s99, 12288
  s_add_u32 s25, s98, 86016
  buffer_load_dwordx4 v224, s[40:43], s25 offen offset:0 lds
  v_cvt_pk_bf16_f32 v64, v96, v97
  v_cvt_pk_bf16_f32 v65, v98, v99
  v_cvt_pk_bf16_f32 v66, v100, v101
  v_cvt_pk_bf16_f32 v67, v102, v103
  v_exp_f32 v104, v104
  v_exp_f32 v105, v105
  v_exp_f32 v106, v106
  s_waitcnt lgkmcnt(4)
  v_mfma_f32_32x32x16_bf16 v[112:127], v[76:79], v[92:95], v[112:127]
  buffer_load_dwordx4 v225, s[40:43], s25 offen offset:1024 lds
  v_exp_f32 v107, v107
  v_exp_f32 v108, v108
  v_exp_f32 v109, v109
  v_exp_f32 v110, v110
  v_exp_f32 v111, v111
  v_cvt_pk_bf16_f32 v68, v104, v105
  v_cvt_pk_bf16_f32 v69, v106, v107
  v_cvt_pk_bf16_f32 v70, v108, v109
  v_cvt_pk_bf16_f32 v71, v110, v111
  s_waitcnt lgkmcnt(0)
  v_mfma_f32_32x32x16_bf16 v[128:143], v[184:187], v[64:67], v[128:143]
  buffer_load_dword v243, v250, s[60:63], s93 offen offset:128 sc1
  v_exp_f32 v112, v112
  v_exp_f32 v113, v113
  v_exp_f32 v114, v114
  v_exp_f32 v115, v115
  v_mfma_f32_32x32x16_bf16 v[128:143], v[188:191], v[68:71], v[128:143]
  ds_read_b64_tr_b16 v[192:193], v238 offset:14336
  ds_read_b64_tr_b16 v[194:195], v239 offset:14336
  ds_read_b64_tr_b16 v[196:197], v240 offset:14336
  ds_read_b64_tr_b16 v[198:199], v241 offset:14336
  v_exp_f32 v116, v116
  v_exp_f32 v117, v117
  v_exp_f32 v118, v118
  v_exp_f32 v119, v119
  v_mfma_f32_32x32x16_bf16 v[96:111], v[80:83], v[88:91], v[200:215]
  v_cvt_pk_bf16_f32 v72, v112, v113
  v_cvt_pk_bf16_f32 v73, v114, v115
  v_cvt_pk_bf16_f32 v74, v116, v117
  v_cvt_pk_bf16_f32 v75, v118, v119
  v_exp_f32 v120, v120
  v_exp_f32 v121, v121
  v_exp_f32 v122, v122
  v_mfma_f32_32x32x16_bf16 v[96:111], v[84:87], v[92:95], v[96:111]
  v_exp_f32 v123, v123
  v_exp_f32 v124, v124
  v_exp_f32 v125, v125
  v_exp_f32 v126, v126
  v_exp_f32 v127, v127
  v_cvt_pk_bf16_f32 v76, v120, v121
  v_cvt_pk_bf16_f32 v77, v122, v123
  v_cvt_pk_bf16_f32 v78, v124, v125
  v_cvt_pk_bf16_f32 v79, v126, v127
  s_waitcnt lgkmcnt(0)
  v_mfma_f32_32x32x16_bf16 v[128:143], v[192:195], v[72:75], v[128:143]
  s_nop 0
  v_exp_f32 v96, v96
  v_exp_f32 v97, v97
  v_exp_f32 v98, v98
  v_exp_f32 v99, v99
  v_mfma_f32_32x32x16_bf16 v[128:143], v[196:199], v[76:79], v[128:143]
  ds_read_b64_tr_b16 v[144:145], v238 offset:16384
  ds_read_b64_tr_b16 v[146:147], v239 offset:16384
  ds_read_b64_tr_b16 v[148:149], v240 offset:16384
  ds_read_b64_tr_b16 v[150:151], v241 offset:16384
  v_exp_f32 v100, v100
  v_exp_f32 v101, v101
  v_exp_f32 v102, v102
  v_exp_f32 v103, v103
  v_cvt_pk_bf16_f32 v80, v96, v97
  v_cvt_pk_bf16_f32 v81, v98, v99
  v_cvt_pk_bf16_f32 v82, v100, v101
  v_cvt_pk_bf16_f32 v83, v102, v103
  v_exp_f32 v104, v104
  v_exp_f32 v105, v105
  v_exp_f32 v106, v106
  v_exp_f32 v107, v107
  v_exp_f32 v108, v108
  v_exp_f32 v109, v109
  v_exp_f32 v110, v110
  v_exp_f32 v111, v111
  v_cvt_pk_bf16_f32 v84, v104, v105
  v_cvt_pk_bf16_f32 v85, v106, v107
  v_cvt_pk_bf16_f32 v86, v108, v109
  v_cvt_pk_bf16_f32 v87, v110, v111
  s_waitcnt lgkmcnt(2)
  v_mfma_f32_32x32x16_bf16 v[128:143], v[144:147], v[80:83], v[128:143]
  s_waitcnt lgkmcnt(0)
  v_mfma_f32_32x32x16_bf16 v[128:143], v[148:151], v[84:87], v[128:143]
  s_lshl_b32 s15, s86, 7
  s_add_u32 s15, s15, s12
  s_add_u32 s15, s15, s93
  s_waitcnt vmcnt(13)
  v_min3_u32 v10, v168, v172, v176
  s_waitcnt vmcnt(9)
  v_min_u32 v10, v10, v180
  v_cmp_eq_u32 vcc, 0, v10
  s_cbranch_vccnz L_ws_rr_96
L_ws_rb_97:
  s_nop 2
  v_mov_b32 v10, v140
  v_mov_b32 v11, v140
  s_nop 1
  v_permlane32_swap_b32 v10, v11
  v_cmp_ngt_f32 vcc, 0x5f800000, v11
  s_cbranch_vccnz L_ws_fb_94
L_ws_fbb_95:
  v_rcp_f32 v10, v11
  s_mov_b32 exec_lo, 0
  v_mov_b32 v140, 0
  s_mov_b32 exec_lo, -1
  v_pk_mul_f32 v[12:13], v[128:129], v[168:169]
  v_pk_mul_f32 v[128:129], v[128:129], v[10:11] op_sel_hi:[1,0]
  v_pk_fma_f32 v[12:13], v[130:131], v[170:171], v[12:13]
  v_pk_mul_f32 v[130:131], v[130:131], v[10:11] op_sel_hi:[1,0]
  v_pk_fma_f32 v[12:13], v[132:133], v[172:173], v[12:13]
  v_pk_mul_f32 v[132:133], v[132:133], v[10:11] op_sel_hi:[1,0]
  v_pk_fma_f32 v[12:13], v[134:135], v[174:175], v[12:13]
  v_pk_mul_f32 v[134:135], v[134:135], v[10:11] op_sel_hi:[1,0]
  v_pk_fma_f32 v[12:13], v[136:137], v[176:177], v[12:13]
  v_pk_mul_f32 v[136:137], v[136:137], v[10:11] op_sel_hi:[1,0]
  v_pk_fma_f32 v[12:13], v[138:139], v[178:179], v[12:13]
  v_pk_mul_f32 v[138:139], v[138:139], v[10:11] op_sel_hi:[1,0]
  v_pk_fma_f32 v[12:13], v[140:141], v[180:181], v[12:13]
  v_pk_mul_f32 v[140:141], v[140:141], v[10:11] op_sel_hi:[1,0]
  v_pk_fma_f32 v[12:13], v[142:143], v[182:183], v[12:13]
  v_pk_mul_f32 v[142:143], v[142:143], v[10:11] op_sel_hi:[1,0]
  v_add_f32 v12, v12, v13
  v_mul_f32 v12, v12, v10
  v_mov_b32 v13, v12
  v_cvt_pk_bf16_f32 v144, v128, v129
  v_cvt_pk_bf16_f32 v145, v130, v131
  v_permlane32_swap_b32 v12, v13
  v_cvt_pk_bf16_f32 v146, v132, v133
  v_cvt_pk_bf16_f32 v147, v134, v135
  v_cvt_pk_bf16_f32 v148, v136, v137
  v_cvt_pk_bf16_f32 v149, v138, v139
  v_cvt_pk_bf16_f32 v150, v140, v141
  v_cvt_pk_bf16_f32 v151, v142, v143
  s_mov_b32 exec_lo, 0
  v_add_f32 v150, v12, v13
  s_mov_b32 exec_lo, -1
  buffer_store_dwordx4 v[144:147], v1, s[60:63], s88 offen offset:0 sc1
  buffer_store_dwordx4 v[148:151], v1, s[60:63], s88 offen offset:1024 sc1
  s_lshl_b32 s14, s22, 7
  s_lshl_b32 s16, s21, 3
  s_add_u32 s14, s14, s16
  s_add_u32 s64, s14, s93
  v_and_b32 v156, 4, v3
  s_lshl_b32 s66, s22, 15
  s_add_u32 s66, s66, s10
  s_lshl_b32 s16, s21, 14
  s_add_u32 s65, s66, s16
  v_add_u32 v171, 106496, v166
  v_mov_b32 v170, v166
  v_lshrrev_b32 v153, 5, v0
  s_lshl_b32 s14, s21, 6
  v_xor_b32 v168, s14, v6
  v_lshl_add_u32 v168, v153, 9, v168
  s_mul_i32 s14, s21, 28672
  v_add_u32 v168, s14, v168
  v_xor_b32 v169, 64, v168
  s_lshl_b32 s14, s6, 12
  s_add_u32 s14, s14, 65536
  v_add_u32 v172, s14, v1
  v_xor_b32 v173, 0x2000, v172
  s_mov_b32 s17, 0xffff0000
  v_add_u32 v174, -1, v153
  v_mov_b32 v175, 0
  s_mul_i32 s18, s6, 4096
  s_lshl_b32 s14, s6, 8
  v_add_u32 v176, s14, v3
  v_xor_b32 v177, 0x200, v176
  s_lshl_b32 s14, s23, 11
  s_mul_i32 s68, s22, 28672
  s_add_u32 s68, s68, s14
  s_add_u32 s68, s68, s10
  s_add_u32 s68, s68, 0x40000
  s_lshl_b32 s14, s22, 7
  s_add_u32 s14, s14, s23
  s_add_u32 s69, s14, s93
  v_lshl_add_u32 v158, v153, 30, v1
  v_lshlrev_b32 v80, 16, v244
  v_and_b32 v81, s17, v244
  v_lshlrev_b32 v82, 16, v245
  v_and_b32 v83, s17, v245
  v_lshlrev_b32 v84, 16, v246
  v_and_b32 v85, s17, v246
  v_lshlrev_b32 v86, 16, v247
  v_and_b32 v87, s17, v247
  v_lshlrev_b32 v88, 16, v252
  v_and_b32 v89, s17, v252
  v_lshlrev_b32 v90, 16, v253
  v_and_b32 v91, s17, v253
  v_lshlrev_b32 v92, 16, v254
  v_and_b32 v93, s17, v254
  v_lshlrev_b32 v94, 16, v255
  v_and_b32 v95, s17, v255
  s_waitcnt vmcnt(0)
  buffer_store_byte v5, v4, s[60:63], s15 offen offset:3072 sc1
  s_barrier
  s_mov_b32 s27, 200000
  buffer_load_dword v10, v156, s[60:63], s64 offen offset:3072 sc1
  ds_read_b64_tr_b16 a[116:117], v169 offset:0
  ds_read_b64_tr_b16 a[118:119], v169 offset:1024
  ds_read_b64_tr_b16 a[112:113], v168 offset:0
  ds_read_b64_tr_b16 a[114:115], v168 offset:1024
  ds_read_b64_tr_b16 a[124:125], v169 offset:2048
  ds_read_b64_tr_b16 a[126:127], v169 offset:3072
  ds_read_b64_tr_b16 a[120:121], v168 offset:2048
  ds_read_b64_tr_b16 a[122:123], v168 offset:3072
  buffer_load_dword v11, v156, s[60:63], s64 offen offset:3072 sc1
  ds_read_b64_tr_b16 a[132:133], v169 offset:3584
  ds_read_b64_tr_b16 a[134:135], v169 offset:4608
  ds_read_b64_tr_b16 a[128:129], v168 offset:3584
  ds_read_b64_tr_b16 a[130:131], v168 offset:4608
  ds_read_b64_tr_b16 a[140:141], v169 offset:5632
  ds_read_b64_tr_b16 a[142:143], v169 offset:6656
  ds_read_b64_tr_b16 a[136:137], v168 offset:5632
  ds_read_b64_tr_b16 a[138:139], v168 offset:6656
L_ws_pp_99:
  buffer_load_dword v12, v156, s[60:63], s64 offen offset:3072 sc1
  s_waitcnt vmcnt(2)
  v_cmp_ne_u32 vcc, 0x01010101, v10
  s_cbranch_vccz L_ws_pd_100
  buffer_load_dword v10, v156, s[60:63], s64 offen offset:3072 sc1
  s_waitcnt vmcnt(2)
  v_cmp_ne_u32 vcc, 0x01010101, v11
  s_cbranch_vccz L_ws_pd_100
  buffer_load_dword v11, v156, s[60:63], s64 offen offset:3072 sc1
  s_waitcnt vmcnt(2)
  v_cmp_ne_u32 vcc, 0x01010101, v12
  s_cbranch_vccz L_ws_pd_100
  s_sub_u32 s27, s27, 1
  s_cmp_lg_u32 s27, 0
  s_cbranch_scc1 L_ws_pp_99
L_ws_pd_100:
  buffer_load_dwordx4 v[16:19], v1, s[60:63], s65 offen offset:0 sc1
  ds_read_b64_tr_b16 a[148:149], v169 offset:7168
  ds_read_b64_tr_b16 a[150:151], v169 offset:8192
  ds_read_b64_tr_b16 a[144:145], v168 offset:7168
  ds_read_b64_tr_b16 a[146:147], v168 offset:8192
  buffer_load_dwordx4 v[20:23], v1, s[60:63], s65 offen offset:1024 sc1
  ds_read_b64_tr_b16 a[156:157], v169 offset:9216
  ds_read_b64_tr_b16 a[158:159], v169 offset:10240
  ds_read_b64_tr_b16 a[152:153], v168 offset:9216
  ds_read_b64_tr_b16 a[154:155], v168 offset:10240
  buffer_load_dwordx4 v[24:27], v1, s[60:63], s65 offen offset:2048 sc1
  ds_read_b64_tr_b16 a[164:165], v169 offset:10752
  ds_read_b64_tr_b16 a[166:167], v169 offset:11776
  ds_read_b64_tr_b16 a[160:161], v168 offset:10752
  ds_read_b64_tr_b16 a[162:163], v168 offset:11776
  buffer_load_dwordx4 v[28:31], v1, s[60:63], s65 offen offset:3072 sc1
  ds_read_b64_tr_b16 a[172:173], v169 offset:12800
  ds_read_b64_tr_b16 a[174:175], v169 offset:13824
  ds_read_b64_tr_b16 a[168:169], v168 offset:12800
  ds_read_b64_tr_b16 a[170:171], v168 offset:13824
  s_add_u32 s65, s65, 4096
  buffer_load_dwordx4 v[32:35], v1, s[60:63], s65 offen offset:0 sc1
  ds_read_b64_tr_b16 a[180:181], v169 offset:14336
  ds_read_b64_tr_b16 a[182:183], v169 offset:15360
  ds_read_b64_tr_b16 a[176:177], v168 offset:14336
  ds_read_b64_tr_b16 a[178:179], v168 offset:15360
  buffer_load_dwordx4 v[36:39], v1, s[60:63], s65 offen offset:1024 sc1
  ds_read_b64_tr_b16 a[188:189], v169 offset:16384
  ds_read_b64_tr_b16 a[190:191], v169 offset:17408
  ds_read_b64_tr_b16 a[184:185], v168 offset:16384
  ds_read_b64_tr_b16 a[186:187], v168 offset:17408
  s_waitcnt vmcnt(5) lgkmcnt(15)
  v_mfma_f32_32x32x16_bf16 v[96:111], a[116:119], v[16:19], 0
  buffer_load_dwordx4 v[40:43], v1, s[60:63], s65 offen offset:2048 sc1
  v_mfma_f32_32x32x16_bf16 v[80:95], a[112:115], v[16:19], v[80:95]
  ds_read_b64_tr_b16 a[196:197], v169 offset:17920
  ds_read_b64_tr_b16 a[198:199], v169 offset:18944
  ds_read_b64_tr_b16 a[192:193], v168 offset:17920
  ds_read_b64_tr_b16 a[194:195], v168 offset:18944
  s_waitcnt vmcnt(5)
  v_add_f32 v175, v175, v22
  v_and_b32 v22, v174, v22
  s_nop 1
  v_mfma_f32_32x32x16_bf16 v[96:111], a[124:127], v[20:23], v[96:111]
  buffer_load_dwordx4 v[44:47], v1, s[60:63], s65 offen offset:3072 sc1
  v_mfma_f32_32x32x16_bf16 v[80:95], a[120:123], v[20:23], v[80:95]
  ds_read_b64_tr_b16 a[204:205], v169 offset:19968
  ds_read_b64_tr_b16 a[206:207], v169 offset:20992
  ds_read_b64_tr_b16 a[200:201], v168 offset:19968
  ds_read_b64_tr_b16 a[202:203], v168 offset:20992
  s_waitcnt vmcnt(5)
  v_mfma_f32_32x32x16_bf16 v[96:111], a[132:135], v[24:27], v[96:111]
  s_add_u32 s65, s65, 4096
  buffer_load_dwordx4 v[48:51], v1, s[60:63], s65 offen offset:0 sc1
  v_mfma_f32_32x32x16_bf16 v[80:95], a[128:131], v[24:27], v[80:95]
  ds_read_b64_tr_b16 a[212:213], v169 offset:21504
  ds_read_b64_tr_b16 a[214:215], v169 offset:22528
  ds_read_b64_tr_b16 a[208:209], v168 offset:21504
  ds_read_b64_tr_b16 a[210:211], v168 offset:22528
  s_waitcnt vmcnt(5)
  v_add_f32 v175, v175, v30
  v_and_b32 v30, v174, v30
  s_nop 1
  v_mfma_f32_32x32x16_bf16 v[96:111], a[140:143], v[28:31], v[96:111]
  buffer_load_dwordx4 v[52:55], v1, s[60:63], s65 offen offset:1024 sc1
  v_mfma_f32_32x32x16_bf16 v[80:95], a[136:139], v[28:31], v[80:95]
  ds_read_b64_tr_b16 a[220:221], v169 offset:23552
  ds_read_b64_tr_b16 a[222:223], v169 offset:24576
  ds_read_b64_tr_b16 a[216:217], v168 offset:23552
  ds_read_b64_tr_b16 a[218:219], v168 offset:24576
  s_waitcnt vmcnt(5)
  v_mfma_f32_32x32x16_bf16 v[96:111], a[148:151], v[32:35], v[96:111]
  buffer_load_dwordx4 v[56:59], v1, s[60:63], s65 offen offset:2048 sc1
  v_mfma_f32_32x32x16_bf16 v[80:95], a[144:147], v[32:35], v[80:95]
  ds_read_b64_tr_b16 a[228:229], v169 offset:25088
  ds_read_b64_tr_b16 a[230:231], v169 offset:26112
  ds_read_b64_tr_b16 a[224:225], v168 offset:25088
  ds_read_b64_tr_b16 a[226:227], v168 offset:26112
  s_waitcnt vmcnt(5)
  v_add_f32 v175, v175, v38
  v_and_b32 v38, v174, v38
  s_nop 1
  v_mfma_f32_32x32x16_bf16 v[96:111], a[156:159], v[36:39], v[96:111]
  buffer_load_dwordx4 v[60:63], v1, s[60:63], s65 offen offset:3072 sc1
  v_mfma_f32_32x32x16_bf16 v[80:95], a[152:155], v[36:39], v[80:95]
  ds_read_b64_tr_b16 a[236:237], v169 offset:27136
  ds_read_b64_tr_b16 a[238:239], v169 offset:28160
  ds_read_b64_tr_b16 a[232:233], v168 offset:27136
  ds_read_b64_tr_b16 a[234:235], v168 offset:28160
  s_waitcnt vmcnt(5) lgkmcnt(15)
  v_mfma_f32_32x32x16_bf16 v[96:111], a[164:167], v[40:43], v[96:111]
  s_add_u32 s65, s65, 4096
  buffer_load_dwordx4 v[64:67], v1, s[60:63], s65 offen offset:0 sc1
  v_mfma_f32_32x32x16_bf16 v[80:95], a[160:163], v[40:43], v[80:95]
  ds_read_b64_tr_b16 a[56:57], v171 offset:0
  ds_read_b64_tr_b16 a[58:59], v171 offset:14336
  ds_read_b64_tr_b16 a[60:61], v171 offset:1024
  ds_read_b64_tr_b16 a[62:63], v171 offset:15360
  s_waitcnt vmcnt(5)
  v_add_f32 v175, v175, v46
  v_and_b32 v46, v174, v46
  s_nop 1
  v_mfma_f32_32x32x16_bf16 v[96:111], a[172:175], v[44:47], v[96:111]
  buffer_load_dwordx4 v[68:71], v1, s[60:63], s65 offen offset:1024 sc1
  v_mfma_f32_32x32x16_bf16 v[80:95], a[168:171], v[44:47], v[80:95]
  ds_read_b64_tr_b16 a[64:65], v171 offset:2048
  ds_read_b64_tr_b16 a[66:67], v171 offset:16384
  ds_read_b64_tr_b16 a[68:69], v171 offset:3072
  ds_read_b64_tr_b16 a[70:71], v171 offset:17408
  s_waitcnt vmcnt(5)
  v_mfma_f32_32x32x16_bf16 v[96:111], a[180:183], v[48:51], v[96:111]
  buffer_load_dwordx4 v[72:75], v1, s[60:63], s65 offen offset:2048 sc1
  v_mfma_f32_32x32x16_bf16 v[80:95], a[176:179], v[48:51], v[80:95]
  ds_read_b64_tr_b16 a[72:73], v171 offset:4096
  ds_read_b64_tr_b16 a[74:75], v171 offset:18432
  ds_read_b64_tr_b16 a[76:77], v171 offset:5120
  ds_read_b64_tr_b16 a[78:79], v171 offset:19456
  s_waitcnt vmcnt(5)
  v_add_f32 v175, v175, v54
  v_and_b32 v54, v174, v54
  s_nop 1
  v_mfma_f32_32x32x16_bf16 v[96:111], a[188:191], v[52:55], v[96:111]
  buffer_load_dwordx4 v[76:79], v1, s[60:63], s65 offen offset:3072 sc1
  v_mfma_f32_32x32x16_bf16 v[80:95], a[184:187], v[52:55], v[80:95]
  ds_read_b64_tr_b16 a[80:81], v171 offset:6144
  ds_read_b64_tr_b16 a[82:83], v171 offset:20480
  ds_read_b64_tr_b16 a[84:85], v171 offset:7168
  ds_read_b64_tr_b16 a[86:87], v171 offset:21504
  s_waitcnt vmcnt(5)
  v_mfma_f32_32x32x16_bf16 v[96:111], a[196:199], v[56:59], v[96:111]
  v_mfma_f32_32x32x16_bf16 v[80:95], a[192:195], v[56:59], v[80:95]
  ds_read_b64_tr_b16 a[88:89], v171 offset:8192
  ds_read_b64_tr_b16 a[90:91], v171 offset:22528
  ds_read_b64_tr_b16 a[92:93], v171 offset:9216
  ds_read_b64_tr_b16 a[94:95], v171 offset:23552
  s_waitcnt vmcnt(4)
  v_add_f32 v175, v175, v62
  v_and_b32 v62, v174, v62
  s_nop 1
  v_mfma_f32_32x32x16_bf16 v[96:111], a[204:207], v[60:63], v[96:111]
  v_mfma_f32_32x32x16_bf16 v[80:95], a[200:203], v[60:63], v[80:95]
  ds_read_b64_tr_b16 a[96:97], v171 offset:10240
  ds_read_b64_tr_b16 a[98:99], v171 offset:24576
  ds_read_b64_tr_b16 a[100:101], v171 offset:11264
  ds_read_b64_tr_b16 a[102:103], v171 offset:25600
  s_waitcnt vmcnt(3) lgkmcnt(15)
  v_mfma_f32_32x32x16_bf16 v[96:111], a[212:215], v[64:67], v[96:111]
  v_mfma_f32_32x32x16_bf16 v[80:95], a[208:211], v[64:67], v[80:95]
  ds_read_b64_tr_b16 a[104:105], v171 offset:12288
  ds_read_b64_tr_b16 a[106:107], v171 offset:26624
  ds_read_b64_tr_b16 a[108:109], v171 offset:13312
  ds_read_b64_tr_b16 a[110:111], v171 offset:27648
  s_waitcnt vmcnt(2)
  v_add_f32 v175, v175, v70
  v_and_b32 v70, v174, v70
  s_nop 1
  v_mfma_f32_32x32x16_bf16 v[96:111], a[220:223], v[68:71], v[96:111]
  v_mfma_f32_32x32x16_bf16 v[80:95], a[216:219], v[68:71], v[80:95]
  s_waitcnt vmcnt(1)
  v_mfma_f32_32x32x16_bf16 v[96:111], a[228:231], v[72:75], v[96:111]
  v_mfma_f32_32x32x16_bf16 v[80:95], a[224:227], v[72:75], v[80:95]
  s_waitcnt vmcnt(0)
  v_add_f32 v175, v175, v78
  v_and_b32 v78, v174, v78
  s_nop 1
  v_mfma_f32_32x32x16_bf16 v[96:111], a[236:239], v[76:79], v[96:111]
  v_mfma_f32_32x32x16_bf16 v[80:95], a[232:235], v[76:79], v[80:95]
  ds_write_b32 v176, v175 offset:57856
  v_cmp_ne_u32 vcc, 1, v243
  s_cbranch_vccnz L_ws_rr_101
L_ws_rb_102:
  s_nop 7
  ds_write_b128 v172, v[96:99] offset:0
  ds_write_b128 v172, v[100:103] offset:1024
  ds_write_b128 v172, v[104:107] offset:2048
  ds_write_b128 v172, v[108:111] offset:3072
  s_waitcnt lgkmcnt(0)
  s_barrier
  ds_read_b32 v152, v177 offset:57856
  ds_read_b128 v[120:123], v173 offset:0
  ds_read_b128 v[124:127], v173 offset:1024
  ds_read_b128 v[128:131], v173 offset:2048
  ds_read_b128 v[132:135], v173 offset:3072
  s_sub_u32 s28, s20, 1
  s_not_b32 s29, s28
  s_waitcnt lgkmcnt(4)
  v_add_f32 v152, v152, v175
  v_mov_b32 v153, v152
  s_nop 1
  v_permlane32_swap_b32 v152, v153
  v_add_f32 v152, v153, v251
  s_waitcnt lgkmcnt(3)
  v_pk_add_f32 v[80:81], v[80:81], v[120:121]
  v_pk_add_f32 v[82:83], v[82:83], v[122:123]
  s_waitcnt lgkmcnt(2)
  v_pk_add_f32 v[84:85], v[84:85], v[124:125]
  v_pk_add_f32 v[86:87], v[86:87], v[126:127]
  v_pk_add_f32 v[120:121], v[80:81], v[152:153] op_sel_hi:[1,0] neg_lo:[0,1] neg_hi:[0,1]
  v_pk_add_f32 v[122:123], v[82:83], v[152:153] op_sel_hi:[1,0] neg_lo:[0,1] neg_hi:[0,1]
  v_pk_add_f32 v[124:125], v[84:85], v[152:153] op_sel_hi:[1,0] neg_lo:[0,1] neg_hi:[0,1]
  v_pk_add_f32 v[126:127], v[86:87], v[152:153] op_sel_hi:[1,0] neg_lo:[0,1] neg_hi:[0,1]
  v_cvt_pk_bf16_f32 v112, v120, v121
  v_cvt_pk_bf16_f32 v113, v122, v123
  v_cvt_pk_bf16_f32 v114, v124, v125
  v_cvt_pk_bf16_f32 v115, v126, v127
  buffer_store_dwordx4 v[112:115], v1, s[60:63], s68 offen offset:0 sc1
  s_waitcnt lgkmcnt(1)
  v_pk_add_f32 v[88:89], v[88:89], v[128:129]
  v_pk_add_f32 v[90:91], v[90:91], v[130:131]
  s_waitcnt lgkmcnt(0)
  v_pk_add_f32 v[92:93], v[92:93], v[132:133]
  v_pk_add_f32 v[94:95], v[94:95], v[134:135]
  v_pk_add_f32 v[128:129], v[88:89], v[152:153] op_sel_hi:[1,0] neg_lo:[0,1] neg_hi:[0,1]
  v_pk_add_f32 v[130:131], v[90:91], v[152:153] op_sel_hi:[1,0] neg_lo:[0,1] neg_hi:[0,1]
  v_pk_add_f32 v[132:133], v[92:93], v[152:153] op_sel_hi:[1,0] neg_lo:[0,1] neg_hi:[0,1]
  v_pk_add_f32 v[134:135], v[94:95], v[152:153] op_sel_hi:[1,0] neg_lo:[0,1] neg_hi:[0,1]
  v_cvt_pk_bf16_f32 v116, v128, v129
  v_cvt_pk_bf16_f32 v117, v130, v131
  v_cvt_pk_bf16_f32 v118, v132, v133
  v_cvt_pk_bf16_f32 v119, v134, v135
  buffer_store_dwordx4 v[116:119], v1, s[60:63], s68 offen offset:1024 sc1
  v_pk_mul_f32 v[152:153], v[120:121], v[120:121]
  v_pk_mul_f32 v[154:155], v[122:123], v[122:123]
  v_pk_fma_f32 v[152:153], v[124:125], v[124:125], v[152:153]
  v_pk_fma_f32 v[154:155], v[126:127], v[126:127], v[154:155]
  v_pk_fma_f32 v[152:153], v[128:129], v[128:129], v[152:153]
  v_pk_fma_f32 v[154:155], v[130:131], v[130:131], v[154:155]
  v_pk_fma_f32 v[152:153], v[132:133], v[132:133], v[152:153]
  v_pk_fma_f32 v[154:155], v[134:135], v[134:135], v[154:155]
  v_pk_add_f32 v[152:153], v[152:153], v[154:155]
  v_add_f32 v152, v152, v153
  v_mov_b32 v153, v152
  s_nop 1
  v_permlane32_swap_b32 v152, v153
  v_add_f32 v152, v152, v153
  buffer_store_dword v152, v158, s[60:63], s67 offen sc1
  v_and_b32 v167, 12, v3
  v_bfe_u32 v166, v0, 2, 2
  v_lshl_add_u32 v166, v166, 7, v167
  v_mov_b32 v188, 0x01010101
  s_mov_b32 exec_lo, 0x88888888
  s_mov_b32 exec_hi, 0x88888888
  v_mov_b32 v188, 0x101
  s_mov_b64 exec, -1
  s_lshl_b32 s91, s71, 9
  s_add_u32 s91, s91, s93
  s_mul_i32 s86, s6, 7168
  s_mul_i32 s14, s71, 114688
  s_add_u32 s14, s14, s10
  s_add_u32 s14, s14, 0x40000
  s_add_u32 s87, s86, s14
  s_lshl_b32 s24, s6, 10
  s_add_u32 s70, s24, s14
  s_lshl_b32 s15, s71, 2
  s_add_u32 s15, s15, s6
  s_lshl_b32 s15, s15, 11
  s_add_u32 s15, s15, s10
  s_add_u32 s18, s15, 0x194000
  s_lshl_b32 s15, s6, 8
  v_add_u32 v180, s15, v3
  v_add_u32 v182, 106496, v1
  v_add_u32 v183, 49152, v1
  s_lshl_b32 s88, s6, 12
  v_bfe_u32 v161, v0, 4, 1
  v_mul_u32_u24 v163, 20480, v161
  v_sub_u32 v164, v170, v163
  v_add_u32 v164, 81920, v164
  v_mul_u32_u24 v161, 20480, v161
  v_sub_u32 v165, v170, v161
  s_lshl_b32 s14, s6, 4
  s_add_u32 s14, s14, s93
  s_lshl_b32 s15, s71, 9
  s_add_u32 s15, s15, s3
  s_add_u32 s90, s14, s15
  s_lshl_b32 s15, s7, 8
  s_add_u32 s65, s14, s15
  s_mul_i32 s14, s6, 28672
  s_add_u32 s14, s14, s10
  s_mul_i32 s15, s71, 458752
  s_lshl_b32 s17, s3, 10
  s_add_u32 s15, s15, s17
  s_add_u32 s89, s14, s15
  s_mul_i32 s15, s7, 229376
  s_add_u32 s66, s14, s15
  s_waitcnt vmcnt(0)
  buffer_store_byte v5, v4, s[60:63], s69 offen offset:3136 sc1
  s_add_u32 m0, s88, 0
  s_mov_b32 s25, 1792
  buffer_load_dwordx4 v228, s[44:47], s25 offen offset:0 lds
  buffer_load_dwordx4 v229, s[44:47], s25 offen offset:1024 lds
  buffer_load_dwordx4 v230, s[44:47], s25 offen offset:2048 lds
  buffer_load_dwordx4 v231, s[44:47], s25 offen offset:3072 lds
  s_mov_b32 s27, 200000
  buffer_load_dword v10, v167, s[60:63], s91 offen offset:3136 sc1
  s_mul_i32 s14, s6, 14336
  s_lshl_b32 s16, s8, 7
  s_add_u32 s64, s14, s16
  v_add_u32 v226, 55296, v224
  v_add_u32 v227, 55296, v225
  s_lshl_b32 s14, s21, 6
  v_xor_b32 v184, s14, v6
  v_lshrrev_b32 v161, 5, v0
  v_lshl_add_u32 v184, v161, 9, v184
  v_add_u32 v184, s88, v184
  v_xor_b32 v185, 64, v184
  v_bfe_u32 v163, v0, 2, 2
  v_and_b32 v186, 12, v3
  v_lshl_add_u32 v186, v163, 6, v186
  v_and_b32 v163, 31, v0
  v_mul_u32_u24 v163, 272, v163
  v_lshl_add_u32 v163, v161, 7, v163
  s_mul_i32 s14, s6, 8704
  buffer_load_dword v11, v167, s[60:63], s91 offen offset:3136 sc1
  s_add_u32 s14, s14, 94208
  s_lshl_b32 s15, s21, 6
  s_add_u32 s17, s14, s15
  v_add_u32 v189, s17, v163
  s_xor_b32 s15, s15, 64
  s_add_u32 s17, s14, s15
  v_add_u32 v190, s17, v163
  v_and_or_b32 v161, v0, 24, v161
  v_and_b32 v163, 0x70, v1
  s_mul_i32 s14, s6, 544
  s_add_u32 s14, s14, 94208
  v_mul_u32_u24 v191, 272, v161
  v_add3_u32 v191, v191, v163, s14
  v_mul_u32_u24 v9, 896, v161
  v_add_u32 v9, v9, v163
  s_mul_i32 s14, s6, 1792
  s_add_u32 s14, s14, s16
  s_add_u32 s67, s14, s92
L_ws_pp_104:
  buffer_load_dword v12, v167, s[60:63], s91 offen offset:3136 sc1
  s_waitcnt vmcnt(2)
  v_cmp_ne_u32 vcc, v188, v10
  s_cbranch_vccz L_ws_pd_105
  buffer_load_dword v10, v167, s[60:63], s91 offen offset:3136 sc1
  s_waitcnt vmcnt(2)
  v_cmp_ne_u32 vcc, v188, v11
  s_cbranch_vccz L_ws_pd_105
  buffer_load_dword v11, v167, s[60:63], s91 offen offset:3136 sc1
  s_waitcnt vmcnt(2)
  v_cmp_ne_u32 vcc, v188, v12
  s_cbranch_vccz L_ws_pd_105
  s_sub_u32 s27, s27, 1
  s_cmp_lg_u32 s27, 0
  s_cbranch_scc1 L_ws_pp_104
L_ws_pd_105:
  s_add_u32 m0, s24, 135168
  s_add_u32 s25, s70, 0
  buffer_load_dwordx4 v1, s[60:63], s25 offen sc1 lds
  s_add_u32 m0, s24, 139264
  s_add_u32 s25, s70, 4096
  buffer_load_dwordx4 v1, s[60:63], s25 offen sc1 lds
  s_add_u32 m0, s24, 143360
  s_add_u32 s25, s70, 8192
  buffer_load_dwordx4 v1, s[60:63], s25 offen sc1 lds
  s_add_u32 m0, s24, 147456
  s_add_u32 s25, s70, 12288
  buffer_load_dwordx4 v1, s[60:63], s25 offen sc1 lds
  buffer_load_dword v187, v166, s[60:63], s91 offen offset:3136 sc1
  s_add_u32 m0, s24, 151552
  s_add_u32 s25, s70, 16384
  buffer_load_dwordx4 v1, s[60:63], s25 offen sc1 lds
  s_waitcnt vmcnt(3)
  s_barrier
  ds_read_b128 v[128:131], v182 offset:28672
  ds_read_b128 v[132:135], v182 offset:29696
  ds_read_b128 v[136:139], v182 offset:30720
  ds_read_b128 v[140:143], v182 offset:31744
  ds_read_b128 v[144:147], v182 offset:32768
  s_add_u32 m0, s24, 155648
  s_add_u32 s25, s70, 20480
  buffer_load_dwordx4 v1, s[60:63], s25 offen sc1 lds
  s_add_u32 m0, s24, 159744
  s_add_u32 s25, s70, 24576
  buffer_load_dwordx4 v1, s[60:63], s25 offen sc1 lds
  s_waitcnt vmcnt(3)
  v_cmp_ne_u32 vcc, v188, v187
  s_cbranch_vccnz L_ws_rr_106
L_ws_rb_107:
  s_waitcnt lgkmcnt(3)
  v_mfma_f32_32x32x16_bf16 v[96:111], a[0:3], v[128:131], 0
  buffer_load_dwordx4 v[152:155], v1, s[60:63], s18 offen sc1
  ds_read_b128 v[148:151], v182 offset:33792
  v_and_b32 v192, s28, v80
  v_and_b32 v208, s29, v80
  v_and_b32 v193, s28, v81
  v_and_b32 v209, s29, v81
  v_mfma_f32_32x32x16_bf16 v[96:111], a[4:7], v[132:135], v[96:111]
  buffer_load_dwordx3 v[156:158], v1, s[60:63], s18 offen offset:1024 sc1
  ds_read_b128 v[128:131], v182 offset:34816
  s_waitcnt lgkmcnt(3)
  v_mfma_f32_32x32x16_bf16 v[96:111], a[8:11], v[136:139], v[96:111]
  s_add_u32 m0, s86, 106496
  s_add_u32 s25, s87, 57344
  buffer_load_dwordx4 v1, s[60:63], s25 offen offset:0 sc1 lds
  ds_read_b128 v[132:135], v182 offset:35840
  v_and_b32 v194, s28, v82
  v_and_b32 v210, s29, v82
  v_and_b32 v195, s28, v83
  v_and_b32 v211, s29, v83
  v_mfma_f32_32x32x16_bf16 v[96:111], a[12:15], v[140:143], v[96:111]
  buffer_load_dwordx4 v1, s[60:63], s25 offen offset:1024 sc1 lds
  ds_read_b128 v[136:139], v182 offset:36864
  s_waitcnt lgkmcnt(3)
  v_mfma_f32_32x32x16_bf16 v[96:111], a[16:19], v[144:147], v[96:111]
  buffer_load_dwordx4 v1, s[60:63], s25 offen offset:2048 sc1 lds
  ds_read_b128 v[140:143], v182 offset:37888
  v_and_b32 v196, s28, v84
  v_and_b32 v212, s29, v84
  v_and_b32 v197, s28, v85
  v_and_b32 v213, s29, v85
  v_mfma_f32_32x32x16_bf16 v[96:111], a[20:23], v[148:151], v[96:111]
  buffer_load_dwordx4 v1, s[60:63], s25 offen offset:3072 sc1 lds
  ds_read_b128 v[144:147], v182 offset:38912
  s_waitcnt lgkmcnt(3)
  v_mfma_f32_32x32x16_bf16 v[96:111], a[24:27], v[128:131], v[96:111]
  s_add_u32 m0, s86, 110592
  s_add_u32 s25, s87, 61440
  buffer_load_dwordx4 v1, s[60:63], s25 offen offset:0 sc1 lds
  ds_read_b128 v[148:151], v182 offset:39936
  v_and_b32 v198, s28, v86
  v_and_b32 v214, s29, v86
  v_and_b32 v199, s28, v87
  v_and_b32 v215, s29, v87
  v_mfma_f32_32x32x16_bf16 v[96:111], a[28:31], v[132:135], v[96:111]
  buffer_load_dwordx4 v1, s[60:63], s25 offen offset:1024 sc1 lds
  s_barrier
  ds_read_b128 v[128:131], v182 offset:40960
  s_waitcnt lgkmcnt(3)
  v_mfma_f32_32x32x16_bf16 v[96:111], a[32:35], v[136:139], v[96:111]
  buffer_load_dwordx4 v1, s[60:63], s25 offen offset:2048 sc1 lds
  ds_read_b128 v[132:135], v182 offset:41984
  v_and_b32 v200, s28, v88
  v_and_b32 v216, s29, v88
  v_and_b32 v201, s28, v89
  v_and_b32 v217, s29, v89
  v_mfma_f32_32x32x16_bf16 v[96:111], a[36:39], v[140:143], v[96:111]
  s_waitcnt vmcnt(9)
  s_barrier
  ds_read_b128 v[136:139], v182 offset:43008
  s_waitcnt lgkmcnt(3)
  v_mfma_f32_32x32x16_bf16 v[96:111], a[40:43], v[144:147], v[96:111]
  s_add_u32 m0, s88, 16384
  s_mov_b32 s25, 231168
  buffer_load_dwordx4 v228, s[44:47], s25 offen offset:0 lds
  ds_read_b128 v[140:143], v182 offset:44032
  v_and_b32 v202, s28, v90
  v_and_b32 v218, s29, v90
  v_and_b32 v203, s28, v91
  v_and_b32 v219, s29, v91
  v_mfma_f32_32x32x16_bf16 v[96:111], a[44:47], v[148:151], v[96:111]
  buffer_load_dwordx4 v229, s[44:47], s25 offen offset:1024 lds
  ds_read_b128 v[144:147], v182 offset:45056
  s_waitcnt lgkmcnt(3)
  v_mfma_f32_32x32x16_bf16 v[96:111], a[48:51], v[128:131], v[96:111]
  ds_read_b128 v[148:151], v182 offset:46080
  v_and_b32 v204, s28, v92
  v_and_b32 v220, s29, v92
  v_and_b32 v205, s28, v93
  v_and_b32 v221, s29, v93
  v_mfma_f32_32x32x16_bf16 v[96:111], a[52:55], v[132:135], v[96:111]
  buffer_load_dwordx4 v230, s[44:47], s25 offen offset:2048 lds
  ds_read_b128 v[128:131], v182 offset:47104
  s_waitcnt lgkmcnt(3)
  v_mfma_f32_32x32x16_bf16 v[96:111], a[56:59], v[136:139], v[96:111]
  buffer_load_dwordx4 v231, s[44:47], s25 offen offset:3072 lds
  ds_read_b128 v[132:135], v182 offset:48128
  v_mfma_f32_32x32x16_bf16 v[96:111], a[60:63], v[140:143], v[96:111]
  ds_read_b128 v[136:139], v182 offset:49152
  s_waitcnt vmcnt(12)
  v_add_f32 v152, v152, v153
  v_add_f32 v154, v154, v155
  s_waitcnt vmcnt(11)
  v_add_f32 v156, v156, v157
  s_waitcnt lgkmcnt(3)
  v_mfma_f32_32x32x16_bf16 v[96:111], a[64:67], v[144:147], v[96:111]
  s_add_u32 m0, s86, 77824
  s_add_u32 s25, s87, 28672
  buffer_load_dwordx4 v1, s[60:63], s25 offen offset:0 sc1 lds
  ds_read_b128 v[140:143], v182 offset:50176
  v_add_f32 v152, v152, v158
  v_add_f32 v154, v154, v156
  v_add_f32 v152, v152, v154
  v_mfma_f32_32x32x16_bf16 v[96:111], a[68:71], v[148:151], v[96:111]
  ds_read_b128 v[144:147], v182 offset:51200
  v_mov_b32 v153, v152
  v_mov_b32 v154, 0x3727c5ac
  s_nop 0
  s_waitcnt lgkmcnt(3)
  v_mfma_f32_32x32x16_bf16 v[96:111], a[72:75], v[128:131], v[96:111]
  buffer_load_dwordx4 v1, s[60:63], s25 offen offset:1024 sc1 lds
  ds_read_b128 v[148:151], v182 offset:52224
  v_permlane32_swap_b32 v152, v153
  v_add_f32 v152, v152, v153
  v_fmac_f32 v154, 0x3b124925, v152
  v_mfma_f32_32x32x16_bf16 v[96:111], a[76:79], v[132:135], v[96:111]
  buffer_load_dwordx4 v1, s[60:63], s25 offen offset:2048 sc1 lds
  ds_read_b128 v[128:131], v182 offset:53248
  ds_write_b32 v180, v154 offset:49152
  s_waitcnt lgkmcnt(4)
  v_mfma_f32_32x32x16_bf16 v[96:111], a[80:83], v[136:139], v[96:111]
  ds_read_b128 v[132:135], v182 offset:54272
  v_and_b32 v206, s28, v94
  v_and_b32 v222, s29, v94
  v_mfma_f32_32x32x16_bf16 v[96:111], a[84:87], v[140:143], v[96:111]
  buffer_load_dwordx4 v1, s[60:63], s25 offen offset:3072 sc1 lds
  ds_read_b128 v[136:139], v182 offset:55296
  v_and_b32 v207, s28, v95
  v_and_b32 v223, s29, v95
  s_waitcnt lgkmcnt(4)
  v_mfma_f32_32x32x16_bf16 v[96:111], a[88:91], v[144:147], v[96:111]
  ds_read_b128 v[140:143], v182 offset:56320
  v_mfma_f32_32x32x16_bf16 v[96:111], a[92:95], v[148:151], v[96:111]
  s_waitcnt lgkmcnt(3)
  s_waitcnt vmcnt(8)
  s_barrier
  ds_read_b32 v232, v3 offset:49152
  ds_read_b32 v233, v3 offset:49408
  ds_read_b32 v234, v3 offset:49664
  ds_read_b32 v235, v3 offset:49920
  ds_read_b128 v[144:147], v182 offset:0
  s_waitcnt lgkmcnt(7)
  v_mfma_f32_32x32x16_bf16 v[96:111], a[96:99], v[128:131], v[96:111]
  s_add_u32 m0, s88, 32768
  s_mov_b32 s25, 460544
  buffer_load_dwordx4 v228, s[44:47], s25 offen offset:0 lds
  ds_read_b64_tr_b16 a[112:113], v165 offset:0
  ds_read_b128 v[148:151], v182 offset:1024
  v_mfma_f32_32x32x16_bf16 v[96:111], a[100:103], v[132:135], v[96:111]
  buffer_load_dwordx4 v229, s[44:47], s25 offen offset:1024 lds
  ds_read_b64_tr_b16 a[114:115], v165 offset:4096
  ds_read_b128 v[128:131], v182 offset:2048
  s_waitcnt lgkmcnt(9)
  v_mfma_f32_32x32x16_bf16 v[96:111], a[104:107], v[136:139], v[96:111]
  ds_read_b64_tr_b16 a[116:117], v165 offset:1024
  ds_read_b128 v[132:135], v182 offset:3072
  s_waitcnt lgkmcnt(10)
  v_rsq_f32 v236, v232
  v_rcp_f32 v240, v232
  v_mul_f32 v236, 0xc0135761, v236
  v_mfma_f32_32x32x16_bf16 v[96:111], a[108:111], v[140:143], v[96:111]
  buffer_load_dwordx4 v230, s[44:47], s25 offen offset:2048 lds
  ds_read_b64_tr_b16 a[118:119], v165 offset:5120
  ds_read_b128 v[136:139], v182 offset:4096
  v_mul_f32 v240, 0x3d372713, v240
  v_mul_f32 v240, v240, v236
  s_waitcnt lgkmcnt(11)
  v_rsq_f32 v237, v233
  v_rcp_f32 v241, v233
  v_mul_f32 v237, 0xc0135761, v237
  s_waitcnt lgkmcnt(6)
  v_mfma_f32_32x32x16_bf16 v[112:127], a[0:3], v[144:147], 0
  ds_read_b64_tr_b16 a[120:121], v165 offset:2048
  ds_read_b128 v[140:143], v182 offset:5120
  v_mul_f32 v241, 0x3d372713, v241
  v_mul_f32 v241, v241, v237
  v_rsq_f32 v238, v234
  v_rcp_f32 v242, v234
  v_mul_f32 v238, 0xc0135761, v238
  v_mfma_f32_32x32x16_bf16 v[112:127], a[4:7], v[148:151], v[112:127]
  buffer_load_dwordx4 v231, s[44:47], s25 offen offset:3072 lds
  ds_read_b64_tr_b16 a[122:123], v165 offset:6144
  ds_read_b128 v[144:147], v182 offset:6144
  v_mul_f32 v242, 0x3d372713, v242
  v_mul_f32 v242, v242, v238
  v_rsq_f32 v239, v235
  v_rcp_f32 v243, v235
  v_mul_f32 v239, 0xc0135761, v239
  s_waitcnt lgkmcnt(6)
  v_mfma_f32_32x32x16_bf16 v[112:127], a[8:11], v[128:131], v[112:127]
  ds_read_b64_tr_b16 a[124:125], v165 offset:3072
  ds_read_b128 v[148:151], v182 offset:7168
  v_mul_f32 v243, 0x3d372713, v243
  v_mul_f32 v243, v243, v239
  v_mul_f32 v152, v96, v96
  v_mul_f32 v153, v97, v97
  v_mfma_f32_32x32x16_bf16 v[112:127], a[12:15], v[132:135], v[112:127]
  s_add_u32 m0, s86, 81920
  s_add_u32 s25, s87, 32768
  buffer_load_dwordx4 v1, s[60:63], s25 offen offset:0 sc1 lds
  ds_read_b64_tr_b16 a[126:127], v165 offset:7168
  ds_read_b128 v[128:131], v182 offset:8192
  v_mul_f32 v154, v98, v98
  s_waitcnt lgkmcnt(6)
  v_mfma_f32_32x32x16_bf16 v[112:127], a[16:19], v[136:139], v[112:127]
  ds_read_b128 v[132:135], v182 offset:9216
  v_mul_f32 v155, v99, v99
  v_fma_f32 v152, v152, v240, v236
  v_fma_f32 v153, v153, v240, v236
  v_fma_f32 v154, v154, v240, v236
  v_fma_f32 v155, v155, v240, v236
  v_mfma_f32_32x32x16_bf16 v[112:127], a[20:23], v[140:143], v[112:127]
  buffer_load_dwordx4 v1, s[60:63], s25 offen offset:1024 sc1 lds
  ds_read_b128 v[136:139], v182 offset:10240
  v_mul_f32 v152, v152, v96
  v_mul_f32 v153, v153, v97
  v_mul_f32 v154, v154, v98
  v_mul_f32 v155, v155, v99
  s_waitcnt lgkmcnt(4)
  v_mfma_f32_32x32x16_bf16 v[112:127], a[24:27], v[144:147], v[112:127]
  ds_read_b128 v[140:143], v182 offset:11264
  v_exp_f32 v152, v152
  v_mul_f32 v104, v104, v96
  v_exp_f32 v153, v153
  v_mfma_f32_32x32x16_bf16 v[112:127], a[28:31], v[148:151], v[112:127]
  buffer_load_dwordx4 v1, s[60:63], s25 offen offset:2048 sc1 lds
  ds_read_b128 v[144:147], v182 offset:12288
  v_mul_f32 v105, v105, v97
  v_exp_f32 v154, v154
  v_mul_f32 v106, v106, v98
  s_waitcnt lgkmcnt(3)
  v_mfma_f32_32x32x16_bf16 v[112:127], a[32:35], v[128:131], v[112:127]
  ds_read_b128 v[148:151], v182 offset:13312
  v_exp_f32 v155, v155
  v_mul_f32 v107, v107, v99
  v_fma_f32 v152, v152, v232, v232
  v_mfma_f32_32x32x16_bf16 v[112:127], a[36:39], v[132:135], v[112:127]
  s_waitcnt vmcnt(11)
  s_barrier
  ds_read_b128 v[128:131], v182 offset:14336
  v_rcp_f32 v152, v152
  v_fma_f32 v153, v153, v232, v232
  s_waitcnt lgkmcnt(3)
  v_mfma_f32_32x32x16_bf16 v[112:127], a[40:43], v[136:139], v[112:127]
  s_add_u32 m0, s88, 0
  s_mov_b32 s25, 689920
  buffer_load_dwordx4 v228, s[44:47], s25 offen offset:0 lds
  ds_read_b64_tr_b16 a[128:129], v165 offset:16384
  ds_read_b128 v[132:135], v182 offset:15360
  v_mfma_f32_32x32x16_bf16 v[112:127], a[44:47], v[140:143], v[112:127]
  buffer_load_dwordx4 v229, s[44:47], s25 offen offset:1024 lds
  ds_read_b64_tr_b16 a[130:131], v165 offset:20480
  ds_read_b128 v[136:139], v182 offset:16384
  v_rcp_f32 v153, v153
  v_fma_f32 v154, v154, v232, v232
  s_waitcnt lgkmcnt(5)
  v_mfma_f32_32x32x16_bf16 v[112:127], a[48:51], v[144:147], v[112:127]
  ds_read_b64_tr_b16 a[132:133], v165 offset:17408
  ds_read_b128 v[140:143], v182 offset:17408
  v_rcp_f32 v154, v154
  v_fma_f32 v155, v155, v232, v232
  v_rcp_f32 v155, v155
  v_mfma_f32_32x32x16_bf16 v[112:127], a[52:55], v[148:151], v[112:127]
  buffer_load_dwordx4 v230, s[44:47], s25 offen offset:2048 lds
  ds_read_b64_tr_b16 a[134:135], v165 offset:21504
  ds_read_b128 v[144:147], v182 offset:18432
  v_mul_f32 v104, v104, v152
  v_mul_f32 v105, v105, v153
  v_mul_f32 v106, v106, v154
  s_waitcnt lgkmcnt(6)
  v_mfma_f32_32x32x16_bf16 v[112:127], a[56:59], v[128:131], v[112:127]
  buffer_load_dwordx4 v231, s[44:47], s25 offen offset:3072 lds
  ds_read_b64_tr_b16 a[136:137], v165 offset:18432
  ds_read_b128 v[148:151], v182 offset:19456
  v_mul_f32 v107, v107, v155
  v_cvt_pk_bf16_f32 v176, v104, v105
  v_cvt_pk_bf16_f32 v177, v106, v107
  v_mfma_f32_32x32x16_bf16 v[112:127], a[60:63], v[132:135], v[112:127]
  ds_read_b64_tr_b16 a[138:139], v165 offset:22528
  ds_read_b128 v[128:131], v182 offset:20480
  v_mul_f32 v156, v100, v100
  v_mul_f32 v157, v101, v101
  v_mul_f32 v158, v102, v102
  v_mul_f32 v159, v103, v103
  s_waitcnt lgkmcnt(6)
  v_mfma_f32_32x32x16_bf16 v[112:127], a[64:67], v[136:139], v[112:127]
  s_add_u32 m0, s86, 49152
  s_add_u32 s25, s87, 86016
  buffer_load_dwordx4 v1, s[60:63], s25 offen offset:0 sc1 lds
  ds_read_b64_tr_b16 a[140:141], v165 offset:19456
  ds_read_b128 v[132:135], v182 offset:21504
  v_fma_f32 v156, v156, v240, v236
  v_mfma_f32_32x32x16_bf16 v[112:127], a[68:71], v[140:143], v[112:127]
  ds_read_b64_tr_b16 a[142:143], v165 offset:23552
  ds_read_b128 v[136:139], v182 offset:22528
  v_fma_f32 v157, v157, v240, v236
  v_fma_f32 v158, v158, v240, v236
  v_fma_f32 v159, v159, v240, v236
  v_mul_f32 v156, v156, v100
  s_waitcnt lgkmcnt(6)
  v_mfma_f32_32x32x16_bf16 v[112:127], a[72:75], v[144:147], v[112:127]
  buffer_load_dwordx4 v1, s[60:63], s25 offen offset:1024 sc1 lds
  ds_read_b128 v[140:143], v182 offset:23552
  v_mul_f32 v157, v157, v101
  v_mul_f32 v158, v158, v102
  v_mul_f32 v159, v159, v103
  v_mfma_f32_32x32x16_bf16 v[112:127], a[76:79], v[148:151], v[112:127]
  buffer_load_dwordx4 v1, s[60:63], s25 offen offset:2048 sc1 lds
  ds_read_b128 v[144:147], v182 offset:24576
  v_exp_f32 v156, v156
  v_mul_f32 v108, v108, v100
  v_exp_f32 v157, v157
  s_waitcnt lgkmcnt(4)
  v_mfma_f32_32x32x16_bf16 v[112:127], a[80:83], v[128:131], v[112:127]
  ds_read_b128 v[148:151], v182 offset:25600
  v_mul_f32 v109, v109, v101
  v_exp_f32 v158, v158
  v_mul_f32 v110, v110, v102
  v_mfma_f32_32x32x16_bf16 v[112:127], a[84:87], v[132:135], v[112:127]
  buffer_load_dwordx4 v1, s[60:63], s25 offen offset:3072 sc1 lds
  ds_read_b128 v[128:131], v182 offset:26624
  v_exp_f32 v159, v159
  v_mul_f32 v111, v111, v103
  v_fma_f32 v156, v156, v232, v232
  s_waitcnt lgkmcnt(3)
  v_mfma_f32_32x32x16_bf16 v[112:127], a[88:91], v[136:139], v[112:127]
  ds_read_b128 v[132:135], v182 offset:27648
  v_rcp_f32 v156, v156
  v_fma_f32 v157, v157, v232, v232
  v_rcp_f32 v157, v157
  v_fma_f32 v158, v158, v232, v232
  v_mfma_f32_32x32x16_bf16 v[112:127], a[92:95], v[140:143], v[112:127]
  s_waitcnt vmcnt(8)
  s_barrier
  ds_read_b128 v[136:139], v183 offset:28672
  v_rcp_f32 v158, v158
  v_fma_f32 v159, v159, v232, v232
  s_waitcnt lgkmcnt(3)
  v_mfma_f32_32x32x16_bf16 v[112:127], a[96:99], v[144:147], v[112:127]
  s_add_u32 m0, s88, 16384
  s_mov_b32 s25, 919296
  buffer_load_dwordx4 v228, s[44:47], s25 offen offset:0 lds
  ds_read_b64_tr_b16 a[144:145], v165 offset:32768
  ds_read_b128 v[140:143], v183 offset:29696
  v_mfma_f32_32x32x16_bf16 v[112:127], a[100:103], v[148:151], v[112:127]
  buffer_load_dwordx4 v229, s[44:47], s25 offen offset:1024 lds
  ds_read_b64_tr_b16 a[146:147], v165 offset:36864
  ds_read_b128 v[144:147], v183 offset:30720
  v_rcp_f32 v159, v159
  v_mul_f32 v108, v108, v156
  v_mul_f32 v109, v109, v157
  s_waitcnt lgkmcnt(5)
  v_mfma_f32_32x32x16_bf16 v[112:127], a[104:107], v[128:131], v[112:127]
  ds_read_b64_tr_b16 a[148:149], v165 offset:33792
  ds_read_b128 v[148:151], v183 offset:31744
  v_mul_f32 v110, v110, v158
  v_mul_f32 v111, v111, v159
  v_cvt_pk_bf16_f32 v178, v108, v109
  v_cvt_pk_bf16_f32 v179, v110, v111
  v_mfma_f32_32x32x16_bf16 v[112:127], a[108:111], v[132:135], v[112:127]
  s_add_u32 s26, s89, 0xb0000
  buffer_store_dwordx4 v[176:179], v1, s[60:63], s26 offen sc1
  ds_read_b64_tr_b16 a[150:151], v165 offset:37888
  ds_read_b128 v[128:131], v183 offset:32768
  s_waitcnt lgkmcnt(6)
  v_mfma_f32_32x32x16_bf16 v[96:111], a[0:3], v[136:139], 0
  buffer_load_dwordx4 v230, s[44:47], s25 offen offset:2048 lds
  ds_read_b64_tr_b16 a[152:153], v165 offset:34816
  ds_read_b128 v[132:135], v183 offset:33792
  v_mfma_f32_32x32x16_bf16 v[96:111], a[4:7], v[140:143], v[96:111]
  ds_read_b64_tr_b16 a[154:155], v165 offset:38912
  ds_read_b128 v[136:139], v183 offset:34816
  s_waitcnt lgkmcnt(6)
  v_mfma_f32_32x32x16_bf16 v[96:111], a[8:11], v[144:147], v[96:111]
  buffer_load_dwordx4 v231, s[44:47], s25 offen offset:3072 lds
  ds_read_b64_tr_b16 a[156:157], v165 offset:35840
  ds_read_b128 v[140:143], v183 offset:35840
  v_mul_f32 v152, v112, v112
  v_mul_f32 v153, v113, v113
  v_mul_f32 v154, v114, v114
  v_mfma_f32_32x32x16_bf16 v[96:111], a[12:15], v[148:151], v[96:111]
  s_add_u32 m0, s86, 53248
  s_add_u32 s25, s87, 90112
  buffer_load_dwordx4 v1, s[60:63], s25 offen offset:0 sc1 lds
  ds_read_b64_tr_b16 a[158:159], v165 offset:39936
  ds_read_b128 v[144:147], v183 offset:36864
  s_waitcnt lgkmcnt(6)
  v_mfma_f32_32x32x16_bf16 v[96:111], a[16:19], v[128:131], v[96:111]
  ds_read_b128 v[148:151], v183 offset:37888
  v_mul_f32 v155, v115, v115
  v_fma_f32 v152, v152, v242, v238
  v_fma_f32 v153, v153, v242, v238
  v_fma_f32 v154, v154, v242, v238
  v_fma_f32 v155, v155, v242, v238
  v_mul_f32 v152, v152, v112
  v_mfma_f32_32x32x16_bf16 v[96:111], a[20:23], v[132:135], v[96:111]
  buffer_load_dwordx4 v1, s[60:63], s25 offen offset:1024 sc1 lds
  ds_read_b128 v[128:131], v183 offset:38912
  v_mul_f32 v153, v153, v113
  v_mul_f32 v154, v154, v114
  v_mul_f32 v155, v155, v115
  s_waitcnt lgkmcnt(4)
  v_mfma_f32_32x32x16_bf16 v[96:111], a[24:27], v[136:139], v[96:111]
  ds_read_b128 v[132:135], v183 offset:39936
  v_exp_f32 v152, v152
  v_mul_f32 v120, v120, v112
  v_exp_f32 v153, v153
  v_mfma_f32_32x32x16_bf16 v[96:111], a[28:31], v[140:143], v[96:111]
  buffer_load_dwordx4 v1, s[60:63], s25 offen offset:2048 sc1 lds
  ds_read_b128 v[136:139], v183 offset:40960
  v_mul_f32 v121, v121, v113
  v_exp_f32 v154, v154
  s_waitcnt lgkmcnt(3)
  v_mfma_f32_32x32x16_bf16 v[96:111], a[32:35], v[144:147], v[96:111]
  ds_read_b128 v[140:143], v183 offset:41984
  v_mul_f32 v122, v122, v114
  v_exp_f32 v155, v155
  v_mul_f32 v123, v123, v115
  v_fma_f32 v152, v152, v234, v234
  v_mfma_f32_32x32x16_bf16 v[96:111], a[36:39], v[148:151], v[96:111]
  s_waitcnt vmcnt(12)
  s_barrier
  ds_read_b128 v[144:147], v183 offset:43008
  v_rcp_f32 v152, v152
  v_fma_f32 v153, v153, v234, v234
  s_waitcnt lgkmcnt(3)
  v_mfma_f32_32x32x16_bf16 v[96:111], a[40:43], v[128:131], v[96:111]
  s_add_u32 m0, s88, 32768
  s_mov_b32 s25, 1148672
  buffer_load_dwordx4 v228, s[44:47], s25 offen offset:0 lds
  ds_read_b64_tr_b16 a[160:161], v165 offset:0
  ds_read_b128 v[148:151], v183 offset:44032
  v_mfma_f32_32x32x16_bf16 v[96:111], a[44:47], v[132:135], v[96:111]
  ds_read_b64_tr_b16 a[162:163], v165 offset:4096
  ds_read_b128 v[128:131], v183 offset:45056
  v_rcp_f32 v153, v153
  v_fma_f32 v154, v154, v234, v234
  s_waitcnt lgkmcnt(5)
  v_mfma_f32_32x32x16_bf16 v[96:111], a[48:51], v[136:139], v[96:111]
  buffer_load_dwordx4 v229, s[44:47], s25 offen offset:1024 lds
  ds_read_b64_tr_b16 a[164:165], v165 offset:1024
  ds_read_b128 v[132:135], v183 offset:46080
  v_rcp_f32 v154, v154
  v_fma_f32 v155, v155, v234, v234
  v_rcp_f32 v155, v155
  v_mfma_f32_32x32x16_bf16 v[96:111], a[52:55], v[140:143], v[96:111]
  ds_read_b64_tr_b16 a[166:167], v165 offset:5120
  ds_read_b128 v[136:139], v183 offset:47104
  v_mul_f32 v120, v120, v152
  v_mul_f32 v121, v121, v153
  v_mul_f32 v122, v122, v154
  s_waitcnt lgkmcnt(6)
  v_mfma_f32_32x32x16_bf16 v[96:111], a[56:59], v[144:147], v[96:111]
  buffer_load_dwordx4 v230, s[44:47], s25 offen offset:2048 lds
  ds_read_b64_tr_b16 a[168:169], v165 offset:2048
  ds_read_b128 v[140:143], v183 offset:48128
  v_mul_f32 v123, v123, v155
  v_cvt_pk_bf16_f32 v176, v120, v121
  v_cvt_pk_bf16_f32 v177, v122, v123
  v_mfma_f32_32x32x16_bf16 v[96:111], a[60:63], v[148:151], v[96:111]
  ds_read_b64_tr_b16 a[170:171], v165 offset:6144
  ds_read_b128 v[144:147], v183 offset:49152
  v_mul_f32 v156, v116, v116
  v_mul_f32 v157, v117, v117
  v_mul_f32 v158, v118, v118
  s_waitcnt lgkmcnt(6)
  v_mfma_f32_32x32x16_bf16 v[96:111], a[64:67], v[128:131], v[96:111]
  buffer_load_dwordx4 v231, s[44:47], s25 offen offset:3072 lds
  ds_read_b64_tr_b16 a[172:173], v165 offset:3072
  ds_read_b128 v[148:151], v183 offset:50176
  v_mul_f32 v159, v119, v119
  v_fma_f32 v156, v156, v242, v238
  v_fma_f32 v157, v157, v242, v238
  v_fma_f32 v158, v158, v242, v238
  v_mfma_f32_32x32x16_bf16 v[96:111], a[68:71], v[132:135], v[96:111]
  ds_read_b64_tr_b16 a[174:175], v165 offset:7168
  ds_read_b128 v[128:131], v183 offset:51200
  v_fma_f32 v159, v159, v242, v238
  v_mul_f32 v156, v156, v116
  v_mul_f32 v157, v157, v117
  s_waitcnt lgkmcnt(6)
  v_mfma_f32_32x32x16_bf16 v[96:111], a[72:75], v[136:139], v[96:111]
  ds_read_b128 v[132:135], v183 offset:52224
  v_mul_f32 v158, v158, v118
  v_mul_f32 v159, v159, v119
  v_exp_f32 v156, v156
  v_mul_f32 v124, v124, v116
  v_mfma_f32_32x32x16_bf16 v[96:111], a[76:79], v[140:143], v[96:111]
  s_waitcnt vmcnt(9)
  buffer_store_byte v5, v4, s[60:63], s90 offen offset:2048 sc1
  ds_read_b128 v[136:139], v183 offset:53248
  v_exp_f32 v157, v157
  s_waitcnt lgkmcnt(4)
  v_mfma_f32_32x32x16_bf16 v[96:111], a[80:83], v[144:147], v[96:111]
  ds_read_b128 v[140:143], v183 offset:54272
  v_mul_f32 v125, v125, v117
  v_exp_f32 v158, v158
  v_mul_f32 v126, v126, v118
  v_exp_f32 v159, v159
  v_mfma_f32_32x32x16_bf16 v[96:111], a[84:87], v[148:151], v[96:111]
  ds_read_b128 v[144:147], v183 offset:55296
  v_mul_f32 v127, v127, v119
  v_fma_f32 v156, v156, v234, v234
  v_rcp_f32 v156, v156
  s_waitcnt lgkmcnt(3)
  v_mfma_f32_32x32x16_bf16 v[96:111], a[88:91], v[128:131], v[96:111]
  ds_read_b128 v[148:151], v183 offset:56320
  v_fma_f32 v157, v157, v234, v234
  v_rcp_f32 v157, v157
  v_fma_f32 v158, v158, v234, v234
  v_mfma_f32_32x32x16_bf16 v[96:111], a[92:95], v[132:135], v[96:111]
  s_waitcnt vmcnt(5)
  s_barrier
  ds_read_b128 v[128:131], v183 offset:0
  v_rcp_f32 v158, v158
  v_fma_f32 v159, v159, v234, v234
  s_waitcnt lgkmcnt(3)
  v_mfma_f32_32x32x16_bf16 v[96:111], a[96:99], v[136:139], v[96:111]
  s_add_u32 m0, s88, 0
  s_mov_b32 s25, 1378048
  buffer_load_dwordx4 v228, s[44:47], s25 offen offset:0 lds
  ds_read_b64_tr_b16 a[176:177], v165 offset:16384
  ds_read_b128 v[132:135], v183 offset:1024
  v_rcp_f32 v159, v159
  v_mfma_f32_32x32x16_bf16 v[96:111], a[100:103], v[140:143], v[96:111]
  ds_read_b64_tr_b16 a[178:179], v165 offset:20480
  ds_read_b128 v[136:139], v183 offset:2048
  v_mul_f32 v124, v124, v156
  v_mul_f32 v125, v125, v157
  v_mul_f32 v126, v126, v158
  s_waitcnt lgkmcnt(5)
  v_mfma_f32_32x32x16_bf16 v[96:111], a[104:107], v[144:147], v[96:111]
  buffer_load_dwordx4 v229, s[44:47], s25 offen offset:1024 lds
  ds_read_b64_tr_b16 a[180:181], v165 offset:17408
  ds_read_b128 v[140:143], v183 offset:3072
  v_mul_f32 v127, v127, v159
  v_cvt_pk_bf16_f32 v178, v124, v125
  v_cvt_pk_bf16_f32 v179, v126, v127
  v_mfma_f32_32x32x16_bf16 v[96:111], a[108:111], v[148:151], v[96:111]
  s_add_u32 s26, s89, 0xe8000
  buffer_store_dwordx4 v[176:179], v1, s[60:63], s26 offen sc1
  ds_read_b64_tr_b16 a[182:183], v165 offset:21504
  ds_read_b128 v[144:147], v183 offset:4096
  s_waitcnt lgkmcnt(6)
  v_mfma_f32_32x32x16_bf16 v[112:127], a[0:3], v[128:131], 0
  ds_read_b64_tr_b16 a[184:185], v165 offset:18432
  ds_read_b128 v[148:151], v183 offset:5120
  v_mfma_f32_32x32x16_bf16 v[112:127], a[4:7], v[132:135], v[112:127]
  buffer_load_dwordx4 v230, s[44:47], s25 offen offset:2048 lds
  ds_read_b64_tr_b16 a[186:187], v165 offset:22528
  ds_read_b128 v[128:131], v183 offset:6144
  s_waitcnt lgkmcnt(6)
  v_mfma_f32_32x32x16_bf16 v[112:127], a[8:11], v[136:139], v[112:127]
  ds_read_b64_tr_b16 a[188:189], v165 offset:19456
  ds_read_b128 v[132:135], v183 offset:7168
  v_mul_f32 v152, v96, v96
  v_mul_f32 v153, v97, v97
  v_mul_f32 v154, v98, v98
  v_mul_f32 v155, v99, v99
  v_mfma_f32_32x32x16_bf16 v[112:127], a[12:15], v[140:143], v[112:127]
  buffer_load_dwordx4 v231, s[44:47], s25 offen offset:3072 lds
  ds_read_b64_tr_b16 a[190:191], v165 offset:23552
  ds_read_b128 v[136:139], v183 offset:8192
  v_fma_f32 v152, v152, v241, v237
  v_fma_f32 v153, v153, v241, v237
  s_waitcnt lgkmcnt(6)
  v_mfma_f32_32x32x16_bf16 v[112:127], a[16:19], v[144:147], v[112:127]
  ds_read_b128 v[140:143], v183 offset:9216
  v_fma_f32 v154, v154, v241, v237
  v_fma_f32 v155, v155, v241, v237
  v_mul_f32 v152, v152, v96
  v_mul_f32 v153, v153, v97
  v_mul_f32 v154, v154, v98
  v_mfma_f32_32x32x16_bf16 v[112:127], a[20:23], v[148:151], v[112:127]
  ds_read_b128 v[144:147], v183 offset:10240
  v_mul_f32 v155, v155, v99
  v_exp_f32 v152, v152
  v_mul_f32 v104, v104, v96
  s_waitcnt lgkmcnt(4)
  v_mfma_f32_32x32x16_bf16 v[112:127], a[24:27], v[128:131], v[112:127]
  ds_read_b128 v[148:151], v183 offset:11264
  v_exp_f32 v153, v153
  v_mul_f32 v105, v105, v97
  v_exp_f32 v154, v154
  v_mfma_f32_32x32x16_bf16 v[112:127], a[28:31], v[132:135], v[112:127]
  ds_read_b128 v[128:131], v183 offset:12288
  v_mul_f32 v106, v106, v98
  v_exp_f32 v155, v155
  v_mul_f32 v107, v107, v99
  s_waitcnt lgkmcnt(3)
  v_mfma_f32_32x32x16_bf16 v[112:127], a[32:35], v[136:139], v[112:127]
  ds_read_b128 v[132:135], v183 offset:13312
  v_fma_f32 v152, v152, v233, v233
  v_rcp_f32 v152, v152
  v_fma_f32 v153, v153, v233, v233
  v_mfma_f32_32x32x16_bf16 v[112:127], a[36:39], v[140:143], v[112:127]
  s_waitcnt vmcnt(6)
  s_barrier
  ds_read_b128 v[136:139], v183 offset:14336
  v_rcp_f32 v153, v153
  v_fma_f32 v154, v154, v233, v233
  s_waitcnt lgkmcnt(3)
  v_mfma_f32_32x32x16_bf16 v[112:127], a[40:43], v[144:147], v[112:127]
  s_add_u32 m0, s88, 16384
  s_add_u32 s25, s64, 0
  buffer_load_dwordx4 v224, s[48:51], s25 offen offset:0 lds
  ds_read_b64_tr_b16 a[192:193], v165 offset:32768
  ds_read_b128 v[140:143], v183 offset:15360
  v_mfma_f32_32x32x16_bf16 v[112:127], a[44:47], v[148:151], v[112:127]
  ds_read_b64_tr_b16 a[194:195], v165 offset:36864
  ds_read_b128 v[144:147], v183 offset:16384
  v_rcp_f32 v154, v154
  v_fma_f32 v155, v155, v233, v233
  s_waitcnt lgkmcnt(5)
  v_mfma_f32_32x32x16_bf16 v[112:127], a[48:51], v[128:131], v[112:127]
  buffer_load_dwordx4 v225, s[48:51], s25 offen offset:1024 lds
  ds_read_b64_tr_b16 a[196:197], v165 offset:33792
  ds_read_b128 v[148:151], v183 offset:17408
  v_rcp_f32 v155, v155
  v_mul_f32 v104, v104, v152
  v_mul_f32 v105, v105, v153
  v_mul_f32 v106, v106, v154
  v_mfma_f32_32x32x16_bf16 v[112:127], a[52:55], v[132:135], v[112:127]
  ds_read_b64_tr_b16 a[198:199], v165 offset:37888
  ds_read_b128 v[128:131], v183 offset:18432
  v_mul_f32 v107, v107, v155
  v_cvt_pk_bf16_f32 v176, v104, v105
  v_cvt_pk_bf16_f32 v177, v106, v107
  s_waitcnt lgkmcnt(6)
  v_mfma_f32_32x32x16_bf16 v[112:127], a[56:59], v[136:139], v[112:127]
  buffer_load_dwordx4 v226, s[48:51], s25 offen offset:2048 lds
  ds_read_b64_tr_b16 a[200:201], v165 offset:34816
  ds_read_b128 v[132:135], v183 offset:19456
  v_mul_f32 v156, v100, v100
  v_mul_f32 v157, v101, v101
  v_mul_f32 v158, v102, v102
  v_mfma_f32_32x32x16_bf16 v[112:127], a[60:63], v[140:143], v[112:127]
  ds_read_b64_tr_b16 a[202:203], v165 offset:38912
  ds_read_b128 v[136:139], v183 offset:20480
  v_mul_f32 v159, v103, v103
  v_fma_f32 v156, v156, v241, v237
  v_fma_f32 v157, v157, v241, v237
  s_waitcnt lgkmcnt(6)
  v_mfma_f32_32x32x16_bf16 v[112:127], a[64:67], v[144:147], v[112:127]
  buffer_load_dwordx4 v227, s[48:51], s25 offen offset:3072 lds
  ds_read_b64_tr_b16 a[204:205], v165 offset:35840
  ds_read_b128 v[140:143], v183 offset:21504
  v_fma_f32 v158, v158, v241, v237
  v_fma_f32 v159, v159, v241, v237
  v_mul_f32 v156, v156, v100
  v_mfma_f32_32x32x16_bf16 v[112:127], a[68:71], v[148:151], v[112:127]
  ds_read_b64_tr_b16 a[206:207], v165 offset:39936
  ds_read_b128 v[144:147], v183 offset:22528
  v_mul_f32 v157, v157, v101
  v_mul_f32 v158, v158, v102
  v_mul_f32 v159, v159, v103
  s_waitcnt lgkmcnt(6)
  v_mfma_f32_32x32x16_bf16 v[112:127], a[72:75], v[128:131], v[112:127]
  ds_read_b128 v[148:151], v183 offset:23552
  v_exp_f32 v156, v156
  v_mul_f32 v108, v108, v100
  v_exp_f32 v157, v157
  v_mfma_f32_32x32x16_bf16 v[112:127], a[76:79], v[132:135], v[112:127]
  s_waitcnt vmcnt(6)
  buffer_store_byte v5, v4, s[60:63], s90 offen offset:2304 sc1
  ds_read_b128 v[128:131], v183 offset:24576
  v_mul_f32 v109, v109, v101
  s_waitcnt lgkmcnt(4)
  v_mfma_f32_32x32x16_bf16 v[112:127], a[80:83], v[136:139], v[112:127]
  ds_read_b128 v[132:135], v183 offset:25600
  v_exp_f32 v158, v158
  v_mul_f32 v110, v110, v102
  v_exp_f32 v159, v159
  v_mul_f32 v111, v111, v103
  v_mfma_f32_32x32x16_bf16 v[112:127], a[84:87], v[140:143], v[112:127]
  ds_read_b128 v[136:139], v183 offset:26624
  v_fma_f32 v156, v156, v233, v233
  v_rcp_f32 v156, v156
  v_fma_f32 v157, v157, v233, v233
  s_waitcnt lgkmcnt(3)
  v_mfma_f32_32x32x16_bf16 v[112:127], a[88:91], v[144:147], v[112:127]
  ds_read_b128 v[140:143], v183 offset:27648
  v_rcp_f32 v157, v157
  v_fma_f32 v158, v158, v233, v233
  v_rcp_f32 v158, v158
  v_mfma_f32_32x32x16_bf16 v[112:127], a[92:95], v[148:151], v[112:127]
  s_waitcnt vmcnt(5)
  s_barrier
  ds_read_b128 v[144:147], v182 offset:28672
  v_fma_f32 v159, v159, v233, v233
  s_waitcnt lgkmcnt(3)
  v_mfma_f32_32x32x16_bf16 v[112:127], a[96:99], v[128:131], v[112:127]
  s_add_u32 m0, s88, 32768
  s_add_u32 s25, s64, 114688
  buffer_load_dwordx4 v224, s[48:51], s25 offen offset:0 lds
  ds_read_b64_tr_b16 a[208:209], v165 offset:0
  ds_read_b128 v[148:151], v182 offset:29696
  v_rcp_f32 v159, v159
  v_mfma_f32_32x32x16_bf16 v[112:127], a[100:103], v[132:135], v[112:127]
  ds_read_b64_tr_b16 a[210:211], v165 offset:4096
  ds_read_b128 v[128:131], v182 offset:30720
  v_mul_f32 v108, v108, v156
  v_mul_f32 v109, v109, v157
  v_mul_f32 v110, v110, v158
  s_waitcnt lgkmcnt(5)
  v_mfma_f32_32x32x16_bf16 v[112:127], a[104:107], v[136:139], v[112:127]
  buffer_load_dwordx4 v225, s[48:51], s25 offen offset:1024 lds
  ds_read_b64_tr_b16 a[212:213], v165 offset:1024
  ds_read_b128 v[132:135], v182 offset:31744
  v_mul_f32 v111, v111, v159
  v_cvt_pk_bf16_f32 v178, v108, v109
  v_cvt_pk_bf16_f32 v179, v110, v111
  v_mfma_f32_32x32x16_bf16 v[112:127], a[108:111], v[140:143], v[112:127]
  s_add_u32 s26, s89, 0xcc000
  buffer_store_dwordx4 v[176:179], v1, s[60:63], s26 offen sc1
  ds_read_b64_tr_b16 a[214:215], v165 offset:5120
  ds_read_b128 v[136:139], v182 offset:32768
  s_waitcnt lgkmcnt(6)
  v_mfma_f32_32x32x16_bf16 v[96:111], a[112:115], v[144:147], 0
  buffer_load_dwordx4 v226, s[48:51], s25 offen offset:2048 lds
  ds_read_b64_tr_b16 a[216:217], v165 offset:2048
  ds_read_b128 v[140:143], v182 offset:33792
  v_mfma_f32_32x32x16_bf16 v[96:111], a[116:119], v[148:151], v[96:111]
  ds_read_b64_tr_b16 a[218:219], v165 offset:6144
  ds_read_b128 v[144:147], v182 offset:34816
  s_waitcnt lgkmcnt(6)
  v_mfma_f32_32x32x16_bf16 v[96:111], a[120:123], v[128:131], v[96:111]
  buffer_load_dwordx4 v227, s[48:51], s25 offen offset:3072 lds
  ds_read_b64_tr_b16 a[220:221], v165 offset:3072
  s_waitcnt vmcnt(9)
  ds_read_b64_tr_b16 v[16:17], v184 offset:16384
  ds_read_b64_tr_b16 v[20:21], v185 offset:16384
  ds_read_b128 v[148:151], v182 offset:35840
  v_mul_f32 v152, v112, v112
  v_mfma_f32_32x32x16_bf16 v[96:111], a[124:127], v[132:135], v[96:111]
  ds_read_b64_tr_b16 a[222:223], v165 offset:7168
  ds_read_b128 v[128:131], v182 offset:36864
  v_mul_f32 v153, v113, v113
  v_mul_f32 v154, v114, v114
  v_mul_f32 v155, v115, v115
  v_fma_f32 v152, v152, v243, v239
  s_waitcnt lgkmcnt(8)
  v_mfma_f32_32x32x16_bf16 v[96:111], a[128:131], v[136:139], v[96:111]
  s_waitcnt vmcnt(8)
  ds_read_b64_tr_b16 v[18:19], v184 offset:17408
  ds_read_b64_tr_b16 v[22:23], v185 offset:17408
  ds_read_b128 v[132:135], v182 offset:37888
  v_fma_f32 v153, v153, v243, v239
  v_fma_f32 v154, v154, v243, v239
  v_fma_f32 v155, v155, v243, v239
  v_mfma_f32_32x32x16_bf16 v[96:111], a[132:135], v[140:143], v[96:111]
  ds_read_b128 v[136:139], v182 offset:38912
  v_mul_f32 v152, v152, v112
  v_mul_f32 v153, v153, v113
  v_mul_f32 v154, v154, v114
  v_mul_f32 v155, v155, v115
  s_waitcnt lgkmcnt(6)
  v_mfma_f32_32x32x16_bf16 v[96:111], a[136:139], v[144:147], v[96:111]
  s_waitcnt vmcnt(7)
  ds_read_b64_tr_b16 v[24:25], v184 offset:18432
  ds_read_b64_tr_b16 v[28:29], v185 offset:18432
  ds_read_b128 v[140:143], v182 offset:39936
  v_exp_f32 v152, v152
  v_mul_f32 v120, v120, v112
  v_mfma_f32_32x32x16_bf16 v[96:111], a[140:143], v[148:151], v[96:111]
  ds_read_b128 v[144:147], v182 offset:40960
  v_exp_f32 v153, v153
  v_mul_f32 v121, v121, v113
  v_exp_f32 v154, v154
  s_waitcnt lgkmcnt(5)
  v_mfma_f32_32x32x16_bf16 v[96:111], a[144:147], v[128:131], v[96:111]
  s_waitcnt vmcnt(6)
  ds_read_b64_tr_b16 v[26:27], v184 offset:19456
  ds_read_b64_tr_b16 v[30:31], v185 offset:19456
  ds_read_b128 v[148:151], v182 offset:41984
  v_mul_f32 v122, v122, v114
  v_exp_f32 v155, v155
  v_mfma_f32_32x32x16_bf16 v[96:111], a[148:151], v[132:135], v[96:111]
  s_barrier
  ds_read_b128 v[128:131], v182 offset:43008
  v_mul_f32 v123, v123, v115
  v_fma_f32 v152, v152, v235, v235
  s_waitcnt lgkmcnt(5)
  v_mfma_f32_32x32x16_bf16 v[96:111], a[152:155], v[136:139], v[96:111]
  s_add_u32 m0, s88, 0
  s_add_u32 s25, s64, 229376
  buffer_load_dwordx4 v224, s[48:51], s25 offen offset:0 lds
  ds_read_b128 v[132:135], v182 offset:44032
  v_rcp_f32 v152, v152
  v_fma_f32 v153, v153, v235, v235
  v_mfma_f32_32x32x16_bf16 v[96:111], a[156:159], v[140:143], v[96:111]
  ds_read_b128 v[136:139], v182 offset:45056
  v_rcp_f32 v153, v153
  v_fma_f32 v154, v154, v235, v235
  v_rcp_f32 v154, v154
  s_waitcnt lgkmcnt(3)
  v_mfma_f32_32x32x16_bf16 v[96:111], a[160:163], v[144:147], v[96:111]
  buffer_load_dwordx4 v225, s[48:51], s25 offen offset:1024 lds
  ds_read_b128 v[140:143], v182 offset:46080
  v_fma_f32 v155, v155, v235, v235
  v_rcp_f32 v155, v155
  v_mul_f32 v120, v120, v152
  v_mul_f32 v121, v121, v153
  v_mfma_f32_32x32x16_bf16 v[96:111], a[164:167], v[148:151], v[96:111]
  ds_read_b128 v[144:147], v182 offset:47104
  v_mul_f32 v122, v122, v154
  v_mul_f32 v123, v123, v155
  v_cvt_pk_bf16_f32 v176, v120, v121
  v_cvt_pk_bf16_f32 v177, v122, v123
  v_mul_f32 v156, v116, v116
  s_waitcnt lgkmcnt(3)
  v_mfma_f32_32x32x16_bf16 v[96:111], a[168:171], v[128:131], v[96:111]
  buffer_load_dwordx4 v226, s[48:51], s25 offen offset:2048 lds
  ds_read_b128 v[148:151], v182 offset:48128
  v_mul_f32 v157, v117, v117
  v_mul_f32 v158, v118, v118
  v_mul_f32 v159, v119, v119
  v_fma_f32 v156, v156, v243, v239
  v_fma_f32 v157, v157, v243, v239
  v_mfma_f32_32x32x16_bf16 v[96:111], a[172:175], v[132:135], v[96:111]
  ds_read_b128 v[128:131], v182 offset:49152
  v_fma_f32 v158, v158, v243, v239
  v_fma_f32 v159, v159, v243, v239
  v_mul_f32 v156, v156, v116
  v_mul_f32 v157, v157, v117
  v_mul_f32 v158, v158, v118
  s_waitcnt lgkmcnt(3)
  v_mfma_f32_32x32x16_bf16 v[96:111], a[176:179], v[136:139], v[96:111]
  buffer_load_dwordx4 v227, s[48:51], s25 offen offset:3072 lds
  s_waitcnt vmcnt(8)
  ds_read_b64_tr_b16 v[32:33], v184 offset:32768
  ds_read_b64_tr_b16 v[36:37], v185 offset:32768
  ds_read_b128 v[132:135], v182 offset:50176
  v_mul_f32 v159, v159, v119
  v_mfma_f32_32x32x16_bf16 v[96:111], a[180:183], v[140:143], v[96:111]
  ds_read_b128 v[136:139], v182 offset:51200
  v_exp_f32 v156, v156
  v_mul_f32 v124, v124, v116
  v_exp_f32 v157, v157
  v_mul_f32 v125, v125, v117
  s_waitcnt lgkmcnt(5)
  v_mfma_f32_32x32x16_bf16 v[96:111], a[184:187], v[144:147], v[96:111]
  s_add_u32 m0, s88, 16384
  s_add_u32 s25, s64, 344064
  buffer_load_dwordx4 v224, s[48:51], s25 offen offset:0 lds
  s_waitcnt vmcnt(8)
  ds_read_b64_tr_b16 v[34:35], v184 offset:33792
  ds_read_b64_tr_b16 v[38:39], v185 offset:33792
  ds_read_b128 v[140:143], v182 offset:52224
  v_mfma_f32_32x32x16_bf16 v[96:111], a[188:191], v[148:151], v[96:111]
  s_waitcnt vmcnt(7)
  buffer_store_byte v5, v4, s[60:63], s90 offen offset:2176 sc1
  ds_read_b128 v[144:147], v182 offset:53248
  v_exp_f32 v158, v158
  s_waitcnt lgkmcnt(5)
  v_mfma_f32_32x32x16_bf16 v[96:111], a[192:195], v[128:131], v[96:111]
  buffer_load_dwordx4 v225, s[48:51], s25 offen offset:1024 lds
  s_waitcnt vmcnt(8)
  ds_read_b64_tr_b16 v[40:41], v184 offset:34816
  ds_read_b64_tr_b16 v[44:45], v185 offset:34816
  ds_read_b128 v[148:151], v182 offset:54272
  v_mul_f32 v126, v126, v118
  v_mfma_f32_32x32x16_bf16 v[96:111], a[196:199], v[132:135], v[96:111]
  ds_read_b128 v[128:131], v182 offset:55296
  v_exp_f32 v159, v159
  v_mul_f32 v127, v127, v119
  v_fma_f32 v156, v156, v235, v235
  s_waitcnt lgkmcnt(5)
  v_mfma_f32_32x32x16_bf16 v[96:111], a[200:203], v[136:139], v[96:111]
  buffer_load_dwordx4 v226, s[48:51], s25 offen offset:2048 lds
  s_waitcnt vmcnt(8)
  ds_read_b64_tr_b16 v[42:43], v184 offset:35840
  ds_read_b64_tr_b16 v[46:47], v185 offset:35840
  ds_read_b128 v[132:135], v182 offset:56320
  v_rcp_f32 v156, v156
  v_mfma_f32_32x32x16_bf16 v[96:111], a[204:207], v[140:143], v[96:111]
  ds_read_b128 v[136:139], v182 offset:0
  v_fma_f32 v157, v157, v235, v235
  v_rcp_f32 v157, v157
  v_fma_f32 v158, v158, v235, v235
  s_waitcnt lgkmcnt(5)
  v_mfma_f32_32x32x16_bf16 v[96:111], a[208:211], v[144:147], v[96:111]
  buffer_load_dwordx4 v227, s[48:51], s25 offen offset:3072 lds
  ds_read_b128 v[140:143], v182 offset:1024
  v_rcp_f32 v158, v158
  v_fma_f32 v159, v159, v235, v235
  v_rcp_f32 v159, v159
  v_mfma_f32_32x32x16_bf16 v[96:111], a[212:215], v[148:151], v[96:111]
  ds_read_b128 v[144:147], v182 offset:2048
  v_mul_f32 v124, v124, v156
  v_mul_f32 v125, v125, v157
  v_mul_f32 v126, v126, v158
  v_mul_f32 v127, v127, v159
  v_cvt_pk_bf16_f32 v178, v124, v125
  s_waitcnt lgkmcnt(3)
  v_mfma_f32_32x32x16_bf16 v[96:111], a[216:219], v[128:131], v[96:111]
  s_add_u32 m0, s88, 32768
  s_add_u32 s25, s64, 458752
  buffer_load_dwordx4 v224, s[48:51], s25 offen offset:0 lds
  ds_read_b128 v[148:151], v182 offset:3072
  v_cvt_pk_bf16_f32 v179, v126, v127
  v_mfma_f32_32x32x16_bf16 v[96:111], a[220:223], v[132:135], v[96:111]
  s_add_u32 s26, s89, 0x104000
  buffer_store_dwordx4 v[176:179], v1, s[60:63], s26 offen sc1
  ds_read_b128 v[128:131], v182 offset:4096
  s_waitcnt lgkmcnt(3)
  v_mfma_f32_32x32x16_bf16 v[112:127], a[112:115], v[136:139], 0
  buffer_load_dwordx4 v225, s[48:51], s25 offen offset:1024 lds
  ds_read_b128 v[132:135], v182 offset:5120
  v_mfma_f32_32x32x16_bf16 v[112:127], a[116:119], v[140:143], v[112:127]
  s_waitcnt vmcnt(11)
  ds_read_b64_tr_b16 v[48:49], v184 offset:0
  ds_read_b64_tr_b16 v[52:53], v185 offset:0
  ds_read_b128 v[136:139], v182 offset:6144
  s_waitcnt lgkmcnt(5)
  v_mfma_f32_32x32x16_bf16 v[112:127], a[120:123], v[144:147], v[112:127]
  buffer_load_dwordx4 v226, s[48:51], s25 offen offset:2048 lds
  ds_read_b128 v[140:143], v182 offset:7168
  v_mul_f32 v152, v96, v96
  v_mul_f32 v153, v97, v97
  v_mul_f32 v154, v98, v98
  v_mul_f32 v155, v99, v99
  v_fma_f32 v152, v152, v240, v236
  v_mfma_f32_32x32x16_bf16 v[112:127], a[124:127], v[148:151], v[112:127]
  s_waitcnt vmcnt(11)
  ds_read_b64_tr_b16 v[50:51], v184 offset:1024
  ds_read_b64_tr_b16 v[54:55], v185 offset:1024
  ds_read_b128 v[144:147], v182 offset:8192
  v_fma_f32 v153, v153, v240, v236
  v_fma_f32 v154, v154, v240, v236
  s_waitcnt lgkmcnt(7)
  v_mfma_f32_32x32x16_bf16 v[112:127], a[128:131], v[128:131], v[112:127]
  buffer_load_dwordx4 v227, s[48:51], s25 offen offset:3072 lds
  ds_read_b128 v[148:151], v182 offset:9216
  v_fma_f32 v155, v155, v240, v236
  v_mul_f32 v152, v152, v96
  v_mul_f32 v153, v153, v97
  v_mul_f32 v154, v154, v98
  v_mul_f32 v155, v155, v99
  v_mfma_f32_32x32x16_bf16 v[112:127], a[132:135], v[132:135], v[112:127]
  s_waitcnt vmcnt(11)
  ds_read_b64_tr_b16 v[56:57], v184 offset:2048
  ds_read_b64_tr_b16 v[60:61], v185 offset:2048
  ds_read_b128 v[128:131], v182 offset:10240
  v_exp_f32 v152, v152
  v_mul_f32 v104, v104, v96
  s_waitcnt lgkmcnt(7)
  v_mfma_f32_32x32x16_bf16 v[112:127], a[136:139], v[136:139], v[112:127]
  s_add_u32 m0, s88, 0
  s_add_u32 s25, s64, 573440
  buffer_load_dwordx4 v224, s[48:51], s25 offen offset:0 lds
  ds_read_b128 v[132:135], v182 offset:11264
  v_exp_f32 v153, v153
  v_mfma_f32_32x32x16_bf16 v[112:127], a[140:143], v[140:143], v[112:127]
  s_waitcnt vmcnt(11)
  ds_read_b64_tr_b16 v[58:59], v184 offset:3072
  ds_read_b64_tr_b16 v[62:63], v185 offset:3072
  ds_read_b128 v[136:139], v182 offset:12288
  v_mul_f32 v105, v105, v97
  v_exp_f32 v154, v154
  s_waitcnt lgkmcnt(7)
  v_mfma_f32_32x32x16_bf16 v[112:127], a[144:147], v[144:147], v[112:127]
  buffer_load_dwordx4 v225, s[48:51], s25 offen offset:1024 lds
  ds_read_b128 v[140:143], v182 offset:13312
  v_mul_f32 v106, v106, v98
  v_exp_f32 v155, v155
  v_mul_f32 v107, v107, v99
  v_fma_f32 v152, v152, v232, v232
  v_mfma_f32_32x32x16_bf16 v[112:127], a[148:151], v[148:151], v[112:127]
  s_waitcnt vmcnt(11)
  ds_read_b64_tr_b16 v[64:65], v184 offset:16384
  ds_read_b64_tr_b16 v[68:69], v185 offset:16384
  ds_read_b128 v[144:147], v182 offset:14336
  v_rcp_f32 v152, v152
  s_waitcnt lgkmcnt(7)
  v_mfma_f32_32x32x16_bf16 v[112:127], a[152:155], v[128:131], v[112:127]
  buffer_load_dwordx4 v226, s[48:51], s25 offen offset:2048 lds
  ds_read_b128 v[148:151], v182 offset:15360
  v_fma_f32 v153, v153, v232, v232
  v_rcp_f32 v153, v153
  v_fma_f32 v154, v154, v232, v232
  v_mfma_f32_32x32x16_bf16 v[112:127], a[156:159], v[132:135], v[112:127]
  s_waitcnt vmcnt(10)
  ds_read_b64_tr_b16 v[66:67], v184 offset:17408
  ds_read_b64_tr_b16 v[70:71], v185 offset:17408
  ds_read_b128 v[128:131], v182 offset:16384
  v_rcp_f32 v154, v154
  v_fma_f32 v155, v155, v232, v232
  s_waitcnt lgkmcnt(7)
  v_mfma_f32_32x32x16_bf16 v[112:127], a[160:163], v[136:139], v[112:127]
  buffer_load_dwordx4 v227, s[48:51], s25 offen offset:3072 lds
  ds_read_b128 v[132:135], v182 offset:17408
  v_rcp_f32 v155, v155
  v_mul_f32 v104, v104, v152
  v_mul_f32 v105, v105, v153
  v_mul_f32 v106, v106, v154
  v_mfma_f32_32x32x16_bf16 v[112:127], a[164:167], v[140:143], v[112:127]
  s_waitcnt vmcnt(10)
  ds_read_b64_tr_b16 v[72:73], v184 offset:18432
  ds_read_b64_tr_b16 v[76:77], v185 offset:18432
  ds_read_b128 v[136:139], v182 offset:18432
  v_mul_f32 v107, v107, v155
  v_cvt_pk_bf16_f32 v176, v104, v105
  v_cvt_pk_bf16_f32 v177, v106, v107
  s_waitcnt lgkmcnt(7)
  v_mfma_f32_32x32x16_bf16 v[112:127], a[168:171], v[144:147], v[112:127]
  s_add_u32 m0, s88, 16384
  s_add_u32 s25, s64, 688128
  buffer_load_dwordx4 v224, s[48:51], s25 offen offset:0 lds
  ds_read_b128 v[140:143], v182 offset:19456
  v_mul_f32 v156, v100, v100
  v_mul_f32 v157, v101, v101
  v_mfma_f32_32x32x16_bf16 v[112:127], a[172:175], v[148:151], v[112:127]
  s_waitcnt vmcnt(10)
  ds_read_b64_tr_b16 v[74:75], v184 offset:19456
  ds_read_b64_tr_b16 v[78:79], v185 offset:19456
  ds_read_b128 v[144:147], v182 offset:20480
  v_mul_f32 v158, v102, v102
  v_mul_f32 v159, v103, v103
  v_fma_f32 v156, v156, v240, v236
  s_waitcnt lgkmcnt(7)
  v_mfma_f32_32x32x16_bf16 v[112:127], a[176:179], v[128:131], v[112:127]
  buffer_load_dwordx4 v225, s[48:51], s25 offen offset:1024 lds
  ds_read_b128 v[148:151], v182 offset:21504
  v_fma_f32 v157, v157, v240, v236
  v_fma_f32 v158, v158, v240, v236
  v_fma_f32 v159, v159, v240, v236
  v_mul_f32 v156, v156, v100
  v_mul_f32 v157, v157, v101
  v_mfma_f32_32x32x16_bf16 v[112:127], a[180:183], v[132:135], v[112:127]
  s_waitcnt vmcnt(10)
  ds_read_b64_tr_b16 v[80:81], v184 offset:32768
  ds_read_b64_tr_b16 v[84:85], v185 offset:32768
  ds_read_b128 v[128:131], v182 offset:22528
  v_mul_f32 v158, v158, v102
  v_mul_f32 v159, v159, v103
  s_waitcnt lgkmcnt(7)
  v_mfma_f32_32x32x16_bf16 v[112:127], a[184:187], v[136:139], v[112:127]
  buffer_load_dwordx4 v226, s[48:51], s25 offen offset:2048 lds
  ds_read_b128 v[132:135], v182 offset:23552
  v_exp_f32 v156, v156
  v_mul_f32 v108, v108, v100
  v_exp_f32 v157, v157
  v_mfma_f32_32x32x16_bf16 v[112:127], a[188:191], v[140:143], v[112:127]
  s_waitcnt vmcnt(10)
  buffer_store_byte v5, v4, s[60:63], s90 offen offset:2432 sc1
  s_waitcnt vmcnt(10)
  ds_read_b64_tr_b16 v[82:83], v184 offset:33792
  ds_read_b64_tr_b16 v[86:87], v185 offset:33792
  ds_read_b128 v[136:139], v182 offset:24576
  v_mul_f32 v109, v109, v101
  s_waitcnt lgkmcnt(7)
  v_mfma_f32_32x32x16_bf16 v[112:127], a[192:195], v[144:147], v[112:127]
  buffer_load_dwordx4 v227, s[48:51], s25 offen offset:3072 lds
  ds_read_b128 v[140:143], v182 offset:25600
  v_exp_f32 v158, v158
  v_mul_f32 v110, v110, v102
  v_mfma_f32_32x32x16_bf16 v[112:127], a[196:199], v[148:151], v[112:127]
  s_waitcnt vmcnt(10)
  ds_read_b64_tr_b16 v[88:89], v184 offset:34816
  ds_read_b64_tr_b16 v[92:93], v185 offset:34816
  ds_read_b128 v[144:147], v182 offset:26624
  v_exp_f32 v159, v159
  v_mul_f32 v111, v111, v103
  v_fma_f32 v156, v156, v232, v232
  s_waitcnt lgkmcnt(7)
  v_mfma_f32_32x32x16_bf16 v[112:127], a[200:203], v[128:131], v[112:127]
  s_add_u32 m0, s88, 32768
  s_add_u32 s25, s64, 802816
  buffer_load_dwordx4 v224, s[48:51], s25 offen offset:0 lds
  ds_read_b128 v[148:151], v182 offset:27648
  v_rcp_f32 v156, v156
  v_fma_f32 v157, v157, v232, v232
  v_mfma_f32_32x32x16_bf16 v[112:127], a[204:207], v[132:135], v[112:127]
  s_waitcnt vmcnt(10)
  ds_read_b64_tr_b16 v[90:91], v184 offset:35840
  ds_read_b64_tr_b16 v[94:95], v185 offset:35840
  ds_read_b128 v[128:131], v183 offset:28672
  v_rcp_f32 v157, v157
  s_waitcnt lgkmcnt(7)
  v_mfma_f32_32x32x16_bf16 v[112:127], a[208:211], v[136:139], v[112:127]
  buffer_load_dwordx4 v225, s[48:51], s25 offen offset:1024 lds
  ds_read_b128 v[132:135], v183 offset:29696
  v_fma_f32 v158, v158, v232, v232
  v_rcp_f32 v158, v158
  v_fma_f32 v159, v159, v232, v232
  v_mfma_f32_32x32x16_bf16 v[112:127], a[212:215], v[140:143], v[112:127]
  s_waitcnt vmcnt(10)
  ds_read_b64_tr_b16 a[224:225], v184 offset:0
  ds_read_b64_tr_b16 a[228:229], v185 offset:0
  ds_read_b128 v[136:139], v183 offset:30720
  v_rcp_f32 v159, v159
  v_mul_f32 v108, v108, v156
  v_mul_f32 v109, v109, v157
  s_waitcnt lgkmcnt(7)
  v_mfma_f32_32x32x16_bf16 v[112:127], a[216:219], v[144:147], v[112:127]
  buffer_load_dwordx4 v226, s[48:51], s25 offen offset:2048 lds
  ds_read_b128 v[140:143], v183 offset:31744
  v_mul_f32 v110, v110, v158
  v_mul_f32 v111, v111, v159
  v_cvt_pk_bf16_f32 v178, v108, v109
  v_cvt_pk_bf16_f32 v179, v110, v111
  v_mfma_f32_32x32x16_bf16 v[112:127], a[220:223], v[148:151], v[112:127]
  s_add_u32 s26, s89, 0xb3800
  buffer_store_dwordx4 v[176:179], v1, s[60:63], s26 offen sc1
  s_waitcnt vmcnt(11)
  ds_read_b64_tr_b16 a[226:227], v184 offset:1024
  ds_read_b64_tr_b16 a[230:231], v185 offset:1024
  ds_read_b128 v[144:147], v183 offset:32768
  s_waitcnt lgkmcnt(7)
  v_mfma_f32_32x32x16_bf16 v[96:111], a[112:115], v[128:131], 0
  buffer_load_dwordx4 v227, s[48:51], s25 offen offset:3072 lds
  ds_read_b128 v[148:151], v183 offset:33792
  v_mfma_f32_32x32x16_bf16 v[96:111], a[116:119], v[132:135], v[96:111]
  s_waitcnt vmcnt(11)
  ds_read_b64_tr_b16 a[232:233], v184 offset:2048
  ds_read_b64_tr_b16 a[236:237], v185 offset:2048
  ds_read_b128 v[128:131], v183 offset:34816
  s_waitcnt lgkmcnt(7)
  v_mfma_f32_32x32x16_bf16 v[96:111], a[120:123], v[136:139], v[96:111]
  s_add_u32 m0, s88, 0
  s_add_u32 s25, s64, 917504
  buffer_load_dwordx4 v224, s[48:51], s25 offen offset:0 lds
  ds_read_b128 v[132:135], v183 offset:35840
  v_mul_f32 v152, v112, v112
  v_mul_f32 v153, v113, v113
  v_mul_f32 v154, v114, v114
  v_mfma_f32_32x32x16_bf16 v[96:111], a[124:127], v[140:143], v[96:111]
  s_waitcnt vmcnt(11)
  ds_read_b64_tr_b16 a[234:235], v184 offset:3072
  ds_read_b64_tr_b16 a[238:239], v185 offset:3072
  ds_read_b128 v[136:139], v183 offset:36864
  v_mul_f32 v155, v115, v115
  v_fma_f32 v152, v152, v242, v238
  v_fma_f32 v153, v153, v242, v238
  s_waitcnt lgkmcnt(7)
  v_mfma_f32_32x32x16_bf16 v[96:111], a[128:131], v[144:147], v[96:111]
  buffer_load_dwordx4 v225, s[48:51], s25 offen offset:1024 lds
  ds_read_b128 v[140:143], v183 offset:37888
  v_fma_f32 v154, v154, v242, v238
  v_fma_f32 v155, v155, v242, v238
  v_mul_f32 v152, v152, v112
  v_mul_f32 v153, v153, v113
  v_mfma_f32_32x32x16_bf16 v[96:111], a[132:135], v[148:151], v[96:111]
  s_waitcnt vmcnt(11)
  ds_read_b64_tr_b16 a[240:241], v184 offset:16384
  ds_read_b64_tr_b16 a[244:245], v185 offset:16384
  ds_read_b128 v[144:147], v183 offset:38912
  v_mul_f32 v154, v154, v114
  v_mul_f32 v155, v155, v115
  s_waitcnt lgkmcnt(7)
  v_mfma_f32_32x32x16_bf16 v[96:111], a[136:139], v[128:131], v[96:111]
  buffer_load_dwordx4 v226, s[48:51], s25 offen offset:2048 lds
  ds_read_b128 v[148:151], v183 offset:39936
  v_exp_f32 v152, v152
  v_mul_f32 v120, v120, v112
  v_exp_f32 v153, v153
  v_mul_f32 v121, v121, v113
  v_mfma_f32_32x32x16_bf16 v[96:111], a[140:143], v[132:135], v[96:111]
  s_waitcnt vmcnt(11)
  ds_read_b64_tr_b16 a[242:243], v184 offset:17408
  ds_read_b64_tr_b16 a[246:247], v185 offset:17408
  ds_read_b128 v[128:131], v183 offset:40960
  v_exp_f32 v154, v154
  v_mul_f32 v122, v122, v114
  s_waitcnt lgkmcnt(7)
  v_mfma_f32_32x32x16_bf16 v[96:111], a[144:147], v[136:139], v[96:111]
  buffer_load_dwordx4 v227, s[48:51], s25 offen offset:3072 lds
  ds_read_b128 v[132:135], v183 offset:41984
  v_exp_f32 v155, v155
  v_mul_f32 v123, v123, v115
  v_fma_f32 v152, v152, v234, v234
  v_mfma_f32_32x32x16_bf16 v[96:111], a[148:151], v[140:143], v[96:111]
  s_waitcnt vmcnt(11)
  ds_read_b64_tr_b16 a[248:249], v184 offset:18432
  ds_read_b64_tr_b16 a[252:253], v185 offset:18432
  ds_read_b128 v[136:139], v183 offset:43008
  v_rcp_f32 v152, v152
  v_fma_f32 v153, v153, v234, v234
  s_waitcnt lgkmcnt(7)
  v_mfma_f32_32x32x16_bf16 v[96:111], a[152:155], v[144:147], v[96:111]
  s_add_u32 m0, s88, 16384
  s_add_u32 s25, s64, 1032192
  buffer_load_dwordx4 v224, s[48:51], s25 offen offset:0 lds
  ds_read_b128 v[140:143], v183 offset:44032
  v_rcp_f32 v153, v153
  v_fma_f32 v154, v154, v234, v234
  v_mfma_f32_32x32x16_bf16 v[96:111], a[156:159], v[148:151], v[96:111]
  s_waitcnt vmcnt(10)
  ds_read_b64_tr_b16 a[250:251], v184 offset:19456
  ds_read_b64_tr_b16 a[254:255], v185 offset:19456
  ds_read_b128 v[144:147], v183 offset:45056
  v_rcp_f32 v154, v154
  v_fma_f32 v155, v155, v234, v234
  s_waitcnt lgkmcnt(7)
  v_mfma_f32_32x32x16_bf16 v[96:111], a[160:163], v[128:131], v[96:111]
  buffer_load_dwordx4 v225, s[48:51], s25 offen offset:1024 lds
  ds_read_b128 v[148:151], v183 offset:46080
  v_rcp_f32 v155, v155
  v_mul_f32 v120, v120, v152
  v_mul_f32 v121, v121, v153
  v_mul_f32 v122, v122, v154
  v_mfma_f32_32x32x16_bf16 v[96:111], a[164:167], v[132:135], v[96:111]
  s_waitcnt vmcnt(10)
  ds_read_b64_tr_b16 a[0:1], v184 offset:32768
  ds_read_b64_tr_b16 a[4:5], v185 offset:32768
  ds_read_b128 v[128:131], v183 offset:47104
  v_mul_f32 v123, v123, v155
  v_cvt_pk_bf16_f32 v176, v120, v121
  v_cvt_pk_bf16_f32 v177, v122, v123
  s_waitcnt lgkmcnt(7)
  v_mfma_f32_32x32x16_bf16 v[96:111], a[168:171], v[136:139], v[96:111]
  buffer_load_dwordx4 v226, s[48:51], s25 offen offset:2048 lds
  ds_read_b128 v[132:135], v183 offset:48128
  v_mul_f32 v156, v116, v116
  v_mul_f32 v157, v117, v117
  v_mul_f32 v158, v118, v118
  v_mul_f32 v159, v119, v119
  v_mfma_f32_32x32x16_bf16 v[96:111], a[172:175], v[140:143], v[96:111]
  s_waitcnt vmcnt(10)
  ds_read_b64_tr_b16 a[2:3], v184 offset:33792
  ds_read_b64_tr_b16 a[6:7], v185 offset:33792
  ds_read_b128 v[136:139], v183 offset:49152
  v_fma_f32 v156, v156, v242, v238
  v_fma_f32 v157, v157, v242, v238
  v_fma_f32 v158, v158, v242, v238
  s_waitcnt lgkmcnt(7)
  v_mfma_f32_32x32x16_bf16 v[96:111], a[176:179], v[144:147], v[96:111]
  buffer_load_dwordx4 v227, s[48:51], s25 offen offset:3072 lds
  ds_read_b128 v[140:143], v183 offset:50176
  v_fma_f32 v159, v159, v242, v238
  v_mul_f32 v156, v156, v116
  v_mul_f32 v157, v157, v117
  v_mul_f32 v158, v158, v118
  v_mul_f32 v159, v159, v119
  v_mfma_f32_32x32x16_bf16 v[96:111], a[180:183], v[148:151], v[96:111]
  s_waitcnt vmcnt(10)
  ds_read_b64_tr_b16 a[8:9], v184 offset:34816
  ds_read_b64_tr_b16 a[12:13], v185 offset:34816
  ds_read_b128 v[144:147], v183 offset:51200
  v_exp_f32 v156, v156
  v_mul_f32 v124, v124, v116
  s_waitcnt lgkmcnt(7)
  v_mfma_f32_32x32x16_bf16 v[96:111], a[184:187], v[128:131], v[96:111]
  s_add_u32 m0, s88, 32768
  s_add_u32 s25, s64, 1146880
  buffer_load_dwordx4 v224, s[48:51], s25 offen offset:0 lds
  ds_read_b128 v[148:151], v183 offset:52224
  v_exp_f32 v157, v157
  v_mul_f32 v125, v125, v117
  v_mfma_f32_32x32x16_bf16 v[96:111], a[188:191], v[132:135], v[96:111]
  s_waitcnt vmcnt(10)
  buffer_store_byte v5, v4, s[60:63], s90 offen offset:2112 sc1
  s_waitcnt vmcnt(10)
  ds_read_b64_tr_b16 a[10:11], v184 offset:35840
  ds_read_b64_tr_b16 a[14:15], v185 offset:35840
  ds_read_b128 v[128:131], v183 offset:53248
  s_waitcnt lgkmcnt(7)
  v_mfma_f32_32x32x16_bf16 v[96:111], a[192:195], v[136:139], v[96:111]
  buffer_load_dwordx4 v225, s[48:51], s25 offen offset:1024 lds
  ds_read_b128 v[132:135], v183 offset:54272
  v_exp_f32 v158, v158
  v_mul_f32 v126, v126, v118
  v_exp_f32 v159, v159
  v_mfma_f32_32x32x16_bf16 v[96:111], a[196:199], v[140:143], v[96:111]
  s_waitcnt vmcnt(10)
  ds_read_b64_tr_b16 a[16:17], v184 offset:0
  ds_read_b64_tr_b16 a[20:21], v185 offset:0
  ds_read_b128 v[136:139], v183 offset:55296
  v_mul_f32 v127, v127, v119
  v_fma_f32 v156, v156, v234, v234
  s_waitcnt lgkmcnt(7)
  v_mfma_f32_32x32x16_bf16 v[96:111], a[200:203], v[144:147], v[96:111]
  buffer_load_dwordx4 v226, s[48:51], s25 offen offset:2048 lds
  ds_read_b128 v[140:143], v183 offset:56320
  v_rcp_f32 v156, v156
  v_fma_f32 v157, v157, v234, v234
  v_rcp_f32 v157, v157
  v_fma_f32 v158, v158, v234, v234
  v_mfma_f32_32x32x16_bf16 v[96:111], a[204:207], v[148:151], v[96:111]
  buffer_load_dword v187, v186, s[60:63], s65 offen offset:2048 sc1
  s_waitcnt vmcnt(11)
  ds_read_b64_tr_b16 a[18:19], v184 offset:1024
  ds_read_b64_tr_b16 a[22:23], v185 offset:1024
  ds_read_b128 v[144:147], v183 offset:0
  v_rcp_f32 v158, v158
  s_waitcnt lgkmcnt(7)
  v_mfma_f32_32x32x16_bf16 v[96:111], a[208:211], v[128:131], v[96:111]
  buffer_load_dwordx4 v227, s[48:51], s25 offen offset:3072 lds
  ds_read_b128 v[148:151], v183 offset:1024
  v_fma_f32 v159, v159, v234, v234
  v_rcp_f32 v159, v159
  v_mul_f32 v124, v124, v156
  v_mfma_f32_32x32x16_bf16 v[96:111], a[212:215], v[132:135], v[96:111]
  s_waitcnt vmcnt(11)
  ds_read_b64_tr_b16 a[24:25], v184 offset:2048
  ds_read_b64_tr_b16 a[28:29], v185 offset:2048
  ds_read_b128 v[128:131], v183 offset:2048
  v_mul_f32 v125, v125, v157
  v_mul_f32 v126, v126, v158
  v_mul_f32 v127, v127, v159
  s_waitcnt lgkmcnt(7)
  v_mfma_f32_32x32x16_bf16 v[96:111], a[216:219], v[136:139], v[96:111]
  s_add_u32 m0, s88, 0
  s_add_u32 s25, s64, 1261568
  buffer_load_dwordx4 v224, s[48:51], s25 offen offset:0 lds
  ds_read_b128 v[132:135], v183 offset:3072
  v_cvt_pk_bf16_f32 v178, v124, v125
  v_cvt_pk_bf16_f32 v179, v126, v127
  v_mfma_f32_32x32x16_bf16 v[96:111], a[220:223], v[140:143], v[96:111]
  s_add_u32 s26, s89, 0xeb800
  buffer_store_dwordx4 v[176:179], v1, s[60:63], s26 offen sc1
  s_waitcnt vmcnt(12)
  ds_read_b64_tr_b16 a[26:27], v184 offset:3072
  ds_read_b64_tr_b16 a[30:31], v185 offset:3072
  ds_read_b128 v[136:139], v183 offset:4096
  s_waitcnt lgkmcnt(7)
  v_mfma_f32_32x32x16_bf16 v[112:127], a[112:115], v[144:147], 0
  buffer_load_dwordx4 v225, s[48:51], s25 offen offset:1024 lds
  ds_read_b128 v[140:143], v183 offset:5120
  v_mfma_f32_32x32x16_bf16 v[112:127], a[116:119], v[148:151], v[112:127]
  s_waitcnt vmcnt(12)
  ds_read_b64_tr_b16 a[32:33], v184 offset:16384
  ds_read_b64_tr_b16 a[36:37], v185 offset:16384
  ds_read_b128 v[144:147], v183 offset:6144
  s_waitcnt lgkmcnt(7)
  v_mfma_f32_32x32x16_bf16 v[112:127], a[120:123], v[128:131], v[112:127]
  buffer_load_dwordx4 v226, s[48:51], s25 offen offset:2048 lds
  ds_read_b128 v[148:151], v183 offset:7168
  v_mul_f32 v152, v96, v96
  v_mul_f32 v153, v97, v97
  v_mul_f32 v154, v98, v98
  v_mul_f32 v155, v99, v99
  v_mfma_f32_32x32x16_bf16 v[112:127], a[124:127], v[132:135], v[112:127]
  s_waitcnt vmcnt(12)
  ds_read_b64_tr_b16 a[34:35], v184 offset:17408
  ds_read_b64_tr_b16 a[38:39], v185 offset:17408
  ds_read_b128 v[128:131], v183 offset:8192
  v_fma_f32 v152, v152, v241, v237
  v_fma_f32 v153, v153, v241, v237
  s_waitcnt lgkmcnt(7)
  v_mfma_f32_32x32x16_bf16 v[112:127], a[128:131], v[136:139], v[112:127]
  buffer_load_dwordx4 v227, s[48:51], s25 offen offset:3072 lds
  ds_read_b128 v[132:135], v183 offset:9216
  v_fma_f32 v154, v154, v241, v237
  v_fma_f32 v155, v155, v241, v237
  v_mul_f32 v152, v152, v96
  v_mul_f32 v153, v153, v97
  v_mul_f32 v154, v154, v98
  v_mfma_f32_32x32x16_bf16 v[112:127], a[132:135], v[140:143], v[112:127]
  s_waitcnt vmcnt(12)
  ds_read_b64_tr_b16 a[40:41], v184 offset:18432
  ds_read_b64_tr_b16 a[44:45], v185 offset:18432
  ds_read_b128 v[136:139], v183 offset:10240
  v_mul_f32 v155, v155, v99
  s_waitcnt lgkmcnt(7)
  v_mfma_f32_32x32x16_bf16 v[112:127], a[136:139], v[144:147], v[112:127]
  s_add_u32 m0, s88, 16384
  s_add_u32 s25, s64, 1376256
  buffer_load_dwordx4 v224, s[48:51], s25 offen offset:0 lds
  ds_read_b128 v[140:143], v183 offset:11264
  v_exp_f32 v152, v152
  v_mul_f32 v104, v104, v96
  v_mfma_f32_32x32x16_bf16 v[112:127], a[140:143], v[148:151], v[112:127]
  ds_read_b128 v[144:147], v183 offset:12288
  v_exp_f32 v153, v153
  v_mul_f32 v105, v105, v97
  v_exp_f32 v154, v154
  s_waitcnt lgkmcnt(5)
  v_mfma_f32_32x32x16_bf16 v[112:127], a[144:147], v[128:131], v[112:127]
  buffer_load_dwordx4 v225, s[48:51], s25 offen offset:1024 lds
  s_waitcnt vmcnt(13)
  ds_read_b64_tr_b16 a[42:43], v184 offset:19456
  ds_read_b64_tr_b16 a[46:47], v185 offset:19456
  ds_read_b128 v[148:151], v183 offset:13312
  v_mul_f32 v106, v106, v98
  v_mfma_f32_32x32x16_bf16 v[112:127], a[148:151], v[132:135], v[112:127]
  ds_read_b128 v[128:131], v183 offset:14336
  v_exp_f32 v155, v155
  v_mul_f32 v107, v107, v99
  v_fma_f32 v152, v152, v233, v233
  v_rcp_f32 v152, v152
  s_waitcnt lgkmcnt(5)
  v_mfma_f32_32x32x16_bf16 v[112:127], a[152:155], v[136:139], v[112:127]
  buffer_load_dwordx4 v226, s[48:51], s25 offen offset:2048 lds
  s_waitcnt vmcnt(13)
  ds_read_b64_tr_b16 a[48:49], v184 offset:32768
  ds_read_b64_tr_b16 a[52:53], v185 offset:32768
  ds_read_b128 v[132:135], v183 offset:15360
  v_fma_f32 v153, v153, v233, v233
  v_mfma_f32_32x32x16_bf16 v[112:127], a[156:159], v[140:143], v[112:127]
  s_waitcnt vmcnt(9)
  v_cmp_ne_u32 vcc, v188, v187
  s_and_b64 vcc, vcc, 0xf0f
  s_cbranch_vccnz L_ws_rr_109
L_ws_rb_110:
  ds_read_b128 v[136:139], v183 offset:16384
  s_waitcnt lgkmcnt(5)
  v_mfma_f32_32x32x16_bf16 v[112:127], a[160:163], v[144:147], v[112:127]
  s_add_u32 s18, s66, 0xb0000
  buffer_load_dwordx4 a[112:115], v1, s[60:63], s18 offen offset:0 sc1
  ds_read_b64_tr_b16 a[50:51], v184 offset:33792
  ds_read_b64_tr_b16 a[54:55], v185 offset:33792
  ds_read_b128 v[140:143], v183 offset:17408
  v_rcp_f32 v153, v153
  v_fma_f32 v154, v154, v233, v233
  v_mfma_f32_32x32x16_bf16 v[112:127], a[164:167], v[148:151], v[112:127]
  ds_read_b128 v[144:147], v183 offset:18432
  v_rcp_f32 v154, v154
  v_fma_f32 v155, v155, v233, v233
  v_rcp_f32 v155, v155
  s_waitcnt lgkmcnt(5)
  v_mfma_f32_32x32x16_bf16 v[112:127], a[168:171], v[128:131], v[112:127]
  s_add_u32 s19, s66, 0xcc000
  buffer_load_dwordx4 a[116:119], v1, s[60:63], s19 offen offset:0 sc1
  ds_read_b64_tr_b16 a[56:57], v184 offset:34816
  ds_read_b64_tr_b16 a[60:61], v185 offset:34816
  ds_read_b128 v[148:151], v183 offset:19456
  v_mul_f32 v104, v104, v152
  v_mfma_f32_32x32x16_bf16 v[112:127], a[172:175], v[132:135], v[112:127]
  ds_read_b128 v[128:131], v183 offset:20480
  v_mul_f32 v105, v105, v153
  v_mul_f32 v106, v106, v154
  v_mul_f32 v107, v107, v155
  v_cvt_pk_bf16_f32 v176, v104, v105
  v_cvt_pk_bf16_f32 v177, v106, v107
  s_waitcnt lgkmcnt(5)
  v_mfma_f32_32x32x16_bf16 v[112:127], a[176:179], v[136:139], v[112:127]
  buffer_load_dwordx4 a[120:123], v1, s[60:63], s18 offen offset:1024 sc1
  s_waitcnt vmcnt(11)
  ds_read_b64_tr_b16 a[58:59], v184 offset:35840
  ds_read_b64_tr_b16 a[62:63], v185 offset:35840
  ds_read_b128 v[132:135], v183 offset:21504
  v_mul_f32 v156, v100, v100
  v_mul_f32 v157, v101, v101
  v_mul_f32 v158, v102, v102
  v_mfma_f32_32x32x16_bf16 v[112:127], a[180:183], v[140:143], v[112:127]
  ds_read_b128 v[136:139], v183 offset:22528
  v_mul_f32 v159, v103, v103
  v_fma_f32 v156, v156, v241, v237
  v_fma_f32 v157, v157, v241, v237
  v_fma_f32 v158, v158, v241, v237
  v_fma_f32 v159, v159, v241, v237
  s_waitcnt lgkmcnt(5)
  v_mfma_f32_32x32x16_bf16 v[112:127], a[184:187], v[144:147], v[112:127]
  buffer_load_dwordx4 a[124:127], v1, s[60:63], s19 offen offset:1024 sc1
  s_waitcnt vmcnt(11)
  ds_read_b64_tr_b16 a[64:65], v184 offset:0
  ds_read_b64_tr_b16 a[68:69], v185 offset:0
  ds_read_b128 v[140:143], v183 offset:23552
  v_mul_f32 v156, v156, v100
  v_mul_f32 v157, v157, v101
  v_mfma_f32_32x32x16_bf16 v[112:127], a[188:191], v[148:151], v[112:127]
  s_waitcnt vmcnt(10)
  buffer_store_byte v5, v4, s[60:63], s90 offen offset:2368 sc1
  ds_read_b128 v[144:147], v183 offset:24576
  v_mul_f32 v158, v158, v102
  v_mul_f32 v159, v159, v103
  s_waitcnt lgkmcnt(5)
  v_mfma_f32_32x32x16_bf16 v[112:127], a[192:195], v[128:131], v[112:127]
  buffer_load_dwordx4 a[128:131], v1, s[60:63], s18 offen offset:2048 sc1
  s_waitcnt vmcnt(11)
  ds_read_b64_tr_b16 a[66:67], v184 offset:1024
  ds_read_b64_tr_b16 a[70:71], v185 offset:1024
  ds_read_b128 v[148:151], v183 offset:25600
  v_exp_f32 v156, v156
  v_mul_f32 v108, v108, v100
  v_mfma_f32_32x32x16_bf16 v[112:127], a[196:199], v[132:135], v[112:127]
  ds_read_b128 v[128:131], v183 offset:26624
  v_exp_f32 v157, v157
  v_mul_f32 v109, v109, v101
  v_exp_f32 v158, v158
  v_mul_f32 v110, v110, v102
  s_waitcnt lgkmcnt(5)
  v_mfma_f32_32x32x16_bf16 v[112:127], a[200:203], v[136:139], v[112:127]
  buffer_load_dwordx4 a[132:135], v1, s[60:63], s19 offen offset:2048 sc1
  s_waitcnt vmcnt(11)
  ds_read_b64_tr_b16 a[72:73], v184 offset:2048
  ds_read_b64_tr_b16 a[76:77], v185 offset:2048
  ds_read_b128 v[132:135], v183 offset:27648
  v_exp_f32 v159, v159
  v_mfma_f32_32x32x16_bf16 v[112:127], a[204:207], v[140:143], v[112:127]
  v_mul_f32 v111, v111, v103
  v_fma_f32 v156, v156, v233, v233
  v_rcp_f32 v156, v156
  v_fma_f32 v157, v157, v233, v233
  s_waitcnt lgkmcnt(4)
  v_mfma_f32_32x32x16_bf16 v[112:127], a[208:211], v[144:147], v[112:127]
  buffer_load_dwordx4 a[136:139], v1, s[60:63], s18 offen offset:3072 sc1
  s_waitcnt vmcnt(11)
  ds_read_b64_tr_b16 a[74:75], v184 offset:3072
  ds_read_b64_tr_b16 a[78:79], v185 offset:3072
  v_rcp_f32 v157, v157
  v_fma_f32 v158, v158, v233, v233
  v_rcp_f32 v158, v158
  v_mfma_f32_32x32x16_bf16 v[112:127], a[212:215], v[148:151], v[112:127]
  v_fma_f32 v159, v159, v233, v233
  v_rcp_f32 v159, v159
  v_mul_f32 v108, v108, v156
  v_mul_f32 v109, v109, v157
  v_mul_f32 v110, v110, v158
  s_waitcnt lgkmcnt(2)
  v_mfma_f32_32x32x16_bf16 v[112:127], a[216:219], v[128:131], v[112:127]
  buffer_load_dwordx4 a[140:143], v1, s[60:63], s19 offen offset:3072 sc1
  s_waitcnt vmcnt(11)
  ds_read_b64_tr_b16 a[80:81], v184 offset:16384
  ds_read_b64_tr_b16 a[84:85], v185 offset:16384
  v_mul_f32 v111, v111, v159
  v_cvt_pk_bf16_f32 v178, v108, v109
  v_cvt_pk_bf16_f32 v179, v110, v111
  v_mfma_f32_32x32x16_bf16 v[112:127], a[220:223], v[132:135], v[112:127]
  s_add_u32 s26, s89, 0xcf800
  buffer_store_dwordx4 v[176:179], v1, s[60:63], s26 offen sc1
  s_waitcnt vmcnt(9)
  v_mfma_f32_32x32x16_bf16 v[192:207], v[16:19], a[112:115], v[192:207]
  s_add_u32 s18, s66, 0xb1000
  buffer_load_dwordx4 a[144:147], v1, s[60:63], s18 offen offset:0 sc1
  ds_read_b64_tr_b16 a[82:83], v184 offset:17408
  ds_read_b64_tr_b16 a[86:87], v185 offset:17408
  v_mfma_f32_32x32x16_bf16 v[96:111], v[20:23], a[112:115], 0
  buffer_load_dwordx4 v227, s[48:51], s25 offen offset:3072 lds
  s_waitcnt vmcnt(10)
  v_mfma_f32_32x32x16_bf16 v[208:223], v[16:19], a[116:119], v[208:223]
  s_add_u32 s19, s66, 0xcd000
  buffer_load_dwordx4 a[148:151], v1, s[60:63], s19 offen offset:0 sc1
  ds_read_b64_tr_b16 a[88:89], v184 offset:18432
  ds_read_b64_tr_b16 a[92:93], v185 offset:18432
  v_mul_f32 v152, v112, v112
  v_mfma_f32_32x32x16_bf16 v[128:143], v[20:23], a[116:119], 0
  v_mul_f32 v153, v113, v113
  v_mul_f32 v154, v114, v114
  v_mul_f32 v155, v115, v115
  v_fma_f32 v152, v152, v243, v239
  v_fma_f32 v153, v153, v243, v239
  v_fma_f32 v154, v154, v243, v239
  s_waitcnt vmcnt(10)
  v_mfma_f32_32x32x16_bf16 v[192:207], v[24:27], a[120:123], v[192:207]
  buffer_load_dwordx4 a[152:155], v1, s[60:63], s18 offen offset:1024 sc1
  v_fma_f32 v155, v155, v243, v239
  v_mul_f32 v152, v152, v112
  v_mul_f32 v153, v153, v113
  v_mul_f32 v154, v154, v114
  v_mul_f32 v155, v155, v115
  v_mfma_f32_32x32x16_bf16 v[96:111], v[28:31], a[120:123], v[96:111]
  s_add_u32 m0, s88, 32768
  s_add_u32 s25, s64, 1490944
  buffer_load_dwordx4 v224, s[48:51], s25 offen offset:0 lds
  v_exp_f32 v152, v152
  s_waitcnt vmcnt(11)
  v_mfma_f32_32x32x16_bf16 v[208:223], v[24:27], a[124:127], v[208:223]
  buffer_load_dwordx4 a[156:159], v1, s[60:63], s19 offen offset:1024 sc1
  v_mul_f32 v120, v120, v112
  v_exp_f32 v153, v153
  v_mul_f32 v121, v121, v113
  v_mfma_f32_32x32x16_bf16 v[128:143], v[28:31], a[124:127], v[128:143]
  v_exp_f32 v154, v154
  v_mul_f32 v122, v122, v114
  v_exp_f32 v155, v155
  v_mul_f32 v123, v123, v115
  s_waitcnt vmcnt(10)
  v_mfma_f32_32x32x16_bf16 v[192:207], v[32:35], a[128:131], v[192:207]
  buffer_load_dwordx4 a[160:163], v1, s[60:63], s18 offen offset:2048 sc1
  v_fma_f32 v152, v152, v235, v235
  v_rcp_f32 v152, v152
  v_fma_f32 v153, v153, v235, v235
  v_mfma_f32_32x32x16_bf16 v[96:111], v[36:39], a[128:131], v[96:111]
  buffer_load_dwordx4 v225, s[48:51], s25 offen offset:1024 lds
  v_rcp_f32 v153, v153
  v_fma_f32 v154, v154, v235, v235
  v_rcp_f32 v154, v154
  s_waitcnt vmcnt(11)
  v_mfma_f32_32x32x16_bf16 v[208:223], v[32:35], a[132:135], v[208:223]
  buffer_load_dwordx4 a[164:167], v1, s[60:63], s19 offen offset:2048 sc1
  v_fma_f32 v155, v155, v235, v235
  v_rcp_f32 v155, v155
  v_mul_f32 v120, v120, v152
  v_mul_f32 v121, v121, v153
  v_mfma_f32_32x32x16_bf16 v[128:143], v[36:39], a[132:135], v[128:143]
  v_mul_f32 v122, v122, v154
  v_mul_f32 v123, v123, v155
  v_cvt_pk_bf16_f32 v176, v120, v121
  v_cvt_pk_bf16_f32 v177, v122, v123
  v_mul_f32 v156, v116, v116
  v_mul_f32 v157, v117, v117
  s_waitcnt vmcnt(11)
  v_mfma_f32_32x32x16_bf16 v[192:207], v[40:43], a[136:139], v[192:207]
  buffer_load_dwordx4 a[168:171], v1, s[60:63], s18 offen offset:3072 sc1
  v_mul_f32 v158, v118, v118
  v_mul_f32 v159, v119, v119
  v_fma_f32 v156, v156, v243, v239
  v_fma_f32 v157, v157, v243, v239
  v_fma_f32 v158, v158, v243, v239
  v_mfma_f32_32x32x16_bf16 v[96:111], v[44:47], a[136:139], v[96:111]
  buffer_load_dwordx4 v226, s[48:51], s25 offen offset:2048 lds
  v_fma_f32 v159, v159, v243, v239
  v_mul_f32 v156, v156, v116
  v_mul_f32 v157, v157, v117
  v_mul_f32 v158, v158, v118
  s_waitcnt vmcnt(12)
  v_mfma_f32_32x32x16_bf16 v[208:223], v[40:43], a[140:143], v[208:223]
  buffer_load_dwordx4 a[172:175], v1, s[60:63], s19 offen offset:3072 sc1
  v_mul_f32 v159, v159, v119
  v_exp_f32 v156, v156
  v_mul_f32 v124, v124, v116
  v_mfma_f32_32x32x16_bf16 v[128:143], v[44:47], a[140:143], v[128:143]
  v_exp_f32 v157, v157
  v_mul_f32 v125, v125, v117
  v_exp_f32 v158, v158
  v_mul_f32 v126, v126, v118
  s_waitcnt vmcnt(11)
  v_mfma_f32_32x32x16_bf16 v[192:207], v[48:51], a[144:147], v[192:207]
  s_add_u32 s18, s66, 0xb2000
  buffer_load_dwordx4 a[176:179], v1, s[60:63], s18 offen offset:0 sc1
  v_exp_f32 v159, v159
  v_mul_f32 v127, v127, v119
  v_fma_f32 v156, v156, v235, v235
  v_mfma_f32_32x32x16_bf16 v[96:111], v[52:55], a[144:147], v[96:111]
  buffer_load_dwordx4 v227, s[48:51], s25 offen offset:3072 lds
  v_rcp_f32 v156, v156
  v_fma_f32 v157, v157, v235, v235
  s_waitcnt vmcnt(11)
  v_mfma_f32_32x32x16_bf16 v[208:223], v[48:51], a[148:151], v[208:223]
  s_add_u32 s19, s66, 0xce000
  buffer_load_dwordx4 a[180:183], v1, s[60:63], s19 offen offset:0 sc1
  v_rcp_f32 v157, v157
  v_fma_f32 v158, v158, v235, v235
  v_rcp_f32 v158, v158
  v_mfma_f32_32x32x16_bf16 v[128:143], v[52:55], a[148:151], v[128:143]
  buffer_store_byte v5, v4, s[60:63], s90 offen offset:2240 sc1
  v_fma_f32 v159, v159, v235, v235
  v_rcp_f32 v159, v159
  v_mul_f32 v124, v124, v156
  s_waitcnt vmcnt(12)
  v_mfma_f32_32x32x16_bf16 v[192:207], v[56:59], a[152:155], v[192:207]
  buffer_load_dwordx4 a[184:187], v1, s[60:63], s18 offen offset:1024 sc1
  v_mul_f32 v125, v125, v157
  v_mul_f32 v126, v126, v158
  v_mul_f32 v127, v127, v159
  v_cvt_pk_bf16_f32 v178, v124, v125
  v_cvt_pk_bf16_f32 v179, v126, v127
  v_mfma_f32_32x32x16_bf16 v[96:111], v[60:63], a[152:155], v[96:111]
  s_add_u32 s26, s89, 0x107800
  buffer_store_dwordx4 v[176:179], v1, s[60:63], s26 offen sc1
  ds_read_b64_tr_b16 a[90:91], v184 offset:19456
  ds_read_b64_tr_b16 a[94:95], v185 offset:19456
  s_waitcnt vmcnt(12)
  v_mfma_f32_32x32x16_bf16 v[208:223], v[56:59], a[156:159], v[208:223]
  buffer_load_dwordx4 a[188:191], v1, s[60:63], s19 offen offset:1024 sc1
  v_mfma_f32_32x32x16_bf16 v[128:143], v[60:63], a[156:159], v[128:143]
  buffer_load_dword v187, v186, s[60:63], s65 offen offset:2048 sc1
  s_waitcnt vmcnt(13)
  v_mfma_f32_32x32x16_bf16 v[192:207], v[64:67], a[160:163], v[192:207]
  buffer_load_dwordx4 a[192:195], v1, s[60:63], s18 offen offset:2048 sc1
  v_mfma_f32_32x32x16_bf16 v[96:111], v[68:71], a[160:163], v[96:111]
  ds_read_b64_tr_b16 a[96:97], v184 offset:32768
  ds_read_b64_tr_b16 a[100:101], v185 offset:32768
  s_waitcnt vmcnt(12)
  v_mfma_f32_32x32x16_bf16 v[208:223], v[64:67], a[164:167], v[208:223]
  buffer_load_dwordx4 a[196:199], v1, s[60:63], s19 offen offset:2048 sc1
  v_mfma_f32_32x32x16_bf16 v[128:143], v[68:71], a[164:167], v[128:143]
  s_waitcnt vmcnt(12)
  v_mfma_f32_32x32x16_bf16 v[192:207], v[72:75], a[168:171], v[192:207]
  buffer_load_dwordx4 a[200:203], v1, s[60:63], s18 offen offset:3072 sc1
  v_mfma_f32_32x32x16_bf16 v[96:111], v[76:79], a[168:171], v[96:111]
  ds_read_b64_tr_b16 a[98:99], v184 offset:33792
  ds_read_b64_tr_b16 a[102:103], v185 offset:33792
  s_waitcnt vmcnt(11)
  v_mfma_f32_32x32x16_bf16 v[208:223], v[72:75], a[172:175], v[208:223]
  buffer_load_dwordx4 a[204:207], v1, s[60:63], s19 offen offset:3072 sc1
  v_mfma_f32_32x32x16_bf16 v[128:143], v[76:79], a[172:175], v[128:143]
  s_waitcnt vmcnt(11)
  v_mfma_f32_32x32x16_bf16 v[192:207], v[80:83], a[176:179], v[192:207]
  s_add_u32 s18, s66, 0xb3000
  buffer_load_dwordx4 a[208:211], v1, s[60:63], s18 offen offset:0 sc1
  v_mfma_f32_32x32x16_bf16 v[96:111], v[84:87], a[176:179], v[96:111]
  ds_read_b64_tr_b16 a[104:105], v184 offset:34816
  ds_read_b64_tr_b16 a[108:109], v185 offset:34816
  s_waitcnt vmcnt(10)
  v_mfma_f32_32x32x16_bf16 v[208:223], v[80:83], a[180:183], v[208:223]
  s_add_u32 s19, s66, 0xcf000
  buffer_load_dwordx4 a[212:215], v1, s[60:63], s19 offen offset:0 sc1
  v_mfma_f32_32x32x16_bf16 v[128:143], v[84:87], a[180:183], v[128:143]
  s_waitcnt vmcnt(9)
  v_mfma_f32_32x32x16_bf16 v[192:207], v[88:91], a[184:187], v[192:207]
  buffer_load_dwordx4 a[216:219], v1, s[60:63], s18 offen offset:1024 sc1
  v_mfma_f32_32x32x16_bf16 v[96:111], v[92:95], a[184:187], v[96:111]
  ds_read_b64_tr_b16 a[106:107], v184 offset:35840
  ds_read_b64_tr_b16 a[110:111], v185 offset:35840
  s_waitcnt vmcnt(8)
  v_mfma_f32_32x32x16_bf16 v[208:223], v[88:91], a[188:191], v[208:223]
  buffer_load_dwordx4 a[220:223], v1, s[60:63], s19 offen offset:1024 sc1
  v_mfma_f32_32x32x16_bf16 v[128:143], v[92:95], a[188:191], v[128:143]
  s_waitcnt vmcnt(8)
  v_cmp_ne_u32 vcc, v188, v187
  s_and_b64 vcc, vcc, 0xf0
  s_cbranch_vccnz L_ws_rr_112
L_ws_rb_113:
  s_waitcnt vmcnt(7)
  v_mfma_f32_32x32x16_bf16 v[192:207], a[224:227], a[192:195], v[192:207]
  s_add_u32 s18, s66, 0xb3000
  buffer_load_dwordx4 a[112:115], v1, s[60:63], s18 offen offset:2048 sc1
  v_mfma_f32_32x32x16_bf16 v[96:111], a[228:231], a[192:195], v[96:111]
  buffer_store_byte v5, v4, s[60:63], s90 offen offset:2496 sc1
  s_waitcnt vmcnt(8)
  v_mfma_f32_32x32x16_bf16 v[208:223], a[224:227], a[196:199], v[208:223]
  buffer_load_dwordx4 a[116:119], v1, s[60:63], s18 offen offset:3072 sc1
  v_mfma_f32_32x32x16_bf16 v[128:143], a[228:231], a[196:199], v[128:143]
  s_waitcnt vmcnt(8)
  v_mfma_f32_32x32x16_bf16 v[192:207], a[232:235], a[200:203], v[192:207]
  s_add_u32 s18, s66, 0xb4000
  buffer_load_dwordx4 a[120:123], v1, s[60:63], s18 offen offset:0 sc1
  v_mfma_f32_32x32x16_bf16 v[96:111], a[236:239], a[200:203], v[96:111]
  s_waitcnt vmcnt(8)
  v_mfma_f32_32x32x16_bf16 v[208:223], a[232:235], a[204:207], v[208:223]
  buffer_load_dwordx4 a[124:127], v1, s[60:63], s18 offen offset:1024 sc1
  v_mfma_f32_32x32x16_bf16 v[128:143], a[236:239], a[204:207], v[128:143]
  s_waitcnt vmcnt(8)
  v_mfma_f32_32x32x16_bf16 v[192:207], a[240:243], a[208:211], v[192:207]
  buffer_load_dwordx4 a[128:131], v1, s[60:63], s18 offen offset:2048 sc1
  v_mfma_f32_32x32x16_bf16 v[96:111], a[244:247], a[208:211], v[96:111]
  s_waitcnt vmcnt(8)
  v_mfma_f32_32x32x16_bf16 v[208:223], a[240:243], a[212:215], v[208:223]
  buffer_load_dwordx4 a[132:135], v1, s[60:63], s18 offen offset:3072 sc1
  v_mfma_f32_32x32x16_bf16 v[128:143], a[244:247], a[212:215], v[128:143]
  buffer_load_dword v187, v186, s[60:63], s65 offen offset:2048 sc1
  s_waitcnt vmcnt(9)
  v_mfma_f32_32x32x16_bf16 v[192:207], a[248:251], a[216:219], v[192:207]
  s_add_u32 s18, s66, 0xb5000
  buffer_load_dwordx4 a[136:139], v1, s[60:63], s18 offen offset:0 sc1
  v_mfma_f32_32x32x16_bf16 v[96:111], a[252:255], a[216:219], v[96:111]
  s_waitcnt vmcnt(9)
  v_mfma_f32_32x32x16_bf16 v[208:223], a[248:251], a[220:223], v[208:223]
  buffer_load_dwordx4 a[140:143], v1, s[60:63], s18 offen offset:1024 sc1
  v_mfma_f32_32x32x16_bf16 v[128:143], a[252:255], a[220:223], v[128:143]
  s_waitcnt vmcnt(9)
  v_mfma_f32_32x32x16_bf16 v[192:207], a[0:3], a[112:115], v[192:207]
  buffer_load_dwordx4 a[144:147], v1, s[60:63], s18 offen offset:2048 sc1
  v_mfma_f32_32x32x16_bf16 v[96:111], a[4:7], a[112:115], v[96:111]
  s_waitcnt vmcnt(8)
  v_mfma_f32_32x32x16_bf16 v[192:207], a[8:11], a[116:119], v[192:207]
  buffer_load_dwordx4 a[148:151], v1, s[60:63], s18 offen offset:3072 sc1
  v_mfma_f32_32x32x16_bf16 v[96:111], a[12:15], a[116:119], v[96:111]
  s_waitcnt vmcnt(8)
  v_mfma_f32_32x32x16_bf16 v[192:207], a[16:19], a[120:123], v[192:207]
  s_add_u32 s18, s66, 0xb6000
  buffer_load_dwordx4 a[152:155], v1, s[60:63], s18 offen offset:0 sc1
  v_mfma_f32_32x32x16_bf16 v[96:111], a[20:23], a[120:123], v[96:111]
  s_waitcnt vmcnt(8)
  v_mfma_f32_32x32x16_bf16 v[192:207], a[24:27], a[124:127], v[192:207]
  buffer_load_dwordx4 a[156:159], v1, s[60:63], s18 offen offset:1024 sc1
  v_mfma_f32_32x32x16_bf16 v[96:111], a[28:31], a[124:127], v[96:111]
  s_waitcnt vmcnt(8)
  v_mfma_f32_32x32x16_bf16 v[192:207], a[32:35], a[128:131], v[192:207]
  buffer_load_dwordx4 a[160:163], v1, s[60:63], s18 offen offset:2048 sc1
  v_mfma_f32_32x32x16_bf16 v[96:111], a[36:39], a[128:131], v[96:111]
  s_waitcnt vmcnt(8)
  v_mfma_f32_32x32x16_bf16 v[192:207], a[40:43], a[132:135], v[192:207]
  buffer_load_dwordx4 a[164:167], v1, s[60:63], s18 offen offset:3072 sc1
  s_barrier
  v_mfma_f32_32x32x16_bf16 v[96:111], a[44:47], a[132:135], v[96:111]
  s_waitcnt vmcnt(8)
  v_cmp_ne_u32 vcc, v188, v187
  s_and_b64 vcc, vcc, 0xf000
  s_cbranch_vccnz L_ws_rr_115
L_ws_rb_116:
  s_waitcnt vmcnt(7)
  v_mfma_f32_32x32x16_bf16 v[192:207], a[48:51], a[136:139], v[192:207]
  s_add_u32 s19, s66, 0xcf000
  buffer_load_dwordx4 a[168:171], v1, s[60:63], s19 offen offset:2048 sc1
  v_mfma_f32_32x32x16_bf16 v[96:111], a[52:55], a[136:139], v[96:111]
  s_waitcnt vmcnt(7)
  v_mfma_f32_32x32x16_bf16 v[192:207], a[56:59], a[140:143], v[192:207]
  buffer_load_dwordx4 a[172:175], v1, s[60:63], s19 offen offset:3072 sc1
  v_mfma_f32_32x32x16_bf16 v[96:111], a[60:63], a[140:143], v[96:111]
  s_waitcnt vmcnt(7)
  v_mfma_f32_32x32x16_bf16 v[192:207], a[64:67], a[144:147], v[192:207]
  s_add_u32 s19, s66, 0xd0000
  buffer_load_dwordx4 a[176:179], v1, s[60:63], s19 offen offset:0 sc1
  v_mfma_f32_32x32x16_bf16 v[96:111], a[68:71], a[144:147], v[96:111]
  s_waitcnt vmcnt(7) lgkmcnt(15)
  v_mfma_f32_32x32x16_bf16 v[192:207], a[72:75], a[148:151], v[192:207]
  buffer_load_dwordx4 a[180:183], v1, s[60:63], s19 offen offset:1024 sc1
  v_mfma_f32_32x32x16_bf16 v[96:111], a[76:79], a[148:151], v[96:111]
  s_waitcnt vmcnt(7) lgkmcnt(13)
  v_mfma_f32_32x32x16_bf16 v[192:207], a[80:83], a[152:155], v[192:207]
  buffer_load_dwordx4 a[184:187], v1, s[60:63], s19 offen offset:2048 sc1
  s_waitcnt lgkmcnt(12)
  v_mfma_f32_32x32x16_bf16 v[96:111], a[84:87], a[152:155], v[96:111]
  s_waitcnt vmcnt(7) lgkmcnt(9)
  v_mfma_f32_32x32x16_bf16 v[192:207], a[88:91], a[156:159], v[192:207]
  buffer_load_dwordx4 a[188:191], v1, s[60:63], s19 offen offset:3072 sc1
  s_waitcnt lgkmcnt(8)
  v_mfma_f32_32x32x16_bf16 v[96:111], a[92:95], a[156:159], v[96:111]
  s_waitcnt vmcnt(7) lgkmcnt(5)
  v_mfma_f32_32x32x16_bf16 v[192:207], a[96:99], a[160:163], v[192:207]
  s_add_u32 s19, s66, 0xd1000
  buffer_load_dwordx4 a[192:195], v1, s[60:63], s19 offen offset:0 sc1
  s_waitcnt lgkmcnt(4)
  v_mfma_f32_32x32x16_bf16 v[96:111], a[100:103], a[160:163], v[96:111]
  s_waitcnt vmcnt(7) lgkmcnt(1)
  v_mfma_f32_32x32x16_bf16 v[192:207], a[104:107], a[164:167], v[192:207]
  buffer_load_dwordx4 a[196:199], v1, s[60:63], s19 offen offset:1024 sc1
  s_waitcnt lgkmcnt(0)
  v_mfma_f32_32x32x16_bf16 v[96:111], a[108:111], a[164:167], v[96:111]
  s_waitcnt vmcnt(7)
  v_mfma_f32_32x32x16_bf16 v[208:223], a[0:3], a[168:171], v[208:223]
  buffer_load_dwordx4 a[200:203], v1, s[60:63], s19 offen offset:2048 sc1
  v_mfma_f32_32x32x16_bf16 v[128:143], a[4:7], a[168:171], v[128:143]
  s_waitcnt vmcnt(7)
  v_mfma_f32_32x32x16_bf16 v[208:223], a[8:11], a[172:175], v[208:223]
  buffer_load_dwordx4 a[204:207], v1, s[60:63], s19 offen offset:3072 sc1
  s_nop 1
  ds_write_b128 v189, v[192:195] offset:0
  v_mfma_f32_32x32x16_bf16 v[128:143], a[12:15], a[172:175], v[128:143]
  ds_write_b128 v189, v[196:199] offset:16
  s_waitcnt vmcnt(7)
  v_mfma_f32_32x32x16_bf16 v[208:223], a[16:19], a[176:179], v[208:223]
  s_add_u32 s19, s66, 0xd2000
  buffer_load_dwordx4 a[208:211], v1, s[60:63], s19 offen offset:0 sc1
  ds_write_b128 v189, v[200:203] offset:32
  v_mfma_f32_32x32x16_bf16 v[128:143], a[20:23], a[176:179], v[128:143]
  ds_write_b128 v189, v[204:207] offset:48
  s_waitcnt vmcnt(7)
  v_mfma_f32_32x32x16_bf16 v[208:223], a[24:27], a[180:183], v[208:223]
  buffer_load_dwordx4 a[212:215], v1, s[60:63], s19 offen offset:1024 sc1
  ds_write_b128 v190, v[96:99] offset:0
  v_mfma_f32_32x32x16_bf16 v[128:143], a[28:31], a[180:183], v[128:143]
  ds_write_b128 v190, v[100:103] offset:16
  s_waitcnt vmcnt(7)
  v_mfma_f32_32x32x16_bf16 v[208:223], a[32:35], a[184:187], v[208:223]
  buffer_load_dwordx4 a[216:219], v1, s[60:63], s19 offen offset:2048 sc1
  ds_write_b128 v190, v[104:107] offset:32
  v_mfma_f32_32x32x16_bf16 v[128:143], a[36:39], a[184:187], v[128:143]
  ds_write_b128 v190, v[108:111] offset:48
  s_waitcnt vmcnt(7)
  v_mfma_f32_32x32x16_bf16 v[208:223], a[40:43], a[188:191], v[208:223]
  buffer_load_dwordx4 a[220:223], v1, s[60:63], s19 offen offset:3072 sc1
  s_waitcnt lgkmcnt(0)
  s_barrier
  v_mfma_f32_32x32x16_bf16 v[128:143], a[44:47], a[188:191], v[128:143]
  ds_read_b128 v[112:115], v191 offset:0
  ds_read_b128 v[116:119], v191 offset:128
  s_waitcnt vmcnt(7)
  v_mfma_f32_32x32x16_bf16 v[208:223], a[48:51], a[192:195], v[208:223]
  ds_read_b128 v[120:123], v191 offset:8704
  ds_read_b128 v[124:127], v191 offset:8832
  v_mfma_f32_32x32x16_bf16 v[128:143], a[52:55], a[192:195], v[128:143]
  ds_read_b128 v[144:147], v191 offset:17408
  ds_read_b128 v[148:151], v191 offset:17536
  s_waitcnt vmcnt(6)
  v_mfma_f32_32x32x16_bf16 v[208:223], a[56:59], a[196:199], v[208:223]
  ds_read_b128 v[152:155], v191 offset:26112
  ds_read_b128 v[156:159], v191 offset:26240
  v_mfma_f32_32x32x16_bf16 v[128:143], a[60:63], a[196:199], v[128:143]
  s_waitcnt vmcnt(5)
  v_mfma_f32_32x32x16_bf16 v[208:223], a[64:67], a[200:203], v[208:223]
  s_waitcnt vmcnt(4)
  v_mfma_f32_32x32x16_bf16 v[208:223], a[72:75], a[204:207], v[208:223]
  s_waitcnt lgkmcnt(5)
  v_add_f32 v112, v112, v120
  v_add_f32 v113, v113, v121
  v_add_f32 v114, v114, v122
  v_add_f32 v115, v115, v123
  s_waitcnt vmcnt(3)
  v_mfma_f32_32x32x16_bf16 v[208:223], a[80:83], a[208:211], v[208:223]
  s_waitcnt lgkmcnt(4)
  v_add_f32 v116, v116, v124
  v_add_f32 v117, v117, v125
  v_add_f32 v118, v118, v126
  v_add_f32 v119, v119, v127
  s_waitcnt vmcnt(2)
  v_mfma_f32_32x32x16_bf16 v[208:223], a[88:91], a[212:215], v[208:223]
  s_waitcnt lgkmcnt(1)
  v_add_f32 v144, v144, v152
  v_add_f32 v145, v145, v153
  v_add_f32 v146, v146, v154
  v_add_f32 v147, v147, v155
  s_waitcnt vmcnt(1)
  v_mfma_f32_32x32x16_bf16 v[208:223], a[96:99], a[216:219], v[208:223]
  s_waitcnt lgkmcnt(0)
  v_add_f32 v148, v148, v156
  v_add_f32 v149, v149, v157
  v_add_f32 v150, v150, v158
  v_add_f32 v151, v151, v159
  s_waitcnt vmcnt(0)
  v_mfma_f32_32x32x16_bf16 v[208:223], a[104:107], a[220:223], v[208:223]
  v_add_f32 v112, v112, v144
  v_add_f32 v113, v113, v145
  v_add_f32 v114, v114, v146
  v_add_f32 v115, v115, v147
  v_mfma_f32_32x32x16_bf16 v[128:143], a[68:71], a[200:203], v[128:143]
  v_add_f32 v116, v116, v148
  v_add_f32 v117, v117, v149
  v_add_f32 v118, v118, v150
  v_add_f32 v119, v119, v151
  v_mfma_f32_32x32x16_bf16 v[128:143], a[76:79], a[204:207], v[128:143]
  v_cvt_pk_bf16_f32 v176, v112, v113
  v_cvt_pk_bf16_f32 v177, v114, v115
  v_cvt_pk_bf16_f32 v178, v116, v117
  v_cvt_pk_bf16_f32 v179, v118, v119
  v_mfma_f32_32x32x16_bf16 v[128:143], a[84:87], a[208:211], v[128:143]
  s_add_u32 s26, s67, 0
  buffer_store_dwordx4 v[176:179], v9, s[52:55], s26 offen sc1
  ds_write_b128 v189, v[208:211] offset:34816
  v_mfma_f32_32x32x16_bf16 v[128:143], a[92:95], a[212:215], v[128:143]
  ds_write_b128 v189, v[212:215] offset:34832
  v_mfma_f32_32x32x16_bf16 v[128:143], a[100:103], a[216:219], v[128:143]
  ds_write_b128 v189, v[216:219] offset:34848
  v_mfma_f32_32x32x16_bf16 v[128:143], a[108:111], a[220:223], v[128:143]
  ds_write_b128 v189, v[220:223] offset:34864
  s_nop 10
  ds_write_b128 v190, v[128:131] offset:34816
  ds_write_b128 v190, v[132:135] offset:34832
  ds_write_b128 v190, v[136:139] offset:34848
  ds_write_b128 v190, v[140:143] offset:34864
  s_waitcnt lgkmcnt(0)
  s_barrier
  ds_read_b128 v[112:115], v191 offset:34816
  ds_read_b128 v[120:123], v191 offset:43520
  ds_read_b128 v[144:147], v191 offset:52224
  ds_read_b128 v[152:155], v191 offset:60928
  ds_read_b128 v[116:119], v191 offset:34944
  ds_read_b128 v[124:127], v191 offset:43648
  ds_read_b128 v[148:151], v191 offset:52352
  ds_read_b128 v[156:159], v191 offset:61056
  s_add_u32 s26, s67, 28672
  s_waitcnt lgkmcnt(6)
  v_pk_add_f32 v[112:113], v[112:113], v[120:121]
  v_pk_add_f32 v[114:115], v[114:115], v[122:123]
  s_waitcnt lgkmcnt(4)
  v_pk_add_f32 v[144:145], v[144:145], v[152:153]
  v_pk_add_f32 v[146:147], v[146:147], v[154:155]
  v_pk_add_f32 v[112:113], v[112:113], v[144:145]
  v_pk_add_f32 v[114:115], v[114:115], v[146:147]
  v_cvt_pk_bf16_f32 v176, v112, v113
  v_cvt_pk_bf16_f32 v177, v114, v115
  s_waitcnt lgkmcnt(2)
  v_pk_add_f32 v[116:117], v[116:117], v[124:125]
  v_pk_add_f32 v[118:119], v[118:119], v[126:127]
  s_waitcnt lgkmcnt(0)
  v_pk_add_f32 v[148:149], v[148:149], v[156:157]
  v_pk_add_f32 v[150:151], v[150:151], v[158:159]
  v_pk_add_f32 v[116:117], v[116:117], v[148:149]
  v_pk_add_f32 v[118:119], v[118:119], v[150:151]
  v_cvt_pk_bf16_f32 v178, v116, v117
  v_cvt_pk_bf16_f32 v179, v118, v119
  buffer_store_dwordx4 v[176:179], v9, s[52:55], s26 offen sc1
  s_endpgm
L_spare_slow:
  s_mov_b32 s27, 200000
L_ss_poll_129:
  buffer_load_dword v253, off, s[60:63], s89 offset:1024 sc1
  s_waitcnt vmcnt(0)
  v_cmp_ne_u32 vcc, 1, v253
  s_cbranch_vccz L_ss_done_130
  s_sub_u32 s27, s27, 1
  s_cmp_lg_u32 s27, 0
  s_cbranch_scc1 L_ss_poll_129
L_ss_done_130:
  s_add_u32 s16, s4, 7
  s_and_b32 s16, s16, 7
  s_lshl_b64 s[28:29], 1, s16
  s_lshr_b32 s16, s12, 1
  s_bitset1_b32 s28, s16
  s_add_u32 s16, s4, 1
  s_and_b32 s16, s16, 7
  s_bitset1_b32 s28, s16
  v_cmp_eq_u32 vcc, 0, v248
  s_and_b64 vcc, vcc, s[28:29]
  s_cbranch_vccnz L_ss_rr_131
L_ss_rb_132:
  buffer_load_dword v243, v236, s[60:63], 0 offen sc1
  s_waitcnt vmcnt(0)
  v_cmp_ne_u32 vcc, 1, v243
  s_and_b64 vcc, vcc, 0x3f
  s_cbranch_vccnz L_ss_rr_134
L_ss_rb_135:
  s_add_u32 m0, s24, 81920
  s_nop 0
  buffer_load_dwordx4 v1, s[60:63], s68 offen offset:0 sc1 lds
  s_add_u32 m0, s24, 90112
  s_nop 0
  buffer_load_dwordx4 v1, s[60:63], s69 offen offset:0 sc1 lds
  s_add_u32 m0, s24, 98304
  s_nop 0
  buffer_load_dwordx4 v1, s[60:63], s70 offen offset:0 sc1 lds
  s_add_u32 m0, s24, 81920
  s_mov_b32 exec_hi, 0xffff
  buffer_load_dwordx4 v1, s[60:63], s68 offen offset:1024 sc1 lds
  s_mov_b32 exec_hi, -1
  s_add_u32 m0, s24, 90112
  s_mov_b32 exec_hi, 0xffff
  buffer_load_dwordx4 v1, s[60:63], s69 offen offset:1024 sc1 lds
  s_mov_b32 exec_hi, -1
  s_add_u32 m0, s24, 98304
  s_mov_b32 exec_hi, 0xffff
  buffer_load_dwordx4 v1, s[60:63], s70 offen offset:1024 sc1 lds
  s_mov_b32 exec_hi, -1
  s_add_u32 s68, s68, 0x38000
  s_add_u32 s69, s69, 0x38000
  s_add_u32 s70, s70, 0x38000
  ds_write_b64 v13, v[160:161] offset:1792
  ds_write_b64 v13, v[162:163] offset:9984
  ds_write_b64 v13, v[164:165] offset:18176
  s_waitcnt vmcnt(5)
  buffer_load_dword v249, v242, s[60:63], 0 offen sc1
  s_waitcnt vmcnt(0)
  v_cmp_ne_u32 vcc, 1, v249
  s_cbranch_vccnz L_ss_rr_137
L_ss_rb_138:
  buffer_load_dwordx2 v[88:89], v2, s[60:63], s88 offen offset:0 sc1
  buffer_load_dwordx2 v[90:91], v2, s[60:63], s88 offen offset:512 sc1
  buffer_load_dwordx2 v[92:93], v2, s[60:63], s88 offen offset:1024 sc1
  buffer_load_dwordx2 v[94:95], v2, s[60:63], s88 offen offset:1536 sc1
  s_waitcnt lgkmcnt(0)
  s_barrier
  ds_read_b64 v[80:81], v237 offset:16384
  ds_read_b64 v[82:83], v237 offset:16896
  ds_read_b64 v[84:85], v237 offset:17408
  ds_read_b64 v[86:87], v237 offset:17920
  s_add_u32 m0, s24, 57344
  s_nop 0
  buffer_load_dwordx4 v1, s[60:63], s68 offen offset:0 sc1 lds
  ds_read_b64 v[16:17], v237 offset:0
  ds_read_b64 v[18:19], v237 offset:512
  ds_read_b64 v[20:21], v237 offset:1024
  ds_read_b64 v[22:23], v237 offset:1536
  s_add_u32 m0, s24, 65536
  s_nop 0
  buffer_load_dwordx4 v1, s[60:63], s69 offen offset:0 sc1 lds
  ds_read_b64 v[24:25], v237 offset:2048
  ds_read_b64 v[26:27], v237 offset:2560
  ds_read_b64 v[28:29], v237 offset:3072
  ds_read_b64 v[30:31], v237 offset:3584
  s_add_u32 m0, s24, 73728
  s_nop 0
  buffer_load_dwordx4 v1, s[60:63], s70 offen offset:0 sc1 lds
  s_mov_b32 exec_lo, 0
  s_waitcnt vmcnt(3)
  v_mov_b32 v94, 0
  v_mov_b32 v95, 1.0
  s_mov_b32 exec_lo, -1
  s_waitcnt lgkmcnt(10)
  v_mfma_f32_32x32x16_bf16 v[96:111], v[80:83], v[88:91], v[200:215]
  s_add_u32 m0, s24, 57344
  s_mov_b32 exec_hi, 0xffff
  buffer_load_dwordx4 v1, s[60:63], s68 offen offset:1024 sc1 lds
  s_mov_b32 exec_hi, -1
  s_waitcnt lgkmcnt(8)
  v_mfma_f32_32x32x16_bf16 v[96:111], v[84:87], v[92:95], v[96:111]
  s_add_u32 m0, s24, 65536
  s_mov_b32 exec_hi, 0xffff
  buffer_load_dwordx4 v1, s[60:63], s69 offen offset:1024 sc1 lds
  s_mov_b32 exec_hi, -1
  s_lshr_b32 s90, s12, 1
  s_mul_i32 s90, s90, 0x19b000
  s_and_b32 s14, s12, 1
  s_mul_i32 s14, s14, 112
  s_add_u32 s90, s90, s14
  s_add_u32 s90, s90, 0x198000
  s_add_u32 m0, s24, 73728
  s_mov_b32 exec_hi, 0xffff
  buffer_load_dwordx4 v1, s[60:63], s70 offen offset:1024 sc1 lds
  s_mov_b32 exec_hi, -1
  v_max_f32 v10, v96, v97
  v_max_f32 v11, v98, v99
  v_max3_f32 v10, v10, v100, v101
  v_max3_f32 v11, v11, v102, v103
  v_max3_f32 v10, v10, v104, v105
  v_max3_f32 v11, v11, v106, v107
  v_max3_f32 v10, v10, v108, v109
  v_max3_f32 v11, v11, v110, v111
  v_max_f32 v10, v10, v11
  v_mov_b32 v11, v10
  s_mov_b32 s16, 0xffff0000
  s_mov_b32 s17, 0x07060302
  v_permlane32_swap_b32 v10, v11
  v_min_f32 v10, -v10, -v11
  v_and_b32 v11, s16, v10
  v_sub_f32 v11, v10, v11
  v_and_b32 v14, s16, v11
  v_sub_f32 v14, v11, v14
  s_mov_b32 exec_lo, 0
  v_perm_b32 v94, v11, v10, s17
  v_perm_b32 v95, v95, v14, s17
  s_mov_b32 exec_lo, -1
  s_waitcnt lgkmcnt(6)
  v_mfma_f32_32x32x16_bf16 v[96:111], v[16:19], v[88:91], v[168:183]
  s_waitcnt lgkmcnt(4)
  v_mfma_f32_32x32x16_bf16 v[96:111], v[20:23], v[92:95], v[96:111]
  s_lshl_b32 s14, s6, 28
  s_lshl2_add_u32 s15, s5, s93
  s_add_u32 s14, s14, s15
  buffer_store_dword v5, v4, s[60:63], s14 offen offset:128 sc1
  v_lshrrev_b32 v13, 5, v0
  v_lshlrev_b32 v13, 4, v13
  v_mov_b32 v12, 0
  s_nop 4
  v_exp_f32 v96, v96
  v_exp_f32 v97, v97
  v_exp_f32 v98, v98
  v_exp_f32 v99, v99
  v_exp_f32 v100, v100
  v_exp_f32 v101, v101
  v_exp_f32 v102, v102
  v_exp_f32 v103, v103
  s_waitcnt lgkmcnt(2)
  v_mfma_f32_32x32x16_bf16 v[112:127], v[24:27], v[88:91], 0
  ds_read_b64 v[32:33], v237 offset:4096
  ds_read_b64 v[34:35], v237 offset:4608
  ds_read_b64 v[36:37], v237 offset:5120
  ds_read_b64 v[38:39], v237 offset:5632
  v_cvt_pk_bf16_f32 v16, v96, v97
  v_cvt_pk_bf16_f32 v17, v98, v99
  v_cvt_pk_bf16_f32 v18, v100, v101
  v_cvt_pk_bf16_f32 v19, v102, v103
  v_exp_f32 v104, v104
  v_exp_f32 v105, v105
  s_waitcnt lgkmcnt(4)
  v_mfma_f32_32x32x16_bf16 v[112:127], v[28:31], v[92:95], v[112:127]
  v_exp_f32 v106, v106
  v_exp_f32 v107, v107
  v_exp_f32 v108, v108
  v_exp_f32 v109, v109
  v_exp_f32 v110, v110
  v_exp_f32 v111, v111
  v_cvt_pk_bf16_f32 v20, v104, v105
  v_cvt_pk_bf16_f32 v21, v106, v107
  v_cvt_pk_bf16_f32 v22, v108, v109
  v_cvt_pk_bf16_f32 v23, v110, v111
  buffer_load_dwordx4 v[168:171], v13, s[60:63], s90 offen offset:1792 sc1
  s_nop 0
  v_exp_f32 v112, v112
  v_exp_f32 v113, v113
  v_exp_f32 v114, v114
  v_exp_f32 v115, v115
  v_exp_f32 v116, v116
  v_exp_f32 v117, v117
  v_exp_f32 v118, v118
  v_exp_f32 v119, v119
  s_waitcnt lgkmcnt(2)
  v_mfma_f32_32x32x16_bf16 v[96:111], v[32:35], v[88:91], 0
  ds_read_b64 v[40:41], v237 offset:6144
  ds_read_b64 v[42:43], v237 offset:6656
  ds_read_b64 v[44:45], v237 offset:7168
  ds_read_b64 v[46:47], v237 offset:7680
  v_cvt_pk_bf16_f32 v24, v112, v113
  v_cvt_pk_bf16_f32 v25, v114, v115
  v_cvt_pk_bf16_f32 v26, v116, v117
  v_cvt_pk_bf16_f32 v27, v118, v119
  v_exp_f32 v120, v120
  v_exp_f32 v121, v121
  s_waitcnt lgkmcnt(4)
  v_mfma_f32_32x32x16_bf16 v[96:111], v[36:39], v[92:95], v[96:111]
  v_exp_f32 v122, v122
  v_exp_f32 v123, v123
  v_exp_f32 v124, v124
  v_exp_f32 v125, v125
  v_exp_f32 v126, v126
  v_exp_f32 v127, v127
  v_cvt_pk_bf16_f32 v28, v120, v121
  v_cvt_pk_bf16_f32 v29, v122, v123
  v_cvt_pk_bf16_f32 v30, v124, v125
  v_cvt_pk_bf16_f32 v31, v126, v127
  buffer_load_dwordx4 v[172:175], v13, s[60:63], s90 offen offset:1824 sc1
  s_nop 0
  v_exp_f32 v96, v96
  v_exp_f32 v97, v97
  v_exp_f32 v98, v98
  v_exp_f32 v99, v99
  v_exp_f32 v100, v100
  v_exp_f32 v101, v101
  v_exp_f32 v102, v102
  v_exp_f32 v103, v103
  s_waitcnt lgkmcnt(2)
  v_mfma_f32_32x32x16_bf16 v[112:127], v[40:43], v[88:91], 0
  ds_read_b64 v[48:49], v237 offset:8192
  ds_read_b64 v[50:51], v237 offset:8704
  ds_read_b64 v[52:53], v237 offset:9216
  ds_read_b64 v[54:55], v237 offset:9728
  v_cvt_pk_bf16_f32 v32, v96, v97
  v_cvt_pk_bf16_f32 v33, v98, v99
  v_cvt_pk_bf16_f32 v34, v100, v101
  v_cvt_pk_bf16_f32 v35, v102, v103
  v_exp_f32 v104, v104
  v_exp_f32 v105, v105
  s_waitcnt lgkmcnt(4)
  v_mfma_f32_32x32x16_bf16 v[112:127], v[44:47], v[92:95], v[112:127]
  v_exp_f32 v106, v106
  v_exp_f32 v107, v107
  s_waitcnt vmcnt(3)
  s_barrier
  ds_read_b64_tr_b16 v[144:145], v238 offset:0
  ds_read_b64_tr_b16 v[146:147], v239 offset:0
  ds_read_b64_tr_b16 v[148:149], v240 offset:0
  ds_read_b64_tr_b16 v[150:151], v241 offset:0
  ds_read_b64_tr_b16 v[152:153], v238 offset:2048
  ds_read_b64_tr_b16 v[154:155], v239 offset:2048
  ds_read_b64_tr_b16 v[156:157], v240 offset:2048
  ds_read_b64_tr_b16 v[158:159], v241 offset:2048
  v_exp_f32 v108, v108
  v_exp_f32 v109, v109
  v_exp_f32 v110, v110
  v_exp_f32 v111, v111
  v_cvt_pk_bf16_f32 v36, v104, v105
  v_cvt_pk_bf16_f32 v37, v106, v107
  v_cvt_pk_bf16_f32 v38, v108, v109
  v_cvt_pk_bf16_f32 v39, v110, v111
  s_waitcnt lgkmcnt(0)
  v_mfma_f32_32x32x16_bf16 v[128:143], v[144:147], v[16:19], 0
  buffer_load_dwordx4 v[176:179], v13, s[60:63], s90 offen offset:1856 sc1
  v_exp_f32 v112, v112
  v_exp_f32 v113, v113
  v_exp_f32 v114, v114
  v_mfma_f32_32x32x16_bf16 v[128:143], v[148:151], v[20:23], v[128:143]
  v_exp_f32 v115, v115
  v_exp_f32 v116, v116
  v_exp_f32 v117, v117
  v_mfma_f32_32x32x16_bf16 v[128:143], v[152:155], v[24:27], v[128:143]
  ds_read_b64_tr_b16 v[184:185], v238 offset:4096
  ds_read_b64_tr_b16 v[186:187], v239 offset:4096
  ds_read_b64_tr_b16 v[188:189], v240 offset:4096
  ds_read_b64_tr_b16 v[190:191], v241 offset:4096
  v_exp_f32 v118, v118
  v_exp_f32 v119, v119
  v_mfma_f32_32x32x16_bf16 v[128:143], v[156:159], v[28:31], v[128:143]
  ds_read_b64_tr_b16 v[192:193], v238 offset:6144
  ds_read_b64_tr_b16 v[194:195], v239 offset:6144
  ds_read_b64_tr_b16 v[196:197], v240 offset:6144
  ds_read_b64_tr_b16 v[198:199], v241 offset:6144
  v_cvt_pk_bf16_f32 v40, v112, v113
  v_cvt_pk_bf16_f32 v41, v114, v115
  v_cvt_pk_bf16_f32 v42, v116, v117
  v_cvt_pk_bf16_f32 v43, v118, v119
  v_mfma_f32_32x32x16_bf16 v[96:111], v[48:51], v[88:91], 0
  ds_read_b64 v[56:57], v237 offset:10240
  ds_read_b64 v[58:59], v237 offset:10752
  ds_read_b64 v[60:61], v237 offset:11264
  ds_read_b64 v[62:63], v237 offset:11776
  v_exp_f32 v120, v120
  v_exp_f32 v121, v121
  v_exp_f32 v122, v122
  v_mfma_f32_32x32x16_bf16 v[96:111], v[52:55], v[92:95], v[96:111]
  v_exp_f32 v123, v123
  v_exp_f32 v124, v124
  v_exp_f32 v125, v125
  v_exp_f32 v126, v126
  v_exp_f32 v127, v127
  v_cvt_pk_bf16_f32 v44, v120, v121
  v_cvt_pk_bf16_f32 v45, v122, v123
  v_cvt_pk_bf16_f32 v46, v124, v125
  v_cvt_pk_bf16_f32 v47, v126, v127
  s_waitcnt lgkmcnt(4)
  v_mfma_f32_32x32x16_bf16 v[128:143], v[184:187], v[32:35], v[128:143]
  buffer_load_dwordx4 v[180:183], v12, s[60:63], s90 offen offset:1888 sc1
  v_exp_f32 v96, v96
  v_exp_f32 v97, v97
  v_exp_f32 v98, v98
  v_mfma_f32_32x32x16_bf16 v[128:143], v[188:191], v[36:39], v[128:143]
  v_exp_f32 v99, v99
  v_exp_f32 v100, v100
  v_exp_f32 v101, v101
  v_mfma_f32_32x32x16_bf16 v[128:143], v[192:195], v[40:43], v[128:143]
  ds_read_b64_tr_b16 v[144:145], v238 offset:8192
  ds_read_b64_tr_b16 v[146:147], v239 offset:8192
  ds_read_b64_tr_b16 v[148:149], v240 offset:8192
  ds_read_b64_tr_b16 v[150:151], v241 offset:8192
  v_exp_f32 v102, v102
  v_exp_f32 v103, v103
  v_mfma_f32_32x32x16_bf16 v[128:143], v[196:199], v[44:47], v[128:143]
  v_cvt_pk_bf16_f32 v48, v96, v97
  v_cvt_pk_bf16_f32 v49, v98, v99
  v_cvt_pk_bf16_f32 v50, v100, v101
  v_cvt_pk_bf16_f32 v51, v102, v103
  s_waitcnt lgkmcnt(6)
  v_mfma_f32_32x32x16_bf16 v[112:127], v[56:59], v[88:91], 0
  ds_read_b64 v[64:65], v237 offset:12288
  ds_read_b64 v[66:67], v237 offset:12800
  ds_read_b64 v[68:69], v237 offset:13312
  ds_read_b64 v[70:71], v237 offset:13824
  v_exp_f32 v104, v104
  v_exp_f32 v105, v105
  v_exp_f32 v106, v106
  s_waitcnt lgkmcnt(8)
  v_mfma_f32_32x32x16_bf16 v[112:127], v[60:63], v[92:95], v[112:127]
  v_exp_f32 v107, v107
  v_exp_f32 v108, v108
  v_exp_f32 v109, v109
  v_exp_f32 v110, v110
  v_exp_f32 v111, v111
  v_cvt_pk_bf16_f32 v52, v104, v105
  v_cvt_pk_bf16_f32 v53, v106, v107
  v_cvt_pk_bf16_f32 v54, v108, v109
  v_cvt_pk_bf16_f32 v55, v110, v111
  s_waitcnt lgkmcnt(4)
  v_mfma_f32_32x32x16_bf16 v[128:143], v[144:147], v[48:51], v[128:143]
  s_nop 0
  v_exp_f32 v112, v112
  v_exp_f32 v113, v113
  v_exp_f32 v114, v114
  v_exp_f32 v115, v115
  v_mfma_f32_32x32x16_bf16 v[128:143], v[148:151], v[52:55], v[128:143]
  ds_read_b64_tr_b16 v[152:153], v238 offset:10240
  ds_read_b64_tr_b16 v[154:155], v239 offset:10240
  ds_read_b64_tr_b16 v[156:157], v240 offset:10240
  ds_read_b64_tr_b16 v[158:159], v241 offset:10240
  v_exp_f32 v116, v116
  v_exp_f32 v117, v117
  v_exp_f32 v118, v118
  v_exp_f32 v119, v119
  s_waitcnt lgkmcnt(6)
  v_mfma_f32_32x32x16_bf16 v[96:111], v[64:67], v[88:91], 0
  ds_read_b64 v[72:73], v237 offset:14336
  ds_read_b64 v[74:75], v237 offset:14848
  ds_read_b64 v[76:77], v237 offset:15360
  ds_read_b64 v[78:79], v237 offset:15872
  v_cvt_pk_bf16_f32 v56, v112, v113
  v_cvt_pk_bf16_f32 v57, v114, v115
  v_cvt_pk_bf16_f32 v58, v116, v117
  v_cvt_pk_bf16_f32 v59, v118, v119
  v_exp_f32 v120, v120
  v_exp_f32 v121, v121
  v_exp_f32 v122, v122
  s_waitcnt lgkmcnt(8)
  v_mfma_f32_32x32x16_bf16 v[96:111], v[68:71], v[92:95], v[96:111]
  v_exp_f32 v123, v123
  v_exp_f32 v124, v124
  v_exp_f32 v125, v125
  v_exp_f32 v126, v126
  v_exp_f32 v127, v127
  v_cvt_pk_bf16_f32 v60, v120, v121
  v_cvt_pk_bf16_f32 v61, v122, v123
  v_cvt_pk_bf16_f32 v62, v124, v125
  v_cvt_pk_bf16_f32 v63, v126, v127
  s_waitcnt lgkmcnt(4)
  v_mfma_f32_32x32x16_bf16 v[128:143], v[152:155], v[56:59], v[128:143]
  s_nop 0
  v_exp_f32 v96, v96
  v_exp_f32 v97, v97
  v_exp_f32 v98, v98
  v_exp_f32 v99, v99
  v_mfma_f32_32x32x16_bf16 v[128:143], v[156:159], v[60:63], v[128:143]
  ds_read_b64_tr_b16 v[184:185], v238 offset:12288
  ds_read_b64_tr_b16 v[186:187], v239 offset:12288
  ds_read_b64_tr_b16 v[188:189], v240 offset:12288
  ds_read_b64_tr_b16 v[190:191], v241 offset:12288
  v_exp_f32 v100, v100
  v_exp_f32 v101, v101
  v_exp_f32 v102, v102
  v_exp_f32 v103, v103
  s_waitcnt lgkmcnt(6)
  v_mfma_f32_32x32x16_bf16 v[112:127], v[72:75], v[88:91], 0
  v_cvt_pk_bf16_f32 v64, v96, v97
  v_cvt_pk_bf16_f32 v65, v98, v99
  v_cvt_pk_bf16_f32 v66, v100, v101
  v_cvt_pk_bf16_f32 v67, v102, v103
  v_exp_f32 v104, v104
  v_exp_f32 v105, v105
  v_exp_f32 v106, v106
  s_waitcnt lgkmcnt(4)
  v_mfma_f32_32x32x16_bf16 v[112:127], v[76:79], v[92:95], v[112:127]
  v_exp_f32 v107, v107
  v_exp_f32 v108, v108
  v_exp_f32 v109, v109
  v_exp_f32 v110, v110
  v_exp_f32 v111, v111
  v_cvt_pk_bf16_f32 v68, v104, v105
  v_cvt_pk_bf16_f32 v69, v106, v107
  v_cvt_pk_bf16_f32 v70, v108, v109
  v_cvt_pk_bf16_f32 v71, v110, v111
  s_waitcnt lgkmcnt(0)
  v_mfma_f32_32x32x16_bf16 v[128:143], v[184:187], v[64:67], v[128:143]
  s_nop 0
  v_exp_f32 v112, v112
  v_exp_f32 v113, v113
  v_exp_f32 v114, v114
  v_exp_f32 v115, v115
  v_mfma_f32_32x32x16_bf16 v[128:143], v[188:191], v[68:71], v[128:143]
  ds_read_b64_tr_b16 v[192:193], v238 offset:14336
  ds_read_b64_tr_b16 v[194:195], v239 offset:14336
  ds_read_b64_tr_b16 v[196:197], v240 offset:14336
  ds_read_b64_tr_b16 v[198:199], v241 offset:14336
  v_exp_f32 v116, v116
  v_exp_f32 v117, v117
  v_exp_f32 v118, v118
  v_exp_f32 v119, v119
  v_mfma_f32_32x32x16_bf16 v[96:111], v[80:83], v[88:91], v[200:215]
  v_cvt_pk_bf16_f32 v72, v112, v113
  v_cvt_pk_bf16_f32 v73, v114, v115
  v_cvt_pk_bf16_f32 v74, v116, v117
  v_cvt_pk_bf16_f32 v75, v118, v119
  v_exp_f32 v120, v120
  v_exp_f32 v121, v121
  v_exp_f32 v122, v122
  v_mfma_f32_32x32x16_bf16 v[96:111], v[84:87], v[92:95], v[96:111]
  v_exp_f32 v123, v123
  v_exp_f32 v124, v124
  v_exp_f32 v125, v125
  v_exp_f32 v126, v126
  v_exp_f32 v127, v127
  v_cvt_pk_bf16_f32 v76, v120, v121
  v_cvt_pk_bf16_f32 v77, v122, v123
  v_cvt_pk_bf16_f32 v78, v124, v125
  v_cvt_pk_bf16_f32 v79, v126, v127
  s_waitcnt lgkmcnt(0)
  v_mfma_f32_32x32x16_bf16 v[128:143], v[192:195], v[72:75], v[128:143]
  s_nop 0
  v_exp_f32 v96, v96
  v_exp_f32 v97, v97
  v_exp_f32 v98, v98
  v_exp_f32 v99, v99
  v_mfma_f32_32x32x16_bf16 v[128:143], v[196:199], v[76:79], v[128:143]
  ds_read_b64_tr_b16 v[144:145], v238 offset:16384
  ds_read_b64_tr_b16 v[146:147], v239 offset:16384
  ds_read_b64_tr_b16 v[148:149], v240 offset:16384
  ds_read_b64_tr_b16 v[150:151], v241 offset:16384
  v_exp_f32 v100, v100
  v_exp_f32 v101, v101
  v_exp_f32 v102, v102
  v_exp_f32 v103, v103
  v_cvt_pk_bf16_f32 v80, v96, v97
  v_cvt_pk_bf16_f32 v81, v98, v99
  v_cvt_pk_bf16_f32 v82, v100, v101
  v_cvt_pk_bf16_f32 v83, v102, v103
  v_exp_f32 v104, v104
  v_exp_f32 v105, v105
  v_exp_f32 v106, v106
  v_exp_f32 v107, v107
  v_exp_f32 v108, v108
  v_exp_f32 v109, v109
  v_exp_f32 v110, v110
  v_exp_f32 v111, v111
  v_cvt_pk_bf16_f32 v84, v104, v105
  v_cvt_pk_bf16_f32 v85, v106, v107
  v_cvt_pk_bf16_f32 v86, v108, v109
  v_cvt_pk_bf16_f32 v87, v110, v111
  s_waitcnt lgkmcnt(2)
  v_mfma_f32_32x32x16_bf16 v[128:143], v[144:147], v[80:83], v[128:143]
  s_waitcnt lgkmcnt(0)
  v_mfma_f32_32x32x16_bf16 v[128:143], v[148:151], v[84:87], v[128:143]
  s_lshl_b32 s15, s86, 7
  s_add_u32 s15, s15, s12
  s_add_u32 s15, s15, s93
  s_waitcnt vmcnt(1)
  v_min3_u32 v10, v168, v172, v176
  s_waitcnt vmcnt(0)
  v_min_u32 v10, v10, v180
  v_cmp_eq_u32 vcc, 0, v10
  s_cbranch_vccnz L_ss_rr_142
L_ss_rb_143:
  s_nop 2
  v_mov_b32 v10, v140
  v_mov_b32 v11, v140
  s_nop 1
  v_permlane32_swap_b32 v10, v11
  v_cmp_ngt_f32 vcc, 0x5f800000, v11
  s_cbranch_vccnz L_ss_fb_140
L_ss_fbb_141:
  v_rcp_f32 v10, v11
  s_mov_b32 exec_lo, 0
  v_mov_b32 v140, 0
  s_mov_b32 exec_lo, -1
  v_pk_mul_f32 v[12:13], v[128:129], v[168:169]
  v_pk_mul_f32 v[128:129], v[128:129], v[10:11] op_sel_hi:[1,0]
  v_pk_fma_f32 v[12:13], v[130:131], v[170:171], v[12:13]
  v_pk_mul_f32 v[130:131], v[130:131], v[10:11] op_sel_hi:[1,0]
  v_pk_fma_f32 v[12:13], v[132:133], v[172:173], v[12:13]
  v_pk_mul_f32 v[132:133], v[132:133], v[10:11] op_sel_hi:[1,0]
  v_pk_fma_f32 v[12:13], v[134:135], v[174:175], v[12:13]
  v_pk_mul_f32 v[134:135], v[134:135], v[10:11] op_sel_hi:[1,0]
  v_pk_fma_f32 v[12:13], v[136:137], v[176:177], v[12:13]
  v_pk_mul_f32 v[136:137], v[136:137], v[10:11] op_sel_hi:[1,0]
  v_pk_fma_f32 v[12:13], v[138:139], v[178:179], v[12:13]
  v_pk_mul_f32 v[138:139], v[138:139], v[10:11] op_sel_hi:[1,0]
  v_pk_fma_f32 v[12:13], v[140:141], v[180:181], v[12:13]
  v_pk_mul_f32 v[140:141], v[140:141], v[10:11] op_sel_hi:[1,0]
  v_pk_fma_f32 v[12:13], v[142:143], v[182:183], v[12:13]
  v_pk_mul_f32 v[142:143], v[142:143], v[10:11] op_sel_hi:[1,0]
  v_add_f32 v12, v12, v13
  v_mul_f32 v12, v12, v10
  v_mov_b32 v13, v12
  v_cvt_pk_bf16_f32 v144, v128, v129
  v_cvt_pk_bf16_f32 v145, v130, v131
  v_permlane32_swap_b32 v12, v13
  v_cvt_pk_bf16_f32 v146, v132, v133
  v_cvt_pk_bf16_f32 v147, v134, v135
  v_cvt_pk_bf16_f32 v148, v136, v137
  v_cvt_pk_bf16_f32 v149, v138, v139
  v_cvt_pk_bf16_f32 v150, v140, v141
  v_cvt_pk_bf16_f32 v151, v142, v143
  s_mov_b32 exec_lo, 0
  v_add_f32 v150, v12, v13
  s_mov_b32 exec_lo, -1
  buffer_store_dwordx4 v[144:147], v1, s[60:63], s88 offen offset:0 sc1
  buffer_store_dwordx4 v[148:151], v1, s[60:63], s88 offen offset:1024 sc1
  s_waitcnt vmcnt(0)
  buffer_store_byte v5, v4, s[60:63], s15 offen offset:3072 sc1
  s_mov_b64 s[32:33], s[72:73]
  s_mov_b32 s34, 0x188000
  s_mov_b32 s35, 0x20000
  s_mov_b64 s[36:37], s[74:75]
  s_mov_b32 s38, 0x188000
  s_mov_b32 s39, 0x20000
  s_mul_i32 s14, s4, 1683456
  s_add_u32 s14, s14, 1654784
  s_mul_i32 s15, s3, 10
  v_min_u32 v252, 9, v0
  v_add_lshl_u32 v252, v252, s15, 7
  buffer_load_dword v253, v252, s[60:63], s14 offen
  buffer_load_dword v253, v254, s[52:55], 0 offen
  s_mul_i32 s14, s4, 0
  s_add_u32 s14, s14, 1792
  s_mul_i32 s15, s3, 14336
  s_add_u32 s14, s14, s15
  v_min_u32 v252, 12416, v255
  buffer_load_dword v253, v252, s[32:35], s14 offen
  s_waitcnt vmcnt(1)
L_ss_pfs_145:
  s_mul_i32 s14, s4, 0
  s_add_u32 s14, s14, 1792
  s_mul_i32 s15, s3, 14336
  s_add_u32 s14, s14, s15
  v_min_u32 v252, 12416, v255
  buffer_load_dword v253, v252, s[36:39], s14 offen
  s_waitcnt vmcnt(1)
L_ss_pfs_146:
  s_mul_i32 s14, s4, 200704
  s_add_u32 s14, s14, 1792
  s_mul_i32 s15, s3, 14336
  s_add_u32 s14, s14, s15
  v_min_u32 v252, 12416, v255
  buffer_load_dword v253, v252, s[32:35], s14 offen
  s_waitcnt vmcnt(1)
L_ss_pfs_147:
  s_mul_i32 s14, s4, 200704
  s_add_u32 s14, s14, 1792
  s_mul_i32 s15, s3, 14336
  s_add_u32 s14, s14, s15
  v_min_u32 v252, 12416, v255
  buffer_load_dword v253, v252, s[36:39], s14 offen
  s_waitcnt vmcnt(1)
L_ss_pfs_148:
  s_mul_i32 s14, s4, 200704
  s_add_u32 s14, s14, 0
  s_mul_i32 s15, s3, 49
  v_min_u32 v252, 48, v0
  v_add_lshl_u32 v252, v252, s15, 7
  buffer_load_dword v253, v252, s[48:51], s14 offen
  s_waitcnt vmcnt(1)
L_ss_pfs_149:
  s_mul_i32 s14, s4, 200704
  s_add_u32 s14, s14, 100352
  s_mul_i32 s15, s3, 49
  v_min_u32 v252, 48, v0
  v_add_lshl_u32 v252, v252, s15, 7
  buffer_load_dword v253, v252, s[48:51], s14 offen
  s_waitcnt vmcnt(1)
L_ss_pfs_150:
  s_endpgm
L_ws_rr_85:
  s_mov_b32 s27, 200000
L_ws_rl_87:
  buffer_load_dword v248, v3, s[56:59], 0 offen sc1
  s_waitcnt vmcnt(0)
  v_cmp_eq_u32 vcc, 0, v248
  s_and_b64 vcc, vcc, s[28:29]
  s_cbranch_vccz L_ws_rb_86
  s_sub_u32 s27, s27, 1
  s_cmp_lg_u32 s27, 0
  s_cbranch_scc1 L_ws_rl_87
  s_branch L_ws_rb_86
L_ws_rr_88:
  s_mov_b32 s27, 200000
L_ws_rl_90:
  buffer_load_dword v243, v236, s[60:63], 0 offen sc1
  s_waitcnt vmcnt(0)
  v_cmp_ne_u32 vcc, 1, v243
  s_and_b64 vcc, vcc, 0x3f
  s_cbranch_vccz L_ws_rb_89
  s_sub_u32 s27, s27, 1
  s_cmp_lg_u32 s27, 0
  s_cbranch_scc1 L_ws_rl_90
  s_branch L_ws_rb_89
L_ws_rr_91:
  s_mov_b32 s27, 200000
L_ws_rl_93:
  buffer_load_dword v249, v242, s[60:63], 0 offen sc1
  s_waitcnt vmcnt(0)
  v_cmp_ne_u32 vcc, 1, v249
  s_cbranch_vccz L_ws_rb_92
  s_sub_u32 s27, s27, 1
  s_cmp_lg_u32 s27, 0
  s_cbranch_scc1 L_ws_rl_93
  s_branch L_ws_rb_92
L_ws_rr_96:
  s_mov_b32 s27, 200000
L_ws_rl_98:
  buffer_load_dwordx4 v[168:171], v13, s[60:63], s90 offen offset:1792 sc1
  buffer_load_dwordx4 v[172:175], v13, s[60:63], s90 offen offset:1824 sc1
  buffer_load_dwordx4 v[176:179], v13, s[60:63], s90 offen offset:1856 sc1
  buffer_load_dwordx4 v[180:183], v12, s[60:63], s90 offen offset:1888 sc1
  s_waitcnt vmcnt(0)
  v_min3_u32 v10, v168, v172, v176
  v_min_u32 v10, v10, v180
  v_cmp_eq_u32 vcc, 0, v10
  s_cbranch_vccz L_ws_rb_97
  s_sub_u32 s27, s27, 1
  s_cmp_lg_u32 s27, 0
  s_cbranch_scc1 L_ws_rl_98
  s_branch L_ws_rb_97
L_ws_rr_101:
  s_mov_b32 s27, 200000
L_ws_rl_103:
  buffer_load_dword v243, v250, s[60:63], s93 offen offset:128 sc1
  s_waitcnt vmcnt(0)
  v_cmp_ne_u32 vcc, 1, v243
  s_cbranch_vccz L_ws_rb_102
  s_sub_u32 s27, s27, 1
  s_cmp_lg_u32 s27, 0
  s_cbranch_scc1 L_ws_rl_103
  s_branch L_ws_rb_102
L_ws_rr_106:
  s_mov_b32 s27, 200000
L_ws_rl_108:
  buffer_load_dword v187, v166, s[60:63], s91 offen offset:3136 sc1
  s_waitcnt vmcnt(0)
  v_cmp_ne_u32 vcc, v188, v187
  s_cbranch_vccz L_ws_rb_107
  s_sub_u32 s27, s27, 1
  s_cmp_lg_u32 s27, 0
  s_cbranch_scc1 L_ws_rl_108
  s_branch L_ws_rb_107
L_ws_rr_109:
  s_mov_b32 s27, 200000
L_ws_rl_111:
  buffer_load_dword v187, v186, s[60:63], s65 offen offset:2048 sc1
  s_waitcnt vmcnt(0)
  v_cmp_ne_u32 vcc, v188, v187
  s_and_b64 vcc, vcc, 0xf0f
  s_cbranch_vccz L_ws_rb_110
  s_sub_u32 s27, s27, 1
  s_cmp_lg_u32 s27, 0
  s_cbranch_scc1 L_ws_rl_111
  s_branch L_ws_rb_110
L_ws_rr_112:
  s_mov_b32 s27, 200000
L_ws_rl_114:
  buffer_load_dword v187, v186, s[60:63], s65 offen offset:2048 sc1
  s_waitcnt vmcnt(0)
  v_cmp_ne_u32 vcc, v188, v187
  s_and_b64 vcc, vcc, 0xf0
  s_cbranch_vccz L_ws_rb_113
  s_sub_u32 s27, s27, 1
  s_cmp_lg_u32 s27, 0
  s_cbranch_scc1 L_ws_rl_114
  s_branch L_ws_rb_113
L_ws_rr_115:
  s_mov_b32 s27, 200000
L_ws_rl_117:
  buffer_load_dword v187, v186, s[60:63], s65 offen offset:2048 sc1
  s_waitcnt vmcnt(0)
  v_cmp_ne_u32 vcc, v188, v187
  s_and_b64 vcc, vcc, 0xf000
  s_cbranch_vccz L_ws_rb_116
  s_sub_u32 s27, s27, 1
  s_cmp_lg_u32 s27, 0
  s_cbranch_scc1 L_ws_rl_117
  s_branch L_ws_rb_116
L_ss_rr_131:
  s_mov_b32 s27, 200000
L_ss_rl_133:
  buffer_load_dword v248, v3, s[56:59], 0 offen sc1
  s_waitcnt vmcnt(0)
  v_cmp_eq_u32 vcc, 0, v248
  s_and_b64 vcc, vcc, s[28:29]
  s_cbranch_vccz L_ss_rb_132
  s_sub_u32 s27, s27, 1
  s_cmp_lg_u32 s27, 0
  s_cbranch_scc1 L_ss_rl_133
  s_branch L_ss_rb_132
L_ss_rr_134:
  s_mov_b32 s27, 200000
L_ss_rl_136:
  buffer_load_dword v243, v236, s[60:63], 0 offen sc1
  s_waitcnt vmcnt(0)
  v_cmp_ne_u32 vcc, 1, v243
  s_and_b64 vcc, vcc, 0x3f
  s_cbranch_vccz L_ss_rb_135
  s_sub_u32 s27, s27, 1
  s_cmp_lg_u32 s27, 0
  s_cbranch_scc1 L_ss_rl_136
  s_branch L_ss_rb_135
L_ss_rr_137:
  s_mov_b32 s27, 200000
L_ss_rl_139:
  buffer_load_dword v249, v242, s[60:63], 0 offen sc1
  s_waitcnt vmcnt(0)
  v_cmp_ne_u32 vcc, 1, v249
  s_cbranch_vccz L_ss_rb_138
  s_sub_u32 s27, s27, 1
  s_cmp_lg_u32 s27, 0
  s_cbranch_scc1 L_ss_rl_139
  s_branch L_ss_rb_138
L_ss_rr_142:
  s_mov_b32 s27, 200000
L_ss_rl_144:
  buffer_load_dwordx4 v[168:171], v13, s[60:63], s90 offen offset:1792 sc1
  buffer_load_dwordx4 v[172:175], v13, s[60:63], s90 offen offset:1824 sc1
  buffer_load_dwordx4 v[176:179], v13, s[60:63], s90 offen offset:1856 sc1
  buffer_load_dwordx4 v[180:183], v12, s[60:63], s90 offen offset:1888 sc1
  s_waitcnt vmcnt(0)
  v_min3_u32 v10, v168, v172, v176
  v_min_u32 v10, v10, v180
  v_cmp_eq_u32 vcc, 0, v10
  s_cbranch_vccz L_ss_rb_143
  s_sub_u32 s27, s27, 1
  s_cmp_lg_u32 s27, 0
  s_cbranch_scc1 L_ss_rl_144
  s_branch L_ss_rb_143
L_wf_fb_19:
  s_mov_b32 exec_lo, 0
  v_mov_b32 v94, 0
  v_mov_b32 v95, 1.0
  s_mov_b32 exec_lo, -1
  ds_read_b64 v[16:17], v237 offset:0
  ds_read_b64 v[18:19], v237 offset:512
  ds_read_b64 v[20:21], v237 offset:1024
  ds_read_b64 v[22:23], v237 offset:1536
  v_sub_f32 v96, 0xf149f2ca, v200
  v_sub_f32 v97, 0xf149f2ca, v201
  v_sub_f32 v98, 0xf149f2ca, v202
  v_sub_f32 v99, 0xf149f2ca, v203
  v_sub_f32 v100, 0xf149f2ca, v204
  v_sub_f32 v101, 0xf149f2ca, v205
  v_sub_f32 v102, 0xf149f2ca, v206
  v_sub_f32 v103, 0xf149f2ca, v207
  v_sub_f32 v104, 0xf149f2ca, v208
  v_sub_f32 v105, 0xf149f2ca, v209
  v_sub_f32 v106, 0xf149f2ca, v210
  v_sub_f32 v107, 0xf149f2ca, v211
  v_sub_f32 v108, 0xf149f2ca, v212
  v_sub_f32 v109, 0xf149f2ca, v213
  v_sub_f32 v110, 0xf149f2ca, v214
  v_sub_f32 v111, 0xf149f2ca, v215
  s_waitcnt lgkmcnt(2)
  s_nop 0
  v_mfma_f32_32x32x16_bf16 v[96:111], v[16:19], v[88:91], v[96:111]
  s_waitcnt lgkmcnt(0)
  v_mfma_f32_32x32x16_bf16 v[96:111], v[20:23], v[92:95], v[96:111]
  s_nop 11
  v_max_f32 v10, v96, v97
  v_max_f32 v11, v98, v99
  v_max3_f32 v10, v10, v100, v101
  v_max3_f32 v11, v11, v102, v103
  v_max3_f32 v10, v10, v104, v105
  v_max3_f32 v11, v11, v106, v107
  v_max3_f32 v10, v10, v108, v109
  v_max3_f32 v11, v11, v110, v111
  ds_read_b64 v[24:25], v237 offset:2048
  ds_read_b64 v[26:27], v237 offset:2560
  ds_read_b64 v[28:29], v237 offset:3072
  ds_read_b64 v[30:31], v237 offset:3584
  s_waitcnt lgkmcnt(2)
  v_mfma_f32_32x32x16_bf16 v[112:127], v[24:27], v[88:91], 0
  s_waitcnt lgkmcnt(0)
  v_mfma_f32_32x32x16_bf16 v[112:127], v[28:31], v[92:95], v[112:127]
  s_nop 11
  v_max3_f32 v10, v10, v112, v113
  v_max3_f32 v11, v11, v114, v115
  v_max3_f32 v10, v10, v116, v117
  v_max3_f32 v11, v11, v118, v119
  v_max3_f32 v10, v10, v120, v121
  v_max3_f32 v11, v11, v122, v123
  v_max3_f32 v10, v10, v124, v125
  v_max3_f32 v11, v11, v126, v127
  ds_read_b64 v[32:33], v237 offset:4096
  ds_read_b64 v[34:35], v237 offset:4608
  ds_read_b64 v[36:37], v237 offset:5120
  ds_read_b64 v[38:39], v237 offset:5632
  s_waitcnt lgkmcnt(2)
  v_mfma_f32_32x32x16_bf16 v[96:111], v[32:35], v[88:91], 0
  s_waitcnt lgkmcnt(0)
  v_mfma_f32_32x32x16_bf16 v[96:111], v[36:39], v[92:95], v[96:111]
  s_nop 11
  v_max3_f32 v10, v10, v96, v97
  v_max3_f32 v11, v11, v98, v99
  v_max3_f32 v10, v10, v100, v101
  v_max3_f32 v11, v11, v102, v103
  v_max3_f32 v10, v10, v104, v105
  v_max3_f32 v11, v11, v106, v107
  v_max3_f32 v10, v10, v108, v109
  v_max3_f32 v11, v11, v110, v111
  ds_read_b64 v[40:41], v237 offset:6144
  ds_read_b64 v[42:43], v237 offset:6656
  ds_read_b64 v[44:45], v237 offset:7168
  ds_read_b64 v[46:47], v237 offset:7680
  s_waitcnt lgkmcnt(2)
  v_mfma_f32_32x32x16_bf16 v[112:127], v[40:43], v[88:91], 0
  s_waitcnt lgkmcnt(0)
  v_mfma_f32_32x32x16_bf16 v[112:127], v[44:47], v[92:95], v[112:127]
  s_nop 11
  v_max3_f32 v10, v10, v112, v113
  v_max3_f32 v11, v11, v114, v115
  v_max3_f32 v10, v10, v116, v117
  v_max3_f32 v11, v11, v118, v119
  v_max3_f32 v10, v10, v120, v121
  v_max3_f32 v11, v11, v122, v123
  v_max3_f32 v10, v10, v124, v125
  v_max3_f32 v11, v11, v126, v127
  ds_read_b64 v[48:49], v237 offset:8192
  ds_read_b64 v[50:51], v237 offset:8704
  ds_read_b64 v[52:53], v237 offset:9216
  ds_read_b64 v[54:55], v237 offset:9728
  s_waitcnt lgkmcnt(2)
  v_mfma_f32_32x32x16_bf16 v[96:111], v[48:51], v[88:91], 0
  s_waitcnt lgkmcnt(0)
  v_mfma_f32_32x32x16_bf16 v[96:111], v[52:55], v[92:95], v[96:111]
  s_nop 11
  v_max3_f32 v10, v10, v96, v97
  v_max3_f32 v11, v11, v98, v99
  v_max3_f32 v10, v10, v100, v101
  v_max3_f32 v11, v11, v102, v103
  v_max3_f32 v10, v10, v104, v105
  v_max3_f32 v11, v11, v106, v107
  v_max3_f32 v10, v10, v108, v109
  v_max3_f32 v11, v11, v110, v111
  ds_read_b64 v[56:57], v237 offset:10240
  ds_read_b64 v[58:59], v237 offset:10752
  ds_read_b64 v[60:61], v237 offset:11264
  ds_read_b64 v[62:63], v237 offset:11776
  s_waitcnt lgkmcnt(2)
  v_mfma_f32_32x32x16_bf16 v[112:127], v[56:59], v[88:91], 0
  s_waitcnt lgkmcnt(0)
  v_mfma_f32_32x32x16_bf16 v[112:127], v[60:63], v[92:95], v[112:127]
  s_nop 11
  v_max3_f32 v10, v10, v112, v113
  v_max3_f32 v11, v11, v114, v115
  v_max3_f32 v10, v10, v116, v117
  v_max3_f32 v11, v11, v118, v119
  v_max3_f32 v10, v10, v120, v121
  v_max3_f32 v11, v11, v122, v123
  v_max3_f32 v10, v10, v124, v125
  v_max3_f32 v11, v11, v126, v127
  ds_read_b64 v[64:65], v237 offset:12288
  ds_read_b64 v[66:67], v237 offset:12800
  ds_read_b64 v[68:69], v237 offset:13312
  ds_read_b64 v[70:71], v237 offset:13824
  s_waitcnt lgkmcnt(2)
  v_mfma_f32_32x32x16_bf16 v[96:111], v[64:67], v[88:91], 0
  s_waitcnt lgkmcnt(0)
  v_mfma_f32_32x32x16_bf16 v[96:111], v[68:71], v[92:95], v[96:111]
  s_nop 11
  v_max3_f32 v10, v10, v96, v97
  v_max3_f32 v11, v11, v98, v99
  v_max3_f32 v10, v10, v100, v101
  v_max3_f32 v11, v11, v102, v103
  v_max3_f32 v10, v10, v104, v105
  v_max3_f32 v11, v11, v106, v107
  v_max3_f32 v10, v10, v108, v109
  v_max3_f32 v11, v11, v110, v111
  ds_read_b64 v[72:73], v237 offset:14336
  ds_read_b64 v[74:75], v237 offset:14848
  ds_read_b64 v[76:77], v237 offset:15360
  ds_read_b64 v[78:79], v237 offset:15872
  s_waitcnt lgkmcnt(2)
  v_mfma_f32_32x32x16_bf16 v[112:127], v[72:75], v[88:91], 0
  s_waitcnt lgkmcnt(0)
  v_mfma_f32_32x32x16_bf16 v[112:127], v[76:79], v[92:95], v[112:127]
  s_nop 11
  v_max3_f32 v10, v10, v112, v113
  v_max3_f32 v11, v11, v114, v115
  v_max3_f32 v10, v10, v116, v117
  v_max3_f32 v11, v11, v118, v119
  v_max3_f32 v10, v10, v120, v121
  v_max3_f32 v11, v11, v122, v123
  v_max3_f32 v10, v10, v124, v125
  v_max3_f32 v11, v11, v126, v127
  ds_read_b64 v[80:81], v237 offset:16384
  ds_read_b64 v[82:83], v237 offset:16896
  ds_read_b64 v[84:85], v237 offset:17408
  ds_read_b64 v[86:87], v237 offset:17920
  s_waitcnt lgkmcnt(2)
  v_mfma_f32_32x32x16_bf16 v[96:111], v[80:83], v[88:91], v[200:215]
  s_waitcnt lgkmcnt(0)
  v_mfma_f32_32x32x16_bf16 v[96:111], v[84:87], v[92:95], v[96:111]
  s_nop 11
  v_max3_f32 v10, v10, v96, v97
  v_max3_f32 v11, v11, v98, v99
  v_max3_f32 v10, v10, v100, v101
  v_max3_f32 v11, v11, v102, v103
  v_max3_f32 v10, v10, v104, v105
  v_max3_f32 v11, v11, v106, v107
  v_max3_f32 v10, v10, v108, v109
  v_max3_f32 v11, v11, v110, v111
  v_max_f32 v10, v10, v11
  v_mov_b32 v11, v10
  s_mov_b32 s16, 0xffff0000
  s_mov_b32 s17, 0x07060302
  v_permlane32_swap_b32 v10, v11
  v_min_f32 v10, -v10, -v11
  v_and_b32 v11, s16, v10
  v_sub_f32 v11, v10, v11
  v_and_b32 v14, s16, v11
  v_sub_f32 v14, v11, v14
  s_mov_b32 exec_lo, 0
  v_perm_b32 v94, v11, v10, s17
  v_perm_b32 v95, v95, v14, s17
  s_mov_b32 exec_lo, -1
  v_sub_f32 v96, 0xf149f2ca, v200
  v_sub_f32 v97, 0xf149f2ca, v201
  v_sub_f32 v98, 0xf149f2ca, v202
  v_sub_f32 v99, 0xf149f2ca, v203
  v_sub_f32 v100, 0xf149f2ca, v204
  v_sub_f32 v101, 0xf149f2ca, v205
  v_sub_f32 v102, 0xf149f2ca, v206
  v_sub_f32 v103, 0xf149f2ca, v207
  v_sub_f32 v104, 0xf149f2ca, v208
  v_sub_f32 v105, 0xf149f2ca, v209
  v_sub_f32 v106, 0xf149f2ca, v210
  v_sub_f32 v107, 0xf149f2ca, v211
  v_sub_f32 v108, 0xf149f2ca, v212
  v_sub_f32 v109, 0xf149f2ca, v213
  v_sub_f32 v110, 0xf149f2ca, v214
  v_sub_f32 v111, 0xf149f2ca, v215
  s_nop 1
  v_mfma_f32_32x32x16_bf16 v[96:111], v[16:19], v[88:91], v[96:111]
  v_mfma_f32_32x32x16_bf16 v[96:111], v[20:23], v[92:95], v[96:111]
  ds_read_b64_tr_b16 v[144:145], v238 offset:0
  ds_read_b64_tr_b16 v[146:147], v239 offset:0
  ds_read_b64_tr_b16 v[148:149], v240 offset:0
  ds_read_b64_tr_b16 v[150:151], v241 offset:0
  s_nop 7
  v_exp_f32 v96, v96
  v_exp_f32 v97, v97
  v_exp_f32 v98, v98
  v_exp_f32 v99, v99
  v_exp_f32 v100, v100
  v_exp_f32 v101, v101
  v_exp_f32 v102, v102
  v_exp_f32 v103, v103
  v_exp_f32 v104, v104
  v_exp_f32 v105, v105
  v_exp_f32 v106, v106
  v_exp_f32 v107, v107
  v_exp_f32 v108, v108
  v_exp_f32 v109, v109
  v_exp_f32 v110, v110
  v_exp_f32 v111, v111
  v_cvt_pk_bf16_f32 v16, v96, v97
  v_cvt_pk_bf16_f32 v17, v98, v99
  v_cvt_pk_bf16_f32 v18, v100, v101
  v_cvt_pk_bf16_f32 v19, v102, v103
  v_cvt_pk_bf16_f32 v20, v104, v105
  v_cvt_pk_bf16_f32 v21, v106, v107
  v_cvt_pk_bf16_f32 v22, v108, v109
  v_cvt_pk_bf16_f32 v23, v110, v111
  s_waitcnt lgkmcnt(2)
  v_mfma_f32_32x32x16_bf16 v[128:143], v[144:147], v[16:19], 0
  s_waitcnt lgkmcnt(0)
  v_mfma_f32_32x32x16_bf16 v[128:143], v[148:151], v[20:23], v[128:143]
  v_mfma_f32_32x32x16_bf16 v[112:127], v[24:27], v[88:91], 0
  v_mfma_f32_32x32x16_bf16 v[112:127], v[28:31], v[92:95], v[112:127]
  ds_read_b64_tr_b16 v[152:153], v238 offset:2048
  ds_read_b64_tr_b16 v[154:155], v239 offset:2048
  ds_read_b64_tr_b16 v[156:157], v240 offset:2048
  ds_read_b64_tr_b16 v[158:159], v241 offset:2048
  s_nop 7
  v_exp_f32 v112, v112
  v_exp_f32 v113, v113
  v_exp_f32 v114, v114
  v_exp_f32 v115, v115
  v_exp_f32 v116, v116
  v_exp_f32 v117, v117
  v_exp_f32 v118, v118
  v_exp_f32 v119, v119
  v_exp_f32 v120, v120
  v_exp_f32 v121, v121
  v_exp_f32 v122, v122
  v_exp_f32 v123, v123
  v_exp_f32 v124, v124
  v_exp_f32 v125, v125
  v_exp_f32 v126, v126
  v_exp_f32 v127, v127
  v_cvt_pk_bf16_f32 v24, v112, v113
  v_cvt_pk_bf16_f32 v25, v114, v115
  v_cvt_pk_bf16_f32 v26, v116, v117
  v_cvt_pk_bf16_f32 v27, v118, v119
  v_cvt_pk_bf16_f32 v28, v120, v121
  v_cvt_pk_bf16_f32 v29, v122, v123
  v_cvt_pk_bf16_f32 v30, v124, v125
  v_cvt_pk_bf16_f32 v31, v126, v127
  s_waitcnt lgkmcnt(2)
  v_mfma_f32_32x32x16_bf16 v[128:143], v[152:155], v[24:27], v[128:143]
  s_waitcnt lgkmcnt(0)
  v_mfma_f32_32x32x16_bf16 v[128:143], v[156:159], v[28:31], v[128:143]
  v_mfma_f32_32x32x16_bf16 v[96:111], v[32:35], v[88:91], 0
  v_mfma_f32_32x32x16_bf16 v[96:111], v[36:39], v[92:95], v[96:111]
  ds_read_b64_tr_b16 v[184:185], v238 offset:4096
  ds_read_b64_tr_b16 v[186:187], v239 offset:4096
  ds_read_b64_tr_b16 v[188:189], v240 offset:4096
  ds_read_b64_tr_b16 v[190:191], v241 offset:4096
  s_nop 7
  v_exp_f32 v96, v96
  v_exp_f32 v97, v97
  v_exp_f32 v98, v98
  v_exp_f32 v99, v99
  v_exp_f32 v100, v100
  v_exp_f32 v101, v101
  v_exp_f32 v102, v102
  v_exp_f32 v103, v103
  v_exp_f32 v104, v104
  v_exp_f32 v105, v105
  v_exp_f32 v106, v106
  v_exp_f32 v107, v107
  v_exp_f32 v108, v108
  v_exp_f32 v109, v109
  v_exp_f32 v110, v110
  v_exp_f32 v111, v111
  v_cvt_pk_bf16_f32 v32, v96, v97
  v_cvt_pk_bf16_f32 v33, v98, v99
  v_cvt_pk_bf16_f32 v34, v100, v101
  v_cvt_pk_bf16_f32 v35, v102, v103
  v_cvt_pk_bf16_f32 v36, v104, v105
  v_cvt_pk_bf16_f32 v37, v106, v107
  v_cvt_pk_bf16_f32 v38, v108, v109
  v_cvt_pk_bf16_f32 v39, v110, v111
  s_waitcnt lgkmcnt(2)
  v_mfma_f32_32x32x16_bf16 v[128:143], v[184:187], v[32:35], v[128:143]
  s_waitcnt lgkmcnt(0)
  v_mfma_f32_32x32x16_bf16 v[128:143], v[188:191], v[36:39], v[128:143]
  v_mfma_f32_32x32x16_bf16 v[112:127], v[40:43], v[88:91], 0
  v_mfma_f32_32x32x16_bf16 v[112:127], v[44:47], v[92:95], v[112:127]
  ds_read_b64_tr_b16 v[192:193], v238 offset:6144
  ds_read_b64_tr_b16 v[194:195], v239 offset:6144
  ds_read_b64_tr_b16 v[196:197], v240 offset:6144
  ds_read_b64_tr_b16 v[198:199], v241 offset:6144
  s_nop 7
  v_exp_f32 v112, v112
  v_exp_f32 v113, v113
  v_exp_f32 v114, v114
  v_exp_f32 v115, v115
  v_exp_f32 v116, v116
  v_exp_f32 v117, v117
  v_exp_f32 v118, v118
  v_exp_f32 v119, v119
  v_exp_f32 v120, v120
  v_exp_f32 v121, v121
  v_exp_f32 v122, v122
  v_exp_f32 v123, v123
  v_exp_f32 v124, v124
  v_exp_f32 v125, v125
  v_exp_f32 v126, v126
  v_exp_f32 v127, v127
  v_cvt_pk_bf16_f32 v40, v112, v113
  v_cvt_pk_bf16_f32 v41, v114, v115
  v_cvt_pk_bf16_f32 v42, v116, v117
  v_cvt_pk_bf16_f32 v43, v118, v119
  v_cvt_pk_bf16_f32 v44, v120, v121
  v_cvt_pk_bf16_f32 v45, v122, v123
  v_cvt_pk_bf16_f32 v46, v124, v125
  v_cvt_pk_bf16_f32 v47, v126, v127
  s_waitcnt lgkmcnt(2)
  v_mfma_f32_32x32x16_bf16 v[128:143], v[192:195], v[40:43], v[128:143]
  s_waitcnt lgkmcnt(0)
  v_mfma_f32_32x32x16_bf16 v[128:143], v[196:199], v[44:47], v[128:143]
  v_mfma_f32_32x32x16_bf16 v[96:111], v[48:51], v[88:91], 0
  v_mfma_f32_32x32x16_bf16 v[96:111], v[52:55], v[92:95], v[96:111]
  ds_read_b64_tr_b16 v[144:145], v238 offset:8192
  ds_read_b64_tr_b16 v[146:147], v239 offset:8192
  ds_read_b64_tr_b16 v[148:149], v240 offset:8192
  ds_read_b64_tr_b16 v[150:151], v241 offset:8192
  s_nop 7
  v_exp_f32 v96, v96
  v_exp_f32 v97, v97
  v_exp_f32 v98, v98
  v_exp_f32 v99, v99
  v_exp_f32 v100, v100
  v_exp_f32 v101, v101
  v_exp_f32 v102, v102
  v_exp_f32 v103, v103
  v_exp_f32 v104, v104
  v_exp_f32 v105, v105
  v_exp_f32 v106, v106
  v_exp_f32 v107, v107
  v_exp_f32 v108, v108
  v_exp_f32 v109, v109
  v_exp_f32 v110, v110
  v_exp_f32 v111, v111
  v_cvt_pk_bf16_f32 v48, v96, v97
  v_cvt_pk_bf16_f32 v49, v98, v99
  v_cvt_pk_bf16_f32 v50, v100, v101
  v_cvt_pk_bf16_f32 v51, v102, v103
  v_cvt_pk_bf16_f32 v52, v104, v105
  v_cvt_pk_bf16_f32 v53, v106, v107
  v_cvt_pk_bf16_f32 v54, v108, v109
  v_cvt_pk_bf16_f32 v55, v110, v111
  s_waitcnt lgkmcnt(2)
  v_mfma_f32_32x32x16_bf16 v[128:143], v[144:147], v[48:51], v[128:143]
  s_waitcnt lgkmcnt(0)
  v_mfma_f32_32x32x16_bf16 v[128:143], v[148:151], v[52:55], v[128:143]
  v_mfma_f32_32x32x16_bf16 v[112:127], v[56:59], v[88:91], 0
  v_mfma_f32_32x32x16_bf16 v[112:127], v[60:63], v[92:95], v[112:127]
  ds_read_b64_tr_b16 v[152:153], v238 offset:10240
  ds_read_b64_tr_b16 v[154:155], v239 offset:10240
  ds_read_b64_tr_b16 v[156:157], v240 offset:10240
  ds_read_b64_tr_b16 v[158:159], v241 offset:10240
  s_nop 7
  v_exp_f32 v112, v112
  v_exp_f32 v113, v113
  v_exp_f32 v114, v114
  v_exp_f32 v115, v115
  v_exp_f32 v116, v116
  v_exp_f32 v117, v117
  v_exp_f32 v118, v118
  v_exp_f32 v119, v119
  v_exp_f32 v120, v120
  v_exp_f32 v121, v121
  v_exp_f32 v122, v122
  v_exp_f32 v123, v123
  v_exp_f32 v124, v124
  v_exp_f32 v125, v125
  v_exp_f32 v126, v126
  v_exp_f32 v127, v127
  v_cvt_pk_bf16_f32 v56, v112, v113
  v_cvt_pk_bf16_f32 v57, v114, v115
  v_cvt_pk_bf16_f32 v58, v116, v117
  v_cvt_pk_bf16_f32 v59, v118, v119
  v_cvt_pk_bf16_f32 v60, v120, v121
  v_cvt_pk_bf16_f32 v61, v122, v123
  v_cvt_pk_bf16_f32 v62, v124, v125
  v_cvt_pk_bf16_f32 v63, v126, v127
  s_waitcnt lgkmcnt(2)
  v_mfma_f32_32x32x16_bf16 v[128:143], v[152:155], v[56:59], v[128:143]
  s_waitcnt lgkmcnt(0)
  v_mfma_f32_32x32x16_bf16 v[128:143], v[156:159], v[60:63], v[128:143]
  v_mfma_f32_32x32x16_bf16 v[96:111], v[64:67], v[88:91], 0
  v_mfma_f32_32x32x16_bf16 v[96:111], v[68:71], v[92:95], v[96:111]
  ds_read_b64_tr_b16 v[184:185], v238 offset:12288
  ds_read_b64_tr_b16 v[186:187], v239 offset:12288
  ds_read_b64_tr_b16 v[188:189], v240 offset:12288
  ds_read_b64_tr_b16 v[190:191], v241 offset:12288
  s_nop 7
  v_exp_f32 v96, v96
  v_exp_f32 v97, v97
  v_exp_f32 v98, v98
  v_exp_f32 v99, v99
  v_exp_f32 v100, v100
  v_exp_f32 v101, v101
  v_exp_f32 v102, v102
  v_exp_f32 v103, v103
  v_exp_f32 v104, v104
  v_exp_f32 v105, v105
  v_exp_f32 v106, v106
  v_exp_f32 v107, v107
  v_exp_f32 v108, v108
  v_exp_f32 v109, v109
  v_exp_f32 v110, v110
  v_exp_f32 v111, v111
  v_cvt_pk_bf16_f32 v64, v96, v97
  v_cvt_pk_bf16_f32 v65, v98, v99
  v_cvt_pk_bf16_f32 v66, v100, v101
  v_cvt_pk_bf16_f32 v67, v102, v103
  v_cvt_pk_bf16_f32 v68, v104, v105
  v_cvt_pk_bf16_f32 v69, v106, v107
  v_cvt_pk_bf16_f32 v70, v108, v109
  v_cvt_pk_bf16_f32 v71, v110, v111
  s_waitcnt lgkmcnt(2)
  v_mfma_f32_32x32x16_bf16 v[128:143], v[184:187], v[64:67], v[128:143]
  s_waitcnt lgkmcnt(0)
  v_mfma_f32_32x32x16_bf16 v[128:143], v[188:191], v[68:71], v[128:143]
  v_mfma_f32_32x32x16_bf16 v[112:127], v[72:75], v[88:91], 0
  v_mfma_f32_32x32x16_bf16 v[112:127], v[76:79], v[92:95], v[112:127]
  ds_read_b64_tr_b16 v[192:193], v238 offset:14336
  ds_read_b64_tr_b16 v[194:195], v239 offset:14336
  ds_read_b64_tr_b16 v[196:197], v240 offset:14336
  ds_read_b64_tr_b16 v[198:199], v241 offset:14336
  s_nop 7
  v_exp_f32 v112, v112
  v_exp_f32 v113, v113
  v_exp_f32 v114, v114
  v_exp_f32 v115, v115
  v_exp_f32 v116, v116
  v_exp_f32 v117, v117
  v_exp_f32 v118, v118
  v_exp_f32 v119, v119
  v_exp_f32 v120, v120
  v_exp_f32 v121, v121
  v_exp_f32 v122, v122
  v_exp_f32 v123, v123
  v_exp_f32 v124, v124
  v_exp_f32 v125, v125
  v_exp_f32 v126, v126
  v_exp_f32 v127, v127
  v_cvt_pk_bf16_f32 v72, v112, v113
  v_cvt_pk_bf16_f32 v73, v114, v115
  v_cvt_pk_bf16_f32 v74, v116, v117
  v_cvt_pk_bf16_f32 v75, v118, v119
  v_cvt_pk_bf16_f32 v76, v120, v121
  v_cvt_pk_bf16_f32 v77, v122, v123
  v_cvt_pk_bf16_f32 v78, v124, v125
  v_cvt_pk_bf16_f32 v79, v126, v127
  s_waitcnt lgkmcnt(2)
  v_mfma_f32_32x32x16_bf16 v[128:143], v[192:195], v[72:75], v[128:143]
  s_waitcnt lgkmcnt(0)
  v_mfma_f32_32x32x16_bf16 v[128:143], v[196:199], v[76:79], v[128:143]
  v_mfma_f32_32x32x16_bf16 v[96:111], v[80:83], v[88:91], v[200:215]
  v_mfma_f32_32x32x16_bf16 v[96:111], v[84:87], v[92:95], v[96:111]
  ds_read_b64_tr_b16 v[144:145], v238 offset:16384
  ds_read_b64_tr_b16 v[146:147], v239 offset:16384
  ds_read_b64_tr_b16 v[148:149], v240 offset:16384
  ds_read_b64_tr_b16 v[150:151], v241 offset:16384
  s_nop 7
  v_exp_f32 v96, v96
  v_exp_f32 v97, v97
  v_exp_f32 v98, v98
  v_exp_f32 v99, v99
  v_exp_f32 v100, v100
  v_exp_f32 v101, v101
  v_exp_f32 v102, v102
  v_exp_f32 v103, v103
  v_exp_f32 v104, v104
  v_exp_f32 v105, v105
  v_exp_f32 v106, v106
  v_exp_f32 v107, v107
  v_exp_f32 v108, v108
  v_exp_f32 v109, v109
  v_exp_f32 v110, v110
  v_exp_f32 v111, v111
  v_cvt_pk_bf16_f32 v80, v96, v97
  v_cvt_pk_bf16_f32 v81, v98, v99
  v_cvt_pk_bf16_f32 v82, v100, v101
  v_cvt_pk_bf16_f32 v83, v102, v103
  v_cvt_pk_bf16_f32 v84, v104, v105
  v_cvt_pk_bf16_f32 v85, v106, v107
  v_cvt_pk_bf16_f32 v86, v108, v109
  v_cvt_pk_bf16_f32 v87, v110, v111
  s_waitcnt lgkmcnt(2)
  v_mfma_f32_32x32x16_bf16 v[128:143], v[144:147], v[80:83], v[128:143]
  s_waitcnt lgkmcnt(0)
  v_mfma_f32_32x32x16_bf16 v[128:143], v[148:151], v[84:87], v[128:143]
  s_nop 11
  v_mov_b32 v10, v140
  v_mov_b32 v11, v140
  s_nop 1
  v_permlane32_swap_b32 v10, v11
  s_branch L_wf_fbb_20
L_sf_fb_65:
  s_mov_b32 exec_lo, 0
  v_mov_b32 v94, 0
  v_mov_b32 v95, 1.0
  s_mov_b32 exec_lo, -1
  ds_read_b64 v[16:17], v237 offset:0
  ds_read_b64 v[18:19], v237 offset:512
  ds_read_b64 v[20:21], v237 offset:1024
  ds_read_b64 v[22:23], v237 offset:1536
  v_sub_f32 v96, 0xf149f2ca, v200
  v_sub_f32 v97, 0xf149f2ca, v201
  v_sub_f32 v98, 0xf149f2ca, v202
  v_sub_f32 v99, 0xf149f2ca, v203
  v_sub_f32 v100, 0xf149f2ca, v204
  v_sub_f32 v101, 0xf149f2ca, v205
  v_sub_f32 v102, 0xf149f2ca, v206
  v_sub_f32 v103, 0xf149f2ca, v207
  v_sub_f32 v104, 0xf149f2ca, v208
  v_sub_f32 v105, 0xf149f2ca, v209
  v_sub_f32 v106, 0xf149f2ca, v210
  v_sub_f32 v107, 0xf149f2ca, v211
  v_sub_f32 v108, 0xf149f2ca, v212
  v_sub_f32 v109, 0xf149f2ca, v213
  v_sub_f32 v110, 0xf149f2ca, v214
  v_sub_f32 v111, 0xf149f2ca, v215
  s_waitcnt lgkmcnt(2)
  s_nop 0
  v_mfma_f32_32x32x16_bf16 v[96:111], v[16:19], v[88:91], v[96:111]
  s_waitcnt lgkmcnt(0)
  v_mfma_f32_32x32x16_bf16 v[96:111], v[20:23], v[92:95], v[96:111]
  s_nop 11
  v_max_f32 v10, v96, v97
  v_max_f32 v11, v98, v99
  v_max3_f32 v10, v10, v100, v101
  v_max3_f32 v11, v11, v102, v103
  v_max3_f32 v10, v10, v104, v105
  v_max3_f32 v11, v11, v106, v107
  v_max3_f32 v10, v10, v108, v109
  v_max3_f32 v11, v11, v110, v111
  ds_read_b64 v[24:25], v237 offset:2048
  ds_read_b64 v[26:27], v237 offset:2560
  ds_read_b64 v[28:29], v237 offset:3072
  ds_read_b64 v[30:31], v237 offset:3584
  s_waitcnt lgkmcnt(2)
  v_mfma_f32_32x32x16_bf16 v[112:127], v[24:27], v[88:91], 0
  s_waitcnt lgkmcnt(0)
  v_mfma_f32_32x32x16_bf16 v[112:127], v[28:31], v[92:95], v[112:127]
  s_nop 11
  v_max3_f32 v10, v10, v112, v113
  v_max3_f32 v11, v11, v114, v115
  v_max3_f32 v10, v10, v116, v117
  v_max3_f32 v11, v11, v118, v119
  v_max3_f32 v10, v10, v120, v121
  v_max3_f32 v11, v11, v122, v123
  v_max3_f32 v10, v10, v124, v125
  v_max3_f32 v11, v11, v126, v127
  ds_read_b64 v[32:33], v237 offset:4096
  ds_read_b64 v[34:35], v237 offset:4608
  ds_read_b64 v[36:37], v237 offset:5120
  ds_read_b64 v[38:39], v237 offset:5632
  s_waitcnt lgkmcnt(2)
  v_mfma_f32_32x32x16_bf16 v[96:111], v[32:35], v[88:91], 0
  s_waitcnt lgkmcnt(0)
  v_mfma_f32_32x32x16_bf16 v[96:111], v[36:39], v[92:95], v[96:111]
  s_nop 11
  v_max3_f32 v10, v10, v96, v97
  v_max3_f32 v11, v11, v98, v99
  v_max3_f32 v10, v10, v100, v101
  v_max3_f32 v11, v11, v102, v103
  v_max3_f32 v10, v10, v104, v105
  v_max3_f32 v11, v11, v106, v107
  v_max3_f32 v10, v10, v108, v109
  v_max3_f32 v11, v11, v110, v111
  ds_read_b64 v[40:41], v237 offset:6144
  ds_read_b64 v[42:43], v237 offset:6656
  ds_read_b64 v[44:45], v237 offset:7168
  ds_read_b64 v[46:47], v237 offset:7680
  s_waitcnt lgkmcnt(2)
  v_mfma_f32_32x32x16_bf16 v[112:127], v[40:43], v[88:91], 0
  s_waitcnt lgkmcnt(0)
  v_mfma_f32_32x32x16_bf16 v[112:127], v[44:47], v[92:95], v[112:127]
  s_nop 11
  v_max3_f32 v10, v10, v112, v113
  v_max3_f32 v11, v11, v114, v115
  v_max3_f32 v10, v10, v116, v117
  v_max3_f32 v11, v11, v118, v119
  v_max3_f32 v10, v10, v120, v121
  v_max3_f32 v11, v11, v122, v123
  v_max3_f32 v10, v10, v124, v125
  v_max3_f32 v11, v11, v126, v127
  ds_read_b64 v[48:49], v237 offset:8192
  ds_read_b64 v[50:51], v237 offset:8704
  ds_read_b64 v[52:53], v237 offset:9216
  ds_read_b64 v[54:55], v237 offset:9728
  s_waitcnt lgkmcnt(2)
  v_mfma_f32_32x32x16_bf16 v[96:111], v[48:51], v[88:91], 0
  s_waitcnt lgkmcnt(0)
  v_mfma_f32_32x32x16_bf16 v[96:111], v[52:55], v[92:95], v[96:111]
  s_nop 11
  v_max3_f32 v10, v10, v96, v97
  v_max3_f32 v11, v11, v98, v99
  v_max3_f32 v10, v10, v100, v101
  v_max3_f32 v11, v11, v102, v103
  v_max3_f32 v10, v10, v104, v105
  v_max3_f32 v11, v11, v106, v107
  v_max3_f32 v10, v10, v108, v109
  v_max3_f32 v11, v11, v110, v111
  ds_read_b64 v[56:57], v237 offset:10240
  ds_read_b64 v[58:59], v237 offset:10752
  ds_read_b64 v[60:61], v237 offset:11264
  ds_read_b64 v[62:63], v237 offset:11776
  s_waitcnt lgkmcnt(2)
  v_mfma_f32_32x32x16_bf16 v[112:127], v[56:59], v[88:91], 0
  s_waitcnt lgkmcnt(0)
  v_mfma_f32_32x32x16_bf16 v[112:127], v[60:63], v[92:95], v[112:127]
  s_nop 11
  v_max3_f32 v10, v10, v112, v113
  v_max3_f32 v11, v11, v114, v115
  v_max3_f32 v10, v10, v116, v117
  v_max3_f32 v11, v11, v118, v119
  v_max3_f32 v10, v10, v120, v121
  v_max3_f32 v11, v11, v122, v123
  v_max3_f32 v10, v10, v124, v125
  v_max3_f32 v11, v11, v126, v127
  ds_read_b64 v[64:65], v237 offset:12288
  ds_read_b64 v[66:67], v237 offset:12800
  ds_read_b64 v[68:69], v237 offset:13312
  ds_read_b64 v[70:71], v237 offset:13824
  s_waitcnt lgkmcnt(2)
  v_mfma_f32_32x32x16_bf16 v[96:111], v[64:67], v[88:91], 0
  s_waitcnt lgkmcnt(0)
  v_mfma_f32_32x32x16_bf16 v[96:111], v[68:71], v[92:95], v[96:111]
  s_nop 11
  v_max3_f32 v10, v10, v96, v97
  v_max3_f32 v11, v11, v98, v99
  v_max3_f32 v10, v10, v100, v101
  v_max3_f32 v11, v11, v102, v103
  v_max3_f32 v10, v10, v104, v105
  v_max3_f32 v11, v11, v106, v107
  v_max3_f32 v10, v10, v108, v109
  v_max3_f32 v11, v11, v110, v111
  ds_read_b64 v[72:73], v237 offset:14336
  ds_read_b64 v[74:75], v237 offset:14848
  ds_read_b64 v[76:77], v237 offset:15360
  ds_read_b64 v[78:79], v237 offset:15872
  s_waitcnt lgkmcnt(2)
  v_mfma_f32_32x32x16_bf16 v[112:127], v[72:75], v[88:91], 0
  s_waitcnt lgkmcnt(0)
  v_mfma_f32_32x32x16_bf16 v[112:127], v[76:79], v[92:95], v[112:127]
  s_nop 11
  v_max3_f32 v10, v10, v112, v113
  v_max3_f32 v11, v11, v114, v115
  v_max3_f32 v10, v10, v116, v117
  v_max3_f32 v11, v11, v118, v119
  v_max3_f32 v10, v10, v120, v121
  v_max3_f32 v11, v11, v122, v123
  v_max3_f32 v10, v10, v124, v125
  v_max3_f32 v11, v11, v126, v127
  ds_read_b64 v[80:81], v237 offset:16384
  ds_read_b64 v[82:83], v237 offset:16896
  ds_read_b64 v[84:85], v237 offset:17408
  ds_read_b64 v[86:87], v237 offset:17920
  s_waitcnt lgkmcnt(2)
  v_mfma_f32_32x32x16_bf16 v[96:111], v[80:83], v[88:91], v[200:215]
  s_waitcnt lgkmcnt(0)
  v_mfma_f32_32x32x16_bf16 v[96:111], v[84:87], v[92:95], v[96:111]
  s_nop 11
  v_max3_f32 v10, v10, v96, v97
  v_max3_f32 v11, v11, v98, v99
  v_max3_f32 v10, v10, v100, v101
  v_max3_f32 v11, v11, v102, v103
  v_max3_f32 v10, v10, v104, v105
  v_max3_f32 v11, v11, v106, v107
  v_max3_f32 v10, v10, v108, v109
  v_max3_f32 v11, v11, v110, v111
  v_max_f32 v10, v10, v11
  v_mov_b32 v11, v10
  s_mov_b32 s16, 0xffff0000
  s_mov_b32 s17, 0x07060302
  v_permlane32_swap_b32 v10, v11
  v_min_f32 v10, -v10, -v11
  v_and_b32 v11, s16, v10
  v_sub_f32 v11, v10, v11
  v_and_b32 v14, s16, v11
  v_sub_f32 v14, v11, v14
  s_mov_b32 exec_lo, 0
  v_perm_b32 v94, v11, v10, s17
  v_perm_b32 v95, v95, v14, s17
  s_mov_b32 exec_lo, -1
  v_sub_f32 v96, 0xf149f2ca, v200
  v_sub_f32 v97, 0xf149f2ca, v201
  v_sub_f32 v98, 0xf149f2ca, v202
  v_sub_f32 v99, 0xf149f2ca, v203
  v_sub_f32 v100, 0xf149f2ca, v204
  v_sub_f32 v101, 0xf149f2ca, v205
  v_sub_f32 v102, 0xf149f2ca, v206
  v_sub_f32 v103, 0xf149f2ca, v207
  v_sub_f32 v104, 0xf149f2ca, v208
  v_sub_f32 v105, 0xf149f2ca, v209
  v_sub_f32 v106, 0xf149f2ca, v210
  v_sub_f32 v107, 0xf149f2ca, v211
  v_sub_f32 v108, 0xf149f2ca, v212
  v_sub_f32 v109, 0xf149f2ca, v213
  v_sub_f32 v110, 0xf149f2ca, v214
  v_sub_f32 v111, 0xf149f2ca, v215
  s_nop 1
  v_mfma_f32_32x32x16_bf16 v[96:111], v[16:19], v[88:91], v[96:111]
  v_mfma_f32_32x32x16_bf16 v[96:111], v[20:23], v[92:95], v[96:111]
  ds_read_b64_tr_b16 v[144:145], v238 offset:0
  ds_read_b64_tr_b16 v[146:147], v239 offset:0
  ds_read_b64_tr_b16 v[148:149], v240 offset:0
  ds_read_b64_tr_b16 v[150:151], v241 offset:0
  s_nop 7
  v_exp_f32 v96, v96
  v_exp_f32 v97, v97
  v_exp_f32 v98, v98
  v_exp_f32 v99, v99
  v_exp_f32 v100, v100
  v_exp_f32 v101, v101
  v_exp_f32 v102, v102
  v_exp_f32 v103, v103
  v_exp_f32 v104, v104
  v_exp_f32 v105, v105
  v_exp_f32 v106, v106
  v_exp_f32 v107, v107
  v_exp_f32 v108, v108
  v_exp_f32 v109, v109
  v_exp_f32 v110, v110
  v_exp_f32 v111, v111
  v_cvt_pk_bf16_f32 v16, v96, v97
  v_cvt_pk_bf16_f32 v17, v98, v99
  v_cvt_pk_bf16_f32 v18, v100, v101
  v_cvt_pk_bf16_f32 v19, v102, v103
  v_cvt_pk_bf16_f32 v20, v104, v105
  v_cvt_pk_bf16_f32 v21, v106, v107
  v_cvt_pk_bf16_f32 v22, v108, v109
  v_cvt_pk_bf16_f32 v23, v110, v111
  s_waitcnt lgkmcnt(2)
  v_mfma_f32_32x32x16_bf16 v[128:143], v[144:147], v[16:19], 0
  s_waitcnt lgkmcnt(0)
  v_mfma_f32_32x32x16_bf16 v[128:143], v[148:151], v[20:23], v[128:143]
  v_mfma_f32_32x32x16_bf16 v[112:127], v[24:27], v[88:91], 0
  v_mfma_f32_32x32x16_bf16 v[112:127], v[28:31], v[92:95], v[112:127]
  ds_read_b64_tr_b16 v[152:153], v238 offset:2048
  ds_read_b64_tr_b16 v[154:155], v239 offset:2048
  ds_read_b64_tr_b16 v[156:157], v240 offset:2048
  ds_read_b64_tr_b16 v[158:159], v241 offset:2048
  s_nop 7
  v_exp_f32 v112, v112
  v_exp_f32 v113, v113
  v_exp_f32 v114, v114
  v_exp_f32 v115, v115
  v_exp_f32 v116, v116
  v_exp_f32 v117, v117
  v_exp_f32 v118, v118
  v_exp_f32 v119, v119
  v_exp_f32 v120, v120
  v_exp_f32 v121, v121
  v_exp_f32 v122, v122
  v_exp_f32 v123, v123
  v_exp_f32 v124, v124
  v_exp_f32 v125, v125
  v_exp_f32 v126, v126
  v_exp_f32 v127, v127
  v_cvt_pk_bf16_f32 v24, v112, v113
  v_cvt_pk_bf16_f32 v25, v114, v115
  v_cvt_pk_bf16_f32 v26, v116, v117
  v_cvt_pk_bf16_f32 v27, v118, v119
  v_cvt_pk_bf16_f32 v28, v120, v121
  v_cvt_pk_bf16_f32 v29, v122, v123
  v_cvt_pk_bf16_f32 v30, v124, v125
  v_cvt_pk_bf16_f32 v31, v126, v127
  s_waitcnt lgkmcnt(2)
  v_mfma_f32_32x32x16_bf16 v[128:143], v[152:155], v[24:27], v[128:143]
  s_waitcnt lgkmcnt(0)
  v_mfma_f32_32x32x16_bf16 v[128:143], v[156:159], v[28:31], v[128:143]
  v_mfma_f32_32x32x16_bf16 v[96:111], v[32:35], v[88:91], 0
  v_mfma_f32_32x32x16_bf16 v[96:111], v[36:39], v[92:95], v[96:111]
  ds_read_b64_tr_b16 v[184:185], v238 offset:4096
  ds_read_b64_tr_b16 v[186:187], v239 offset:4096
  ds_read_b64_tr_b16 v[188:189], v240 offset:4096
  ds_read_b64_tr_b16 v[190:191], v241 offset:4096
  s_nop 7
  v_exp_f32 v96, v96
  v_exp_f32 v97, v97
  v_exp_f32 v98, v98
  v_exp_f32 v99, v99
  v_exp_f32 v100, v100
  v_exp_f32 v101, v101
  v_exp_f32 v102, v102
  v_exp_f32 v103, v103
  v_exp_f32 v104, v104
  v_exp_f32 v105, v105
  v_exp_f32 v106, v106
  v_exp_f32 v107, v107
  v_exp_f32 v108, v108
  v_exp_f32 v109, v109
  v_exp_f32 v110, v110
  v_exp_f32 v111, v111
  v_cvt_pk_bf16_f32 v32, v96, v97
  v_cvt_pk_bf16_f32 v33, v98, v99
  v_cvt_pk_bf16_f32 v34, v100, v101
  v_cvt_pk_bf16_f32 v35, v102, v103
  v_cvt_pk_bf16_f32 v36, v104, v105
  v_cvt_pk_bf16_f32 v37, v106, v107
  v_cvt_pk_bf16_f32 v38, v108, v109
  v_cvt_pk_bf16_f32 v39, v110, v111
  s_waitcnt lgkmcnt(2)
  v_mfma_f32_32x32x16_bf16 v[128:143], v[184:187], v[32:35], v[128:143]
  s_waitcnt lgkmcnt(0)
  v_mfma_f32_32x32x16_bf16 v[128:143], v[188:191], v[36:39], v[128:143]
  v_mfma_f32_32x32x16_bf16 v[112:127], v[40:43], v[88:91], 0
  v_mfma_f32_32x32x16_bf16 v[112:127], v[44:47], v[92:95], v[112:127]
  ds_read_b64_tr_b16 v[192:193], v238 offset:6144
  ds_read_b64_tr_b16 v[194:195], v239 offset:6144
  ds_read_b64_tr_b16 v[196:197], v240 offset:6144
  ds_read_b64_tr_b16 v[198:199], v241 offset:6144
  s_nop 7
  v_exp_f32 v112, v112
  v_exp_f32 v113, v113
  v_exp_f32 v114, v114
  v_exp_f32 v115, v115
  v_exp_f32 v116, v116
  v_exp_f32 v117, v117
  v_exp_f32 v118, v118
  v_exp_f32 v119, v119
  v_exp_f32 v120, v120
  v_exp_f32 v121, v121
  v_exp_f32 v122, v122
  v_exp_f32 v123, v123
  v_exp_f32 v124, v124
  v_exp_f32 v125, v125
  v_exp_f32 v126, v126
  v_exp_f32 v127, v127
  v_cvt_pk_bf16_f32 v40, v112, v113
  v_cvt_pk_bf16_f32 v41, v114, v115
  v_cvt_pk_bf16_f32 v42, v116, v117
  v_cvt_pk_bf16_f32 v43, v118, v119
  v_cvt_pk_bf16_f32 v44, v120, v121
  v_cvt_pk_bf16_f32 v45, v122, v123
  v_cvt_pk_bf16_f32 v46, v124, v125
  v_cvt_pk_bf16_f32 v47, v126, v127
  s_waitcnt lgkmcnt(2)
  v_mfma_f32_32x32x16_bf16 v[128:143], v[192:195], v[40:43], v[128:143]
  s_waitcnt lgkmcnt(0)
  v_mfma_f32_32x32x16_bf16 v[128:143], v[196:199], v[44:47], v[128:143]
  v_mfma_f32_32x32x16_bf16 v[96:111], v[48:51], v[88:91], 0
  v_mfma_f32_32x32x16_bf16 v[96:111], v[52:55], v[92:95], v[96:111]
  ds_read_b64_tr_b16 v[144:145], v238 offset:8192
  ds_read_b64_tr_b16 v[146:147], v239 offset:8192
  ds_read_b64_tr_b16 v[148:149], v240 offset:8192
  ds_read_b64_tr_b16 v[150:151], v241 offset:8192
  s_nop 7
  v_exp_f32 v96, v96
  v_exp_f32 v97, v97
  v_exp_f32 v98, v98
  v_exp_f32 v99, v99
  v_exp_f32 v100, v100
  v_exp_f32 v101, v101
  v_exp_f32 v102, v102
  v_exp_f32 v103, v103
  v_exp_f32 v104, v104
  v_exp_f32 v105, v105
  v_exp_f32 v106, v106
  v_exp_f32 v107, v107
  v_exp_f32 v108, v108
  v_exp_f32 v109, v109
  v_exp_f32 v110, v110
  v_exp_f32 v111, v111
  v_cvt_pk_bf16_f32 v48, v96, v97
  v_cvt_pk_bf16_f32 v49, v98, v99
  v_cvt_pk_bf16_f32 v50, v100, v101
  v_cvt_pk_bf16_f32 v51, v102, v103
  v_cvt_pk_bf16_f32 v52, v104, v105
  v_cvt_pk_bf16_f32 v53, v106, v107
  v_cvt_pk_bf16_f32 v54, v108, v109
  v_cvt_pk_bf16_f32 v55, v110, v111
  s_waitcnt lgkmcnt(2)
  v_mfma_f32_32x32x16_bf16 v[128:143], v[144:147], v[48:51], v[128:143]
  s_waitcnt lgkmcnt(0)
  v_mfma_f32_32x32x16_bf16 v[128:143], v[148:151], v[52:55], v[128:143]
  v_mfma_f32_32x32x16_bf16 v[112:127], v[56:59], v[88:91], 0
  v_mfma_f32_32x32x16_bf16 v[112:127], v[60:63], v[92:95], v[112:127]
  ds_read_b64_tr_b16 v[152:153], v238 offset:10240
  ds_read_b64_tr_b16 v[154:155], v239 offset:10240
  ds_read_b64_tr_b16 v[156:157], v240 offset:10240
  ds_read_b64_tr_b16 v[158:159], v241 offset:10240
  s_nop 7
  v_exp_f32 v112, v112
  v_exp_f32 v113, v113
  v_exp_f32 v114, v114
  v_exp_f32 v115, v115
  v_exp_f32 v116, v116
  v_exp_f32 v117, v117
  v_exp_f32 v118, v118
  v_exp_f32 v119, v119
  v_exp_f32 v120, v120
  v_exp_f32 v121, v121
  v_exp_f32 v122, v122
  v_exp_f32 v123, v123
  v_exp_f32 v124, v124
  v_exp_f32 v125, v125
  v_exp_f32 v126, v126
  v_exp_f32 v127, v127
  v_cvt_pk_bf16_f32 v56, v112, v113
  v_cvt_pk_bf16_f32 v57, v114, v115
  v_cvt_pk_bf16_f32 v58, v116, v117
  v_cvt_pk_bf16_f32 v59, v118, v119
  v_cvt_pk_bf16_f32 v60, v120, v121
  v_cvt_pk_bf16_f32 v61, v122, v123
  v_cvt_pk_bf16_f32 v62, v124, v125
  v_cvt_pk_bf16_f32 v63, v126, v127
  s_waitcnt lgkmcnt(2)
  v_mfma_f32_32x32x16_bf16 v[128:143], v[152:155], v[56:59], v[128:143]
  s_waitcnt lgkmcnt(0)
  v_mfma_f32_32x32x16_bf16 v[128:143], v[156:159], v[60:63], v[128:143]
  v_mfma_f32_32x32x16_bf16 v[96:111], v[64:67], v[88:91], 0
  v_mfma_f32_32x32x16_bf16 v[96:111], v[68:71], v[92:95], v[96:111]
  ds_read_b64_tr_b16 v[184:185], v238 offset:12288
  ds_read_b64_tr_b16 v[186:187], v239 offset:12288
  ds_read_b64_tr_b16 v[188:189], v240 offset:12288
  ds_read_b64_tr_b16 v[190:191], v241 offset:12288
  s_nop 7
  v_exp_f32 v96, v96
  v_exp_f32 v97, v97
  v_exp_f32 v98, v98
  v_exp_f32 v99, v99
  v_exp_f32 v100, v100
  v_exp_f32 v101, v101
  v_exp_f32 v102, v102
  v_exp_f32 v103, v103
  v_exp_f32 v104, v104
  v_exp_f32 v105, v105
  v_exp_f32 v106, v106
  v_exp_f32 v107, v107
  v_exp_f32 v108, v108
  v_exp_f32 v109, v109
  v_exp_f32 v110, v110
  v_exp_f32 v111, v111
  v_cvt_pk_bf16_f32 v64, v96, v97
  v_cvt_pk_bf16_f32 v65, v98, v99
  v_cvt_pk_bf16_f32 v66, v100, v101
  v_cvt_pk_bf16_f32 v67, v102, v103
  v_cvt_pk_bf16_f32 v68, v104, v105
  v_cvt_pk_bf16_f32 v69, v106, v107
  v_cvt_pk_bf16_f32 v70, v108, v109
  v_cvt_pk_bf16_f32 v71, v110, v111
  s_waitcnt lgkmcnt(2)
  v_mfma_f32_32x32x16_bf16 v[128:143], v[184:187], v[64:67], v[128:143]
  s_waitcnt lgkmcnt(0)
  v_mfma_f32_32x32x16_bf16 v[128:143], v[188:191], v[68:71], v[128:143]
  v_mfma_f32_32x32x16_bf16 v[112:127], v[72:75], v[88:91], 0
  v_mfma_f32_32x32x16_bf16 v[112:127], v[76:79], v[92:95], v[112:127]
  ds_read_b64_tr_b16 v[192:193], v238 offset:14336
  ds_read_b64_tr_b16 v[194:195], v239 offset:14336
  ds_read_b64_tr_b16 v[196:197], v240 offset:14336
  ds_read_b64_tr_b16 v[198:199], v241 offset:14336
  s_nop 7
  v_exp_f32 v112, v112
  v_exp_f32 v113, v113
  v_exp_f32 v114, v114
  v_exp_f32 v115, v115
  v_exp_f32 v116, v116
  v_exp_f32 v117, v117
  v_exp_f32 v118, v118
  v_exp_f32 v119, v119
  v_exp_f32 v120, v120
  v_exp_f32 v121, v121
  v_exp_f32 v122, v122
  v_exp_f32 v123, v123
  v_exp_f32 v124, v124
  v_exp_f32 v125, v125
  v_exp_f32 v126, v126
  v_exp_f32 v127, v127
  v_cvt_pk_bf16_f32 v72, v112, v113
  v_cvt_pk_bf16_f32 v73, v114, v115
  v_cvt_pk_bf16_f32 v74, v116, v117
  v_cvt_pk_bf16_f32 v75, v118, v119
  v_cvt_pk_bf16_f32 v76, v120, v121
  v_cvt_pk_bf16_f32 v77, v122, v123
  v_cvt_pk_bf16_f32 v78, v124, v125
  v_cvt_pk_bf16_f32 v79, v126, v127
  s_waitcnt lgkmcnt(2)
  v_mfma_f32_32x32x16_bf16 v[128:143], v[192:195], v[72:75], v[128:143]
  s_waitcnt lgkmcnt(0)
  v_mfma_f32_32x32x16_bf16 v[128:143], v[196:199], v[76:79], v[128:143]
  v_mfma_f32_32x32x16_bf16 v[96:111], v[80:83], v[88:91], v[200:215]
  v_mfma_f32_32x32x16_bf16 v[96:111], v[84:87], v[92:95], v[96:111]
  ds_read_b64_tr_b16 v[144:145], v238 offset:16384
  ds_read_b64_tr_b16 v[146:147], v239 offset:16384
  ds_read_b64_tr_b16 v[148:149], v240 offset:16384
  ds_read_b64_tr_b16 v[150:151], v241 offset:16384
  s_nop 7
  v_exp_f32 v96, v96
  v_exp_f32 v97, v97
  v_exp_f32 v98, v98
  v_exp_f32 v99, v99
  v_exp_f32 v100, v100
  v_exp_f32 v101, v101
  v_exp_f32 v102, v102
  v_exp_f32 v103, v103
  v_exp_f32 v104, v104
  v_exp_f32 v105, v105
  v_exp_f32 v106, v106
  v_exp_f32 v107, v107
  v_exp_f32 v108, v108
  v_exp_f32 v109, v109
  v_exp_f32 v110, v110
  v_exp_f32 v111, v111
  v_cvt_pk_bf16_f32 v80, v96, v97
  v_cvt_pk_bf16_f32 v81, v98, v99
  v_cvt_pk_bf16_f32 v82, v100, v101
  v_cvt_pk_bf16_f32 v83, v102, v103
  v_cvt_pk_bf16_f32 v84, v104, v105
  v_cvt_pk_bf16_f32 v85, v106, v107
  v_cvt_pk_bf16_f32 v86, v108, v109
  v_cvt_pk_bf16_f32 v87, v110, v111
  s_waitcnt lgkmcnt(2)
  v_mfma_f32_32x32x16_bf16 v[128:143], v[144:147], v[80:83], v[128:143]
  s_waitcnt lgkmcnt(0)
  v_mfma_f32_32x32x16_bf16 v[128:143], v[148:151], v[84:87], v[128:143]
  s_nop 11
  v_mov_b32 v10, v140
  v_mov_b32 v11, v140
  s_nop 1
  v_permlane32_swap_b32 v10, v11
  s_branch L_sf_fbb_66
L_ws_fb_94:
  s_mov_b32 exec_lo, 0
  v_mov_b32 v94, 0
  v_mov_b32 v95, 1.0
  s_mov_b32 exec_lo, -1
  ds_read_b64 v[16:17], v237 offset:0
  ds_read_b64 v[18:19], v237 offset:512
  ds_read_b64 v[20:21], v237 offset:1024
  ds_read_b64 v[22:23], v237 offset:1536
  v_sub_f32 v96, 0xf149f2ca, v200
  v_sub_f32 v97, 0xf149f2ca, v201
  v_sub_f32 v98, 0xf149f2ca, v202
  v_sub_f32 v99, 0xf149f2ca, v203
  v_sub_f32 v100, 0xf149f2ca, v204
  v_sub_f32 v101, 0xf149f2ca, v205
  v_sub_f32 v102, 0xf149f2ca, v206
  v_sub_f32 v103, 0xf149f2ca, v207
  v_sub_f32 v104, 0xf149f2ca, v208
  v_sub_f32 v105, 0xf149f2ca, v209
  v_sub_f32 v106, 0xf149f2ca, v210
  v_sub_f32 v107, 0xf149f2ca, v211
  v_sub_f32 v108, 0xf149f2ca, v212
  v_sub_f32 v109, 0xf149f2ca, v213
  v_sub_f32 v110, 0xf149f2ca, v214
  v_sub_f32 v111, 0xf149f2ca, v215
  s_waitcnt lgkmcnt(2)
  s_nop 0
  v_mfma_f32_32x32x16_bf16 v[96:111], v[16:19], v[88:91], v[96:111]
  s_waitcnt lgkmcnt(0)
  v_mfma_f32_32x32x16_bf16 v[96:111], v[20:23], v[92:95], v[96:111]
  s_nop 11
  v_max_f32 v10, v96, v97
  v_max_f32 v11, v98, v99
  v_max3_f32 v10, v10, v100, v101
  v_max3_f32 v11, v11, v102, v103
  v_max3_f32 v10, v10, v104, v105
  v_max3_f32 v11, v11, v106, v107
  v_max3_f32 v10, v10, v108, v109
  v_max3_f32 v11, v11, v110, v111
  ds_read_b64 v[24:25], v237 offset:2048
  ds_read_b64 v[26:27], v237 offset:2560
  ds_read_b64 v[28:29], v237 offset:3072
  ds_read_b64 v[30:31], v237 offset:3584
  s_waitcnt lgkmcnt(2)
  v_mfma_f32_32x32x16_bf16 v[112:127], v[24:27], v[88:91], 0
  s_waitcnt lgkmcnt(0)
  v_mfma_f32_32x32x16_bf16 v[112:127], v[28:31], v[92:95], v[112:127]
  s_nop 11
  v_max3_f32 v10, v10, v112, v113
  v_max3_f32 v11, v11, v114, v115
  v_max3_f32 v10, v10, v116, v117
  v_max3_f32 v11, v11, v118, v119
  v_max3_f32 v10, v10, v120, v121
  v_max3_f32 v11, v11, v122, v123
  v_max3_f32 v10, v10, v124, v125
  v_max3_f32 v11, v11, v126, v127
  ds_read_b64 v[32:33], v237 offset:4096
  ds_read_b64 v[34:35], v237 offset:4608
  ds_read_b64 v[36:37], v237 offset:5120
  ds_read_b64 v[38:39], v237 offset:5632
  s_waitcnt lgkmcnt(2)
  v_mfma_f32_32x32x16_bf16 v[96:111], v[32:35], v[88:91], 0
  s_waitcnt lgkmcnt(0)
  v_mfma_f32_32x32x16_bf16 v[96:111], v[36:39], v[92:95], v[96:111]
  s_nop 11
  v_max3_f32 v10, v10, v96, v97
  v_max3_f32 v11, v11, v98, v99
  v_max3_f32 v10, v10, v100, v101
  v_max3_f32 v11, v11, v102, v103
  v_max3_f32 v10, v10, v104, v105
  v_max3_f32 v11, v11, v106, v107
  v_max3_f32 v10, v10, v108, v109
  v_max3_f32 v11, v11, v110, v111
  ds_read_b64 v[40:41], v237 offset:6144
  ds_read_b64 v[42:43], v237 offset:6656
  ds_read_b64 v[44:45], v237 offset:7168
  ds_read_b64 v[46:47], v237 offset:7680
  s_waitcnt lgkmcnt(2)
  v_mfma_f32_32x32x16_bf16 v[112:127], v[40:43], v[88:91], 0
  s_waitcnt lgkmcnt(0)
  v_mfma_f32_32x32x16_bf16 v[112:127], v[44:47], v[92:95], v[112:127]
  s_nop 11
  v_max3_f32 v10, v10, v112, v113
  v_max3_f32 v11, v11, v114, v115
  v_max3_f32 v10, v10, v116, v117
  v_max3_f32 v11, v11, v118, v119
  v_max3_f32 v10, v10, v120, v121
  v_max3_f32 v11, v11, v122, v123
  v_max3_f32 v10, v10, v124, v125
  v_max3_f32 v11, v11, v126, v127
  ds_read_b64 v[48:49], v237 offset:8192
  ds_read_b64 v[50:51], v237 offset:8704
  ds_read_b64 v[52:53], v237 offset:9216
  ds_read_b64 v[54:55], v237 offset:9728
  s_waitcnt lgkmcnt(2)
  v_mfma_f32_32x32x16_bf16 v[96:111], v[48:51], v[88:91], 0
  s_waitcnt lgkmcnt(0)
  v_mfma_f32_32x32x16_bf16 v[96:111], v[52:55], v[92:95], v[96:111]
  s_nop 11
  v_max3_f32 v10, v10, v96, v97
  v_max3_f32 v11, v11, v98, v99
  v_max3_f32 v10, v10, v100, v101
  v_max3_f32 v11, v11, v102, v103
  v_max3_f32 v10, v10, v104, v105
  v_max3_f32 v11, v11, v106, v107
  v_max3_f32 v10, v10, v108, v109
  v_max3_f32 v11, v11, v110, v111
  ds_read_b64 v[56:57], v237 offset:10240
  ds_read_b64 v[58:59], v237 offset:10752
  ds_read_b64 v[60:61], v237 offset:11264
  ds_read_b64 v[62:63], v237 offset:11776
  s_waitcnt lgkmcnt(2)
  v_mfma_f32_32x32x16_bf16 v[112:127], v[56:59], v[88:91], 0
  s_waitcnt lgkmcnt(0)
  v_mfma_f32_32x32x16_bf16 v[112:127], v[60:63], v[92:95], v[112:127]
  s_nop 11
  v_max3_f32 v10, v10, v112, v113
  v_max3_f32 v11, v11, v114, v115
  v_max3_f32 v10, v10, v116, v117
  v_max3_f32 v11, v11, v118, v119
  v_max3_f32 v10, v10, v120, v121
  v_max3_f32 v11, v11, v122, v123
  v_max3_f32 v10, v10, v124, v125
  v_max3_f32 v11, v11, v126, v127
  ds_read_b64 v[64:65], v237 offset:12288
  ds_read_b64 v[66:67], v237 offset:12800
  ds_read_b64 v[68:69], v237 offset:13312
  ds_read_b64 v[70:71], v237 offset:13824
  s_waitcnt lgkmcnt(2)
  v_mfma_f32_32x32x16_bf16 v[96:111], v[64:67], v[88:91], 0
  s_waitcnt lgkmcnt(0)
  v_mfma_f32_32x32x16_bf16 v[96:111], v[68:71], v[92:95], v[96:111]
  s_nop 11
  v_max3_f32 v10, v10, v96, v97
  v_max3_f32 v11, v11, v98, v99
  v_max3_f32 v10, v10, v100, v101
  v_max3_f32 v11, v11, v102, v103
  v_max3_f32 v10, v10, v104, v105
  v_max3_f32 v11, v11, v106, v107
  v_max3_f32 v10, v10, v108, v109
  v_max3_f32 v11, v11, v110, v111
  ds_read_b64 v[72:73], v237 offset:14336
  ds_read_b64 v[74:75], v237 offset:14848
  ds_read_b64 v[76:77], v237 offset:15360
  ds_read_b64 v[78:79], v237 offset:15872
  s_waitcnt lgkmcnt(2)
  v_mfma_f32_32x32x16_bf16 v[112:127], v[72:75], v[88:91], 0
  s_waitcnt lgkmcnt(0)
  v_mfma_f32_32x32x16_bf16 v[112:127], v[76:79], v[92:95], v[112:127]
  s_nop 11
  v_max3_f32 v10, v10, v112, v113
  v_max3_f32 v11, v11, v114, v115
  v_max3_f32 v10, v10, v116, v117
  v_max3_f32 v11, v11, v118, v119
  v_max3_f32 v10, v10, v120, v121
  v_max3_f32 v11, v11, v122, v123
  v_max3_f32 v10, v10, v124, v125
  v_max3_f32 v11, v11, v126, v127
  ds_read_b64 v[80:81], v237 offset:16384
  ds_read_b64 v[82:83], v237 offset:16896
  ds_read_b64 v[84:85], v237 offset:17408
  ds_read_b64 v[86:87], v237 offset:17920
  s_waitcnt lgkmcnt(2)
  v_mfma_f32_32x32x16_bf16 v[96:111], v[80:83], v[88:91], v[200:215]
  s_waitcnt lgkmcnt(0)
  v_mfma_f32_32x32x16_bf16 v[96:111], v[84:87], v[92:95], v[96:111]
  s_nop 11
  v_max3_f32 v10, v10, v96, v97
  v_max3_f32 v11, v11, v98, v99
  v_max3_f32 v10, v10, v100, v101
  v_max3_f32 v11, v11, v102, v103
  v_max3_f32 v10, v10, v104, v105
  v_max3_f32 v11, v11, v106, v107
  v_max3_f32 v10, v10, v108, v109
  v_max3_f32 v11, v11, v110, v111
  v_max_f32 v10, v10, v11
  v_mov_b32 v11, v10
  s_mov_b32 s16, 0xffff0000
  s_mov_b32 s17, 0x07060302
  v_permlane32_swap_b32 v10, v11
  v_min_f32 v10, -v10, -v11
  v_and_b32 v11, s16, v10
  v_sub_f32 v11, v10, v11
  v_and_b32 v14, s16, v11
  v_sub_f32 v14, v11, v14
  s_mov_b32 exec_lo, 0
  v_perm_b32 v94, v11, v10, s17
  v_perm_b32 v95, v95, v14, s17
  s_mov_b32 exec_lo, -1
  v_sub_f32 v96, 0xf149f2ca, v200
  v_sub_f32 v97, 0xf149f2ca, v201
  v_sub_f32 v98, 0xf149f2ca, v202
  v_sub_f32 v99, 0xf149f2ca, v203
  v_sub_f32 v100, 0xf149f2ca, v204
  v_sub_f32 v101, 0xf149f2ca, v205
  v_sub_f32 v102, 0xf149f2ca, v206
  v_sub_f32 v103, 0xf149f2ca, v207
  v_sub_f32 v104, 0xf149f2ca, v208
  v_sub_f32 v105, 0xf149f2ca, v209
  v_sub_f32 v106, 0xf149f2ca, v210
  v_sub_f32 v107, 0xf149f2ca, v211
  v_sub_f32 v108, 0xf149f2ca, v212
  v_sub_f32 v109, 0xf149f2ca, v213
  v_sub_f32 v110, 0xf149f2ca, v214
  v_sub_f32 v111, 0xf149f2ca, v215
  s_nop 1
  v_mfma_f32_32x32x16_bf16 v[96:111], v[16:19], v[88:91], v[96:111]
  v_mfma_f32_32x32x16_bf16 v[96:111], v[20:23], v[92:95], v[96:111]
  ds_read_b64_tr_b16 v[144:145], v238 offset:0
  ds_read_b64_tr_b16 v[146:147], v239 offset:0
  ds_read_b64_tr_b16 v[148:149], v240 offset:0
  ds_read_b64_tr_b16 v[150:151], v241 offset:0
  s_nop 7
  v_exp_f32 v96, v96
  v_exp_f32 v97, v97
  v_exp_f32 v98, v98
  v_exp_f32 v99, v99
  v_exp_f32 v100, v100
  v_exp_f32 v101, v101
  v_exp_f32 v102, v102
  v_exp_f32 v103, v103
  v_exp_f32 v104, v104
  v_exp_f32 v105, v105
  v_exp_f32 v106, v106
  v_exp_f32 v107, v107
  v_exp_f32 v108, v108
  v_exp_f32 v109, v109
  v_exp_f32 v110, v110
  v_exp_f32 v111, v111
  v_cvt_pk_bf16_f32 v16, v96, v97
  v_cvt_pk_bf16_f32 v17, v98, v99
  v_cvt_pk_bf16_f32 v18, v100, v101
  v_cvt_pk_bf16_f32 v19, v102, v103
  v_cvt_pk_bf16_f32 v20, v104, v105
  v_cvt_pk_bf16_f32 v21, v106, v107
  v_cvt_pk_bf16_f32 v22, v108, v109
  v_cvt_pk_bf16_f32 v23, v110, v111
  s_waitcnt lgkmcnt(2)
  v_mfma_f32_32x32x16_bf16 v[128:143], v[144:147], v[16:19], 0
  s_waitcnt lgkmcnt(0)
  v_mfma_f32_32x32x16_bf16 v[128:143], v[148:151], v[20:23], v[128:143]
  v_mfma_f32_32x32x16_bf16 v[112:127], v[24:27], v[88:91], 0
  v_mfma_f32_32x32x16_bf16 v[112:127], v[28:31], v[92:95], v[112:127]
  ds_read_b64_tr_b16 v[152:153], v238 offset:2048
  ds_read_b64_tr_b16 v[154:155], v239 offset:2048
  ds_read_b64_tr_b16 v[156:157], v240 offset:2048
  ds_read_b64_tr_b16 v[158:159], v241 offset:2048
  s_nop 7
  v_exp_f32 v112, v112
  v_exp_f32 v113, v113
  v_exp_f32 v114, v114
  v_exp_f32 v115, v115
  v_exp_f32 v116, v116
  v_exp_f32 v117, v117
  v_exp_f32 v118, v118
  v_exp_f32 v119, v119
  v_exp_f32 v120, v120
  v_exp_f32 v121, v121
  v_exp_f32 v122, v122
  v_exp_f32 v123, v123
  v_exp_f32 v124, v124
  v_exp_f32 v125, v125
  v_exp_f32 v126, v126
  v_exp_f32 v127, v127
  v_cvt_pk_bf16_f32 v24, v112, v113
  v_cvt_pk_bf16_f32 v25, v114, v115
  v_cvt_pk_bf16_f32 v26, v116, v117
  v_cvt_pk_bf16_f32 v27, v118, v119
  v_cvt_pk_bf16_f32 v28, v120, v121
  v_cvt_pk_bf16_f32 v29, v122, v123
  v_cvt_pk_bf16_f32 v30, v124, v125
  v_cvt_pk_bf16_f32 v31, v126, v127
  s_waitcnt lgkmcnt(2)
  v_mfma_f32_32x32x16_bf16 v[128:143], v[152:155], v[24:27], v[128:143]
  s_waitcnt lgkmcnt(0)
  v_mfma_f32_32x32x16_bf16 v[128:143], v[156:159], v[28:31], v[128:143]
  v_mfma_f32_32x32x16_bf16 v[96:111], v[32:35], v[88:91], 0
  v_mfma_f32_32x32x16_bf16 v[96:111], v[36:39], v[92:95], v[96:111]
  ds_read_b64_tr_b16 v[184:185], v238 offset:4096
  ds_read_b64_tr_b16 v[186:187], v239 offset:4096
  ds_read_b64_tr_b16 v[188:189], v240 offset:4096
  ds_read_b64_tr_b16 v[190:191], v241 offset:4096
  s_nop 7
  v_exp_f32 v96, v96
  v_exp_f32 v97, v97
  v_exp_f32 v98, v98
  v_exp_f32 v99, v99
  v_exp_f32 v100, v100
  v_exp_f32 v101, v101
  v_exp_f32 v102, v102
  v_exp_f32 v103, v103
  v_exp_f32 v104, v104
  v_exp_f32 v105, v105
  v_exp_f32 v106, v106
  v_exp_f32 v107, v107
  v_exp_f32 v108, v108
  v_exp_f32 v109, v109
  v_exp_f32 v110, v110
  v_exp_f32 v111, v111
  v_cvt_pk_bf16_f32 v32, v96, v97
  v_cvt_pk_bf16_f32 v33, v98, v99
  v_cvt_pk_bf16_f32 v34, v100, v101
  v_cvt_pk_bf16_f32 v35, v102, v103
  v_cvt_pk_bf16_f32 v36, v104, v105
  v_cvt_pk_bf16_f32 v37, v106, v107
  v_cvt_pk_bf16_f32 v38, v108, v109
  v_cvt_pk_bf16_f32 v39, v110, v111
  s_waitcnt lgkmcnt(2)
  v_mfma_f32_32x32x16_bf16 v[128:143], v[184:187], v[32:35], v[128:143]
  s_waitcnt lgkmcnt(0)
  v_mfma_f32_32x32x16_bf16 v[128:143], v[188:191], v[36:39], v[128:143]
  v_mfma_f32_32x32x16_bf16 v[112:127], v[40:43], v[88:91], 0
  v_mfma_f32_32x32x16_bf16 v[112:127], v[44:47], v[92:95], v[112:127]
  ds_read_b64_tr_b16 v[192:193], v238 offset:6144
  ds_read_b64_tr_b16 v[194:195], v239 offset:6144
  ds_read_b64_tr_b16 v[196:197], v240 offset:6144
  ds_read_b64_tr_b16 v[198:199], v241 offset:6144
  s_nop 7
  v_exp_f32 v112, v112
  v_exp_f32 v113, v113
  v_exp_f32 v114, v114
  v_exp_f32 v115, v115
  v_exp_f32 v116, v116
  v_exp_f32 v117, v117
  v_exp_f32 v118, v118
  v_exp_f32 v119, v119
  v_exp_f32 v120, v120
  v_exp_f32 v121, v121
  v_exp_f32 v122, v122
  v_exp_f32 v123, v123
  v_exp_f32 v124, v124
  v_exp_f32 v125, v125
  v_exp_f32 v126, v126
  v_exp_f32 v127, v127
  v_cvt_pk_bf16_f32 v40, v112, v113
  v_cvt_pk_bf16_f32 v41, v114, v115
  v_cvt_pk_bf16_f32 v42, v116, v117
  v_cvt_pk_bf16_f32 v43, v118, v119
  v_cvt_pk_bf16_f32 v44, v120, v121
  v_cvt_pk_bf16_f32 v45, v122, v123
  v_cvt_pk_bf16_f32 v46, v124, v125
  v_cvt_pk_bf16_f32 v47, v126, v127
  s_waitcnt lgkmcnt(2)
  v_mfma_f32_32x32x16_bf16 v[128:143], v[192:195], v[40:43], v[128:143]
  s_waitcnt lgkmcnt(0)
  v_mfma_f32_32x32x16_bf16 v[128:143], v[196:199], v[44:47], v[128:143]
  v_mfma_f32_32x32x16_bf16 v[96:111], v[48:51], v[88:91], 0
  v_mfma_f32_32x32x16_bf16 v[96:111], v[52:55], v[92:95], v[96:111]
  ds_read_b64_tr_b16 v[144:145], v238 offset:8192
  ds_read_b64_tr_b16 v[146:147], v239 offset:8192
  ds_read_b64_tr_b16 v[148:149], v240 offset:8192
  ds_read_b64_tr_b16 v[150:151], v241 offset:8192
  s_nop 7
  v_exp_f32 v96, v96
  v_exp_f32 v97, v97
  v_exp_f32 v98, v98
  v_exp_f32 v99, v99
  v_exp_f32 v100, v100
  v_exp_f32 v101, v101
  v_exp_f32 v102, v102
  v_exp_f32 v103, v103
  v_exp_f32 v104, v104
  v_exp_f32 v105, v105
  v_exp_f32 v106, v106
  v_exp_f32 v107, v107
  v_exp_f32 v108, v108
  v_exp_f32 v109, v109
  v_exp_f32 v110, v110
  v_exp_f32 v111, v111
  v_cvt_pk_bf16_f32 v48, v96, v97
  v_cvt_pk_bf16_f32 v49, v98, v99
  v_cvt_pk_bf16_f32 v50, v100, v101
  v_cvt_pk_bf16_f32 v51, v102, v103
  v_cvt_pk_bf16_f32 v52, v104, v105
  v_cvt_pk_bf16_f32 v53, v106, v107
  v_cvt_pk_bf16_f32 v54, v108, v109
  v_cvt_pk_bf16_f32 v55, v110, v111
  s_waitcnt lgkmcnt(2)
  v_mfma_f32_32x32x16_bf16 v[128:143], v[144:147], v[48:51], v[128:143]
  s_waitcnt lgkmcnt(0)
  v_mfma_f32_32x32x16_bf16 v[128:143], v[148:151], v[52:55], v[128:143]
  v_mfma_f32_32x32x16_bf16 v[112:127], v[56:59], v[88:91], 0
  v_mfma_f32_32x32x16_bf16 v[112:127], v[60:63], v[92:95], v[112:127]
  ds_read_b64_tr_b16 v[152:153], v238 offset:10240
  ds_read_b64_tr_b16 v[154:155], v239 offset:10240
  ds_read_b64_tr_b16 v[156:157], v240 offset:10240
  ds_read_b64_tr_b16 v[158:159], v241 offset:10240
  s_nop 7
  v_exp_f32 v112, v112
  v_exp_f32 v113, v113
  v_exp_f32 v114, v114
  v_exp_f32 v115, v115
  v_exp_f32 v116, v116
  v_exp_f32 v117, v117
  v_exp_f32 v118, v118
  v_exp_f32 v119, v119
  v_exp_f32 v120, v120
  v_exp_f32 v121, v121
  v_exp_f32 v122, v122
  v_exp_f32 v123, v123
  v_exp_f32 v124, v124
  v_exp_f32 v125, v125
  v_exp_f32 v126, v126
  v_exp_f32 v127, v127
  v_cvt_pk_bf16_f32 v56, v112, v113
  v_cvt_pk_bf16_f32 v57, v114, v115
  v_cvt_pk_bf16_f32 v58, v116, v117
  v_cvt_pk_bf16_f32 v59, v118, v119
  v_cvt_pk_bf16_f32 v60, v120, v121
  v_cvt_pk_bf16_f32 v61, v122, v123
  v_cvt_pk_bf16_f32 v62, v124, v125
  v_cvt_pk_bf16_f32 v63, v126, v127
  s_waitcnt lgkmcnt(2)
  v_mfma_f32_32x32x16_bf16 v[128:143], v[152:155], v[56:59], v[128:143]
  s_waitcnt lgkmcnt(0)
  v_mfma_f32_32x32x16_bf16 v[128:143], v[156:159], v[60:63], v[128:143]
  v_mfma_f32_32x32x16_bf16 v[96:111], v[64:67], v[88:91], 0
  v_mfma_f32_32x32x16_bf16 v[96:111], v[68:71], v[92:95], v[96:111]
  ds_read_b64_tr_b16 v[184:185], v238 offset:12288
  ds_read_b64_tr_b16 v[186:187], v239 offset:12288
  ds_read_b64_tr_b16 v[188:189], v240 offset:12288
  ds_read_b64_tr_b16 v[190:191], v241 offset:12288
  s_nop 7
  v_exp_f32 v96, v96
  v_exp_f32 v97, v97
  v_exp_f32 v98, v98
  v_exp_f32 v99, v99
  v_exp_f32 v100, v100
  v_exp_f32 v101, v101
  v_exp_f32 v102, v102
  v_exp_f32 v103, v103
  v_exp_f32 v104, v104
  v_exp_f32 v105, v105
  v_exp_f32 v106, v106
  v_exp_f32 v107, v107
  v_exp_f32 v108, v108
  v_exp_f32 v109, v109
  v_exp_f32 v110, v110
  v_exp_f32 v111, v111
  v_cvt_pk_bf16_f32 v64, v96, v97
  v_cvt_pk_bf16_f32 v65, v98, v99
  v_cvt_pk_bf16_f32 v66, v100, v101
  v_cvt_pk_bf16_f32 v67, v102, v103
  v_cvt_pk_bf16_f32 v68, v104, v105
  v_cvt_pk_bf16_f32 v69, v106, v107
  v_cvt_pk_bf16_f32 v70, v108, v109
  v_cvt_pk_bf16_f32 v71, v110, v111
  s_waitcnt lgkmcnt(2)
  v_mfma_f32_32x32x16_bf16 v[128:143], v[184:187], v[64:67], v[128:143]
  s_waitcnt lgkmcnt(0)
  v_mfma_f32_32x32x16_bf16 v[128:143], v[188:191], v[68:71], v[128:143]
  v_mfma_f32_32x32x16_bf16 v[112:127], v[72:75], v[88:91], 0
  v_mfma_f32_32x32x16_bf16 v[112:127], v[76:79], v[92:95], v[112:127]
  ds_read_b64_tr_b16 v[192:193], v238 offset:14336
  ds_read_b64_tr_b16 v[194:195], v239 offset:14336
  ds_read_b64_tr_b16 v[196:197], v240 offset:14336
  ds_read_b64_tr_b16 v[198:199], v241 offset:14336
  s_nop 7
  v_exp_f32 v112, v112
  v_exp_f32 v113, v113
  v_exp_f32 v114, v114
  v_exp_f32 v115, v115
  v_exp_f32 v116, v116
  v_exp_f32 v117, v117
  v_exp_f32 v118, v118
  v_exp_f32 v119, v119
  v_exp_f32 v120, v120
  v_exp_f32 v121, v121
  v_exp_f32 v122, v122
  v_exp_f32 v123, v123
  v_exp_f32 v124, v124
  v_exp_f32 v125, v125
  v_exp_f32 v126, v126
  v_exp_f32 v127, v127
  v_cvt_pk_bf16_f32 v72, v112, v113
  v_cvt_pk_bf16_f32 v73, v114, v115
  v_cvt_pk_bf16_f32 v74, v116, v117
  v_cvt_pk_bf16_f32 v75, v118, v119
  v_cvt_pk_bf16_f32 v76, v120, v121
  v_cvt_pk_bf16_f32 v77, v122, v123
  v_cvt_pk_bf16_f32 v78, v124, v125
  v_cvt_pk_bf16_f32 v79, v126, v127
  s_waitcnt lgkmcnt(2)
  v_mfma_f32_32x32x16_bf16 v[128:143], v[192:195], v[72:75], v[128:143]
  s_waitcnt lgkmcnt(0)
  v_mfma_f32_32x32x16_bf16 v[128:143], v[196:199], v[76:79], v[128:143]
  v_mfma_f32_32x32x16_bf16 v[96:111], v[80:83], v[88:91], v[200:215]
  v_mfma_f32_32x32x16_bf16 v[96:111], v[84:87], v[92:95], v[96:111]
  ds_read_b64_tr_b16 v[144:145], v238 offset:16384
  ds_read_b64_tr_b16 v[146:147], v239 offset:16384
  ds_read_b64_tr_b16 v[148:149], v240 offset:16384
  ds_read_b64_tr_b16 v[150:151], v241 offset:16384
  s_nop 7
  v_exp_f32 v96, v96
  v_exp_f32 v97, v97
  v_exp_f32 v98, v98
  v_exp_f32 v99, v99
  v_exp_f32 v100, v100
  v_exp_f32 v101, v101
  v_exp_f32 v102, v102
  v_exp_f32 v103, v103
  v_exp_f32 v104, v104
  v_exp_f32 v105, v105
  v_exp_f32 v106, v106
  v_exp_f32 v107, v107
  v_exp_f32 v108, v108
  v_exp_f32 v109, v109
  v_exp_f32 v110, v110
  v_exp_f32 v111, v111
  v_cvt_pk_bf16_f32 v80, v96, v97
  v_cvt_pk_bf16_f32 v81, v98, v99
  v_cvt_pk_bf16_f32 v82, v100, v101
  v_cvt_pk_bf16_f32 v83, v102, v103
  v_cvt_pk_bf16_f32 v84, v104, v105
  v_cvt_pk_bf16_f32 v85, v106, v107
  v_cvt_pk_bf16_f32 v86, v108, v109
  v_cvt_pk_bf16_f32 v87, v110, v111
  s_waitcnt lgkmcnt(2)
  v_mfma_f32_32x32x16_bf16 v[128:143], v[144:147], v[80:83], v[128:143]
  s_waitcnt lgkmcnt(0)
  v_mfma_f32_32x32x16_bf16 v[128:143], v[148:151], v[84:87], v[128:143]
  s_nop 11
  v_mov_b32 v10, v140
  v_mov_b32 v11, v140
  s_nop 1
  v_permlane32_swap_b32 v10, v11
  s_branch L_ws_fbb_95
L_ss_fb_140:
  s_mov_b32 exec_lo, 0
  v_mov_b32 v94, 0
  v_mov_b32 v95, 1.0
  s_mov_b32 exec_lo, -1
  ds_read_b64 v[16:17], v237 offset:0
  ds_read_b64 v[18:19], v237 offset:512
  ds_read_b64 v[20:21], v237 offset:1024
  ds_read_b64 v[22:23], v237 offset:1536
  v_sub_f32 v96, 0xf149f2ca, v200
  v_sub_f32 v97, 0xf149f2ca, v201
  v_sub_f32 v98, 0xf149f2ca, v202
  v_sub_f32 v99, 0xf149f2ca, v203
  v_sub_f32 v100, 0xf149f2ca, v204
  v_sub_f32 v101, 0xf149f2ca, v205
  v_sub_f32 v102, 0xf149f2ca, v206
  v_sub_f32 v103, 0xf149f2ca, v207
  v_sub_f32 v104, 0xf149f2ca, v208
  v_sub_f32 v105, 0xf149f2ca, v209
  v_sub_f32 v106, 0xf149f2ca, v210
  v_sub_f32 v107, 0xf149f2ca, v211
  v_sub_f32 v108, 0xf149f2ca, v212
  v_sub_f32 v109, 0xf149f2ca, v213
  v_sub_f32 v110, 0xf149f2ca, v214
  v_sub_f32 v111, 0xf149f2ca, v215
  s_waitcnt lgkmcnt(2)
  s_nop 0
  v_mfma_f32_32x32x16_bf16 v[96:111], v[16:19], v[88:91], v[96:111]
  s_waitcnt lgkmcnt(0)
  v_mfma_f32_32x32x16_bf16 v[96:111], v[20:23], v[92:95], v[96:111]
  s_nop 11
  v_max_f32 v10, v96, v97
  v_max_f32 v11, v98, v99
  v_max3_f32 v10, v10, v100, v101
  v_max3_f32 v11, v11, v102, v103
  v_max3_f32 v10, v10, v104, v105
  v_max3_f32 v11, v11, v106, v107
  v_max3_f32 v10, v10, v108, v109
  v_max3_f32 v11, v11, v110, v111
  ds_read_b64 v[24:25], v237 offset:2048
  ds_read_b64 v[26:27], v237 offset:2560
  ds_read_b64 v[28:29], v237 offset:3072
  ds_read_b64 v[30:31], v237 offset:3584
  s_waitcnt lgkmcnt(2)
  v_mfma_f32_32x32x16_bf16 v[112:127], v[24:27], v[88:91], 0
  s_waitcnt lgkmcnt(0)
  v_mfma_f32_32x32x16_bf16 v[112:127], v[28:31], v[92:95], v[112:127]
  s_nop 11
  v_max3_f32 v10, v10, v112, v113
  v_max3_f32 v11, v11, v114, v115
  v_max3_f32 v10, v10, v116, v117
  v_max3_f32 v11, v11, v118, v119
  v_max3_f32 v10, v10, v120, v121
  v_max3_f32 v11, v11, v122, v123
  v_max3_f32 v10, v10, v124, v125
  v_max3_f32 v11, v11, v126, v127
  ds_read_b64 v[32:33], v237 offset:4096
  ds_read_b64 v[34:35], v237 offset:4608
  ds_read_b64 v[36:37], v237 offset:5120
  ds_read_b64 v[38:39], v237 offset:5632
  s_waitcnt lgkmcnt(2)
  v_mfma_f32_32x32x16_bf16 v[96:111], v[32:35], v[88:91], 0
  s_waitcnt lgkmcnt(0)
  v_mfma_f32_32x32x16_bf16 v[96:111], v[36:39], v[92:95], v[96:111]
  s_nop 11
  v_max3_f32 v10, v10, v96, v97
  v_max3_f32 v11, v11, v98, v99
  v_max3_f32 v10, v10, v100, v101
  v_max3_f32 v11, v11, v102, v103
  v_max3_f32 v10, v10, v104, v105
  v_max3_f32 v11, v11, v106, v107
  v_max3_f32 v10, v10, v108, v109
  v_max3_f32 v11, v11, v110, v111
  ds_read_b64 v[40:41], v237 offset:6144
  ds_read_b64 v[42:43], v237 offset:6656
  ds_read_b64 v[44:45], v237 offset:7168
  ds_read_b64 v[46:47], v237 offset:7680
  s_waitcnt lgkmcnt(2)
  v_mfma_f32_32x32x16_bf16 v[112:127], v[40:43], v[88:91], 0
  s_waitcnt lgkmcnt(0)
  v_mfma_f32_32x32x16_bf16 v[112:127], v[44:47], v[92:95], v[112:127]
  s_nop 11
  v_max3_f32 v10, v10, v112, v113
  v_max3_f32 v11, v11, v114, v115
  v_max3_f32 v10, v10, v116, v117
  v_max3_f32 v11, v11, v118, v119
  v_max3_f32 v10, v10, v120, v121
  v_max3_f32 v11, v11, v122, v123
  v_max3_f32 v10, v10, v124, v125
  v_max3_f32 v11, v11, v126, v127
  ds_read_b64 v[48:49], v237 offset:8192
  ds_read_b64 v[50:51], v237 offset:8704
  ds_read_b64 v[52:53], v237 offset:9216
  ds_read_b64 v[54:55], v237 offset:9728
  s_waitcnt lgkmcnt(2)
  v_mfma_f32_32x32x16_bf16 v[96:111], v[48:51], v[88:91], 0
  s_waitcnt lgkmcnt(0)
  v_mfma_f32_32x32x16_bf16 v[96:111], v[52:55], v[92:95], v[96:111]
  s_nop 11
  v_max3_f32 v10, v10, v96, v97
  v_max3_f32 v11, v11, v98, v99
  v_max3_f32 v10, v10, v100, v101
  v_max3_f32 v11, v11, v102, v103
  v_max3_f32 v10, v10, v104, v105
  v_max3_f32 v11, v11, v106, v107
  v_max3_f32 v10, v10, v108, v109
  v_max3_f32 v11, v11, v110, v111
  ds_read_b64 v[56:57], v237 offset:10240
  ds_read_b64 v[58:59], v237 offset:10752
  ds_read_b64 v[60:61], v237 offset:11264
  ds_read_b64 v[62:63], v237 offset:11776
  s_waitcnt lgkmcnt(2)
  v_mfma_f32_32x32x16_bf16 v[112:127], v[56:59], v[88:91], 0
  s_waitcnt lgkmcnt(0)
  v_mfma_f32_32x32x16_bf16 v[112:127], v[60:63], v[92:95], v[112:127]
  s_nop 11
  v_max3_f32 v10, v10, v112, v113
  v_max3_f32 v11, v11, v114, v115
  v_max3_f32 v10, v10, v116, v117
  v_max3_f32 v11, v11, v118, v119
  v_max3_f32 v10, v10, v120, v121
  v_max3_f32 v11, v11, v122, v123
  v_max3_f32 v10, v10, v124, v125
  v_max3_f32 v11, v11, v126, v127
  ds_read_b64 v[64:65], v237 offset:12288
  ds_read_b64 v[66:67], v237 offset:12800
  ds_read_b64 v[68:69], v237 offset:13312
  ds_read_b64 v[70:71], v237 offset:13824
  s_waitcnt lgkmcnt(2)
  v_mfma_f32_32x32x16_bf16 v[96:111], v[64:67], v[88:91], 0
  s_waitcnt lgkmcnt(0)
  v_mfma_f32_32x32x16_bf16 v[96:111], v[68:71], v[92:95], v[96:111]
  s_nop 11
  v_max3_f32 v10, v10, v96, v97
  v_max3_f32 v11, v11, v98, v99
  v_max3_f32 v10, v10, v100, v101
  v_max3_f32 v11, v11, v102, v103
  v_max3_f32 v10, v10, v104, v105
  v_max3_f32 v11, v11, v106, v107
  v_max3_f32 v10, v10, v108, v109
  v_max3_f32 v11, v11, v110, v111
  ds_read_b64 v[72:73], v237 offset:14336
  ds_read_b64 v[74:75], v237 offset:14848
  ds_read_b64 v[76:77], v237 offset:15360
  ds_read_b64 v[78:79], v237 offset:15872
  s_waitcnt lgkmcnt(2)
  v_mfma_f32_32x32x16_bf16 v[112:127], v[72:75], v[88:91], 0
  s_waitcnt lgkmcnt(0)
  v_mfma_f32_32x32x16_bf16 v[112:127], v[76:79], v[92:95], v[112:127]
  s_nop 11
  v_max3_f32 v10, v10, v112, v113
  v_max3_f32 v11, v11, v114, v115
  v_max3_f32 v10, v10, v116, v117
  v_max3_f32 v11, v11, v118, v119
  v_max3_f32 v10, v10, v120, v121
  v_max3_f32 v11, v11, v122, v123
  v_max3_f32 v10, v10, v124, v125
  v_max3_f32 v11, v11, v126, v127
  ds_read_b64 v[80:81], v237 offset:16384
  ds_read_b64 v[82:83], v237 offset:16896
  ds_read_b64 v[84:85], v237 offset:17408
  ds_read_b64 v[86:87], v237 offset:17920
  s_waitcnt lgkmcnt(2)
  v_mfma_f32_32x32x16_bf16 v[96:111], v[80:83], v[88:91], v[200:215]
  s_waitcnt lgkmcnt(0)
  v_mfma_f32_32x32x16_bf16 v[96:111], v[84:87], v[92:95], v[96:111]
  s_nop 11
  v_max3_f32 v10, v10, v96, v97
  v_max3_f32 v11, v11, v98, v99
  v_max3_f32 v10, v10, v100, v101
  v_max3_f32 v11, v11, v102, v103
  v_max3_f32 v10, v10, v104, v105
  v_max3_f32 v11, v11, v106, v107
  v_max3_f32 v10, v10, v108, v109
  v_max3_f32 v11, v11, v110, v111
  v_max_f32 v10, v10, v11
  v_mov_b32 v11, v10
  s_mov_b32 s16, 0xffff0000
  s_mov_b32 s17, 0x07060302
  v_permlane32_swap_b32 v10, v11
  v_min_f32 v10, -v10, -v11
  v_and_b32 v11, s16, v10
  v_sub_f32 v11, v10, v11
  v_and_b32 v14, s16, v11
  v_sub_f32 v14, v11, v14
  s_mov_b32 exec_lo, 0
  v_perm_b32 v94, v11, v10, s17
  v_perm_b32 v95, v95, v14, s17
  s_mov_b32 exec_lo, -1
  v_sub_f32 v96, 0xf149f2ca, v200
  v_sub_f32 v97, 0xf149f2ca, v201
  v_sub_f32 v98, 0xf149f2ca, v202
  v_sub_f32 v99, 0xf149f2ca, v203
  v_sub_f32 v100, 0xf149f2ca, v204
  v_sub_f32 v101, 0xf149f2ca, v205
  v_sub_f32 v102, 0xf149f2ca, v206
  v_sub_f32 v103, 0xf149f2ca, v207
  v_sub_f32 v104, 0xf149f2ca, v208
  v_sub_f32 v105, 0xf149f2ca, v209
  v_sub_f32 v106, 0xf149f2ca, v210
  v_sub_f32 v107, 0xf149f2ca, v211
  v_sub_f32 v108, 0xf149f2ca, v212
  v_sub_f32 v109, 0xf149f2ca, v213
  v_sub_f32 v110, 0xf149f2ca, v214
  v_sub_f32 v111, 0xf149f2ca, v215
  s_nop 1
  v_mfma_f32_32x32x16_bf16 v[96:111], v[16:19], v[88:91], v[96:111]
  v_mfma_f32_32x32x16_bf16 v[96:111], v[20:23], v[92:95], v[96:111]
  ds_read_b64_tr_b16 v[144:145], v238 offset:0
  ds_read_b64_tr_b16 v[146:147], v239 offset:0
  ds_read_b64_tr_b16 v[148:149], v240 offset:0
  ds_read_b64_tr_b16 v[150:151], v241 offset:0
  s_nop 7
  v_exp_f32 v96, v96
  v_exp_f32 v97, v97
  v_exp_f32 v98, v98
  v_exp_f32 v99, v99
  v_exp_f32 v100, v100
  v_exp_f32 v101, v101
  v_exp_f32 v102, v102
  v_exp_f32 v103, v103
  v_exp_f32 v104, v104
  v_exp_f32 v105, v105
  v_exp_f32 v106, v106
  v_exp_f32 v107, v107
  v_exp_f32 v108, v108
  v_exp_f32 v109, v109
  v_exp_f32 v110, v110
  v_exp_f32 v111, v111
  v_cvt_pk_bf16_f32 v16, v96, v97
  v_cvt_pk_bf16_f32 v17, v98, v99
  v_cvt_pk_bf16_f32 v18, v100, v101
  v_cvt_pk_bf16_f32 v19, v102, v103
  v_cvt_pk_bf16_f32 v20, v104, v105
  v_cvt_pk_bf16_f32 v21, v106, v107
  v_cvt_pk_bf16_f32 v22, v108, v109
  v_cvt_pk_bf16_f32 v23, v110, v111
  s_waitcnt lgkmcnt(2)
  v_mfma_f32_32x32x16_bf16 v[128:143], v[144:147], v[16:19], 0
  s_waitcnt lgkmcnt(0)
  v_mfma_f32_32x32x16_bf16 v[128:143], v[148:151], v[20:23], v[128:143]
  v_mfma_f32_32x32x16_bf16 v[112:127], v[24:27], v[88:91], 0
  v_mfma_f32_32x32x16_bf16 v[112:127], v[28:31], v[92:95], v[112:127]
  ds_read_b64_tr_b16 v[152:153], v238 offset:2048
  ds_read_b64_tr_b16 v[154:155], v239 offset:2048
  ds_read_b64_tr_b16 v[156:157], v240 offset:2048
  ds_read_b64_tr_b16 v[158:159], v241 offset:2048
  s_nop 7
  v_exp_f32 v112, v112
  v_exp_f32 v113, v113
  v_exp_f32 v114, v114
  v_exp_f32 v115, v115
  v_exp_f32 v116, v116
  v_exp_f32 v117, v117
  v_exp_f32 v118, v118
  v_exp_f32 v119, v119
  v_exp_f32 v120, v120
  v_exp_f32 v121, v121
  v_exp_f32 v122, v122
  v_exp_f32 v123, v123
  v_exp_f32 v124, v124
  v_exp_f32 v125, v125
  v_exp_f32 v126, v126
  v_exp_f32 v127, v127
  v_cvt_pk_bf16_f32 v24, v112, v113
  v_cvt_pk_bf16_f32 v25, v114, v115
  v_cvt_pk_bf16_f32 v26, v116, v117
  v_cvt_pk_bf16_f32 v27, v118, v119
  v_cvt_pk_bf16_f32 v28, v120, v121
  v_cvt_pk_bf16_f32 v29, v122, v123
  v_cvt_pk_bf16_f32 v30, v124, v125
  v_cvt_pk_bf16_f32 v31, v126, v127
  s_waitcnt lgkmcnt(2)
  v_mfma_f32_32x32x16_bf16 v[128:143], v[152:155], v[24:27], v[128:143]
  s_waitcnt lgkmcnt(0)
  v_mfma_f32_32x32x16_bf16 v[128:143], v[156:159], v[28:31], v[128:143]
  v_mfma_f32_32x32x16_bf16 v[96:111], v[32:35], v[88:91], 0
  v_mfma_f32_32x32x16_bf16 v[96:111], v[36:39], v[92:95], v[96:111]
  ds_read_b64_tr_b16 v[184:185], v238 offset:4096
  ds_read_b64_tr_b16 v[186:187], v239 offset:4096
  ds_read_b64_tr_b16 v[188:189], v240 offset:4096
  ds_read_b64_tr_b16 v[190:191], v241 offset:4096
  s_nop 7
  v_exp_f32 v96, v96
  v_exp_f32 v97, v97
  v_exp_f32 v98, v98
  v_exp_f32 v99, v99
  v_exp_f32 v100, v100
  v_exp_f32 v101, v101
  v_exp_f32 v102, v102
  v_exp_f32 v103, v103
  v_exp_f32 v104, v104
  v_exp_f32 v105, v105
  v_exp_f32 v106, v106
  v_exp_f32 v107, v107
  v_exp_f32 v108, v108
  v_exp_f32 v109, v109
  v_exp_f32 v110, v110
  v_exp_f32 v111, v111
  v_cvt_pk_bf16_f32 v32, v96, v97
  v_cvt_pk_bf16_f32 v33, v98, v99
  v_cvt_pk_bf16_f32 v34, v100, v101
  v_cvt_pk_bf16_f32 v35, v102, v103
  v_cvt_pk_bf16_f32 v36, v104, v105
  v_cvt_pk_bf16_f32 v37, v106, v107
  v_cvt_pk_bf16_f32 v38, v108, v109
  v_cvt_pk_bf16_f32 v39, v110, v111
  s_waitcnt lgkmcnt(2)
  v_mfma_f32_32x32x16_bf16 v[128:143], v[184:187], v[32:35], v[128:143]
  s_waitcnt lgkmcnt(0)
  v_mfma_f32_32x32x16_bf16 v[128:143], v[188:191], v[36:39], v[128:143]
  v_mfma_f32_32x32x16_bf16 v[112:127], v[40:43], v[88:91], 0
  v_mfma_f32_32x32x16_bf16 v[112:127], v[44:47], v[92:95], v[112:127]
  ds_read_b64_tr_b16 v[192:193], v238 offset:6144
  ds_read_b64_tr_b16 v[194:195], v239 offset:6144
  ds_read_b64_tr_b16 v[196:197], v240 offset:6144
  ds_read_b64_tr_b16 v[198:199], v241 offset:6144
  s_nop 7
  v_exp_f32 v112, v112
  v_exp_f32 v113, v113
  v_exp_f32 v114, v114
  v_exp_f32 v115, v115
  v_exp_f32 v116, v116
  v_exp_f32 v117, v117
  v_exp_f32 v118, v118
  v_exp_f32 v119, v119
  v_exp_f32 v120, v120
  v_exp_f32 v121, v121
  v_exp_f32 v122, v122
  v_exp_f32 v123, v123
  v_exp_f32 v124, v124
  v_exp_f32 v125, v125
  v_exp_f32 v126, v126
  v_exp_f32 v127, v127
  v_cvt_pk_bf16_f32 v40, v112, v113
  v_cvt_pk_bf16_f32 v41, v114, v115
  v_cvt_pk_bf16_f32 v42, v116, v117
  v_cvt_pk_bf16_f32 v43, v118, v119
  v_cvt_pk_bf16_f32 v44, v120, v121
  v_cvt_pk_bf16_f32 v45, v122, v123
  v_cvt_pk_bf16_f32 v46, v124, v125
  v_cvt_pk_bf16_f32 v47, v126, v127
  s_waitcnt lgkmcnt(2)
  v_mfma_f32_32x32x16_bf16 v[128:143], v[192:195], v[40:43], v[128:143]
  s_waitcnt lgkmcnt(0)
  v_mfma_f32_32x32x16_bf16 v[128:143], v[196:199], v[44:47], v[128:143]
  v_mfma_f32_32x32x16_bf16 v[96:111], v[48:51], v[88:91], 0
  v_mfma_f32_32x32x16_bf16 v[96:111], v[52:55], v[92:95], v[96:111]
  ds_read_b64_tr_b16 v[144:145], v238 offset:8192
  ds_read_b64_tr_b16 v[146:147], v239 offset:8192
  ds_read_b64_tr_b16 v[148:149], v240 offset:8192
  ds_read_b64_tr_b16 v[150:151], v241 offset:8192
  s_nop 7
  v_exp_f32 v96, v96
  v_exp_f32 v97, v97
  v_exp_f32 v98, v98
  v_exp_f32 v99, v99
  v_exp_f32 v100, v100
  v_exp_f32 v101, v101
  v_exp_f32 v102, v102
  v_exp_f32 v103, v103
  v_exp_f32 v104, v104
  v_exp_f32 v105, v105
  v_exp_f32 v106, v106
  v_exp_f32 v107, v107
  v_exp_f32 v108, v108
  v_exp_f32 v109, v109
  v_exp_f32 v110, v110
  v_exp_f32 v111, v111
  v_cvt_pk_bf16_f32 v48, v96, v97
  v_cvt_pk_bf16_f32 v49, v98, v99
  v_cvt_pk_bf16_f32 v50, v100, v101
  v_cvt_pk_bf16_f32 v51, v102, v103
  v_cvt_pk_bf16_f32 v52, v104, v105
  v_cvt_pk_bf16_f32 v53, v106, v107
  v_cvt_pk_bf16_f32 v54, v108, v109
  v_cvt_pk_bf16_f32 v55, v110, v111
  s_waitcnt lgkmcnt(2)
  v_mfma_f32_32x32x16_bf16 v[128:143], v[144:147], v[48:51], v[128:143]
  s_waitcnt lgkmcnt(0)
  v_mfma_f32_32x32x16_bf16 v[128:143], v[148:151], v[52:55], v[128:143]
  v_mfma_f32_32x32x16_bf16 v[112:127], v[56:59], v[88:91], 0
  v_mfma_f32_32x32x16_bf16 v[112:127], v[60:63], v[92:95], v[112:127]
  ds_read_b64_tr_b16 v[152:153], v238 offset:10240
  ds_read_b64_tr_b16 v[154:155], v239 offset:10240
  ds_read_b64_tr_b16 v[156:157], v240 offset:10240
  ds_read_b64_tr_b16 v[158:159], v241 offset:10240
  s_nop 7
  v_exp_f32 v112, v112
  v_exp_f32 v113, v113
  v_exp_f32 v114, v114
  v_exp_f32 v115, v115
  v_exp_f32 v116, v116
  v_exp_f32 v117, v117
  v_exp_f32 v118, v118
  v_exp_f32 v119, v119
  v_exp_f32 v120, v120
  v_exp_f32 v121, v121
  v_exp_f32 v122, v122
  v_exp_f32 v123, v123
  v_exp_f32 v124, v124
  v_exp_f32 v125, v125
  v_exp_f32 v126, v126
  v_exp_f32 v127, v127
  v_cvt_pk_bf16_f32 v56, v112, v113
  v_cvt_pk_bf16_f32 v57, v114, v115
  v_cvt_pk_bf16_f32 v58, v116, v117
  v_cvt_pk_bf16_f32 v59, v118, v119
  v_cvt_pk_bf16_f32 v60, v120, v121
  v_cvt_pk_bf16_f32 v61, v122, v123
  v_cvt_pk_bf16_f32 v62, v124, v125
  v_cvt_pk_bf16_f32 v63, v126, v127
  s_waitcnt lgkmcnt(2)
  v_mfma_f32_32x32x16_bf16 v[128:143], v[152:155], v[56:59], v[128:143]
  s_waitcnt lgkmcnt(0)
  v_mfma_f32_32x32x16_bf16 v[128:143], v[156:159], v[60:63], v[128:143]
  v_mfma_f32_32x32x16_bf16 v[96:111], v[64:67], v[88:91], 0
  v_mfma_f32_32x32x16_bf16 v[96:111], v[68:71], v[92:95], v[96:111]
  ds_read_b64_tr_b16 v[184:185], v238 offset:12288
  ds_read_b64_tr_b16 v[186:187], v239 offset:12288
  ds_read_b64_tr_b16 v[188:189], v240 offset:12288
  ds_read_b64_tr_b16 v[190:191], v241 offset:12288
  s_nop 7
  v_exp_f32 v96, v96
  v_exp_f32 v97, v97
  v_exp_f32 v98, v98
  v_exp_f32 v99, v99
  v_exp_f32 v100, v100
  v_exp_f32 v101, v101
  v_exp_f32 v102, v102
  v_exp_f32 v103, v103
  v_exp_f32 v104, v104
  v_exp_f32 v105, v105
  v_exp_f32 v106, v106
  v_exp_f32 v107, v107
  v_exp_f32 v108, v108
  v_exp_f32 v109, v109
  v_exp_f32 v110, v110
  v_exp_f32 v111, v111
  v_cvt_pk_bf16_f32 v64, v96, v97
  v_cvt_pk_bf16_f32 v65, v98, v99
  v_cvt_pk_bf16_f32 v66, v100, v101
  v_cvt_pk_bf16_f32 v67, v102, v103
  v_cvt_pk_bf16_f32 v68, v104, v105
  v_cvt_pk_bf16_f32 v69, v106, v107
  v_cvt_pk_bf16_f32 v70, v108, v109
  v_cvt_pk_bf16_f32 v71, v110, v111
  s_waitcnt lgkmcnt(2)
  v_mfma_f32_32x32x16_bf16 v[128:143], v[184:187], v[64:67], v[128:143]
  s_waitcnt lgkmcnt(0)
  v_mfma_f32_32x32x16_bf16 v[128:143], v[188:191], v[68:71], v[128:143]
  v_mfma_f32_32x32x16_bf16 v[112:127], v[72:75], v[88:91], 0
  v_mfma_f32_32x32x16_bf16 v[112:127], v[76:79], v[92:95], v[112:127]
  ds_read_b64_tr_b16 v[192:193], v238 offset:14336
  ds_read_b64_tr_b16 v[194:195], v239 offset:14336
  ds_read_b64_tr_b16 v[196:197], v240 offset:14336
  ds_read_b64_tr_b16 v[198:199], v241 offset:14336
  s_nop 7
  v_exp_f32 v112, v112
  v_exp_f32 v113, v113
  v_exp_f32 v114, v114
  v_exp_f32 v115, v115
  v_exp_f32 v116, v116
  v_exp_f32 v117, v117
  v_exp_f32 v118, v118
  v_exp_f32 v119, v119
  v_exp_f32 v120, v120
  v_exp_f32 v121, v121
  v_exp_f32 v122, v122
  v_exp_f32 v123, v123
  v_exp_f32 v124, v124
  v_exp_f32 v125, v125
  v_exp_f32 v126, v126
  v_exp_f32 v127, v127
  v_cvt_pk_bf16_f32 v72, v112, v113
  v_cvt_pk_bf16_f32 v73, v114, v115
  v_cvt_pk_bf16_f32 v74, v116, v117
  v_cvt_pk_bf16_f32 v75, v118, v119
  v_cvt_pk_bf16_f32 v76, v120, v121
  v_cvt_pk_bf16_f32 v77, v122, v123
  v_cvt_pk_bf16_f32 v78, v124, v125
  v_cvt_pk_bf16_f32 v79, v126, v127
  s_waitcnt lgkmcnt(2)
  v_mfma_f32_32x32x16_bf16 v[128:143], v[192:195], v[72:75], v[128:143]
  s_waitcnt lgkmcnt(0)
  v_mfma_f32_32x32x16_bf16 v[128:143], v[196:199], v[76:79], v[128:143]
  v_mfma_f32_32x32x16_bf16 v[96:111], v[80:83], v[88:91], v[200:215]
  v_mfma_f32_32x32x16_bf16 v[96:111], v[84:87], v[92:95], v[96:111]
  ds_read_b64_tr_b16 v[144:145], v238 offset:16384
  ds_read_b64_tr_b16 v[146:147], v239 offset:16384
  ds_read_b64_tr_b16 v[148:149], v240 offset:16384
  ds_read_b64_tr_b16 v[150:151], v241 offset:16384
  s_nop 7
  v_exp_f32 v96, v96
  v_exp_f32 v97, v97
  v_exp_f32 v98, v98
  v_exp_f32 v99, v99
  v_exp_f32 v100, v100
  v_exp_f32 v101, v101
  v_exp_f32 v102, v102
  v_exp_f32 v103, v103
  v_exp_f32 v104, v104
  v_exp_f32 v105, v105
  v_exp_f32 v106, v106
  v_exp_f32 v107, v107
  v_exp_f32 v108, v108
  v_exp_f32 v109, v109
  v_exp_f32 v110, v110
  v_exp_f32 v111, v111
  v_cvt_pk_bf16_f32 v80, v96, v97
  v_cvt_pk_bf16_f32 v81, v98, v99
  v_cvt_pk_bf16_f32 v82, v100, v101
  v_cvt_pk_bf16_f32 v83, v102, v103
  v_cvt_pk_bf16_f32 v84, v104, v105
  v_cvt_pk_bf16_f32 v85, v106, v107
  v_cvt_pk_bf16_f32 v86, v108, v109
  v_cvt_pk_bf16_f32 v87, v110, v111
  s_waitcnt lgkmcnt(2)
  v_mfma_f32_32x32x16_bf16 v[128:143], v[144:147], v[80:83], v[128:143]
  s_waitcnt lgkmcnt(0)
  v_mfma_f32_32x32x16_bf16 v[128:143], v[148:151], v[84:87], v[128:143]
  s_nop 11
  v_mov_b32 v10, v140
  v_mov_b32 v11, v140
  s_nop 1
  v_permlane32_swap_b32 v10, v11
  s_branch L_ss_fbb_141
.section .rodata,"a"
.p2align 6
.amdhsa_kernel sequential_preLN__sliding_block__geglu_ffn__prompt_kernel
  .amdhsa_next_free_vgpr 512
  .amdhsa_next_free_sgpr 102
  .amdhsa_accum_offset 256
  .amdhsa_group_segment_fixed_size 0
  .amdhsa_kernarg_size 80
  .amdhsa_user_sgpr_count 2
  .amdhsa_user_sgpr_kernarg_segment_ptr 1
  .amdhsa_system_sgpr_workgroup_id_x 1
.end_amdhsa_kernel
```
